```python
import torch

def _softmax(x, axis=-1):
    return torch.softmax(x, dim=axis)

def _gelu(x):
    return torch.nn.functional.gelu(x, approximate='tanh')

def _silu(x):
    return torch.nn.functional.silu(x)

def _sigmoid(x):
    return torch.sigmoid(x)

def _layernorm(x, axis=-1, eps=1e-05):
    m = x.mean(dim=axis, keepdim=True)
    v = x.var(dim=axis, keepdim=True, unbiased=False)
    return (x - m) / torch.sqrt(v + eps)

def _scatter_add(tgt, idx, src, axis=0):
    return tgt.clone().index_add_(axis, idx, src)

def _segment_sum(src, seg, n):
    out = torch.zeros((n,) + src.shape[1:], dtype=src.dtype)
    return out.index_add_(0, seg, src)

def _pad(x, pw):
    flat = tuple((v for pair in reversed(pw) for v in pair))
    return torch.nn.functional.pad(x, flat)
kernel_name = 'recurrent_scan__sliding_block_cached__mixer_gmlp__prompt'

def setup_inputs():

    _w = lambda a: (lambda t: t.to(torch.bfloat16) if t.is_floating_point() else t)(torch.as_tensor(a))

    def _A_setup():
        B, Sq, D = (1, 2048, 1024)
        Hq, Hkv, Sk, Dh = (32, 4, 2048, 128)
        assert Hq % Hkv == 0, (Hq, Hkv)
        return {'x': _w((lambda *s: torch.randn(*s, dtype=torch.bfloat16) * 0.05)(B, Sq, D)), 'k_cache': _w((lambda *s: torch.randn(*s, dtype=torch.bfloat16) * 0.8)(B, Hkv, Sk, Dh)), 'v_cache': _w((lambda *s: torch.randn(*s, dtype=torch.bfloat16) * 0.2)(B, Hkv, Sk, Dh)), 'wq': _w((lambda *s: torch.randn(*s, dtype=torch.bfloat16) * 0.8)(D, Hq * Dh) * D ** (-0.5)), 'wo': _w((lambda *s: torch.randn(*s, dtype=torch.bfloat16) * 0.2)(Hq * Dh, D) * (Hq * Dh) ** (-0.5))}
    _A_in = _A_setup()

    def _B_setup():
        B, S, D, F = (1, 2048, 1024, 3584)
        Fh = F // 2
        return {'x': _w((lambda *s: torch.randn(*s, dtype=torch.bfloat16) * 0.05)(B, S, D)), 'w_in': _w((lambda *s: torch.randn(*s, dtype=torch.bfloat16) * 0.4)(D, 2 * Fh)), 'w_sp': _w(0.01 * (lambda *s: torch.randn(*s, dtype=torch.bfloat16) * 0.4)(S, S)), 'b_sp': _w(1.0 + 0.01 * (lambda *s: torch.randn(*s, dtype=torch.bfloat16) * 0.1)(S)), 'w_out': _w((lambda *s: torch.randn(*s, dtype=torch.bfloat16) * 0.1)(Fh, D))}
    _B_in = _B_setup()
    return {'A_x': _A_in['x'], 'A_k_cache': _A_in['k_cache'], 'A_v_cache': _A_in['v_cache'], 'A_wq': _A_in['wq'], 'A_wo': _A_in['wo'], 'B_x': _B_in['x'], 'B_w_in': _B_in['w_in'], 'B_w_sp': _B_in['w_sp'], 'B_b_sp': _B_in['b_sp'], 'B_w_out': _B_in['w_out']}

def reference(A_x, A_k_cache, A_v_cache, A_wq, A_wo, B_x, B_w_in, B_w_sp, B_b_sp, B_w_out):

    def _A_ref(x, k_cache, v_cache, wq, wo):
        B, Sq, D = x.shape
        Hq, Dh = (32, 128)
        Hkv, Sk = (k_cache.shape[1], k_cache.shape[2])
        W = min(4096, max(256, Sk // 4))
        rep = Hq // Hkv
        q = (lambda x, *d: x.permute(*d))((x @ wq).reshape(B, Sq, Hq, Dh), 0, 2, 1, 3)
        k = (lambda x, n, axis: torch.repeat_interleave(x, n, dim=axis))(k_cache[:, :, Sk - W:, :], rep, axis=1)
        v = (lambda x, n, axis: torch.repeat_interleave(x, n, dim=axis))(v_cache[:, :, Sk - W:, :], rep, axis=1)
        scores = torch.einsum('bhqd,bhkd->bhqk', q, k) * Dh ** (-0.5)
        p = _softmax(scores, axis=-1)
        o = torch.einsum('bhqk,bhkd->bhqd', p, v)
        return (lambda x, *d: x.permute(*d))(o, 0, 2, 1, 3).reshape(B, Sq, Hq * Dh) @ wo

    def _B_ref(x, w_in, w_sp, b_sp, w_out):
        B, S, D = x.shape
        F = w_in.shape[-1]
        Fh = F // 2
        z = _gelu(torch.einsum('bsd,df->bsf', x, w_in))
        z1 = z[..., :Fh].clone()
        z2 = _layernorm(z[..., Fh:], axis=-1)
        g = torch.einsum('ts,bsf->btf', w_sp, z2) + b_sp[None, :, None]
        return torch.einsum('bsf,fd->bsd', z1 * g, w_out)
    x = A_x
    xn = _layernorm(x, axis=-1)
    s = _A_ref(xn, A_k_cache, A_v_cache, A_wq, A_wo)
    g = _silu(_B_ref(xn, B_w_in, B_w_sp, B_b_sp, B_w_out))
    return x + s * g
```

```asm
; @launch grid=(256,1,1) block=(256,1,1) lds=163840
.amdgcn_target "amdgcn-amd-amdhsa--gfx950"
.text
.macro MA d,a,b
v_mfma_f32_16x16x32_bf16 a[\d:\d+3], v[\a:\a+3], v[\b:\b+3], a[\d:\d+3]
.endm
.macro MZ d,a,b
v_mfma_f32_16x16x32_bf16 a[\d:\d+3], v[\a:\a+3], v[\b:\b+3], 0
.endm
.macro PA d,a,b
v_mfma_f32_32x32x16_bf16 a[\d:\d+15], v[\a:\a+3], v[\b:\b+3], a[\d:\d+15]
.endm
.macro PZ d,a,b
v_mfma_f32_32x32x16_bf16 a[\d:\d+15], v[\a:\a+3], v[\b:\b+3], 0
.endm
.macro QA d,a,b
v_mfma_f32_32x32x16_bf16 v[\d:\d+15], v[\a:\a+3], v[\b:\b+3], v[\d:\d+15]
.endm
.macro QZ d,a,b
v_mfma_f32_32x32x16_bf16 v[\d:\d+15], v[\a:\a+3], v[\b:\b+3], 0
.endm
.macro TR d,a,o
ds_read_b64_tr_b16 v[\d:\d+1], v\a offset:\o
.endm
.macro RD d,a,o
ds_read_b128 v[\d:\d+3], v\a offset:\o
.endm
.macro AR d,s
v_accvgpr_read_b32 v\d, a\s
.endm
.macro AW d,s
v_accvgpr_write_b32 a\d, \s
.endm
.macro CV d,a,b
v_cvt_pk_bf16_f32 v\d, v\a, v\b
.endm
.macro PM d,a,b
v_pk_mul_f32 v[\d:\d+1], v[\a:\a+1], v[\b:\b+1]
.endm
.macro PD d,a,b
v_pk_add_f32 v[\d:\d+1], v[\a:\a+1], v[\b:\b+1]
.endm
.globl recurrent_scan__sliding_block_cached__mixer_gmlp__prompt_kernel
.p2align 8
.type recurrent_scan__sliding_block_cached__mixer_gmlp__prompt_kernel,@function
recurrent_scan__sliding_block_cached__mixer_gmlp__prompt_kernel:
s_cmp_ge_u32 s2, 256
s_cbranch_scc1 L_end
s_load_dwordx2 s[56:57], s[0:1], 0
s_load_dwordx4 s[60:63], s[0:1], 8
s_load_dwordx4 s[4:7], s[0:1], 24
s_load_dwordx2 s[100:101], s[0:1], 48
s_load_dwordx4 s[52:55], s[0:1], 56
s_load_dwordx4 s[40:43], s[0:1], 72
s_load_dwordx2 s[8:9], s[0:1], 96
v_and_b32 v1, 63, v0
v_lshrrev_b32 v2, 6, v0
s_and_b32 s11, s2, 7
v_readfirstlane_b32 s10, v2
s_lshr_b32 s12, s2, 3
s_and_b32 s13, s11, 1
s_lshl_b32 s13, s13, 2
s_and_b32 s14, s12, 3
s_add_u32 s13, s13, s14
s_lshr_b32 s14, s11, 1
s_lshl_b32 s14, s14, 2
s_bfe_u32 s15, s12, 0x20002
s_add_u32 s14, s14, s15
v_and_b32 v16, 7, v1
v_lshrrev_b32 v17, 3, v1
v_lshlrev_b32 v18, 11, v16
v_lshl_add_u32 v18, v17, 4, v18
v_lshl_add_u32 v18, v2, 9, v18
s_lshl_b32 s3, s2, 14
s_mov_b32 s98, 0x400000
s_mov_b32 s99, 0x00020000
s_waitcnt lgkmcnt(0)
s_mov_b32 s96, s56
s_mov_b32 s97, s57
buffer_load_dwordx4 v[24:27], v18, s[96:99], s3 offen offset:0
buffer_load_dwordx4 v[28:31], v18, s[96:99], s3 offen offset:128
buffer_load_dwordx4 v[32:35], v18, s[96:99], s3 offen offset:256
buffer_load_dwordx4 v[36:39], v18, s[96:99], s3 offen offset:384
s_add_u32 s48, s8, 0x3000000
s_addc_u32 s49, s9, 0
s_mov_b32 s50, 0x92080
s_mov_b32 s51, 0x00020000
s_mov_b32 s3, 598016
buffer_load_dword v240, off, s[48:51], s3 sc1
s_cmp_lt_u32 s12, 16
s_cselect_b32 s16, s100, s4
s_cselect_b32 s17, s101, s5
s_mov_b32 s15, 0x800000
s_cselect_b32 s18, 0x700000, s15
s_mov_b32 s19, 0x00020000
s_mov_b32 s20, s8
s_mov_b32 s21, s9
s_mov_b32 s22, 0x400000
s_mov_b32 s23, 0x00020000
L_code_begin:
s_cmp_lt_u32 s12, 16
s_cbranch_scc1 L_path_b
v_lshrrev_b32 v3, 5, v1
v_lshl_add_u32 v3, v3, 2, v2
v_lshlrev_b32 v4, 13, v3
v_and_b32 v3, 31, v1
v_lshl_add_u32 v4, v3, 4, v4
s_lshl_b32 s15, s14, 9
v_add_u32 v4, s15, v4
v_add_u32 v5, 0xfbe0, v4
v_add_u32 v6, 0xfbe0, v5
v_add_u32 v7, 0xfbe0, v6
v_and_b32 v8, 15, v1
v_lshlrev_b32 v8, 4, v8
v_lshrrev_b32 v3, 4, v1
v_lshl_add_u32 v8, v3, 9, v8
v_lshl_add_u32 v8, v2, 12, v8
s_mov_b32 s32, 0
s_lshl_b32 s33, s13, 19
s_mul_i32 s35, s10, 4416
s_lshr_b32 s15, s14, 2
s_lshl_b32 s15, s15, 18
s_add_u32 s24, s8, s15
s_addc_u32 s25, s9, 0
s_add_u32 s24, s24, 0x400000
s_addc_u32 s25, s25, 0
s_mov_b32 s26, 0x40000
s_mov_b32 s27, 0x00020000
s_add_u32 m0, s35, 0
s_nop 0
buffer_load_dwordx4 v4, s[16:19], s32 offen lds
buffer_load_dwordx4 v5, s[16:19], s32 offen offset:1056 lds
buffer_load_dwordx4 v6, s[16:19], s32 offen offset:2112 lds
buffer_load_dwordx4 v7, s[16:19], s32 offen offset:3168 lds
s_add_u32 s32, s32, 0x40000
s_add_u32 m0, s35, 17664
s_nop 0
buffer_load_dwordx4 v4, s[16:19], s32 offen lds
buffer_load_dwordx4 v5, s[16:19], s32 offen offset:1056 lds
buffer_load_dwordx4 v6, s[16:19], s32 offen offset:2112 lds
buffer_load_dwordx4 v7, s[16:19], s32 offen offset:3168 lds
s_add_u32 s32, s32, 0x40000
v_lshlrev_b32 v19, 2, v0
v_mov_b32 v20, -1
s_lshl_b32 s3, s2, 10
buffer_store_dword v20, v19, s[48:51], s3 offen sc1
s_getpc_b64 s[96:97]
L_a_pc:
s_sub_u32 s96, s96, L_a_pc-L_code_begin
s_subb_u32 s97, s97, 0
s_lshl_b32 s15, s12, 2
s_add_u32 s15, s15, s10
s_lshl_b32 s15, s15, 4
v_and_b32 v22, 15, v1
v_add_u32 v22, s15, v22
v_lshlrev_b32 v22, 7, v22
v_min_u32 v22, L_code_end-L_code_begin-4, v22
global_load_dword v21, v22, s[96:97]
v_lshrrev_b32 v18, 2, v17
v_lshl_add_u32 v18, v2, 3, v18
v_lshlrev_b32 v18, 14, v18
v_and_b32 v17, 3, v17
v_lshl_add_u32 v18, v17, 9, v18
v_lshl_add_u32 v18, v16, 4, v18
s_lshr_b32 s3, s2, 5
s_lshl_b32 s3, s3, 19
s_bfe_u32 s15, s2, 0x30002
s_lshl_b32 s15, s15, 11
s_add_u32 s3, s3, s15
s_and_b32 s15, s2, 3
s_lshl_b32 s15, s15, 7
s_add_u32 s3, s3, s15
v_lshlrev_b32 v16, 3, v16
v_add_u32 v16, 163584, v16
v_lshl_add_u32 v17, v2, 6, v16
s_and_b32 s58, s14, 3
s_lshl_b32 s38, s13, 2
s_add_u32 s58, s58, s38
s_lshr_b32 s38, s14, 2
s_lshl_b32 s39, s38, 19
s_lshr_b32 s34, s58, 1
s_lshl_b32 s59, s34, 13
s_add_u32 s39, s39, s59
s_add_u32 s39, s39, 393216
s_lshl_b32 s34, s34, 14
s_bitcmp1_b32 s58, 0
s_cselect_b32 s28, s62, s60
s_cselect_b32 s29, s63, s61
s_mov_b32 s30, 0x200000
s_mov_b32 s31, 0x00020000
v_and_b32 v104, 15, v1
v_lshrrev_b32 v105, 4, v1
v_lshlrev_b32 v106, 8, v104
v_lshl_add_u32 v106, v105, 3, v106
v_lshl_add_u32 v106, v2, 6, v106
v_lshlrev_b32 v108, 1, v104
v_lshl_add_u32 v108, v105, 10, v108
v_lshl_add_u32 v108, v2, 6, v108
v_add_u32 v109, 0x1000, v108
v_add_u32 v107, 0x1000, v106
v_lshlrev_b32 v110, 4, v1
v_lshl_add_u32 v110, v2, 11, v110
v_mov_b32 v120, 0
v_mov_b32 v121, 0
v_mov_b32 v122, 0
v_mov_b32 v123, 0
s_waitcnt vmcnt(14)
v_lshlrev_b32 v56, 16, v24
v_and_b32 v57, 0xffff0000, v24
v_lshlrev_b32 v58, 16, v25
v_and_b32 v59, 0xffff0000, v25
v_lshlrev_b32 v60, 16, v26
v_and_b32 v61, 0xffff0000, v26
v_lshlrev_b32 v62, 16, v27
v_and_b32 v63, 0xffff0000, v27
PD 120,120,56
v_pk_fma_f32 v[122:123], v[56:57], v[56:57], v[122:123]
PD 120,120,58
v_pk_fma_f32 v[122:123], v[58:59], v[58:59], v[122:123]
PD 120,120,60
v_pk_fma_f32 v[122:123], v[60:61], v[60:61], v[122:123]
PD 120,120,62
v_pk_fma_f32 v[122:123], v[62:63], v[62:63], v[122:123]
s_waitcnt vmcnt(13)
v_lshlrev_b32 v64, 16, v28
v_and_b32 v65, 0xffff0000, v28
v_lshlrev_b32 v66, 16, v29
v_and_b32 v67, 0xffff0000, v29
v_lshlrev_b32 v68, 16, v30
v_and_b32 v69, 0xffff0000, v30
v_lshlrev_b32 v70, 16, v31
v_and_b32 v71, 0xffff0000, v31
PD 120,120,64
v_pk_fma_f32 v[122:123], v[64:65], v[64:65], v[122:123]
PD 120,120,66
v_pk_fma_f32 v[122:123], v[66:67], v[66:67], v[122:123]
PD 120,120,68
v_pk_fma_f32 v[122:123], v[68:69], v[68:69], v[122:123]
PD 120,120,70
v_pk_fma_f32 v[122:123], v[70:71], v[70:71], v[122:123]
s_waitcnt vmcnt(12)
v_lshlrev_b32 v72, 16, v32
v_and_b32 v73, 0xffff0000, v32
v_lshlrev_b32 v74, 16, v33
v_and_b32 v75, 0xffff0000, v33
v_lshlrev_b32 v76, 16, v34
v_and_b32 v77, 0xffff0000, v34
v_lshlrev_b32 v78, 16, v35
v_and_b32 v79, 0xffff0000, v35
PD 120,120,72
v_pk_fma_f32 v[122:123], v[72:73], v[72:73], v[122:123]
PD 120,120,74
v_pk_fma_f32 v[122:123], v[74:75], v[74:75], v[122:123]
PD 120,120,76
v_pk_fma_f32 v[122:123], v[76:77], v[76:77], v[122:123]
PD 120,120,78
v_pk_fma_f32 v[122:123], v[78:79], v[78:79], v[122:123]
s_waitcnt vmcnt(11)
v_lshlrev_b32 v80, 16, v36
v_and_b32 v81, 0xffff0000, v36
v_lshlrev_b32 v82, 16, v37
v_and_b32 v83, 0xffff0000, v37
v_lshlrev_b32 v84, 16, v38
v_and_b32 v85, 0xffff0000, v38
v_lshlrev_b32 v86, 16, v39
v_and_b32 v87, 0xffff0000, v39
PD 120,120,80
v_pk_fma_f32 v[122:123], v[80:81], v[80:81], v[122:123]
PD 120,120,82
v_pk_fma_f32 v[122:123], v[82:83], v[82:83], v[122:123]
PD 120,120,84
v_pk_fma_f32 v[122:123], v[84:85], v[84:85], v[122:123]
PD 120,120,86
v_pk_fma_f32 v[122:123], v[86:87], v[86:87], v[122:123]
v_add_f32 v120, v120, v121
v_add_f32 v121, v122, v123
s_nop 1
v_add_f32_dpp v120, v120, v120 row_ror:8 row_mask:0xf bank_mask:0xf
v_add_f32_dpp v121, v121, v121 row_ror:8 row_mask:0xf bank_mask:0xf
v_mov_b32 v122, v120
v_mov_b32 v123, v121
s_nop 1
v_permlane16_swap_b32 v120, v122
v_permlane16_swap_b32 v121, v123
s_nop 1
PD 120,120,122
v_mov_b32 v122, v120
v_mov_b32 v123, v121
s_nop 1
v_permlane32_swap_b32 v120, v122
v_permlane32_swap_b32 v121, v123
s_nop 1
PD 120,120,122
ds_write_b64 v17, v[120:121]
s_waitcnt lgkmcnt(0)
s_barrier
ds_read_b64 v[120:121], v16 offset:0
ds_read_b64 v[122:123], v16 offset:64
ds_read_b64 v[124:125], v16 offset:128
ds_read_b64 v[126:127], v16 offset:192
s_waitcnt lgkmcnt(0)
PD 120,120,122
PD 124,124,126
PD 120,120,124
v_mul_f32 v120, 0x3a800000, v120
v_mul_f32 v121, 0x3a800000, v121
v_fma_f32 v121, -v120, v120, v121
v_max_f32 v121, 0, v121
CV 120,120,120
v_and_b32 v120, 0xffff0000, v120
CV 121,121,121
v_and_b32 v121, 0xffff0000, v121
v_add_f32 v121, 0x3727c5ac, v121
CV 121,121,121
v_and_b32 v121, 0xffff0000, v121
v_sqrt_f32 v121, v121
v_sub_f32 v120, 0, v120
CV 121,121,121
v_and_b32 v121, 0xffff0000, v121
v_rcp_f32 v121, v121
s_nop 0
v_pk_add_f32 v[56:57], v[56:57], v[120:121] op_sel_hi:[1,0]
v_pk_add_f32 v[58:59], v[58:59], v[120:121] op_sel_hi:[1,0]
v_pk_add_f32 v[60:61], v[60:61], v[120:121] op_sel_hi:[1,0]
v_pk_add_f32 v[62:63], v[62:63], v[120:121] op_sel_hi:[1,0]
CV 24,56,57
CV 25,58,59
CV 26,60,61
CV 27,62,63
v_lshlrev_b32 v56, 16, v24
v_and_b32 v57, 0xffff0000, v24
v_lshlrev_b32 v58, 16, v25
v_and_b32 v59, 0xffff0000, v25
v_lshlrev_b32 v60, 16, v26
v_and_b32 v61, 0xffff0000, v26
v_lshlrev_b32 v62, 16, v27
v_and_b32 v63, 0xffff0000, v27
v_pk_mul_f32 v[56:57], v[56:57], v[120:121] op_sel:[0,1] op_sel_hi:[1,1]
v_pk_mul_f32 v[58:59], v[58:59], v[120:121] op_sel:[0,1] op_sel_hi:[1,1]
v_pk_mul_f32 v[60:61], v[60:61], v[120:121] op_sel:[0,1] op_sel_hi:[1,1]
v_pk_mul_f32 v[62:63], v[62:63], v[120:121] op_sel:[0,1] op_sel_hi:[1,1]
CV 24,56,57
CV 25,58,59
CV 26,60,61
CV 27,62,63
buffer_store_dwordx4 v[24:27], v18, s[20:23], s3 offen sc1
s_add_u32 s3, s3, 0x8000
v_pk_add_f32 v[64:65], v[64:65], v[120:121] op_sel_hi:[1,0]
v_pk_add_f32 v[66:67], v[66:67], v[120:121] op_sel_hi:[1,0]
v_pk_add_f32 v[68:69], v[68:69], v[120:121] op_sel_hi:[1,0]
v_pk_add_f32 v[70:71], v[70:71], v[120:121] op_sel_hi:[1,0]
CV 28,64,65
CV 29,66,67
CV 30,68,69
CV 31,70,71
v_lshlrev_b32 v64, 16, v28
v_and_b32 v65, 0xffff0000, v28
v_lshlrev_b32 v66, 16, v29
v_and_b32 v67, 0xffff0000, v29
v_lshlrev_b32 v68, 16, v30
v_and_b32 v69, 0xffff0000, v30
v_lshlrev_b32 v70, 16, v31
v_and_b32 v71, 0xffff0000, v31
v_pk_mul_f32 v[64:65], v[64:65], v[120:121] op_sel:[0,1] op_sel_hi:[1,1]
v_pk_mul_f32 v[66:67], v[66:67], v[120:121] op_sel:[0,1] op_sel_hi:[1,1]
v_pk_mul_f32 v[68:69], v[68:69], v[120:121] op_sel:[0,1] op_sel_hi:[1,1]
v_pk_mul_f32 v[70:71], v[70:71], v[120:121] op_sel:[0,1] op_sel_hi:[1,1]
CV 28,64,65
CV 29,66,67
CV 30,68,69
CV 31,70,71
buffer_store_dwordx4 v[28:31], v18, s[20:23], s3 offen sc1
s_add_u32 s3, s3, 0x8000
v_pk_add_f32 v[72:73], v[72:73], v[120:121] op_sel_hi:[1,0]
v_pk_add_f32 v[74:75], v[74:75], v[120:121] op_sel_hi:[1,0]
v_pk_add_f32 v[76:77], v[76:77], v[120:121] op_sel_hi:[1,0]
v_pk_add_f32 v[78:79], v[78:79], v[120:121] op_sel_hi:[1,0]
CV 32,72,73
CV 33,74,75
CV 34,76,77
CV 35,78,79
v_lshlrev_b32 v72, 16, v32
v_and_b32 v73, 0xffff0000, v32
v_lshlrev_b32 v74, 16, v33
v_and_b32 v75, 0xffff0000, v33
v_lshlrev_b32 v76, 16, v34
v_and_b32 v77, 0xffff0000, v34
v_lshlrev_b32 v78, 16, v35
v_and_b32 v79, 0xffff0000, v35
v_pk_mul_f32 v[72:73], v[72:73], v[120:121] op_sel:[0,1] op_sel_hi:[1,1]
v_pk_mul_f32 v[74:75], v[74:75], v[120:121] op_sel:[0,1] op_sel_hi:[1,1]
v_pk_mul_f32 v[76:77], v[76:77], v[120:121] op_sel:[0,1] op_sel_hi:[1,1]
v_pk_mul_f32 v[78:79], v[78:79], v[120:121] op_sel:[0,1] op_sel_hi:[1,1]
CV 32,72,73
CV 33,74,75
CV 34,76,77
CV 35,78,79
buffer_store_dwordx4 v[32:35], v18, s[20:23], s3 offen sc1
s_add_u32 s3, s3, 0x8000
v_pk_add_f32 v[80:81], v[80:81], v[120:121] op_sel_hi:[1,0]
v_pk_add_f32 v[82:83], v[82:83], v[120:121] op_sel_hi:[1,0]
v_pk_add_f32 v[84:85], v[84:85], v[120:121] op_sel_hi:[1,0]
v_pk_add_f32 v[86:87], v[86:87], v[120:121] op_sel_hi:[1,0]
CV 36,80,81
CV 37,82,83
CV 38,84,85
CV 39,86,87
v_lshlrev_b32 v80, 16, v36
v_and_b32 v81, 0xffff0000, v36
v_lshlrev_b32 v82, 16, v37
v_and_b32 v83, 0xffff0000, v37
v_lshlrev_b32 v84, 16, v38
v_and_b32 v85, 0xffff0000, v38
v_lshlrev_b32 v86, 16, v39
v_and_b32 v87, 0xffff0000, v39
v_pk_mul_f32 v[80:81], v[80:81], v[120:121] op_sel:[0,1] op_sel_hi:[1,1]
v_pk_mul_f32 v[82:83], v[82:83], v[120:121] op_sel:[0,1] op_sel_hi:[1,1]
v_pk_mul_f32 v[84:85], v[84:85], v[120:121] op_sel:[0,1] op_sel_hi:[1,1]
v_pk_mul_f32 v[86:87], v[86:87], v[120:121] op_sel:[0,1] op_sel_hi:[1,1]
CV 36,80,81
CV 37,82,83
CV 38,84,85
CV 39,86,87
buffer_store_dwordx4 v[36:39], v18, s[20:23], s3 offen sc1
s_lshl_b32 s3, s2, 2
s_add_u32 s3, s3, s10
s_lshl_b32 s3, s3, 6
s_add_u32 s3, s3, 262144
s_bitcmp1_b32 s58, 0
s_cbranch_scc1 L_a_vld
buffer_load_dwordx2 v[128:129], v106, s[28:31], s39 offen offset:0
buffer_load_dwordx2 v[130:131], v106, s[28:31], s39 offen offset:32
buffer_load_dwordx2 v[132:133], v107, s[28:31], s39 offen offset:0
buffer_load_dwordx2 v[134:135], v107, s[28:31], s39 offen offset:32
s_waitcnt vmcnt(4)
s_branch L_a_kvld
L_a_vld:
buffer_load_ushort v128, v108, s[28:31], s39 offen offset:0
buffer_load_ushort v129, v108, s[28:31], s39 offen offset:256
buffer_load_ushort v130, v108, s[28:31], s39 offen offset:512
buffer_load_ushort v131, v108, s[28:31], s39 offen offset:768
buffer_load_ushort v132, v109, s[28:31], s39 offen offset:0
buffer_load_ushort v133, v109, s[28:31], s39 offen offset:256
buffer_load_ushort v134, v109, s[28:31], s39 offen offset:512
buffer_load_ushort v135, v109, s[28:31], s39 offen offset:768
buffer_load_ushort v136, v108, s[28:31], s39 offen offset:32
buffer_load_ushort v137, v108, s[28:31], s39 offen offset:288
buffer_load_ushort v138, v108, s[28:31], s39 offen offset:544
buffer_load_ushort v139, v108, s[28:31], s39 offen offset:800
buffer_load_ushort v140, v109, s[28:31], s39 offen offset:32
buffer_load_ushort v141, v109, s[28:31], s39 offen offset:288
buffer_load_ushort v142, v109, s[28:31], s39 offen offset:544
buffer_load_ushort v143, v109, s[28:31], s39 offen offset:800
s_waitcnt vmcnt(16)
L_a_kvld:
v_readfirstlane_b32 s100, v240
s_nop 1
s_add_u32 s100, s100, 1
v_mov_b32 v16, s100
s_mov_b64 exec, 1
buffer_store_dword v16, off, s[48:51], s3 sc1
s_mov_b64 exec, -1
s_add_u32 m0, s35, 35328
s_nop 0
buffer_load_dwordx4 v4, s[16:19], s32 offen lds
buffer_load_dwordx4 v5, s[16:19], s32 offen offset:1056 lds
buffer_load_dwordx4 v6, s[16:19], s32 offen offset:2112 lds
buffer_load_dwordx4 v7, s[16:19], s32 offen offset:3168 lds
s_add_u32 s32, s32, 0x40000
s_add_u32 m0, s35, 52992
s_nop 0
buffer_load_dwordx4 v4, s[16:19], s32 offen lds
buffer_load_dwordx4 v5, s[16:19], s32 offen offset:1056 lds
buffer_load_dwordx4 v6, s[16:19], s32 offen offset:2112 lds
buffer_load_dwordx4 v7, s[16:19], s32 offen offset:3168 lds
s_add_u32 s32, s32, 0x40000
v_and_b32 v16, 31, v1
v_lshlrev_b32 v16, 6, v16
s_lshl_b32 s3, s13, 2
s_add_u32 s3, s3, s10
s_lshl_b32 s3, s3, 11
s_add_u32 s3, s3, 262144
s_waitcnt vmcnt(9)
s_bitcmp1_b32 s58, 0
s_cbranch_scc1 L_a_vst
s_mov_b32 s15, 0x3e0293ee
v_lshlrev_b32 v20, 16, v128
v_and_b32 v21, 0xffff0000, v128
v_mul_f32 v20, s15, v20
v_mul_f32 v21, s15, v21
CV 160,20,21
v_lshlrev_b32 v20, 16, v129
v_and_b32 v21, 0xffff0000, v129
v_mul_f32 v20, s15, v20
v_mul_f32 v21, s15, v21
CV 161,20,21
v_lshlrev_b32 v20, 16, v130
v_and_b32 v21, 0xffff0000, v130
v_mul_f32 v20, s15, v20
v_mul_f32 v21, s15, v21
CV 162,20,21
v_lshlrev_b32 v20, 16, v131
v_and_b32 v21, 0xffff0000, v131
v_mul_f32 v20, s15, v20
v_mul_f32 v21, s15, v21
CV 163,20,21
v_lshlrev_b32 v20, 16, v132
v_and_b32 v21, 0xffff0000, v132
v_mul_f32 v20, s15, v20
v_mul_f32 v21, s15, v21
CV 164,20,21
v_lshlrev_b32 v20, 16, v133
v_and_b32 v21, 0xffff0000, v133
v_mul_f32 v20, s15, v20
v_mul_f32 v21, s15, v21
CV 165,20,21
v_lshlrev_b32 v20, 16, v134
v_and_b32 v21, 0xffff0000, v134
v_mul_f32 v20, s15, v20
v_mul_f32 v21, s15, v21
CV 166,20,21
v_lshlrev_b32 v20, 16, v135
v_and_b32 v21, 0xffff0000, v135
v_mul_f32 v20, s15, v20
v_mul_f32 v21, s15, v21
CV 167,20,21
s_branch L_a_kvst
L_a_vst:
v_lshl_or_b32 v160, v129, 16, v128
v_lshl_or_b32 v161, v131, 16, v130
v_lshl_or_b32 v162, v133, 16, v132
v_lshl_or_b32 v163, v135, 16, v134
v_lshl_or_b32 v164, v137, 16, v136
v_lshl_or_b32 v165, v139, 16, v138
v_lshl_or_b32 v166, v141, 16, v140
v_lshl_or_b32 v167, v143, 16, v142
s_add_u32 s34, s34, 0x2000
L_a_kvst:
buffer_store_dwordx4 v[160:163], v110, s[24:27], s34 offen sc1
buffer_store_dwordx4 v[164:167], v110, s[24:27], s34 offen offset:1024 sc1
s_mov_b32 s37, 0
L_a_pollx:
buffer_load_dword v17, v16, s[48:51], s3 offen sc1
s_waitcnt vmcnt(0)
v_cmp_ne_u32 vcc, s100, v17
s_add_u32 s37, s37, 1
s_cmp_ge_u32 s37, 65536
s_cbranch_scc1 L_a_pollx_done
s_cbranch_vccnz L_a_pollx
L_a_pollx_done:
buffer_load_dwordx4 v[144:147], v8, s[20:23], s33 offen sc1
buffer_load_dwordx4 v[148:151], v8, s[20:23], s33 offen offset:256 sc1
buffer_load_dwordx4 v[152:155], v8, s[20:23], s33 offen offset:2048 sc1
buffer_load_dwordx4 v[156:159], v8, s[20:23], s33 offen offset:2304 sc1
s_add_u32 s33, s33, 0x4000
buffer_load_dwordx4 v[160:163], v8, s[20:23], s33 offen sc1
buffer_load_dwordx4 v[164:167], v8, s[20:23], s33 offen offset:256 sc1
buffer_load_dwordx4 v[168:171], v8, s[20:23], s33 offen offset:2048 sc1
buffer_load_dwordx4 v[172:175], v8, s[20:23], s33 offen offset:2304 sc1
s_add_u32 s33, s33, 0x4000
buffer_load_dwordx4 v[176:179], v8, s[20:23], s33 offen sc1
buffer_load_dwordx4 v[180:183], v8, s[20:23], s33 offen offset:256 sc1
buffer_load_dwordx4 v[184:187], v8, s[20:23], s33 offen offset:2048 sc1
buffer_load_dwordx4 v[188:191], v8, s[20:23], s33 offen offset:2304 sc1
s_add_u32 s33, s33, 0x4000
v_bfe_u32 v3, v1, 2, 2
v_mul_u32_u24 v9, 4416, v3
v_lshrrev_b32 v3, 4, v1
v_mul_u32_u24 v3, 1056, v3
v_add_u32 v9, v9, v3
v_and_b32 v3, 3, v1
v_lshl_add_u32 v9, v3, 3, v9
v_add_u32 v10, 52992, v9
s_and_b32 s59, s2, 127
s_lshl_b32 s59, s59, 2
s_add_u32 s59, s59, s10
s_mul_i32 s59, s59, 1024
s_add_u32 s59, s59, 2097152
v_lshlrev_b32 v243, 7, v1
v_cmp_lt_u32 vcc, 7, v1
v_mov_b32 v3, 0x40000000
s_nop 0
v_cndmask_b32 v246, v243, v3, vcc
v_cmp_lt_u32 vcc, 10, v1
s_and_b32 s58, s2, 127
s_lshl_b32 s58, s58, 2
s_add_u32 s58, s58, s10
s_lshl_b32 s58, s58, 14
v_cndmask_b32 v245, v243, v3, vcc
s_and_b32 s36, s14, 3
s_lshl_b32 s38, s13, 2
s_add_u32 s36, s36, s38
s_lshr_b32 s38, s14, 2
s_lshl_b32 s38, s38, 5
s_add_u32 s36, s36, s38
s_lshl_b32 s60, s36, 6
s_add_u32 s60, s60, 327680
s_lshl_b32 s61, s38, 6
s_add_u32 s61, s61, 327680
s_add_u32 s28, s8, 0x800000
s_addc_u32 s29, s9, 0
s_mov_b32 s30, 0x1044000
s_mov_b32 s31, 0x00020000
v_lshlrev_b32 v11, 4, v1
v_lshl_add_u32 v12, v2, 12, v11
v_add_u32 v11, 32768, v11
s_lshl_b32 s36, s10, 12
s_add_u32 s36, s36, 32768
s_mov_b32 s34, 0
s_and_b32 s39, s12, 15
s_lshl_b32 s39, s39, 2
s_add_u32 s39, s39, s10
s_and_b32 s62, s39, 3
s_and_b32 s63, s13, 4
s_add_u32 s62, s62, s63
s_bfe_u32 s63, s39, 0x30002
s_lshl_b32 s63, s63, 5
v_and_b32 v13, 31, v1
v_lshlrev_b32 v241, 6, v13
v_add_u32 v13, s63, v13
v_lshlrev_b32 v13, 12, v13
v_lshrrev_b32 v3, 5, v1
v_lshl_add_u32 v13, v3, 30, v13
s_lshr_b32 s63, s39, 5
s_lshl_b32 s63, s63, 7
s_lshl_b32 s15, s62, 9
s_add_u32 s63, s63, s15
s_lshl_b32 s62, s62, 20
v_lshlrev_b32 v14, 7, v1
v_cmp_lt_u32 vcc, 13, v1
v_mov_b32 v3, 0x40000000
s_and_b32 s39, s2, 127
s_lshl_b32 s39, s39, 2
v_cndmask_b32 v15, v14, v3, vcc
s_add_u32 s39, s39, s10
s_mov_b32 s44, s52
s_mov_b32 s45, s53
s_mov_b32 s46, 0x800000
s_mov_b32 s47, 0x00020000
s_cmp_lt_u32 s39, 335
s_cselect_b32 s96, s6, s40
s_cselect_b32 s97, s7, s41
s_mov_b32 s15, 0x380000
s_cselect_b32 s98, 0x800000, s15
s_mov_b32 s99, 0x00020000
s_cselect_b32 s15, 0, 335
s_sub_u32 s39, s39, s15
s_mul_i32 s39, s39, 25088
s_waitcnt vmcnt(8)
s_barrier
TR 16,9,0
TR 18,9,512
TR 20,9,32
TR 22,9,544
TR 24,9,64
TR 26,9,576
TR 28,9,96
TR 30,9,608
TR 32,9,128
TR 34,9,640
TR 36,9,160
TR 38,9,672
TR 40,9,192
TR 42,9,704
TR 44,9,224
TR 46,9,736
TR 48,9,256
TR 50,9,768
TR 52,9,288
TR 54,9,800
TR 56,9,320
TR 58,9,832
TR 60,9,352
TR 62,9,864
TR 64,9,384
TR 66,9,896
TR 68,9,416
TR 70,9,928
TR 72,9,448
TR 74,9,960
TR 76,9,480
TR 78,9,992
s_waitcnt vmcnt(8) lgkmcnt(0)
s_barrier
MZ 0,16,144
TR 80,9,17664
MZ 4,20,144
TR 82,9,18176
MZ 36,20,148
buffer_load_dwordx4 v[192:195], v8, s[20:23], s33 offen sc1
MZ 32,16,148
TR 84,9,17696
MZ 64,16,152
TR 86,9,18208
MZ 68,20,152
MZ 100,20,156
TR 88,9,17728
MZ 96,16,156
TR 90,9,18240
MZ 104,24,156
buffer_load_dwordx4 v[196:199], v8, s[20:23], s33 offen offset:256 sc1
MZ 108,28,156
TR 92,9,17760
MZ 76,28,152
TR 94,9,18272
MZ 72,24,152
MZ 40,24,148
TR 96,9,17792
MZ 44,28,148
TR 98,9,18304
MZ 12,28,144
MZ 8,24,144
TR 100,9,17824
MZ 16,32,144
TR 102,9,18336
MZ 20,36,144
buffer_load_dwordx4 v[200:203], v8, s[20:23], s33 offen offset:2048 sc1
MZ 52,36,148
TR 104,9,17856
MZ 48,32,148
TR 106,9,18368
MZ 80,32,152
MZ 84,36,152
TR 108,9,17888
MZ 116,36,156
TR 110,9,18400
MZ 112,32,156
buffer_load_dwordx4 v[204:207], v8, s[20:23], s33 offen offset:2304 sc1
s_add_u32 s33, s33, 0x4000
MZ 120,40,156
TR 112,9,17920
MZ 124,44,156
TR 114,9,18432
MZ 92,44,152
MZ 88,40,152
TR 116,9,17952
MZ 56,40,148
TR 118,9,18464
MZ 60,44,148
MZ 28,44,144
TR 120,9,17984
MZ 24,40,144
TR 122,9,18496
MZ 128,48,144
s_add_u32 m0, s35, 0
MZ 132,52,144
TR 124,9,18016
MZ 164,52,148
TR 126,9,18528
MZ 160,48,148
MZ 192,48,152
TR 128,9,18048
MZ 196,52,152
TR 130,9,18560
MZ 228,52,156
buffer_load_dwordx4 v4, s[16:19], s32 offen lds
MZ 224,48,156
TR 132,9,18080
MZ 232,56,156
TR 134,9,18592
MZ 236,60,156
MZ 204,60,152
TR 136,9,18112
MZ 200,56,152
TR 138,9,18624
MZ 168,56,148
MZ 172,60,148
TR 140,9,18144
MZ 140,60,144
TR 142,9,18656
MZ 136,56,144
buffer_load_dwordx4 v5, s[16:19], s32 offen offset:1056 lds
MZ 144,64,144
MZ 148,68,144
buffer_load_dwordx4 v6, s[16:19], s32 offen offset:2112 lds
MZ 180,68,148
MZ 176,64,148
MZ 208,64,152
buffer_load_dwordx4 v7, s[16:19], s32 offen offset:3168 lds
s_add_u32 s32, s32, 0x40000
MZ 212,68,152
MZ 244,68,156
buffer_load_dword v244, v245, s[44:47], s58 offen
s_add_u32 s58, s58, 1408
MZ 240,64,156
MZ 248,72,156
MZ 252,76,156
buffer_load_dword v244, v246, s[16:19], s59 offen
s_add_u32 s59, s59, 524288
MZ 220,76,152
MZ 216,72,152
v_mov_b32 v242, s100
s_mov_b64 exec, 1
buffer_store_dword v242, off, s[48:51], s60 sc1
s_mov_b64 exec, -1
MZ 184,72,148
MZ 188,76,148
MZ 156,76,144
MZ 152,72,144
s_waitcnt vmcnt(15) lgkmcnt(0)
s_barrier
MA 0,80,160
TR 16,9,35328
MA 4,84,160
TR 18,9,35840
MA 36,84,164
buffer_load_dwordx4 v[144:147], v8, s[20:23], s33 offen sc1
MA 32,80,164
TR 20,9,35360
MA 64,80,168
TR 22,9,35872
MA 68,84,168
MA 100,84,172
TR 24,9,35392
MA 96,80,172
TR 26,9,35904
MA 104,88,172
MA 108,92,172
TR 28,9,35424
MA 76,92,168
TR 30,9,35936
MA 72,88,168
buffer_load_dwordx4 v[148:151], v8, s[20:23], s33 offen offset:256 sc1
MA 40,88,164
TR 32,9,35456
MA 44,92,164
TR 34,9,35968
MA 12,92,160
MA 8,88,160
TR 36,9,35488
MA 16,96,160
TR 38,9,36000
MA 20,100,160
MA 52,100,164
TR 40,9,35520
MA 48,96,164
TR 42,9,36032
MA 80,96,168
buffer_load_dwordx4 v[152:155], v8, s[20:23], s33 offen offset:2048 sc1
MA 84,100,168
TR 44,9,35552
MA 116,100,172
TR 46,9,36064
MA 112,96,172
MA 120,104,172
TR 48,9,35584
MA 124,108,172
TR 50,9,36096
MA 92,108,168
MA 88,104,168
TR 52,9,35616
MA 56,104,164
TR 54,9,36128
MA 60,108,164
MA 28,108,160
TR 56,9,35648
MA 24,104,160
TR 58,9,36160
MA 128,112,160
buffer_load_dwordx4 v[156:159], v8, s[20:23], s33 offen offset:2304 sc1
s_add_u32 s33, s33, 0x4000
MA 132,116,160
TR 60,9,35680
MA 164,116,164
TR 62,9,36192
MA 160,112,164
MA 192,112,168
TR 64,9,35712
MA 196,116,168
TR 66,9,36224
MA 228,116,172
MA 224,112,172
TR 68,9,35744
MA 232,120,172
TR 70,9,36256
MA 236,124,172
s_add_u32 m0, s35, 17664
MA 204,124,168
TR 72,9,35776
MA 200,120,168
TR 74,9,36288
MA 168,120,164
MA 172,124,164
TR 76,9,35808
MA 140,124,160
TR 78,9,36320
MA 136,120,160
MA 144,128,160
buffer_load_dwordx4 v4, s[16:19], s32 offen lds
MA 148,132,160
MA 180,132,164
MA 176,128,164
MA 208,128,168
buffer_load_dwordx4 v5, s[16:19], s32 offen offset:1056 lds
MA 212,132,168
MA 244,132,172
MA 240,128,172
buffer_load_dwordx4 v6, s[16:19], s32 offen offset:2112 lds
MA 248,136,172
MA 252,140,172
MA 220,140,168
buffer_load_dwordx4 v7, s[16:19], s32 offen offset:3168 lds
s_add_u32 s32, s32, 0x40000
MA 216,136,168
MA 184,136,164
MA 188,140,164
MA 156,140,160
MA 152,136,160
s_waitcnt vmcnt(19) lgkmcnt(0)
s_barrier
MA 0,16,176
TR 80,10,0
MA 4,20,176
TR 82,10,512
MA 36,20,180
buffer_load_dwordx4 v[160:163], v8, s[20:23], s33 offen sc1
MA 32,16,180
TR 84,10,32
MA 64,16,184
TR 86,10,544
MA 68,20,184
MA 100,20,188
TR 88,10,64
MA 96,16,188
TR 90,10,576
MA 104,24,188
buffer_load_dwordx4 v[164:167], v8, s[20:23], s33 offen offset:256 sc1
MA 108,28,188
TR 92,10,96
MA 76,28,184
TR 94,10,608
MA 72,24,184
MA 40,24,180
TR 96,10,128
MA 44,28,180
TR 98,10,640
MA 12,28,176
MA 8,24,176
TR 100,10,160
MA 16,32,176
TR 102,10,672
MA 20,36,176
buffer_load_dwordx4 v[168:171], v8, s[20:23], s33 offen offset:2048 sc1
MA 52,36,180
TR 104,10,192
MA 48,32,180
TR 106,10,704
MA 80,32,184
MA 84,36,184
TR 108,10,224
MA 116,36,188
TR 110,10,736
MA 112,32,188
MA 120,40,188
TR 112,10,256
MA 124,44,188
TR 114,10,768
MA 92,44,184
buffer_load_dwordx4 v[172:175], v8, s[20:23], s33 offen offset:2304 sc1
s_add_u32 s33, s33, 0x4000
MA 88,40,184
TR 116,10,288
MA 56,40,180
TR 118,10,800
MA 60,44,180
MA 28,44,176
TR 120,10,320
MA 24,40,176
TR 122,10,832
MA 128,48,176
s_add_u32 m0, s35, 35328
MA 132,52,176
TR 124,10,352
MA 164,52,180
TR 126,10,864
MA 160,48,180
MA 192,48,184
TR 128,10,384
MA 196,52,184
TR 130,10,896
MA 228,52,188
MA 224,48,188
TR 132,10,416
MA 232,56,188
TR 134,10,928
MA 236,60,188
buffer_load_dwordx4 v4, s[16:19], s32 offen lds
MA 204,60,184
TR 136,10,448
MA 200,56,184
TR 138,10,960
MA 168,56,180
MA 172,60,180
TR 140,10,480
MA 140,60,176
TR 142,10,992
MA 136,56,176
MA 144,64,176
buffer_load_dwordx4 v5, s[16:19], s32 offen offset:1056 lds
MA 148,68,176
MA 180,68,180
MA 176,64,180
buffer_load_dwordx4 v6, s[16:19], s32 offen offset:2112 lds
MA 208,64,184
MA 212,68,184
buffer_load_dwordx4 v7, s[16:19], s32 offen offset:3168 lds
s_add_u32 s32, s32, 0x40000
MA 244,68,188
MA 240,64,188
MA 248,72,188
buffer_load_dword v244, v245, s[44:47], s58 offen
s_add_u32 s58, s58, 1408
MA 252,76,188
MA 220,76,184
MA 216,72,184
buffer_load_dword v244, v246, s[16:19], s59 offen
s_add_u32 s59, s59, 524288
MA 184,72,180
MA 188,76,180
MA 156,76,176
MA 152,72,176
s_waitcnt vmcnt(21) lgkmcnt(0)
s_barrier
MA 0,80,192
TR 16,9,0
MA 4,84,192
TR 18,9,512
MA 36,84,196
buffer_load_dwordx4 v[176:179], v8, s[20:23], s33 offen sc1
MA 32,80,196
TR 20,9,32
MA 64,80,200
TR 22,9,544
MA 68,84,200
MA 100,84,204
TR 24,9,64
MA 96,80,204
TR 26,9,576
MA 104,88,204
MA 108,92,204
TR 28,9,96
MA 76,92,200
TR 30,9,608
MA 72,88,200
buffer_load_dwordx4 v[180:183], v8, s[20:23], s33 offen offset:256 sc1
MA 40,88,196
TR 32,9,128
MA 44,92,196
TR 34,9,640
MA 12,92,192
MA 8,88,192
TR 36,9,160
MA 16,96,192
TR 38,9,672
MA 20,100,192
MA 52,100,196
TR 40,9,192
MA 48,96,196
TR 42,9,704
MA 80,96,200
buffer_load_dwordx4 v[184:187], v8, s[20:23], s33 offen offset:2048 sc1
MA 84,100,200
TR 44,9,224
MA 116,100,204
TR 46,9,736
MA 112,96,204
MA 120,104,204
TR 48,9,256
MA 124,108,204
TR 50,9,768
MA 92,108,200
MA 88,104,200
TR 52,9,288
MA 56,104,196
TR 54,9,800
MA 60,108,196
MA 28,108,192
TR 56,9,320
MA 24,104,192
TR 58,9,832
MA 128,112,192
buffer_load_dwordx4 v[188:191], v8, s[20:23], s33 offen offset:2304 sc1
s_add_u32 s33, s33, 0x4000
MA 132,116,192
TR 60,9,352
MA 164,116,196
TR 62,9,864
MA 160,112,196
MA 192,112,200
TR 64,9,384
MA 196,116,200
TR 66,9,896
MA 228,116,204
MA 224,112,204
TR 68,9,416
MA 232,120,204
TR 70,9,928
MA 236,124,204
s_add_u32 m0, s35, 52992
MA 204,124,200
TR 72,9,448
MA 200,120,200
TR 74,9,960
MA 168,120,196
MA 172,124,196
TR 76,9,480
MA 140,124,192
TR 78,9,992
MA 136,120,192
MA 144,128,192
buffer_load_dwordx4 v4, s[16:19], s32 offen lds
MA 148,132,192
MA 180,132,196
MA 176,128,196
MA 208,128,200
buffer_load_dwordx4 v5, s[16:19], s32 offen offset:1056 lds
MA 212,132,200
MA 244,132,204
MA 240,128,204
buffer_load_dwordx4 v6, s[16:19], s32 offen offset:2112 lds
MA 248,136,204
MA 252,140,204
MA 220,140,200
buffer_load_dwordx4 v7, s[16:19], s32 offen offset:3168 lds
s_add_u32 s32, s32, 0x40000
MA 216,136,200
MA 184,136,196
MA 188,140,196
MA 156,140,192
MA 152,136,192
s_mov_b32 s37, 6
.p2align 6
L_a_q_0:
s_waitcnt vmcnt(18) lgkmcnt(0)
s_barrier
MA 0,16,144
TR 80,9,17664
MA 4,20,144
TR 82,9,18176
MA 36,20,148
buffer_load_dwordx4 v[192:195], v8, s[20:23], s33 offen sc1
MA 32,16,148
TR 84,9,17696
MA 64,16,152
TR 86,9,18208
MA 68,20,152
MA 100,20,156
TR 88,9,17728
MA 96,16,156
TR 90,9,18240
MA 104,24,156
buffer_load_dwordx4 v[196:199], v8, s[20:23], s33 offen offset:256 sc1
MA 108,28,156
TR 92,9,17760
MA 76,28,152
TR 94,9,18272
MA 72,24,152
MA 40,24,148
TR 96,9,17792
MA 44,28,148
TR 98,9,18304
MA 12,28,144
MA 8,24,144
TR 100,9,17824
MA 16,32,144
TR 102,9,18336
MA 20,36,144
buffer_load_dwordx4 v[200:203], v8, s[20:23], s33 offen offset:2048 sc1
MA 52,36,148
TR 104,9,17856
MA 48,32,148
TR 106,9,18368
MA 80,32,152
MA 84,36,152
TR 108,9,17888
MA 116,36,156
TR 110,9,18400
MA 112,32,156
MA 120,40,156
TR 112,9,17920
MA 124,44,156
TR 114,9,18432
MA 92,44,152
buffer_load_dwordx4 v[204:207], v8, s[20:23], s33 offen offset:2304 sc1
s_add_u32 s33, s33, 0x4000
MA 88,40,152
TR 116,9,17952
MA 56,40,148
TR 118,9,18464
MA 60,44,148
MA 28,44,144
TR 120,9,17984
MA 24,40,144
TR 122,9,18496
MA 128,48,144
s_add_u32 m0, s35, 0
MA 132,52,144
TR 124,9,18016
MA 164,52,148
TR 126,9,18528
MA 160,48,148
MA 192,48,152
TR 128,9,18048
MA 196,52,152
TR 130,9,18560
MA 228,52,156
MA 224,48,156
TR 132,9,18080
MA 232,56,156
TR 134,9,18592
MA 236,60,156
buffer_load_dwordx4 v4, s[16:19], s32 offen lds
MA 204,60,152
TR 136,9,18112
MA 200,56,152
TR 138,9,18624
MA 168,56,148
MA 172,60,148
TR 140,9,18144
MA 140,60,144
TR 142,9,18656
MA 136,56,144
MA 144,64,144
buffer_load_dwordx4 v5, s[16:19], s32 offen offset:1056 lds
MA 148,68,144
MA 180,68,148
MA 176,64,148
buffer_load_dwordx4 v6, s[16:19], s32 offen offset:2112 lds
MA 208,64,152
MA 212,68,152
buffer_load_dwordx4 v7, s[16:19], s32 offen offset:3168 lds
s_add_u32 s32, s32, 0x40000
MA 244,68,156
MA 240,64,156
MA 248,72,156
buffer_load_dword v244, v245, s[44:47], s58 offen
s_add_u32 s58, s58, 1408
MA 252,76,156
MA 220,76,152
MA 216,72,152
buffer_load_dword v244, v246, s[16:19], s59 offen
s_add_u32 s59, s59, 524288
MA 184,72,148
MA 188,76,148
MA 156,76,144
MA 152,72,144
s_waitcnt vmcnt(20) lgkmcnt(0)
s_barrier
MA 0,80,160
TR 16,9,35328
MA 4,84,160
TR 18,9,35840
MA 36,84,164
buffer_load_dwordx4 v[144:147], v8, s[20:23], s33 offen sc1
MA 32,80,164
TR 20,9,35360
MA 64,80,168
TR 22,9,35872
MA 68,84,168
MA 100,84,172
TR 24,9,35392
MA 96,80,172
TR 26,9,35904
MA 104,88,172
MA 108,92,172
TR 28,9,35424
MA 76,92,168
TR 30,9,35936
MA 72,88,168
buffer_load_dwordx4 v[148:151], v8, s[20:23], s33 offen offset:256 sc1
MA 40,88,164
TR 32,9,35456
MA 44,92,164
TR 34,9,35968
MA 12,92,160
MA 8,88,160
TR 36,9,35488
MA 16,96,160
TR 38,9,36000
MA 20,100,160
MA 52,100,164
TR 40,9,35520
MA 48,96,164
TR 42,9,36032
MA 80,96,168
buffer_load_dwordx4 v[152:155], v8, s[20:23], s33 offen offset:2048 sc1
MA 84,100,168
TR 44,9,35552
MA 116,100,172
TR 46,9,36064
MA 112,96,172
MA 120,104,172
TR 48,9,35584
MA 124,108,172
TR 50,9,36096
MA 92,108,168
MA 88,104,168
TR 52,9,35616
MA 56,104,164
TR 54,9,36128
MA 60,108,164
MA 28,108,160
TR 56,9,35648
MA 24,104,160
TR 58,9,36160
MA 128,112,160
buffer_load_dwordx4 v[156:159], v8, s[20:23], s33 offen offset:2304 sc1
s_add_u32 s33, s33, 0x4000
MA 132,116,160
TR 60,9,35680
MA 164,116,164
TR 62,9,36192
MA 160,112,164
MA 192,112,168
TR 64,9,35712
MA 196,116,168
TR 66,9,36224
MA 228,116,172
MA 224,112,172
TR 68,9,35744
MA 232,120,172
TR 70,9,36256
MA 236,124,172
s_add_u32 m0, s35, 17664
MA 204,124,168
TR 72,9,35776
MA 200,120,168
TR 74,9,36288
MA 168,120,164
MA 172,124,164
TR 76,9,35808
MA 140,124,160
TR 78,9,36320
MA 136,120,160
MA 144,128,160
buffer_load_dwordx4 v4, s[16:19], s32 offen lds
MA 148,132,160
MA 180,132,164
MA 176,128,164
MA 208,128,168
buffer_load_dwordx4 v5, s[16:19], s32 offen offset:1056 lds
MA 212,132,168
MA 244,132,172
MA 240,128,172
buffer_load_dwordx4 v6, s[16:19], s32 offen offset:2112 lds
MA 248,136,172
MA 252,140,172
MA 220,140,168
buffer_load_dwordx4 v7, s[16:19], s32 offen offset:3168 lds
s_add_u32 s32, s32, 0x40000
MA 216,136,168
MA 184,136,164
MA 188,140,164
MA 156,140,160
MA 152,136,160
s_waitcnt vmcnt(18) lgkmcnt(0)
s_barrier
MA 0,16,176
TR 80,10,0
MA 4,20,176
TR 82,10,512
MA 36,20,180
buffer_load_dwordx4 v[160:163], v8, s[20:23], s33 offen sc1
MA 32,16,180
TR 84,10,32
MA 64,16,184
TR 86,10,544
MA 68,20,184
MA 100,20,188
TR 88,10,64
MA 96,16,188
TR 90,10,576
MA 104,24,188
buffer_load_dwordx4 v[164:167], v8, s[20:23], s33 offen offset:256 sc1
MA 108,28,188
TR 92,10,96
MA 76,28,184
TR 94,10,608
MA 72,24,184
MA 40,24,180
TR 96,10,128
MA 44,28,180
TR 98,10,640
MA 12,28,176
MA 8,24,176
TR 100,10,160
MA 16,32,176
TR 102,10,672
MA 20,36,176
buffer_load_dwordx4 v[168:171], v8, s[20:23], s33 offen offset:2048 sc1
MA 52,36,180
TR 104,10,192
MA 48,32,180
TR 106,10,704
MA 80,32,184
MA 84,36,184
TR 108,10,224
MA 116,36,188
TR 110,10,736
MA 112,32,188
MA 120,40,188
TR 112,10,256
MA 124,44,188
TR 114,10,768
MA 92,44,184
buffer_load_dwordx4 v[172:175], v8, s[20:23], s33 offen offset:2304 sc1
s_add_u32 s33, s33, 0x4000
MA 88,40,184
TR 116,10,288
MA 56,40,180
TR 118,10,800
MA 60,44,180
MA 28,44,176
TR 120,10,320
MA 24,40,176
TR 122,10,832
MA 128,48,176
s_add_u32 m0, s35, 35328
MA 132,52,176
TR 124,10,352
MA 164,52,180
TR 126,10,864
MA 160,48,180
MA 192,48,184
TR 128,10,384
MA 196,52,184
TR 130,10,896
MA 228,52,188
MA 224,48,188
TR 132,10,416
MA 232,56,188
TR 134,10,928
MA 236,60,188
buffer_load_dwordx4 v4, s[16:19], s32 offen lds
MA 204,60,184
TR 136,10,448
MA 200,56,184
TR 138,10,960
MA 168,56,180
MA 172,60,180
TR 140,10,480
MA 140,60,176
TR 142,10,992
MA 136,56,176
MA 144,64,176
buffer_load_dwordx4 v5, s[16:19], s32 offen offset:1056 lds
MA 148,68,176
MA 180,68,180
MA 176,64,180
buffer_load_dwordx4 v6, s[16:19], s32 offen offset:2112 lds
MA 208,64,184
MA 212,68,184
buffer_load_dwordx4 v7, s[16:19], s32 offen offset:3168 lds
s_add_u32 s32, s32, 0x40000
MA 244,68,188
MA 240,64,188
MA 248,72,188
buffer_load_dword v244, v245, s[44:47], s58 offen
s_add_u32 s58, s58, 1408
MA 252,76,188
MA 220,76,184
MA 216,72,184
buffer_load_dword v244, v246, s[16:19], s59 offen
s_add_u32 s59, s59, 524288
MA 184,72,180
MA 188,76,180
MA 156,76,176
MA 152,72,176
s_waitcnt vmcnt(20) lgkmcnt(0)
s_barrier
MA 0,80,192
TR 16,9,0
MA 4,84,192
TR 18,9,512
MA 36,84,196
buffer_load_dwordx4 v[176:179], v8, s[20:23], s33 offen sc1
MA 32,80,196
TR 20,9,32
MA 64,80,200
TR 22,9,544
MA 68,84,200
MA 100,84,204
TR 24,9,64
MA 96,80,204
TR 26,9,576
MA 104,88,204
MA 108,92,204
TR 28,9,96
MA 76,92,200
TR 30,9,608
MA 72,88,200
buffer_load_dwordx4 v[180:183], v8, s[20:23], s33 offen offset:256 sc1
MA 40,88,196
TR 32,9,128
MA 44,92,196
TR 34,9,640
MA 12,92,192
MA 8,88,192
TR 36,9,160
MA 16,96,192
TR 38,9,672
MA 20,100,192
MA 52,100,196
TR 40,9,192
MA 48,96,196
TR 42,9,704
MA 80,96,200
buffer_load_dwordx4 v[184:187], v8, s[20:23], s33 offen offset:2048 sc1
MA 84,100,200
TR 44,9,224
MA 116,100,204
TR 46,9,736
MA 112,96,204
MA 120,104,204
TR 48,9,256
MA 124,108,204
TR 50,9,768
MA 92,108,200
MA 88,104,200
TR 52,9,288
MA 56,104,196
TR 54,9,800
MA 60,108,196
MA 28,108,192
TR 56,9,320
MA 24,104,192
TR 58,9,832
MA 128,112,192
buffer_load_dwordx4 v[188:191], v8, s[20:23], s33 offen offset:2304 sc1
s_add_u32 s33, s33, 0x4000
MA 132,116,192
TR 60,9,352
MA 164,116,196
TR 62,9,864
MA 160,112,196
MA 192,112,200
TR 64,9,384
MA 196,116,200
TR 66,9,896
MA 228,116,204
MA 224,112,204
TR 68,9,416
MA 232,120,204
TR 70,9,928
MA 236,124,204
s_add_u32 m0, s35, 52992
MA 204,124,200
TR 72,9,448
MA 200,120,200
TR 74,9,960
MA 168,120,196
MA 172,124,196
TR 76,9,480
MA 140,124,192
TR 78,9,992
MA 136,120,192
MA 144,128,192
buffer_load_dwordx4 v4, s[16:19], s32 offen lds
MA 148,132,192
MA 180,132,196
MA 176,128,196
MA 208,128,200
buffer_load_dwordx4 v5, s[16:19], s32 offen offset:1056 lds
MA 212,132,200
MA 244,132,204
MA 240,128,204
buffer_load_dwordx4 v6, s[16:19], s32 offen offset:2112 lds
MA 248,136,204
MA 252,140,204
MA 220,140,200
buffer_load_dwordx4 v7, s[16:19], s32 offen offset:3168 lds
s_add_u32 s32, s32, 0x40000
MA 216,136,200
MA 184,136,196
MA 188,140,196
MA 156,140,192
MA 152,136,192
s_sub_u32 s37, s37, 1
s_cmp_lg_u32 s37, 0
s_cbranch_scc1 L_a_q_0
s_waitcnt vmcnt(18) lgkmcnt(0)
s_barrier
MA 0,16,144
TR 80,9,17664
MA 4,20,144
TR 82,9,18176
MA 36,20,148
buffer_load_dwordx4 v[192:195], v8, s[20:23], s33 offen sc1
MA 32,16,148
TR 84,9,17696
MA 64,16,152
TR 86,9,18208
MA 68,20,152
buffer_load_dwordx4 v[196:199], v8, s[20:23], s33 offen offset:256 sc1
MA 100,20,156
TR 88,9,17728
MA 96,16,156
TR 90,9,18240
MA 104,24,156
MA 108,28,156
TR 92,9,17760
MA 76,28,152
TR 94,9,18272
MA 72,24,152
buffer_load_dwordx4 v[200:203], v8, s[20:23], s33 offen offset:2048 sc1
MA 40,24,148
TR 96,9,17792
MA 44,28,148
TR 98,9,18304
MA 12,28,144
MA 8,24,144
TR 100,9,17824
MA 16,32,144
TR 102,9,18336
MA 20,36,144
buffer_load_dwordx4 v[204:207], v8, s[20:23], s33 offen offset:2304 sc1
s_add_u32 s33, s33, 0x4000
MA 52,36,148
TR 104,9,17856
MA 48,32,148
TR 106,9,18368
MA 80,32,152
MA 84,36,152
TR 108,9,17888
MA 116,36,156
TR 110,9,18400
MA 112,32,156
buffer_load_dword v242, v241, s[48:51], s61 offen sc1
MA 120,40,156
TR 112,9,17920
MA 124,44,156
TR 114,9,18432
MA 92,44,152
MA 88,40,152
TR 116,9,17952
MA 56,40,148
TR 118,9,18464
MA 60,44,148
s_getpc_b64 s[4:5]
L_ct1:
s_add_u32 s4, s4, L_a_conv-L_ct1
s_addc_u32 s5, s5, 0
MA 28,44,144
TR 120,9,17984
MA 24,40,144
TR 122,9,18496
MA 128,48,144
MA 132,52,144
TR 124,9,18016
MA 164,52,148
TR 126,9,18528
MA 160,48,148
v_lshlrev_b32 v247, 7, v0
MA 192,48,152
TR 128,9,18048
MA 196,52,152
TR 130,9,18560
MA 228,52,156
MA 224,48,156
TR 132,9,18080
MA 232,56,156
TR 134,9,18592
MA 236,60,156
v_min_u32 v247, L_a_eslow-L_a_conv-4, v247
MA 204,60,152
TR 136,9,18112
MA 200,56,152
TR 138,9,18624
MA 168,56,148
MA 172,60,148
TR 140,9,18144
MA 140,60,144
TR 142,9,18656
MA 136,56,144
global_load_dword v244, v247, s[4:5]
MA 144,64,144
v_add_u32 v247, 0x8000, v247
MA 148,68,144
MA 180,68,148
v_min_u32 v247, L_a_eslow-L_a_conv-4, v247
MA 176,64,148
MA 208,64,152
global_load_dword v244, v247, s[4:5]
MA 212,68,152
MA 244,68,156
v_add_u32 v247, 0x8000, v247
MA 240,64,156
MA 248,72,156
v_min_u32 v247, L_a_eslow-L_a_conv-4, v247
MA 252,76,156
MA 220,76,152
global_load_dword v244, v247, s[4:5]
MA 216,72,152
MA 184,72,148
v_add_u32 v14, 0x10000, v11
MA 188,76,148
MA 156,76,144
MA 152,72,144
s_waitcnt vmcnt(3) lgkmcnt(0)
s_barrier
v_cmp_ne_u32 vcc, s100, v242
s_cbranch_vccnz L_a_kvslow
L_a_kvok:
MA 0,80,160
TR 16,9,35328
MA 4,84,160
TR 18,9,35840
MA 36,84,164
s_add_u32 m0, s36, 65536
MA 32,80,164
TR 20,9,35360
MA 64,80,168
TR 22,9,35872
MA 68,84,168
MA 100,84,172
TR 24,9,35392
MA 96,80,172
TR 26,9,35904
MA 104,88,172
buffer_load_dwordx4 v12, s[24:27], s34 offen sc1 lds
MA 108,92,172
TR 28,9,35424
MA 76,92,168
TR 30,9,35936
MA 72,88,168
MA 40,88,164
TR 32,9,35456
MA 44,92,164
TR 34,9,35968
MA 12,92,160
MA 8,88,160
TR 36,9,35488
MA 16,96,160
TR 38,9,36000
MA 20,100,160
buffer_load_dwordx4 v12, s[24:27], s34 offen offset:1024 sc1 lds
MA 52,100,164
TR 40,9,35520
MA 48,96,164
TR 42,9,36032
MA 80,96,168
MA 84,100,168
TR 44,9,35552
MA 116,100,172
TR 46,9,36064
MA 112,96,172
buffer_load_dwordx4 v12, s[24:27], s34 offen offset:2048 sc1 lds
MA 120,104,172
TR 48,9,35584
MA 124,108,172
TR 50,9,36096
MA 92,108,168
MA 88,104,168
TR 52,9,35616
MA 56,104,164
TR 54,9,36128
MA 60,108,164
MA 28,108,160
TR 56,9,35648
MA 24,104,160
TR 58,9,36160
MA 128,112,160
buffer_load_dwordx4 v12, s[24:27], s34 offen offset:3072 sc1 lds
MA 132,116,160
TR 60,9,35680
MA 164,116,164
TR 62,9,36192
MA 160,112,164
MA 192,112,168
TR 64,9,35712
MA 196,116,168
TR 66,9,36224
MA 228,116,172
s_mov_b32 s34, 0x4000
MA 224,112,172
TR 68,9,35744
MA 232,120,172
TR 70,9,36256
MA 236,124,172
MA 204,124,168
TR 72,9,35776
MA 200,120,168
TR 74,9,36288
MA 168,120,164
MA 172,124,164
TR 76,9,35808
MA 140,124,160
TR 78,9,36320
MA 136,120,160
s_add_u32 m0, s36, 81920
MA 144,128,160
MA 148,132,160
buffer_load_dwordx4 v12, s[24:27], s34 offen sc1 lds
MA 180,132,164
MA 176,128,164
MA 208,128,168
buffer_load_dwordx4 v12, s[24:27], s34 offen offset:1024 sc1 lds
MA 212,132,168
MA 244,132,172
buffer_load_dwordx4 v12, s[24:27], s34 offen offset:2048 sc1 lds
MA 240,128,172
MA 248,136,172
MA 252,140,172
buffer_load_dwordx4 v12, s[24:27], s34 offen offset:3072 sc1 lds
MA 220,140,168
MA 216,136,168
s_mov_b32 s34, 0x8000
MA 184,136,164
MA 188,140,164
MA 156,140,160
MA 152,136,160
s_waitcnt vmcnt(16) lgkmcnt(0)
s_barrier
MA 0,16,176
TR 80,10,0
MA 4,20,176
TR 82,10,512
MA 36,20,180
s_add_u32 m0, s36, 98304
MA 32,16,180
TR 84,10,32
MA 64,16,184
TR 86,10,544
MA 68,20,184
MA 100,20,188
TR 88,10,64
MA 96,16,188
TR 90,10,576
MA 104,24,188
MA 108,28,188
TR 92,10,96
MA 76,28,184
TR 94,10,608
MA 72,24,184
MA 40,24,180
TR 96,10,128
MA 44,28,180
TR 98,10,640
MA 12,28,176
MA 8,24,176
TR 100,10,160
MA 16,32,176
TR 102,10,672
MA 20,36,176
buffer_load_dwordx4 v12, s[24:27], s34 offen sc1 lds
MA 52,36,180
TR 104,10,192
MA 48,32,180
TR 106,10,704
MA 80,32,184
MA 84,36,184
TR 108,10,224
MA 116,36,188
TR 110,10,736
MA 112,32,188
MA 120,40,188
TR 112,10,256
MA 124,44,188
TR 114,10,768
MA 92,44,184
MA 88,40,184
TR 116,10,288
MA 56,40,180
TR 118,10,800
MA 60,44,180
MA 28,44,176
TR 120,10,320
MA 24,40,176
TR 122,10,832
MA 128,48,176
buffer_load_dwordx4 v12, s[24:27], s34 offen offset:1024 sc1 lds
MA 132,52,176
TR 124,10,352
MA 164,52,180
TR 126,10,864
MA 160,48,180
MA 192,48,184
TR 128,10,384
MA 196,52,184
TR 130,10,896
MA 228,52,188
MA 224,48,188
TR 132,10,416
MA 232,56,188
TR 134,10,928
MA 236,60,188
MA 204,60,184
TR 136,10,448
MA 200,56,184
TR 138,10,960
MA 168,56,180
MA 172,60,180
TR 140,10,480
MA 140,60,176
TR 142,10,992
MA 136,56,176
buffer_load_dwordx4 v12, s[24:27], s34 offen offset:2048 sc1 lds
MA 144,64,176
MA 148,68,176
MA 180,68,180
MA 176,64,180
MA 208,64,184
buffer_load_dwordx4 v12, s[24:27], s34 offen offset:3072 sc1 lds
MA 212,68,184
MA 244,68,188
MA 240,64,188
MA 248,72,188
MA 252,76,188
s_mov_b32 s34, 0xc000
MA 220,76,184
MA 216,72,184
MA 184,72,180
MA 188,76,180
MA 156,76,176
MA 152,72,176
s_waitcnt vmcnt(8) lgkmcnt(0)
s_barrier
MA 0,80,192
RD 16,14,0
MA 4,84,192
RD 20,14,1024
MA 36,84,196
s_add_u32 m0, s36, 114688
MA 32,80,196
RD 24,14,2048
MA 64,80,200
RD 28,14,3072
MA 68,84,200
MA 100,84,204
RD 32,14,4096
MA 96,80,204
RD 36,14,5120
MA 104,88,204
buffer_load_dwordx4 v12, s[24:27], s34 offen sc1 lds
MA 108,92,204
RD 40,14,6144
MA 76,92,200
RD 44,14,7168
MA 72,88,200
MA 40,88,196
RD 48,14,8192
MA 44,92,196
RD 52,14,9216
MA 12,92,192
MA 8,88,192
RD 56,14,10240
MA 16,96,192
RD 60,14,11264
MA 20,100,192
buffer_load_dwordx4 v12, s[24:27], s34 offen offset:1024 sc1 lds
MA 52,100,196
RD 64,14,12288
MA 48,96,196
RD 68,14,13312
MA 80,96,200
MA 84,100,200
RD 72,14,14336
MA 116,100,204
RD 76,14,15360
MA 112,96,204
buffer_load_dwordx4 v12, s[24:27], s34 offen offset:2048 sc1 lds
MA 120,104,204
MA 124,108,204
MA 92,108,200
buffer_load_dwordx4 v12, s[24:27], s34 offen offset:3072 sc1 lds
MA 88,104,200
MA 56,104,196
s_mov_b32 s34, 0x10000
MA 60,108,196
MA 28,108,192
MA 24,104,192
s_add_u32 m0, s36, 0
MA 128,112,192
MA 132,116,192
buffer_load_dwordx4 v12, s[24:27], s34 offen sc1 lds
MA 164,116,196
MA 160,112,196
MA 192,112,200
buffer_load_dwordx4 v12, s[24:27], s34 offen offset:1024 sc1 lds
MA 196,116,200
MA 228,116,204
MA 224,112,204
buffer_load_dwordx4 v12, s[24:27], s34 offen offset:2048 sc1 lds
MA 232,120,204
MA 236,124,204
buffer_load_dwordx4 v12, s[24:27], s34 offen offset:3072 sc1 lds
MA 204,124,200
MA 200,120,200
MA 168,120,196
s_mov_b32 s34, 0x14000
MA 172,124,196
MA 140,124,192
s_add_u32 m0, s36, 16384
MA 136,120,192
MA 144,128,192
MA 148,132,192
buffer_load_dwordx4 v12, s[24:27], s34 offen sc1 lds
MA 180,132,196
MA 176,128,196
buffer_load_dwordx4 v12, s[24:27], s34 offen offset:1024 sc1 lds
MA 208,128,200
MA 212,132,200
MA 244,132,204
buffer_load_dwordx4 v12, s[24:27], s34 offen offset:2048 sc1 lds
MA 240,128,204
MA 248,136,204
buffer_load_dwordx4 v12, s[24:27], s34 offen offset:3072 sc1 lds
MA 252,140,204
MA 220,140,200
MA 216,136,200
s_mov_b32 s34, 0x18000
MA 184,136,196
MA 188,140,196
MA 156,140,192
MA 152,136,192
L_a_conv:
v_mov_b32 v4, 0
v_mov_b32 v5, 0
v_mov_b32 v6, 0
v_mov_b32 v7, 0
s_mov_b32 s58, 0
s_nop 6
AR 80,0
AR 81,1
AR 82,2
AR 83,3
AR 84,4
AR 85,5
AR 86,6
AR 87,7
CV 128,80,81
CV 129,82,83
CV 130,84,85
CV 131,86,87
AR 88,8
AR 89,9
AR 90,10
AR 91,11
AR 92,12
AR 93,13
AR 94,14
AR 95,15
CV 132,88,89
CV 133,90,91
CV 134,92,93
CV 135,94,95
AR 80,16
AR 81,17
AR 82,18
AR 83,19
AR 84,20
AR 85,21
AR 86,22
AR 87,23
CV 136,80,81
CV 137,82,83
CV 138,84,85
CV 139,86,87
AR 88,24
AR 89,25
AR 90,26
AR 91,27
AR 92,28
AR 93,29
AR 94,30
AR 95,31
CV 140,88,89
CV 141,90,91
CV 142,92,93
CV 143,94,95
AR 80,32
AR 81,33
AR 82,34
AR 83,35
AR 84,36
AR 85,37
AR 86,38
AR 87,39
CV 144,80,81
CV 145,82,83
CV 146,84,85
CV 147,86,87
AR 88,40
AR 89,41
AR 90,42
AR 91,43
AR 92,44
AR 93,45
AR 94,46
AR 95,47
CV 148,88,89
CV 149,90,91
CV 150,92,93
CV 151,94,95
AR 80,48
AR 81,49
AR 82,50
AR 83,51
AR 84,52
AR 85,53
AR 86,54
AR 87,55
CV 152,80,81
CV 153,82,83
CV 154,84,85
CV 155,86,87
AR 88,56
AR 89,57
AR 90,58
AR 91,59
AR 92,60
AR 93,61
AR 94,62
AR 95,63
CV 156,88,89
CV 157,90,91
CV 158,92,93
CV 159,94,95
AR 80,64
AR 81,65
AR 82,66
AR 83,67
AR 84,68
AR 85,69
AR 86,70
AR 87,71
CV 160,80,81
CV 161,82,83
CV 162,84,85
CV 163,86,87
AR 88,72
AR 89,73
AR 90,74
AR 91,75
AR 92,76
AR 93,77
AR 94,78
AR 95,79
CV 164,88,89
CV 165,90,91
CV 166,92,93
CV 167,94,95
AR 80,80
AR 81,81
AR 82,82
AR 83,83
AR 84,84
AR 85,85
AR 86,86
AR 87,87
CV 168,80,81
CV 169,82,83
CV 170,84,85
CV 171,86,87
AR 88,88
AR 89,89
AR 90,90
AR 91,91
AR 92,92
AR 93,93
AR 94,94
AR 95,95
CV 172,88,89
CV 173,90,91
CV 174,92,93
CV 175,94,95
AR 80,96
AR 81,97
AR 82,98
AR 83,99
AR 84,100
AR 85,101
AR 86,102
AR 87,103
CV 176,80,81
CV 177,82,83
CV 178,84,85
CV 179,86,87
AR 88,104
AR 89,105
AR 90,106
AR 91,107
AR 92,108
AR 93,109
AR 94,110
AR 95,111
CV 180,88,89
CV 181,90,91
CV 182,92,93
CV 183,94,95
AR 80,112
AR 81,113
AR 82,114
AR 83,115
AR 84,116
AR 85,117
AR 86,118
AR 87,119
CV 184,80,81
CV 185,82,83
CV 186,84,85
CV 187,86,87
AR 88,120
AR 89,121
AR 90,122
AR 91,123
AR 92,124
AR 93,125
AR 94,126
AR 95,127
CV 188,88,89
CV 189,90,91
CV 190,92,93
CV 191,94,95
s_waitcnt lgkmcnt(0)
s_nop 1
s_waitcnt vmcnt(16)
s_barrier
v_mfma_f32_16x16x32_bf16 v[80:83], v[16:19], v[128:131], 0
v_mfma_f32_16x16x32_bf16 v[88:91], v[16:19], v[144:147], 0
v_mfma_f32_16x16x32_bf16 v[92:95], v[20:23], v[144:147], 0
v_mfma_f32_16x16x32_bf16 v[84:87], v[20:23], v[128:131], 0
v_mfma_f32_16x16x32_bf16 v[80:83], v[24:27], v[132:135], v[80:83]
v_mfma_f32_16x16x32_bf16 v[88:91], v[24:27], v[148:151], v[88:91]
v_mfma_f32_16x16x32_bf16 v[92:95], v[28:31], v[148:151], v[92:95]
v_mfma_f32_16x16x32_bf16 v[84:87], v[28:31], v[132:135], v[84:87]
v_mfma_f32_16x16x32_bf16 v[80:83], v[32:35], v[136:139], v[80:83]
v_mfma_f32_16x16x32_bf16 v[88:91], v[32:35], v[152:155], v[88:91]
v_mfma_f32_16x16x32_bf16 v[92:95], v[36:39], v[152:155], v[92:95]
v_mfma_f32_16x16x32_bf16 v[84:87], v[36:39], v[136:139], v[84:87]
v_mfma_f32_16x16x32_bf16 v[80:83], v[40:43], v[140:143], v[80:83]
v_mfma_f32_16x16x32_bf16 v[88:91], v[40:43], v[156:159], v[88:91]
v_mfma_f32_16x16x32_bf16 v[92:95], v[44:47], v[156:159], v[92:95]
v_mfma_f32_16x16x32_bf16 v[84:87], v[44:47], v[140:143], v[84:87]
v_mfma_f32_16x16x32_bf16 v[96:99], v[16:19], v[160:163], 0
v_mfma_f32_16x16x32_bf16 v[104:107], v[16:19], v[176:179], 0
RD 16,14,16384
v_mfma_f32_16x16x32_bf16 v[108:111], v[20:23], v[176:179], 0
v_exp_f32 v80, v80
v_exp_f32 v81, v81
v_mfma_f32_16x16x32_bf16 v[100:103], v[20:23], v[160:163], 0
RD 20,14,17408
v_exp_f32 v82, v82
v_add_f32 v4, v4, v80
v_add_f32 v4, v4, v81
v_mfma_f32_16x16x32_bf16 v[96:99], v[24:27], v[164:167], v[96:99]
v_exp_f32 v83, v83
CV 112,80,81
v_add_f32 v4, v4, v82
v_mfma_f32_16x16x32_bf16 v[104:107], v[24:27], v[180:183], v[104:107]
RD 24,14,18432
v_exp_f32 v84, v84
CV 113,82,83
v_add_f32 v4, v4, v83
v_mfma_f32_16x16x32_bf16 v[108:111], v[28:31], v[180:183], v[108:111]
v_exp_f32 v85, v85
v_exp_f32 v86, v86
v_add_f32 v4, v4, v84
v_mfma_f32_16x16x32_bf16 v[100:103], v[28:31], v[164:167], v[100:103]
RD 28,14,19456
CV 114,84,85
v_exp_f32 v87, v87
v_mfma_f32_16x16x32_bf16 v[96:99], v[32:35], v[168:171], v[96:99]
v_add_f32 v4, v4, v85
v_add_f32 v4, v4, v86
v_exp_f32 v88, v88
CV 115,86,87
v_mfma_f32_16x16x32_bf16 v[104:107], v[32:35], v[184:187], v[104:107]
RD 32,14,20480
v_add_f32 v4, v4, v87
v_exp_f32 v89, v89
v_mfma_f32_16x16x32_bf16 v[108:111], v[36:39], v[184:187], v[108:111]
v_exp_f32 v90, v90
v_add_f32 v5, v5, v88
CV 116,88,89
v_mfma_f32_16x16x32_bf16 v[100:103], v[36:39], v[168:171], v[100:103]
RD 36,14,21504
v_exp_f32 v91, v91
v_add_f32 v5, v5, v89
v_add_f32 v5, v5, v90
v_mfma_f32_16x16x32_bf16 v[96:99], v[40:43], v[172:175], v[96:99]
v_exp_f32 v92, v92
CV 117,90,91
v_add_f32 v5, v5, v91
v_mfma_f32_16x16x32_bf16 v[104:107], v[40:43], v[188:191], v[104:107]
RD 40,14,22528
v_exp_f32 v93, v93
v_exp_f32 v94, v94
v_mfma_f32_16x16x32_bf16 v[108:111], v[44:47], v[188:191], v[108:111]
v_add_f32 v5, v5, v92
CV 118,92,93
v_exp_f32 v95, v95
v_add_f32 v5, v5, v93
v_mfma_f32_16x16x32_bf16 v[100:103], v[44:47], v[172:175], v[100:103]
RD 44,14,23552
v_add_f32 v5, v5, v94
CV 119,94,95
v_add_f32 v5, v5, v95
s_waitcnt vmcnt(8) lgkmcnt(0)
s_barrier
v_mfma_f32_16x16x32_bf16 v[80:83], v[16:19], v[128:131], 0
v_exp_f32 v96, v96
v_mfma_f32_16x16x32_bf16 v[88:91], v[16:19], v[144:147], 0
v_mfma_f32_16x16x32_bf16 v[92:95], v[20:23], v[144:147], 0
v_exp_f32 v97, v97
v_mfma_f32_16x16x32_bf16 v[84:87], v[20:23], v[128:131], 0
s_add_u32 m0, s36, 32768
s_nop 0
buffer_load_dwordx4 v12, s[24:27], s34 offen sc1 lds
v_add_f32 v6, v6, v96
AR 8,128
MZ 0,48,112
v_exp_f32 v98, v98
MZ 32,48,116
CV 120,96,97
v_add_f32 v6, v6, v97
MZ 36,52,116
v_exp_f32 v99, v99
MZ 4,52,112
v_add_f32 v6, v6, v98
AR 9,129
CV 192,8,9
AR 10,130
AR 2,131
v_mfma_f32_16x16x32_bf16 v[80:83], v[24:27], v[132:135], v[80:83]
v_exp_f32 v100, v100
CV 193,10,2
v_mfma_f32_16x16x32_bf16 v[88:91], v[24:27], v[148:151], v[88:91]
CV 121,98,99
v_add_f32 v6, v6, v99
v_mfma_f32_16x16x32_bf16 v[92:95], v[28:31], v[148:151], v[92:95]
v_exp_f32 v101, v101
AR 8,132
v_mfma_f32_16x16x32_bf16 v[84:87], v[28:31], v[132:135], v[84:87]
buffer_load_dwordx4 v12, s[24:27], s34 offen offset:1024 sc1 lds
v_add_f32 v6, v6, v100
AR 9,133
MZ 8,56,112
v_exp_f32 v102, v102
MZ 40,56,116
CV 122,100,101
v_add_f32 v6, v6, v101
MZ 44,60,116
v_exp_f32 v103, v103
MZ 12,60,112
v_add_f32 v6, v6, v102
CV 194,8,9
AR 10,134
AR 2,135
CV 195,10,2
v_mfma_f32_16x16x32_bf16 v[80:83], v[32:35], v[136:139], v[80:83]
v_exp_f32 v104, v104
v_mfma_f32_16x16x32_bf16 v[88:91], v[32:35], v[152:155], v[88:91]
CV 123,102,103
v_add_f32 v6, v6, v103
AR 8,136
v_mfma_f32_16x16x32_bf16 v[92:95], v[36:39], v[152:155], v[92:95]
v_exp_f32 v105, v105
AR 9,137
v_mfma_f32_16x16x32_bf16 v[84:87], v[36:39], v[136:139], v[84:87]
buffer_load_dwordx4 v12, s[24:27], s34 offen offset:2048 sc1 lds
v_add_f32 v7, v7, v104
CV 196,8,9
MZ 16,64,112
v_exp_f32 v106, v106
MZ 48,64,116
CV 124,104,105
v_add_f32 v7, v7, v105
MZ 52,68,116
v_exp_f32 v107, v107
MZ 20,68,112
v_add_f32 v7, v7, v106
AR 10,138
AR 2,139
CV 197,10,2
v_mfma_f32_16x16x32_bf16 v[80:83], v[40:43], v[140:143], v[80:83]
v_exp_f32 v108, v108
AR 8,140
v_mfma_f32_16x16x32_bf16 v[88:91], v[40:43], v[156:159], v[88:91]
CV 125,106,107
v_add_f32 v7, v7, v107
AR 9,141
v_mfma_f32_16x16x32_bf16 v[92:95], v[44:47], v[156:159], v[92:95]
v_exp_f32 v109, v109
CV 198,8,9
v_mfma_f32_16x16x32_bf16 v[84:87], v[44:47], v[140:143], v[84:87]
buffer_load_dwordx4 v12, s[24:27], s34 offen offset:3072 sc1 lds
s_mov_b32 s34, 0x1c000
v_add_f32 v7, v7, v108
AR 10,142
MZ 24,72,112
v_exp_f32 v110, v110
AR 2,143
MZ 56,72,116
CV 126,108,109
v_add_f32 v7, v7, v109
CV 199,10,2
MZ 60,76,116
v_exp_f32 v111, v111
MZ 28,76,112
v_add_f32 v7, v7, v110
v_mfma_f32_16x16x32_bf16 v[96:99], v[16:19], v[160:163], 0
v_exp_f32 v80, v80
AR 8,144
v_mfma_f32_16x16x32_bf16 v[104:107], v[16:19], v[176:179], 0
RD 16,14,32768
CV 127,110,111
v_add_f32 v7, v7, v111
v_mfma_f32_16x16x32_bf16 v[108:111], v[20:23], v[176:179], 0
v_exp_f32 v81, v81
AR 9,145
v_mfma_f32_16x16x32_bf16 v[100:103], v[20:23], v[160:163], 0
RD 20,14,33792
v_add_f32 v4, v4, v80
MZ 64,48,120
v_exp_f32 v82, v82
MZ 96,48,124
RD 48,14,24576
CV 112,80,81
v_add_f32 v4, v4, v81
CV 200,8,9
MZ 100,52,124
v_exp_f32 v83, v83
MZ 68,52,120
RD 52,14,25600
v_add_f32 v4, v4, v82
AR 10,146
v_mfma_f32_16x16x32_bf16 v[96:99], v[24:27], v[164:167], v[96:99]
v_exp_f32 v84, v84
v_mfma_f32_16x16x32_bf16 v[104:107], v[24:27], v[180:183], v[104:107]
RD 24,14,34816
CV 113,82,83
v_add_f32 v4, v4, v83
v_mfma_f32_16x16x32_bf16 v[108:111], v[28:31], v[180:183], v[108:111]
v_exp_f32 v85, v85
AR 2,147
v_mfma_f32_16x16x32_bf16 v[100:103], v[28:31], v[164:167], v[100:103]
RD 28,14,35840
v_add_f32 v4, v4, v84
MZ 72,56,120
v_exp_f32 v86, v86
CV 201,10,2
MZ 104,56,124
RD 56,14,26624
CV 114,84,85
v_add_f32 v4, v4, v85
MZ 108,60,124
v_exp_f32 v87, v87
MZ 76,60,120
RD 60,14,27648
v_add_f32 v4, v4, v86
AR 8,148
v_mfma_f32_16x16x32_bf16 v[96:99], v[32:35], v[168:171], v[96:99]
v_exp_f32 v88, v88
v_mfma_f32_16x16x32_bf16 v[104:107], v[32:35], v[184:187], v[104:107]
RD 32,14,36864
CV 115,86,87
v_add_f32 v4, v4, v87
v_mfma_f32_16x16x32_bf16 v[108:111], v[36:39], v[184:187], v[108:111]
v_exp_f32 v89, v89
AR 9,149
v_mfma_f32_16x16x32_bf16 v[100:103], v[36:39], v[168:171], v[100:103]
RD 36,14,37888
v_add_f32 v5, v5, v88
MZ 80,64,120
v_exp_f32 v90, v90
CV 202,8,9
MZ 112,64,124
RD 64,14,28672
CV 116,88,89
v_add_f32 v5, v5, v89
MZ 116,68,124
v_exp_f32 v91, v91
MZ 84,68,120
RD 68,14,29696
v_add_f32 v5, v5, v90
AR 10,150
v_mfma_f32_16x16x32_bf16 v[96:99], v[40:43], v[172:175], v[96:99]
v_exp_f32 v92, v92
v_mfma_f32_16x16x32_bf16 v[104:107], v[40:43], v[188:191], v[104:107]
RD 40,14,38912
CV 117,90,91
v_add_f32 v5, v5, v91
AR 2,151
v_mfma_f32_16x16x32_bf16 v[108:111], v[44:47], v[188:191], v[108:111]
v_exp_f32 v93, v93
v_mfma_f32_16x16x32_bf16 v[100:103], v[44:47], v[172:175], v[100:103]
RD 44,14,39936
v_add_f32 v5, v5, v92
MZ 88,72,120
v_exp_f32 v94, v94
CV 203,10,2
MZ 120,72,124
RD 72,14,30720
CV 118,92,93
v_add_f32 v5, v5, v93
MZ 124,76,124
v_exp_f32 v95, v95
MZ 92,76,120
RD 76,14,31744
v_add_f32 v5, v5, v94
s_waitcnt lgkmcnt(4)
v_mfma_f32_16x16x32_bf16 v[80:83], v[16:19], v[128:131], 0
v_exp_f32 v96, v96
AR 8,152
v_mfma_f32_16x16x32_bf16 v[88:91], v[16:19], v[144:147], 0
CV 119,94,95
v_add_f32 v5, v5, v95
AR 9,153
v_mfma_f32_16x16x32_bf16 v[92:95], v[20:23], v[144:147], 0
v_exp_f32 v97, v97
CV 204,8,9
v_mfma_f32_16x16x32_bf16 v[84:87], v[20:23], v[128:131], 0
s_add_u32 m0, s36, 49152
s_nop 0
buffer_load_dwordx4 v12, s[24:27], s34 offen sc1 lds
v_add_f32 v6, v6, v96
AR 10,154
MA 0,48,112
v_exp_f32 v98, v98
MA 32,48,116
CV 120,96,97
v_add_f32 v6, v6, v97
s_getpc_b64 s[62:63]
L_ct2:
MA 36,52,116
v_exp_f32 v99, v99
MA 4,52,112
v_add_f32 v6, v6, v98
AR 2,155
CV 205,10,2
AR 8,156
v_mfma_f32_16x16x32_bf16 v[80:83], v[24:27], v[132:135], v[80:83]
v_exp_f32 v100, v100
v_mfma_f32_16x16x32_bf16 v[88:91], v[24:27], v[148:151], v[88:91]
CV 121,98,99
v_add_f32 v6, v6, v99
v_lshlrev_b32 v0, 7, v1
AR 9,157
v_mfma_f32_16x16x32_bf16 v[92:95], v[28:31], v[148:151], v[92:95]
v_exp_f32 v101, v101
CV 206,8,9
v_mfma_f32_16x16x32_bf16 v[84:87], v[28:31], v[132:135], v[84:87]
buffer_load_dwordx4 v12, s[24:27], s34 offen offset:1024 sc1 lds
v_add_f32 v6, v6, v100
AR 10,158
MA 8,56,112
v_exp_f32 v102, v102
AR 2,159
MA 40,56,116
CV 122,100,101
v_add_f32 v6, v6, v101
v_add_u32 v0, 2048, v0
MA 44,60,116
v_exp_f32 v103, v103
CV 207,10,2
MA 12,60,112
s_waitcnt lgkmcnt(0)
v_add_f32 v6, v6, v102
AR 8,160
v_mfma_f32_16x16x32_bf16 v[80:83], v[32:35], v[136:139], v[80:83]
v_exp_f32 v104, v104
AR 9,161
v_mfma_f32_16x16x32_bf16 v[88:91], v[32:35], v[152:155], v[88:91]
CV 123,102,103
v_add_f32 v6, v6, v103
v_min_u32 v0, L_code_end-L_ct2-4, v0
v_mfma_f32_16x16x32_bf16 v[92:95], v[36:39], v[152:155], v[92:95]
v_exp_f32 v105, v105
CV 208,8,9
v_mfma_f32_16x16x32_bf16 v[84:87], v[36:39], v[136:139], v[84:87]
buffer_load_dwordx4 v12, s[24:27], s34 offen offset:2048 sc1 lds
v_add_f32 v7, v7, v104
AR 10,162
MA 16,64,112
v_exp_f32 v106, v106
MA 48,64,116
global_load_dword v3, v0, s[62:63]
CV 124,104,105
v_add_f32 v7, v7, v105
MA 52,68,116
v_exp_f32 v107, v107
MA 20,68,112
v_add_f32 v7, v7, v106
AR 2,163
CV 209,10,2
AR 8,164
v_mfma_f32_16x16x32_bf16 v[80:83], v[40:43], v[140:143], v[80:83]
v_exp_f32 v108, v108
AR 9,165
v_mfma_f32_16x16x32_bf16 v[88:91], v[40:43], v[156:159], v[88:91]
CV 125,106,107
v_add_f32 v7, v7, v107
CV 210,8,9
v_mfma_f32_16x16x32_bf16 v[92:95], v[44:47], v[156:159], v[92:95]
v_exp_f32 v109, v109
v_mfma_f32_16x16x32_bf16 v[84:87], v[44:47], v[140:143], v[84:87]
buffer_load_dwordx4 v12, s[24:27], s34 offen offset:3072 sc1 lds
s_mov_b32 s34, 0x20000
v_add_f32 v7, v7, v108
AR 10,166
MA 24,72,112
v_exp_f32 v110, v110
AR 2,167
MA 56,72,116
CV 126,108,109
v_add_f32 v7, v7, v109
CV 211,10,2
MA 60,76,116
v_exp_f32 v111, v111
MA 28,76,112
buffer_load_dword v3, v15, s[96:99], s39 offen
s_add_u32 s39, s39, 1792
v_add_f32 v7, v7, v110
v_mfma_f32_16x16x32_bf16 v[96:99], v[16:19], v[160:163], 0
v_exp_f32 v80, v80
AR 8,168
v_mfma_f32_16x16x32_bf16 v[104:107], v[16:19], v[176:179], 0
RD 16,14,49152
CV 127,110,111
v_add_f32 v7, v7, v111
v_mfma_f32_16x16x32_bf16 v[108:111], v[20:23], v[176:179], 0
v_exp_f32 v81, v81
AR 9,169
v_mfma_f32_16x16x32_bf16 v[100:103], v[20:23], v[160:163], 0
RD 20,14,50176
v_add_f32 v4, v4, v80
MA 64,48,120
v_exp_f32 v82, v82
MA 96,48,124
RD 48,14,40960
CV 112,80,81
v_add_f32 v4, v4, v81
CV 212,8,9
MA 100,52,124
v_exp_f32 v83, v83
MA 68,52,120
RD 52,14,41984
v_add_f32 v4, v4, v82
AR 10,170
v_mfma_f32_16x16x32_bf16 v[96:99], v[24:27], v[164:167], v[96:99]
v_exp_f32 v84, v84
v_mfma_f32_16x16x32_bf16 v[104:107], v[24:27], v[180:183], v[104:107]
RD 24,14,51200
CV 113,82,83
v_add_f32 v4, v4, v83
v_mfma_f32_16x16x32_bf16 v[108:111], v[28:31], v[180:183], v[108:111]
v_exp_f32 v85, v85
AR 2,171
v_mfma_f32_16x16x32_bf16 v[100:103], v[28:31], v[164:167], v[100:103]
RD 28,14,52224
v_add_f32 v4, v4, v84
MA 72,56,120
v_exp_f32 v86, v86
CV 213,10,2
MA 104,56,124
RD 56,14,43008
CV 114,84,85
v_add_f32 v4, v4, v85
MA 108,60,124
v_exp_f32 v87, v87
MA 76,60,120
RD 60,14,44032
v_add_f32 v4, v4, v86
AR 8,172
v_mfma_f32_16x16x32_bf16 v[96:99], v[32:35], v[168:171], v[96:99]
v_exp_f32 v88, v88
v_mfma_f32_16x16x32_bf16 v[104:107], v[32:35], v[184:187], v[104:107]
RD 32,14,53248
CV 115,86,87
v_add_f32 v4, v4, v87
v_mfma_f32_16x16x32_bf16 v[108:111], v[36:39], v[184:187], v[108:111]
v_exp_f32 v89, v89
AR 9,173
v_mfma_f32_16x16x32_bf16 v[100:103], v[36:39], v[168:171], v[100:103]
RD 36,14,54272
v_add_f32 v5, v5, v88
MA 80,64,120
v_exp_f32 v90, v90
CV 214,8,9
MA 112,64,124
RD 64,14,45056
CV 116,88,89
v_add_f32 v5, v5, v89
MA 116,68,124
v_exp_f32 v91, v91
MA 84,68,120
RD 68,14,46080
v_add_f32 v5, v5, v90
AR 10,174
v_mfma_f32_16x16x32_bf16 v[96:99], v[40:43], v[172:175], v[96:99]
v_exp_f32 v92, v92
v_mfma_f32_16x16x32_bf16 v[104:107], v[40:43], v[188:191], v[104:107]
RD 40,14,55296
CV 117,90,91
v_add_f32 v5, v5, v91
AR 2,175
v_mfma_f32_16x16x32_bf16 v[108:111], v[44:47], v[188:191], v[108:111]
v_exp_f32 v93, v93
v_mfma_f32_16x16x32_bf16 v[100:103], v[44:47], v[172:175], v[100:103]
RD 44,14,56320
v_add_f32 v5, v5, v92
MA 88,72,120
v_exp_f32 v94, v94
CV 215,10,2
MA 120,72,124
RD 72,14,47104
CV 118,92,93
v_add_f32 v5, v5, v93
MA 124,76,124
v_exp_f32 v95, v95
MA 92,76,120
RD 76,14,48128
v_add_f32 v5, v5, v94
s_waitcnt vmcnt(10) lgkmcnt(4)
s_barrier
v_mfma_f32_16x16x32_bf16 v[80:83], v[16:19], v[128:131], 0
v_exp_f32 v96, v96
AR 8,176
v_mfma_f32_16x16x32_bf16 v[88:91], v[16:19], v[144:147], 0
CV 119,94,95
v_add_f32 v5, v5, v95
AR 9,177
v_mfma_f32_16x16x32_bf16 v[92:95], v[20:23], v[144:147], 0
v_exp_f32 v97, v97
CV 216,8,9
v_mfma_f32_16x16x32_bf16 v[84:87], v[20:23], v[128:131], 0
s_add_u32 m0, s36, 65536
s_nop 0
buffer_load_dwordx4 v12, s[24:27], s34 offen sc1 lds
v_add_f32 v6, v6, v96
AR 10,178
MA 0,48,112
v_exp_f32 v98, v98
MA 32,48,116
CV 120,96,97
v_add_f32 v6, v6, v97
MA 36,52,116
v_exp_f32 v99, v99
MA 4,52,112
v_add_f32 v6, v6, v98
AR 2,179
CV 217,10,2
AR 8,180
v_mfma_f32_16x16x32_bf16 v[80:83], v[24:27], v[132:135], v[80:83]
v_exp_f32 v100, v100
v_mfma_f32_16x16x32_bf16 v[88:91], v[24:27], v[148:151], v[88:91]
CV 121,98,99
v_add_f32 v6, v6, v99
AR 9,181
v_mfma_f32_16x16x32_bf16 v[92:95], v[28:31], v[148:151], v[92:95]
v_exp_f32 v101, v101
CV 218,8,9
v_mfma_f32_16x16x32_bf16 v[84:87], v[28:31], v[132:135], v[84:87]
buffer_load_dwordx4 v12, s[24:27], s34 offen offset:1024 sc1 lds
v_add_f32 v6, v6, v100
AR 10,182
MA 8,56,112
v_exp_f32 v102, v102
AR 2,183
MA 40,56,116
CV 122,100,101
v_add_f32 v6, v6, v101
MA 44,60,116
v_exp_f32 v103, v103
CV 219,10,2
MA 12,60,112
s_waitcnt lgkmcnt(0)
v_add_f32 v6, v6, v102
AR 8,184
v_mfma_f32_16x16x32_bf16 v[80:83], v[32:35], v[136:139], v[80:83]
v_exp_f32 v104, v104
AR 9,185
v_mfma_f32_16x16x32_bf16 v[88:91], v[32:35], v[152:155], v[88:91]
CV 123,102,103
v_add_f32 v6, v6, v103
v_mfma_f32_16x16x32_bf16 v[92:95], v[36:39], v[152:155], v[92:95]
v_exp_f32 v105, v105
CV 220,8,9
v_mfma_f32_16x16x32_bf16 v[84:87], v[36:39], v[136:139], v[84:87]
buffer_load_dwordx4 v12, s[24:27], s34 offen offset:2048 sc1 lds
v_add_f32 v7, v7, v104
AR 10,186
MA 16,64,112
v_exp_f32 v106, v106
MA 48,64,116
CV 124,104,105
v_add_f32 v7, v7, v105
MA 52,68,116
v_exp_f32 v107, v107
MA 20,68,112
v_add_f32 v7, v7, v106
AR 2,187
CV 221,10,2
AR 8,188
v_mfma_f32_16x16x32_bf16 v[80:83], v[40:43], v[140:143], v[80:83]
v_exp_f32 v108, v108
AR 9,189
v_mfma_f32_16x16x32_bf16 v[88:91], v[40:43], v[156:159], v[88:91]
CV 125,106,107
v_add_f32 v7, v7, v107
CV 222,8,9
v_mfma_f32_16x16x32_bf16 v[92:95], v[44:47], v[156:159], v[92:95]
v_exp_f32 v109, v109
v_mfma_f32_16x16x32_bf16 v[84:87], v[44:47], v[140:143], v[84:87]
buffer_load_dwordx4 v12, s[24:27], s34 offen offset:3072 sc1 lds
s_mov_b32 s34, 0x24000
v_add_f32 v7, v7, v108
AR 10,190
MA 24,72,112
v_exp_f32 v110, v110
AR 2,191
MA 56,72,116
CV 126,108,109
v_add_f32 v7, v7, v109
CV 223,10,2
MA 60,76,116
v_exp_f32 v111, v111
MA 28,76,112
v_add_f32 v7, v7, v110
v_mfma_f32_16x16x32_bf16 v[96:99], v[16:19], v[160:163], 0
v_exp_f32 v80, v80
AR 8,192
v_mfma_f32_16x16x32_bf16 v[104:107], v[16:19], v[176:179], 0
RD 16,11,0
CV 127,110,111
v_add_f32 v7, v7, v111
v_mfma_f32_16x16x32_bf16 v[108:111], v[20:23], v[176:179], 0
v_exp_f32 v81, v81
AR 9,193
v_mfma_f32_16x16x32_bf16 v[100:103], v[20:23], v[160:163], 0
RD 20,11,1024
v_add_f32 v4, v4, v80
MA 64,48,120
v_exp_f32 v82, v82
MA 96,48,124
RD 48,14,57344
CV 112,80,81
v_add_f32 v4, v4, v81
CV 224,8,9
MA 100,52,124
v_exp_f32 v83, v83
MA 68,52,120
RD 52,14,58368
v_add_f32 v4, v4, v82
AR 10,194
v_mfma_f32_16x16x32_bf16 v[96:99], v[24:27], v[164:167], v[96:99]
v_exp_f32 v84, v84
v_mfma_f32_16x16x32_bf16 v[104:107], v[24:27], v[180:183], v[104:107]
RD 24,11,2048
CV 113,82,83
v_add_f32 v4, v4, v83
v_mfma_f32_16x16x32_bf16 v[108:111], v[28:31], v[180:183], v[108:111]
v_exp_f32 v85, v85
AR 2,195
v_mfma_f32_16x16x32_bf16 v[100:103], v[28:31], v[164:167], v[100:103]
RD 28,11,3072
v_add_f32 v4, v4, v84
MA 72,56,120
v_exp_f32 v86, v86
CV 225,10,2
MA 104,56,124
RD 56,14,59392
CV 114,84,85
v_add_f32 v4, v4, v85
MA 108,60,124
v_exp_f32 v87, v87
MA 76,60,120
RD 60,14,60416
v_add_f32 v4, v4, v86
AR 8,196
v_mfma_f32_16x16x32_bf16 v[96:99], v[32:35], v[168:171], v[96:99]
v_exp_f32 v88, v88
v_mfma_f32_16x16x32_bf16 v[104:107], v[32:35], v[184:187], v[104:107]
RD 32,11,4096
CV 115,86,87
v_add_f32 v4, v4, v87
v_mfma_f32_16x16x32_bf16 v[108:111], v[36:39], v[184:187], v[108:111]
v_exp_f32 v89, v89
AR 9,197
v_mfma_f32_16x16x32_bf16 v[100:103], v[36:39], v[168:171], v[100:103]
RD 36,11,5120
v_add_f32 v5, v5, v88
MA 80,64,120
v_exp_f32 v90, v90
CV 226,8,9
MA 112,64,124
RD 64,14,61440
CV 116,88,89
v_add_f32 v5, v5, v89
MA 116,68,124
v_exp_f32 v91, v91
MA 84,68,120
RD 68,14,62464
v_add_f32 v5, v5, v90
AR 10,198
v_mfma_f32_16x16x32_bf16 v[96:99], v[40:43], v[172:175], v[96:99]
v_exp_f32 v92, v92
v_mfma_f32_16x16x32_bf16 v[104:107], v[40:43], v[188:191], v[104:107]
RD 40,11,6144
CV 117,90,91
v_add_f32 v5, v5, v91
AR 2,199
v_mfma_f32_16x16x32_bf16 v[108:111], v[44:47], v[188:191], v[108:111]
v_exp_f32 v93, v93
v_mfma_f32_16x16x32_bf16 v[100:103], v[44:47], v[172:175], v[100:103]
RD 44,11,7168
v_add_f32 v5, v5, v92
MA 88,72,120
v_exp_f32 v94, v94
CV 227,10,2
MA 120,72,124
RD 72,14,63488
CV 118,92,93
v_add_f32 v5, v5, v93
MA 124,76,124
v_exp_f32 v95, v95
MA 92,76,120
RD 76,14,64512
v_add_f32 v5, v5, v94
s_waitcnt lgkmcnt(4)
v_mfma_f32_16x16x32_bf16 v[80:83], v[16:19], v[128:131], 0
v_exp_f32 v96, v96
AR 8,200
v_mfma_f32_16x16x32_bf16 v[88:91], v[16:19], v[144:147], 0
CV 119,94,95
v_add_f32 v5, v5, v95
AR 9,201
v_mfma_f32_16x16x32_bf16 v[92:95], v[20:23], v[144:147], 0
v_exp_f32 v97, v97
CV 228,8,9
v_mfma_f32_16x16x32_bf16 v[84:87], v[20:23], v[128:131], 0
s_add_u32 m0, s36, 81920
s_nop 0
buffer_load_dwordx4 v12, s[24:27], s34 offen sc1 lds
v_add_f32 v6, v6, v96
AR 10,202
MA 0,48,112
v_exp_f32 v98, v98
MA 32,48,116
CV 120,96,97
v_add_f32 v6, v6, v97
MA 36,52,116
v_exp_f32 v99, v99
MA 4,52,112
v_add_f32 v6, v6, v98
AR 2,203
CV 229,10,2
AR 8,204
v_mfma_f32_16x16x32_bf16 v[80:83], v[24:27], v[132:135], v[80:83]
v_exp_f32 v100, v100
v_mfma_f32_16x16x32_bf16 v[88:91], v[24:27], v[148:151], v[88:91]
CV 121,98,99
v_add_f32 v6, v6, v99
AR 9,205
v_mfma_f32_16x16x32_bf16 v[92:95], v[28:31], v[148:151], v[92:95]
v_exp_f32 v101, v101
CV 230,8,9
v_mfma_f32_16x16x32_bf16 v[84:87], v[28:31], v[132:135], v[84:87]
buffer_load_dwordx4 v12, s[24:27], s34 offen offset:1024 sc1 lds
v_add_f32 v6, v6, v100
AR 10,206
MA 8,56,112
v_exp_f32 v102, v102
AR 2,207
MA 40,56,116
CV 122,100,101
v_add_f32 v6, v6, v101
MA 44,60,116
v_exp_f32 v103, v103
CV 231,10,2
MA 12,60,112
s_waitcnt lgkmcnt(0)
v_add_f32 v6, v6, v102
AR 8,208
v_mfma_f32_16x16x32_bf16 v[80:83], v[32:35], v[136:139], v[80:83]
v_exp_f32 v104, v104
AR 9,209
v_mfma_f32_16x16x32_bf16 v[88:91], v[32:35], v[152:155], v[88:91]
CV 123,102,103
v_add_f32 v6, v6, v103
v_mfma_f32_16x16x32_bf16 v[92:95], v[36:39], v[152:155], v[92:95]
v_exp_f32 v105, v105
CV 232,8,9
v_mfma_f32_16x16x32_bf16 v[84:87], v[36:39], v[136:139], v[84:87]
buffer_load_dwordx4 v12, s[24:27], s34 offen offset:2048 sc1 lds
v_add_f32 v7, v7, v104
AR 10,210
MA 16,64,112
v_exp_f32 v106, v106
MA 48,64,116
CV 124,104,105
v_add_f32 v7, v7, v105
MA 52,68,116
v_exp_f32 v107, v107
MA 20,68,112
v_add_f32 v7, v7, v106
AR 2,211
CV 233,10,2
AR 8,212
v_mfma_f32_16x16x32_bf16 v[80:83], v[40:43], v[140:143], v[80:83]
v_exp_f32 v108, v108
AR 9,213
v_mfma_f32_16x16x32_bf16 v[88:91], v[40:43], v[156:159], v[88:91]
CV 125,106,107
v_add_f32 v7, v7, v107
CV 234,8,9
v_mfma_f32_16x16x32_bf16 v[92:95], v[44:47], v[156:159], v[92:95]
v_exp_f32 v109, v109
v_mfma_f32_16x16x32_bf16 v[84:87], v[44:47], v[140:143], v[84:87]
buffer_load_dwordx4 v12, s[24:27], s34 offen offset:3072 sc1 lds
s_mov_b32 s34, 0x28000
v_add_f32 v7, v7, v108
AR 10,214
MA 24,72,112
v_exp_f32 v110, v110
AR 2,215
MA 56,72,116
CV 126,108,109
v_add_f32 v7, v7, v109
CV 235,10,2
MA 60,76,116
v_exp_f32 v111, v111
MA 28,76,112
buffer_load_dword v3, v15, s[96:99], s39 offen
s_add_u32 s39, s39, 1792
v_add_f32 v7, v7, v110
v_mfma_f32_16x16x32_bf16 v[96:99], v[16:19], v[160:163], 0
v_exp_f32 v80, v80
AR 8,216
v_mfma_f32_16x16x32_bf16 v[104:107], v[16:19], v[176:179], 0
RD 16,11,16384
CV 127,110,111
v_add_f32 v7, v7, v111
v_mfma_f32_16x16x32_bf16 v[108:111], v[20:23], v[176:179], 0
v_exp_f32 v81, v81
AR 9,217
v_mfma_f32_16x16x32_bf16 v[100:103], v[20:23], v[160:163], 0
RD 20,11,17408
v_add_f32 v4, v4, v80
MA 64,48,120
v_exp_f32 v82, v82
MA 96,48,124
RD 48,11,8192
CV 112,80,81
v_add_f32 v4, v4, v81
CV 236,8,9
MA 100,52,124
v_exp_f32 v83, v83
MA 68,52,120
RD 52,11,9216
v_add_f32 v4, v4, v82
AR 10,218
v_mfma_f32_16x16x32_bf16 v[96:99], v[24:27], v[164:167], v[96:99]
v_exp_f32 v84, v84
v_mfma_f32_16x16x32_bf16 v[104:107], v[24:27], v[180:183], v[104:107]
RD 24,11,18432
CV 113,82,83
v_add_f32 v4, v4, v83
v_mfma_f32_16x16x32_bf16 v[108:111], v[28:31], v[180:183], v[108:111]
v_exp_f32 v85, v85
AR 2,219
v_mfma_f32_16x16x32_bf16 v[100:103], v[28:31], v[164:167], v[100:103]
RD 28,11,19456
v_add_f32 v4, v4, v84
MA 72,56,120
v_exp_f32 v86, v86
CV 237,10,2
MA 104,56,124
RD 56,11,10240
CV 114,84,85
v_add_f32 v4, v4, v85
MA 108,60,124
v_exp_f32 v87, v87
MA 76,60,120
RD 60,11,11264
v_add_f32 v4, v4, v86
AR 8,220
v_mfma_f32_16x16x32_bf16 v[96:99], v[32:35], v[168:171], v[96:99]
v_exp_f32 v88, v88
v_mfma_f32_16x16x32_bf16 v[104:107], v[32:35], v[184:187], v[104:107]
RD 32,11,20480
CV 115,86,87
v_add_f32 v4, v4, v87
v_mfma_f32_16x16x32_bf16 v[108:111], v[36:39], v[184:187], v[108:111]
v_exp_f32 v89, v89
AR 9,221
v_mfma_f32_16x16x32_bf16 v[100:103], v[36:39], v[168:171], v[100:103]
RD 36,11,21504
v_add_f32 v5, v5, v88
MA 80,64,120
v_exp_f32 v90, v90
CV 238,8,9
MA 112,64,124
RD 64,11,12288
CV 116,88,89
v_add_f32 v5, v5, v89
MA 116,68,124
v_exp_f32 v91, v91
MA 84,68,120
RD 68,11,13312
v_add_f32 v5, v5, v90
AR 10,222
v_mfma_f32_16x16x32_bf16 v[96:99], v[40:43], v[172:175], v[96:99]
v_exp_f32 v92, v92
v_mfma_f32_16x16x32_bf16 v[104:107], v[40:43], v[188:191], v[104:107]
RD 40,11,22528
CV 117,90,91
v_add_f32 v5, v5, v91
AR 2,223
v_mfma_f32_16x16x32_bf16 v[108:111], v[44:47], v[188:191], v[108:111]
v_exp_f32 v93, v93
v_mfma_f32_16x16x32_bf16 v[100:103], v[44:47], v[172:175], v[100:103]
RD 44,11,23552
v_add_f32 v5, v5, v92
MA 88,72,120
v_exp_f32 v94, v94
CV 239,10,2
MA 120,72,124
RD 72,11,14336
CV 118,92,93
v_add_f32 v5, v5, v93
MA 124,76,124
v_exp_f32 v95, v95
MA 92,76,120
RD 76,11,15360
v_add_f32 v5, v5, v94
s_waitcnt vmcnt(10) lgkmcnt(4)
s_barrier
v_mfma_f32_16x16x32_bf16 v[80:83], v[16:19], v[128:131], 0
v_exp_f32 v96, v96
AR 8,224
v_mfma_f32_16x16x32_bf16 v[88:91], v[16:19], v[144:147], 0
CV 119,94,95
v_add_f32 v5, v5, v95
AR 9,225
v_mfma_f32_16x16x32_bf16 v[92:95], v[20:23], v[144:147], 0
v_exp_f32 v97, v97
CV 240,8,9
v_mfma_f32_16x16x32_bf16 v[84:87], v[20:23], v[128:131], 0
s_add_u32 m0, s36, 98304
s_nop 0
buffer_load_dwordx4 v12, s[24:27], s34 offen sc1 lds
v_add_f32 v6, v6, v96
AR 10,226
MA 0,48,112
v_exp_f32 v98, v98
MA 32,48,116
CV 120,96,97
v_add_f32 v6, v6, v97
MA 36,52,116
v_exp_f32 v99, v99
MA 4,52,112
v_add_f32 v6, v6, v98
AR 2,227
CV 241,10,2
AR 8,228
v_mfma_f32_16x16x32_bf16 v[80:83], v[24:27], v[132:135], v[80:83]
v_exp_f32 v100, v100
v_mfma_f32_16x16x32_bf16 v[88:91], v[24:27], v[148:151], v[88:91]
CV 121,98,99
v_add_f32 v6, v6, v99
AR 9,229
v_mfma_f32_16x16x32_bf16 v[92:95], v[28:31], v[148:151], v[92:95]
v_exp_f32 v101, v101
CV 242,8,9
v_mfma_f32_16x16x32_bf16 v[84:87], v[28:31], v[132:135], v[84:87]
buffer_load_dwordx4 v12, s[24:27], s34 offen offset:1024 sc1 lds
v_add_f32 v6, v6, v100
AR 10,230
MA 8,56,112
v_exp_f32 v102, v102
AR 2,231
MA 40,56,116
CV 122,100,101
v_add_f32 v6, v6, v101
MA 44,60,116
v_exp_f32 v103, v103
CV 243,10,2
MA 12,60,112
s_waitcnt lgkmcnt(0)
v_add_f32 v6, v6, v102
AR 8,232
v_mfma_f32_16x16x32_bf16 v[80:83], v[32:35], v[136:139], v[80:83]
v_exp_f32 v104, v104
AR 9,233
v_mfma_f32_16x16x32_bf16 v[88:91], v[32:35], v[152:155], v[88:91]
CV 123,102,103
v_add_f32 v6, v6, v103
v_mfma_f32_16x16x32_bf16 v[92:95], v[36:39], v[152:155], v[92:95]
v_exp_f32 v105, v105
CV 244,8,9
v_mfma_f32_16x16x32_bf16 v[84:87], v[36:39], v[136:139], v[84:87]
buffer_load_dwordx4 v12, s[24:27], s34 offen offset:2048 sc1 lds
v_add_f32 v7, v7, v104
AR 10,234
MA 16,64,112
v_exp_f32 v106, v106
MA 48,64,116
CV 124,104,105
v_add_f32 v7, v7, v105
MA 52,68,116
v_exp_f32 v107, v107
MA 20,68,112
v_add_f32 v7, v7, v106
AR 2,235
CV 245,10,2
AR 8,236
v_mfma_f32_16x16x32_bf16 v[80:83], v[40:43], v[140:143], v[80:83]
v_exp_f32 v108, v108
AR 9,237
v_mfma_f32_16x16x32_bf16 v[88:91], v[40:43], v[156:159], v[88:91]
CV 125,106,107
v_add_f32 v7, v7, v107
CV 246,8,9
v_mfma_f32_16x16x32_bf16 v[92:95], v[44:47], v[156:159], v[92:95]
v_exp_f32 v109, v109
v_mfma_f32_16x16x32_bf16 v[84:87], v[44:47], v[140:143], v[84:87]
buffer_load_dwordx4 v12, s[24:27], s34 offen offset:3072 sc1 lds
s_mov_b32 s34, 0x2c000
v_add_f32 v7, v7, v108
AR 10,238
MA 24,72,112
v_exp_f32 v110, v110
AR 2,239
MA 56,72,116
CV 126,108,109
v_add_f32 v7, v7, v109
CV 247,10,2
MA 60,76,116
v_exp_f32 v111, v111
MA 28,76,112
v_add_f32 v7, v7, v110
v_mfma_f32_16x16x32_bf16 v[96:99], v[16:19], v[160:163], 0
v_exp_f32 v80, v80
AR 8,240
v_mfma_f32_16x16x32_bf16 v[104:107], v[16:19], v[176:179], 0
RD 16,11,32768
CV 127,110,111
v_add_f32 v7, v7, v111
v_mfma_f32_16x16x32_bf16 v[108:111], v[20:23], v[176:179], 0
v_exp_f32 v81, v81
AR 9,241
v_mfma_f32_16x16x32_bf16 v[100:103], v[20:23], v[160:163], 0
RD 20,11,33792
v_add_f32 v4, v4, v80
MA 64,48,120
v_exp_f32 v82, v82
MA 96,48,124
RD 48,11,24576
CV 112,80,81
v_add_f32 v4, v4, v81
CV 248,8,9
MA 100,52,124
v_exp_f32 v83, v83
MA 68,52,120
RD 52,11,25600
v_add_f32 v4, v4, v82
AR 10,242
v_mfma_f32_16x16x32_bf16 v[96:99], v[24:27], v[164:167], v[96:99]
v_exp_f32 v84, v84
v_mfma_f32_16x16x32_bf16 v[104:107], v[24:27], v[180:183], v[104:107]
RD 24,11,34816
CV 113,82,83
v_add_f32 v4, v4, v83
v_mfma_f32_16x16x32_bf16 v[108:111], v[28:31], v[180:183], v[108:111]
v_exp_f32 v85, v85
AR 2,243
v_mfma_f32_16x16x32_bf16 v[100:103], v[28:31], v[164:167], v[100:103]
RD 28,11,35840
v_add_f32 v4, v4, v84
MA 72,56,120
v_exp_f32 v86, v86
CV 249,10,2
MA 104,56,124
RD 56,11,26624
CV 114,84,85
v_add_f32 v4, v4, v85
MA 108,60,124
v_exp_f32 v87, v87
MA 76,60,120
RD 60,11,27648
v_add_f32 v4, v4, v86
AR 8,244
v_mfma_f32_16x16x32_bf16 v[96:99], v[32:35], v[168:171], v[96:99]
v_exp_f32 v88, v88
v_mfma_f32_16x16x32_bf16 v[104:107], v[32:35], v[184:187], v[104:107]
RD 32,11,36864
CV 115,86,87
v_add_f32 v4, v4, v87
v_mfma_f32_16x16x32_bf16 v[108:111], v[36:39], v[184:187], v[108:111]
v_exp_f32 v89, v89
AR 9,245
v_mfma_f32_16x16x32_bf16 v[100:103], v[36:39], v[168:171], v[100:103]
RD 36,11,37888
v_add_f32 v5, v5, v88
MA 80,64,120
v_exp_f32 v90, v90
CV 250,8,9
MA 112,64,124
RD 64,11,28672
CV 116,88,89
v_add_f32 v5, v5, v89
MA 116,68,124
v_exp_f32 v91, v91
MA 84,68,120
RD 68,11,29696
v_add_f32 v5, v5, v90
AR 10,246
v_mfma_f32_16x16x32_bf16 v[96:99], v[40:43], v[172:175], v[96:99]
v_exp_f32 v92, v92
v_mfma_f32_16x16x32_bf16 v[104:107], v[40:43], v[188:191], v[104:107]
RD 40,11,38912
CV 117,90,91
v_add_f32 v5, v5, v91
AR 2,247
v_mfma_f32_16x16x32_bf16 v[108:111], v[44:47], v[188:191], v[108:111]
v_exp_f32 v93, v93
v_mfma_f32_16x16x32_bf16 v[100:103], v[44:47], v[172:175], v[100:103]
RD 44,11,39936
v_add_f32 v5, v5, v92
MA 88,72,120
v_exp_f32 v94, v94
CV 251,10,2
MA 120,72,124
RD 72,11,30720
CV 118,92,93
v_add_f32 v5, v5, v93
MA 124,76,124
v_exp_f32 v95, v95
MA 92,76,120
RD 76,11,31744
v_add_f32 v5, v5, v94
s_waitcnt lgkmcnt(4)
v_mfma_f32_16x16x32_bf16 v[80:83], v[16:19], v[128:131], 0
v_exp_f32 v96, v96
AR 8,248
v_mfma_f32_16x16x32_bf16 v[88:91], v[16:19], v[144:147], 0
CV 119,94,95
v_add_f32 v5, v5, v95
AR 9,249
v_mfma_f32_16x16x32_bf16 v[92:95], v[20:23], v[144:147], 0
v_exp_f32 v97, v97
v_mfma_f32_16x16x32_bf16 v[84:87], v[20:23], v[128:131], 0
s_add_u32 m0, s36, 114688
s_nop 0
buffer_load_dwordx4 v12, s[24:27], s34 offen sc1 lds
v_add_f32 v6, v6, v96
CV 252,8,9
MA 0,48,112
v_exp_f32 v98, v98
MA 32,48,116
CV 120,96,97
v_add_f32 v6, v6, v97
MA 36,52,116
v_exp_f32 v99, v99
MA 4,52,112
v_add_f32 v6, v6, v98
AR 10,250
AR 2,251
v_mfma_f32_16x16x32_bf16 v[80:83], v[24:27], v[132:135], v[80:83]
v_exp_f32 v100, v100
v_mfma_f32_16x16x32_bf16 v[88:91], v[24:27], v[148:151], v[88:91]
CV 121,98,99
v_add_f32 v6, v6, v99
CV 253,10,2
v_mfma_f32_16x16x32_bf16 v[92:95], v[28:31], v[148:151], v[92:95]
v_exp_f32 v101, v101
v_mfma_f32_16x16x32_bf16 v[84:87], v[28:31], v[132:135], v[84:87]
buffer_load_dwordx4 v12, s[24:27], s34 offen offset:1024 sc1 lds
v_add_f32 v6, v6, v100
AR 8,252
MA 8,56,112
v_exp_f32 v102, v102
MA 40,56,116
CV 122,100,101
v_add_f32 v6, v6, v101
AR 9,253
MA 44,60,116
v_exp_f32 v103, v103
MA 12,60,112
s_waitcnt lgkmcnt(0)
v_add_f32 v6, v6, v102
CV 254,8,9
v_mfma_f32_16x16x32_bf16 v[80:83], v[32:35], v[136:139], v[80:83]
v_exp_f32 v104, v104
v_mfma_f32_16x16x32_bf16 v[88:91], v[32:35], v[152:155], v[88:91]
CV 123,102,103
v_add_f32 v6, v6, v103
AR 10,254
v_mfma_f32_16x16x32_bf16 v[92:95], v[36:39], v[152:155], v[92:95]
v_exp_f32 v105, v105
v_mfma_f32_16x16x32_bf16 v[84:87], v[36:39], v[136:139], v[84:87]
buffer_load_dwordx4 v12, s[24:27], s34 offen offset:2048 sc1 lds
v_add_f32 v7, v7, v104
AR 2,255
MA 16,64,112
v_exp_f32 v106, v106
MA 48,64,116
CV 124,104,105
v_add_f32 v7, v7, v105
MA 52,68,116
v_exp_f32 v107, v107
MA 20,68,112
v_add_f32 v7, v7, v106
CV 255,10,2
v_mov_b32 v8, 0
v_mfma_f32_16x16x32_bf16 v[80:83], v[40:43], v[140:143], v[80:83]
v_exp_f32 v108, v108
v_mfma_f32_16x16x32_bf16 v[88:91], v[40:43], v[156:159], v[88:91]
CV 125,106,107
v_add_f32 v7, v7, v107
v_mov_b32 v9, 0
v_mfma_f32_16x16x32_bf16 v[92:95], v[44:47], v[156:159], v[92:95]
v_exp_f32 v109, v109
v_mfma_f32_16x16x32_bf16 v[84:87], v[44:47], v[140:143], v[84:87]
buffer_load_dwordx4 v12, s[24:27], s34 offen offset:3072 sc1 lds
s_mov_b32 s34, 0x30000
v_add_f32 v7, v7, v108
v_mov_b32 v10, 0
MA 24,72,112
v_exp_f32 v110, v110
MA 56,72,116
CV 126,108,109
v_add_f32 v7, v7, v109
v_mov_b32 v13, 0
MA 60,76,116
v_exp_f32 v111, v111
MA 28,76,112
buffer_load_dword v3, v15, s[96:99], s39 offen
s_add_u32 s39, s39, 1792
v_add_f32 v7, v7, v110
v_mfma_f32_16x16x32_bf16 v[96:99], v[16:19], v[160:163], 0
v_exp_f32 v80, v80
v_mfma_f32_16x16x32_bf16 v[104:107], v[16:19], v[176:179], 0
RD 16,11,49152
CV 127,110,111
v_add_f32 v7, v7, v111
v_mfma_f32_16x16x32_bf16 v[108:111], v[20:23], v[176:179], 0
v_exp_f32 v81, v81
v_mfma_f32_16x16x32_bf16 v[100:103], v[20:23], v[160:163], 0
RD 20,11,50176
v_add_f32 v4, v4, v80
MA 64,48,120
v_exp_f32 v82, v82
MA 96,48,124
RD 48,11,40960
CV 112,80,81
v_add_f32 v4, v4, v81
MA 100,52,124
v_exp_f32 v83, v83
MA 68,52,120
RD 52,11,41984
v_add_f32 v4, v4, v82
v_mfma_f32_16x16x32_bf16 v[96:99], v[24:27], v[164:167], v[96:99]
v_exp_f32 v84, v84
v_mfma_f32_16x16x32_bf16 v[104:107], v[24:27], v[180:183], v[104:107]
RD 24,11,51200
CV 113,82,83
v_add_f32 v4, v4, v83
v_mfma_f32_16x16x32_bf16 v[108:111], v[28:31], v[180:183], v[108:111]
v_exp_f32 v85, v85
v_mfma_f32_16x16x32_bf16 v[100:103], v[28:31], v[164:167], v[100:103]
RD 28,11,52224
v_add_f32 v4, v4, v84
MA 72,56,120
v_exp_f32 v86, v86
MA 104,56,124
RD 56,11,43008
CV 114,84,85
v_add_f32 v4, v4, v85
MA 108,60,124
v_exp_f32 v87, v87
MA 76,60,120
RD 60,11,44032
v_add_f32 v4, v4, v86
v_mfma_f32_16x16x32_bf16 v[96:99], v[32:35], v[168:171], v[96:99]
v_exp_f32 v88, v88
v_mfma_f32_16x16x32_bf16 v[104:107], v[32:35], v[184:187], v[104:107]
RD 32,11,53248
CV 115,86,87
v_add_f32 v4, v4, v87
v_mfma_f32_16x16x32_bf16 v[108:111], v[36:39], v[184:187], v[108:111]
v_exp_f32 v89, v89
v_mfma_f32_16x16x32_bf16 v[100:103], v[36:39], v[168:171], v[100:103]
RD 36,11,54272
v_add_f32 v5, v5, v88
MA 80,64,120
v_exp_f32 v90, v90
MA 112,64,124
RD 64,11,45056
CV 116,88,89
v_add_f32 v5, v5, v89
MA 116,68,124
v_exp_f32 v91, v91
MA 84,68,120
RD 68,11,46080
v_add_f32 v5, v5, v90
v_mfma_f32_16x16x32_bf16 v[96:99], v[40:43], v[172:175], v[96:99]
v_exp_f32 v92, v92
v_mfma_f32_16x16x32_bf16 v[104:107], v[40:43], v[188:191], v[104:107]
RD 40,11,55296
CV 117,90,91
v_add_f32 v5, v5, v91
v_mfma_f32_16x16x32_bf16 v[108:111], v[44:47], v[188:191], v[108:111]
v_exp_f32 v93, v93
v_mfma_f32_16x16x32_bf16 v[100:103], v[44:47], v[172:175], v[100:103]
RD 44,11,56320
v_add_f32 v5, v5, v92
MA 88,72,120
v_exp_f32 v94, v94
MA 120,72,124
RD 72,11,47104
CV 118,92,93
v_add_f32 v5, v5, v93
MA 124,76,124
v_exp_f32 v95, v95
MA 92,76,120
RD 76,11,48128
v_add_f32 v5, v5, v94
s_waitcnt vmcnt(14) lgkmcnt(4)
s_barrier
v_mfma_f32_16x16x32_bf16 v[80:83], v[16:19], v[128:131], 0
v_exp_f32 v96, v96
v_mfma_f32_16x16x32_bf16 v[88:91], v[16:19], v[144:147], 0
CV 119,94,95
v_add_f32 v5, v5, v95
v_mfma_f32_16x16x32_bf16 v[92:95], v[20:23], v[144:147], 0
v_exp_f32 v97, v97
v_mfma_f32_16x16x32_bf16 v[84:87], v[20:23], v[128:131], 0
s_add_u32 m0, s36, 0
s_nop 0
buffer_load_dwordx4 v12, s[24:27], s34 offen sc1 lds
v_add_f32 v6, v6, v96
MA 0,48,112
v_exp_f32 v98, v98
MA 32,48,116
CV 120,96,97
v_add_f32 v6, v6, v97
MA 36,52,116
v_exp_f32 v99, v99
MA 4,52,112
v_add_f32 v6, v6, v98
v_mfma_f32_16x16x32_bf16 v[80:83], v[24:27], v[132:135], v[80:83]
v_exp_f32 v100, v100
v_mfma_f32_16x16x32_bf16 v[88:91], v[24:27], v[148:151], v[88:91]
CV 121,98,99
v_add_f32 v6, v6, v99
v_mfma_f32_16x16x32_bf16 v[92:95], v[28:31], v[148:151], v[92:95]
v_exp_f32 v101, v101
v_mfma_f32_16x16x32_bf16 v[84:87], v[28:31], v[132:135], v[84:87]
buffer_load_dwordx4 v12, s[24:27], s34 offen offset:1024 sc1 lds
v_add_f32 v6, v6, v100
MA 8,56,112
v_exp_f32 v102, v102
MA 40,56,116
CV 122,100,101
v_add_f32 v6, v6, v101
MA 44,60,116
v_exp_f32 v103, v103
MA 12,60,112
s_waitcnt lgkmcnt(0)
v_add_f32 v6, v6, v102
v_mfma_f32_16x16x32_bf16 v[80:83], v[32:35], v[136:139], v[80:83]
v_exp_f32 v104, v104
v_mfma_f32_16x16x32_bf16 v[88:91], v[32:35], v[152:155], v[88:91]
CV 123,102,103
v_add_f32 v6, v6, v103
v_mfma_f32_16x16x32_bf16 v[92:95], v[36:39], v[152:155], v[92:95]
v_exp_f32 v105, v105
v_mfma_f32_16x16x32_bf16 v[84:87], v[36:39], v[136:139], v[84:87]
buffer_load_dwordx4 v12, s[24:27], s34 offen offset:2048 sc1 lds
v_add_f32 v7, v7, v104
MA 16,64,112
v_exp_f32 v106, v106
MA 48,64,116
CV 124,104,105
v_add_f32 v7, v7, v105
MA 52,68,116
v_exp_f32 v107, v107
MA 20,68,112
v_add_f32 v7, v7, v106
v_mfma_f32_16x16x32_bf16 v[80:83], v[40:43], v[140:143], v[80:83]
v_exp_f32 v108, v108
v_mfma_f32_16x16x32_bf16 v[88:91], v[40:43], v[156:159], v[88:91]
CV 125,106,107
v_add_f32 v7, v7, v107
v_mfma_f32_16x16x32_bf16 v[92:95], v[44:47], v[156:159], v[92:95]
v_exp_f32 v109, v109
v_mfma_f32_16x16x32_bf16 v[84:87], v[44:47], v[140:143], v[84:87]
buffer_load_dwordx4 v12, s[24:27], s34 offen offset:3072 sc1 lds
s_mov_b32 s34, 0x34000
v_add_f32 v7, v7, v108
MA 24,72,112
v_exp_f32 v110, v110
MA 56,72,116
CV 126,108,109
v_add_f32 v7, v7, v109
MA 60,76,116
v_exp_f32 v111, v111
MA 28,76,112
v_add_f32 v7, v7, v110
v_mfma_f32_16x16x32_bf16 v[96:99], v[16:19], v[160:163], 0
v_exp_f32 v80, v80
v_mfma_f32_16x16x32_bf16 v[104:107], v[16:19], v[176:179], 0
RD 16,14,0
CV 127,110,111
v_add_f32 v7, v7, v111
v_mfma_f32_16x16x32_bf16 v[108:111], v[20:23], v[176:179], 0
v_exp_f32 v81, v81
v_mfma_f32_16x16x32_bf16 v[100:103], v[20:23], v[160:163], 0
RD 20,14,1024
v_add_f32 v4, v4, v80
MA 64,48,120
v_exp_f32 v82, v82
MA 96,48,124
RD 48,11,57344
CV 112,80,81
v_add_f32 v4, v4, v81
MA 100,52,124
v_exp_f32 v83, v83
MA 68,52,120
RD 52,11,58368
v_add_f32 v4, v4, v82
v_mfma_f32_16x16x32_bf16 v[96:99], v[24:27], v[164:167], v[96:99]
v_exp_f32 v84, v84
v_mfma_f32_16x16x32_bf16 v[104:107], v[24:27], v[180:183], v[104:107]
RD 24,14,2048
CV 113,82,83
v_add_f32 v4, v4, v83
v_mfma_f32_16x16x32_bf16 v[108:111], v[28:31], v[180:183], v[108:111]
v_exp_f32 v85, v85
v_mfma_f32_16x16x32_bf16 v[100:103], v[28:31], v[164:167], v[100:103]
RD 28,14,3072
v_add_f32 v4, v4, v84
MA 72,56,120
v_exp_f32 v86, v86
MA 104,56,124
RD 56,11,59392
CV 114,84,85
v_add_f32 v4, v4, v85
MA 108,60,124
v_exp_f32 v87, v87
MA 76,60,120
RD 60,11,60416
v_add_f32 v4, v4, v86
v_mfma_f32_16x16x32_bf16 v[96:99], v[32:35], v[168:171], v[96:99]
v_exp_f32 v88, v88
v_mfma_f32_16x16x32_bf16 v[104:107], v[32:35], v[184:187], v[104:107]
RD 32,14,4096
CV 115,86,87
v_add_f32 v4, v4, v87
v_mfma_f32_16x16x32_bf16 v[108:111], v[36:39], v[184:187], v[108:111]
v_exp_f32 v89, v89
v_mfma_f32_16x16x32_bf16 v[100:103], v[36:39], v[168:171], v[100:103]
RD 36,14,5120
v_add_f32 v5, v5, v88
MA 80,64,120
v_exp_f32 v90, v90
MA 112,64,124
RD 64,11,61440
CV 116,88,89
v_add_f32 v5, v5, v89
MA 116,68,124
v_exp_f32 v91, v91
MA 84,68,120
RD 68,11,62464
v_add_f32 v5, v5, v90
v_mfma_f32_16x16x32_bf16 v[96:99], v[40:43], v[172:175], v[96:99]
v_exp_f32 v92, v92
v_mfma_f32_16x16x32_bf16 v[104:107], v[40:43], v[188:191], v[104:107]
RD 40,14,6144
CV 117,90,91
v_add_f32 v5, v5, v91
v_mfma_f32_16x16x32_bf16 v[108:111], v[44:47], v[188:191], v[108:111]
v_exp_f32 v93, v93
v_mfma_f32_16x16x32_bf16 v[100:103], v[44:47], v[172:175], v[100:103]
RD 44,14,7168
v_add_f32 v5, v5, v92
MA 88,72,120
v_exp_f32 v94, v94
MA 120,72,124
RD 72,11,63488
CV 118,92,93
v_add_f32 v5, v5, v93
MA 124,76,124
v_exp_f32 v95, v95
MA 92,76,120
RD 76,11,64512
v_add_f32 v5, v5, v94
s_waitcnt lgkmcnt(4)
v_mfma_f32_16x16x32_bf16 v[80:83], v[16:19], v[128:131], 0
v_exp_f32 v96, v96
v_mfma_f32_16x16x32_bf16 v[88:91], v[16:19], v[144:147], 0
CV 119,94,95
v_add_f32 v5, v5, v95
v_mfma_f32_16x16x32_bf16 v[92:95], v[20:23], v[144:147], 0
v_exp_f32 v97, v97
v_mfma_f32_16x16x32_bf16 v[84:87], v[20:23], v[128:131], 0
s_add_u32 m0, s36, 16384
s_nop 0
buffer_load_dwordx4 v12, s[24:27], s34 offen sc1 lds
v_add_f32 v6, v6, v96
MA 0,48,112
v_exp_f32 v98, v98
MA 32,48,116
CV 120,96,97
v_add_f32 v6, v6, v97
s_getpc_b64 s[62:63]
L_ct3:
MA 36,52,116
v_exp_f32 v99, v99
MA 4,52,112
v_add_f32 v6, v6, v98
v_mfma_f32_16x16x32_bf16 v[80:83], v[24:27], v[132:135], v[80:83]
v_exp_f32 v100, v100
v_mfma_f32_16x16x32_bf16 v[88:91], v[24:27], v[148:151], v[88:91]
CV 121,98,99
v_add_f32 v6, v6, v99
v_lshlrev_b32 v0, 7, v1
v_mfma_f32_16x16x32_bf16 v[92:95], v[28:31], v[148:151], v[92:95]
v_exp_f32 v101, v101
v_mfma_f32_16x16x32_bf16 v[84:87], v[28:31], v[132:135], v[84:87]
buffer_load_dwordx4 v12, s[24:27], s34 offen offset:1024 sc1 lds
v_add_f32 v6, v6, v100
MA 8,56,112
v_exp_f32 v102, v102
MA 40,56,116
CV 122,100,101
v_add_f32 v6, v6, v101
v_add_u32 v0, 2048, v0
MA 44,60,116
v_exp_f32 v103, v103
MA 12,60,112
s_waitcnt lgkmcnt(0)
v_add_f32 v6, v6, v102
v_mfma_f32_16x16x32_bf16 v[80:83], v[32:35], v[136:139], v[80:83]
v_exp_f32 v104, v104
v_mfma_f32_16x16x32_bf16 v[88:91], v[32:35], v[152:155], v[88:91]
CV 123,102,103
v_add_f32 v6, v6, v103
v_min_u32 v0, L_code_end-L_ct3-4, v0
v_mfma_f32_16x16x32_bf16 v[92:95], v[36:39], v[152:155], v[92:95]
v_exp_f32 v105, v105
v_mfma_f32_16x16x32_bf16 v[84:87], v[36:39], v[136:139], v[84:87]
buffer_load_dwordx4 v12, s[24:27], s34 offen offset:2048 sc1 lds
v_add_f32 v7, v7, v104
MA 16,64,112
v_exp_f32 v106, v106
MA 48,64,116
global_load_dword v3, v0, s[62:63]
CV 124,104,105
v_add_f32 v7, v7, v105
MA 52,68,116
v_exp_f32 v107, v107
MA 20,68,112
v_add_f32 v7, v7, v106
v_mfma_f32_16x16x32_bf16 v[80:83], v[40:43], v[140:143], v[80:83]
v_exp_f32 v108, v108
v_mfma_f32_16x16x32_bf16 v[88:91], v[40:43], v[156:159], v[88:91]
CV 125,106,107
v_add_f32 v7, v7, v107
v_mfma_f32_16x16x32_bf16 v[92:95], v[44:47], v[156:159], v[92:95]
v_exp_f32 v109, v109
v_mfma_f32_16x16x32_bf16 v[84:87], v[44:47], v[140:143], v[84:87]
buffer_load_dwordx4 v12, s[24:27], s34 offen offset:3072 sc1 lds
s_mov_b32 s34, 0x38000
v_add_f32 v7, v7, v108
MA 24,72,112
v_exp_f32 v110, v110
MA 56,72,116
CV 126,108,109
v_add_f32 v7, v7, v109
MA 60,76,116
v_exp_f32 v111, v111
MA 28,76,112
buffer_load_dword v3, v15, s[96:99], s39 offen
s_add_u32 s39, s39, 1792
v_add_f32 v7, v7, v110
v_mfma_f32_16x16x32_bf16 v[96:99], v[16:19], v[160:163], 0
v_exp_f32 v80, v80
v_mfma_f32_16x16x32_bf16 v[104:107], v[16:19], v[176:179], 0
CV 127,110,111
v_add_f32 v7, v7, v111
v_mfma_f32_16x16x32_bf16 v[108:111], v[20:23], v[176:179], 0
v_exp_f32 v81, v81
v_mfma_f32_16x16x32_bf16 v[100:103], v[20:23], v[160:163], 0
v_add_f32 v4, v4, v80
MA 64,48,120
v_exp_f32 v82, v82
MA 96,48,124
CV 112,80,81
v_add_f32 v4, v4, v81
MA 100,52,124
v_exp_f32 v83, v83
MA 68,52,120
RD 48,14,8192
v_add_f32 v4, v4, v82
v_mfma_f32_16x16x32_bf16 v[96:99], v[24:27], v[164:167], v[96:99]
v_exp_f32 v84, v84
v_mfma_f32_16x16x32_bf16 v[104:107], v[24:27], v[180:183], v[104:107]
CV 113,82,83
v_add_f32 v4, v4, v83
v_mfma_f32_16x16x32_bf16 v[108:111], v[28:31], v[180:183], v[108:111]
v_exp_f32 v85, v85
v_mfma_f32_16x16x32_bf16 v[100:103], v[28:31], v[164:167], v[100:103]
RD 52,14,9216
v_add_f32 v4, v4, v84
MA 72,56,120
v_exp_f32 v86, v86
MA 104,56,124
CV 114,84,85
v_add_f32 v4, v4, v85
MA 108,60,124
v_exp_f32 v87, v87
MA 76,60,120
RD 56,14,10240
v_add_f32 v4, v4, v86
v_mfma_f32_16x16x32_bf16 v[96:99], v[32:35], v[168:171], v[96:99]
v_exp_f32 v88, v88
v_mfma_f32_16x16x32_bf16 v[104:107], v[32:35], v[184:187], v[104:107]
CV 115,86,87
v_add_f32 v4, v4, v87
v_mfma_f32_16x16x32_bf16 v[108:111], v[36:39], v[184:187], v[108:111]
v_exp_f32 v89, v89
v_mfma_f32_16x16x32_bf16 v[100:103], v[36:39], v[168:171], v[100:103]
RD 60,14,11264
v_add_f32 v5, v5, v88
MA 80,64,120
v_exp_f32 v90, v90
MA 112,64,124
CV 116,88,89
v_add_f32 v5, v5, v89
MA 116,68,124
v_exp_f32 v91, v91
MA 84,68,120
RD 64,14,12288
v_add_f32 v5, v5, v90
v_mfma_f32_16x16x32_bf16 v[96:99], v[40:43], v[172:175], v[96:99]
v_exp_f32 v92, v92
v_mfma_f32_16x16x32_bf16 v[104:107], v[40:43], v[188:191], v[104:107]
CV 117,90,91
v_add_f32 v5, v5, v91
v_mfma_f32_16x16x32_bf16 v[108:111], v[44:47], v[188:191], v[108:111]
v_exp_f32 v93, v93
v_mfma_f32_16x16x32_bf16 v[100:103], v[44:47], v[172:175], v[100:103]
RD 68,14,13312
v_add_f32 v5, v5, v92
MA 88,72,120
v_exp_f32 v94, v94
MA 120,72,124
CV 118,92,93
v_add_f32 v5, v5, v93
MA 124,76,124
v_exp_f32 v95, v95
MA 92,76,120
RD 72,14,14336
RD 76,14,15360
v_add_f32 v5, v5, v94
s_waitcnt vmcnt(15) lgkmcnt(2)
s_barrier
v_mfma_f32_16x16x32_bf16 v[80:83], v[16:19], v[192:195], 0
v_exp_f32 v96, v96
v_mfma_f32_16x16x32_bf16 v[88:91], v[16:19], v[208:211], 0
CV 119,94,95
v_add_f32 v5, v5, v95
v_mfma_f32_16x16x32_bf16 v[92:95], v[20:23], v[208:211], 0
v_exp_f32 v97, v97
v_mfma_f32_16x16x32_bf16 v[84:87], v[20:23], v[192:195], 0
s_add_u32 m0, s36, 32768
s_nop 0
buffer_load_dwordx4 v12, s[24:27], s34 offen sc1 lds
v_add_f32 v6, v6, v96
MA 0,48,112
v_exp_f32 v98, v98
MA 32,48,116
CV 120,96,97
v_add_f32 v6, v6, v97
MA 36,52,116
v_exp_f32 v99, v99
MA 4,52,112
v_add_f32 v6, v6, v98
v_mfma_f32_16x16x32_bf16 v[80:83], v[24:27], v[196:199], v[80:83]
v_exp_f32 v100, v100
v_mfma_f32_16x16x32_bf16 v[88:91], v[24:27], v[212:215], v[88:91]
CV 121,98,99
v_add_f32 v6, v6, v99
v_mfma_f32_16x16x32_bf16 v[92:95], v[28:31], v[212:215], v[92:95]
v_exp_f32 v101, v101
v_mfma_f32_16x16x32_bf16 v[84:87], v[28:31], v[196:199], v[84:87]
buffer_load_dwordx4 v12, s[24:27], s34 offen offset:1024 sc1 lds
v_add_f32 v6, v6, v100
MA 8,56,112
v_exp_f32 v102, v102
MA 40,56,116
CV 122,100,101
v_add_f32 v6, v6, v101
MA 44,60,116
v_exp_f32 v103, v103
MA 12,60,112
s_waitcnt lgkmcnt(0)
v_add_f32 v6, v6, v102
v_mfma_f32_16x16x32_bf16 v[80:83], v[32:35], v[200:203], v[80:83]
v_exp_f32 v104, v104
v_mfma_f32_16x16x32_bf16 v[88:91], v[32:35], v[216:219], v[88:91]
CV 123,102,103
v_add_f32 v6, v6, v103
v_mfma_f32_16x16x32_bf16 v[92:95], v[36:39], v[216:219], v[92:95]
v_exp_f32 v105, v105
v_mfma_f32_16x16x32_bf16 v[84:87], v[36:39], v[200:203], v[84:87]
buffer_load_dwordx4 v12, s[24:27], s34 offen offset:2048 sc1 lds
v_add_f32 v7, v7, v104
MA 16,64,112
v_exp_f32 v106, v106
MA 48,64,116
CV 124,104,105
v_add_f32 v7, v7, v105
MA 52,68,116
v_exp_f32 v107, v107
MA 20,68,112
v_add_f32 v7, v7, v106
v_mfma_f32_16x16x32_bf16 v[80:83], v[40:43], v[204:207], v[80:83]
v_exp_f32 v108, v108
v_mfma_f32_16x16x32_bf16 v[88:91], v[40:43], v[220:223], v[88:91]
CV 125,106,107
v_add_f32 v7, v7, v107
v_mfma_f32_16x16x32_bf16 v[92:95], v[44:47], v[220:223], v[92:95]
v_exp_f32 v109, v109
v_mfma_f32_16x16x32_bf16 v[84:87], v[44:47], v[204:207], v[84:87]
buffer_load_dwordx4 v12, s[24:27], s34 offen offset:3072 sc1 lds
s_mov_b32 s34, 0x3c000
v_add_f32 v7, v7, v108
MA 24,72,112
v_exp_f32 v110, v110
MA 56,72,116
CV 126,108,109
v_add_f32 v7, v7, v109
MA 60,76,116
v_exp_f32 v111, v111
MA 28,76,112
v_add_f32 v7, v7, v110
v_mfma_f32_16x16x32_bf16 v[96:99], v[16:19], v[224:227], 0
v_exp_f32 v80, v80
v_mfma_f32_16x16x32_bf16 v[104:107], v[16:19], v[240:243], 0
CV 127,110,111
v_add_f32 v7, v7, v111
v_mfma_f32_16x16x32_bf16 v[108:111], v[20:23], v[240:243], 0
v_exp_f32 v81, v81
v_mfma_f32_16x16x32_bf16 v[100:103], v[20:23], v[224:227], 0
RD 16,14,16384
v_add_f32 v8, v8, v80
MA 64,48,120
v_exp_f32 v82, v82
MA 96,48,124
CV 112,80,81
v_add_f32 v8, v8, v81
MA 100,52,124
v_exp_f32 v83, v83
MA 68,52,120
RD 20,14,17408
v_add_f32 v8, v8, v82
v_mfma_f32_16x16x32_bf16 v[96:99], v[24:27], v[228:231], v[96:99]
v_exp_f32 v84, v84
v_mfma_f32_16x16x32_bf16 v[104:107], v[24:27], v[244:247], v[104:107]
CV 113,82,83
v_add_f32 v8, v8, v83
v_mfma_f32_16x16x32_bf16 v[108:111], v[28:31], v[244:247], v[108:111]
v_exp_f32 v85, v85
v_mfma_f32_16x16x32_bf16 v[100:103], v[28:31], v[228:231], v[100:103]
RD 24,14,18432
v_add_f32 v8, v8, v84
MA 72,56,120
v_exp_f32 v86, v86
MA 104,56,124
CV 114,84,85
v_add_f32 v8, v8, v85
MA 108,60,124
v_exp_f32 v87, v87
MA 76,60,120
RD 28,14,19456
v_add_f32 v8, v8, v86
v_mfma_f32_16x16x32_bf16 v[96:99], v[32:35], v[232:235], v[96:99]
v_exp_f32 v88, v88
v_mfma_f32_16x16x32_bf16 v[104:107], v[32:35], v[248:251], v[104:107]
CV 115,86,87
v_add_f32 v8, v8, v87
v_mfma_f32_16x16x32_bf16 v[108:111], v[36:39], v[248:251], v[108:111]
v_exp_f32 v89, v89
v_mfma_f32_16x16x32_bf16 v[100:103], v[36:39], v[232:235], v[100:103]
RD 32,14,20480
v_add_f32 v9, v9, v88
MA 80,64,120
v_exp_f32 v90, v90
MA 112,64,124
CV 116,88,89
v_add_f32 v9, v9, v89
MA 116,68,124
v_exp_f32 v91, v91
MA 84,68,120
RD 36,14,21504
v_add_f32 v9, v9, v90
v_mfma_f32_16x16x32_bf16 v[96:99], v[40:43], v[236:239], v[96:99]
v_exp_f32 v92, v92
v_mfma_f32_16x16x32_bf16 v[104:107], v[40:43], v[252:255], v[104:107]
CV 117,90,91
v_add_f32 v9, v9, v91
v_mfma_f32_16x16x32_bf16 v[108:111], v[44:47], v[252:255], v[108:111]
v_exp_f32 v93, v93
v_mfma_f32_16x16x32_bf16 v[100:103], v[44:47], v[236:239], v[100:103]
RD 40,14,22528
v_add_f32 v9, v9, v92
MA 88,72,120
v_exp_f32 v94, v94
MA 120,72,124
CV 118,92,93
v_add_f32 v9, v9, v93
MA 124,76,124
v_exp_f32 v95, v95
MA 92,76,120
RD 44,14,23552
v_add_f32 v9, v9, v94
s_waitcnt lgkmcnt(2)
v_mfma_f32_16x16x32_bf16 v[80:83], v[16:19], v[128:131], 0
v_exp_f32 v96, v96
v_mfma_f32_16x16x32_bf16 v[88:91], v[16:19], v[144:147], 0
CV 119,94,95
v_add_f32 v9, v9, v95
v_mfma_f32_16x16x32_bf16 v[92:95], v[20:23], v[144:147], 0
v_exp_f32 v97, v97
v_mfma_f32_16x16x32_bf16 v[84:87], v[20:23], v[128:131], 0
s_add_u32 m0, s36, 49152
s_nop 0
buffer_load_dwordx4 v12, s[24:27], s34 offen sc1 lds
v_add_f32 v10, v10, v96
MZ 128,48,112
v_exp_f32 v98, v98
MZ 160,48,116
CV 120,96,97
v_add_f32 v10, v10, v97
MZ 164,52,116
v_exp_f32 v99, v99
MZ 132,52,112
v_add_f32 v10, v10, v98
v_mfma_f32_16x16x32_bf16 v[80:83], v[24:27], v[132:135], v[80:83]
v_exp_f32 v100, v100
v_mfma_f32_16x16x32_bf16 v[88:91], v[24:27], v[148:151], v[88:91]
CV 121,98,99
v_add_f32 v10, v10, v99
v_mfma_f32_16x16x32_bf16 v[92:95], v[28:31], v[148:151], v[92:95]
v_exp_f32 v101, v101
v_mfma_f32_16x16x32_bf16 v[84:87], v[28:31], v[132:135], v[84:87]
buffer_load_dwordx4 v12, s[24:27], s34 offen offset:1024 sc1 lds
v_add_f32 v10, v10, v100
MZ 136,56,112
v_exp_f32 v102, v102
MZ 168,56,116
CV 122,100,101
v_add_f32 v10, v10, v101
MZ 172,60,116
v_exp_f32 v103, v103
MZ 140,60,112
s_waitcnt lgkmcnt(0)
v_add_f32 v10, v10, v102
v_mfma_f32_16x16x32_bf16 v[80:83], v[32:35], v[136:139], v[80:83]
v_exp_f32 v104, v104
v_mfma_f32_16x16x32_bf16 v[88:91], v[32:35], v[152:155], v[88:91]
CV 123,102,103
v_add_f32 v10, v10, v103
v_mfma_f32_16x16x32_bf16 v[92:95], v[36:39], v[152:155], v[92:95]
v_exp_f32 v105, v105
v_mfma_f32_16x16x32_bf16 v[84:87], v[36:39], v[136:139], v[84:87]
buffer_load_dwordx4 v12, s[24:27], s34 offen offset:2048 sc1 lds
v_add_f32 v13, v13, v104
MZ 144,64,112
v_exp_f32 v106, v106
MZ 176,64,116
CV 124,104,105
v_add_f32 v13, v13, v105
MZ 180,68,116
v_exp_f32 v107, v107
MZ 148,68,112
v_add_f32 v13, v13, v106
v_mfma_f32_16x16x32_bf16 v[80:83], v[40:43], v[140:143], v[80:83]
v_exp_f32 v108, v108
v_mfma_f32_16x16x32_bf16 v[88:91], v[40:43], v[156:159], v[88:91]
CV 125,106,107
v_add_f32 v13, v13, v107
v_mfma_f32_16x16x32_bf16 v[92:95], v[44:47], v[156:159], v[92:95]
v_exp_f32 v109, v109
v_mfma_f32_16x16x32_bf16 v[84:87], v[44:47], v[140:143], v[84:87]
buffer_load_dwordx4 v12, s[24:27], s34 offen offset:3072 sc1 lds
s_mov_b32 s34, 0x0
v_add_f32 v13, v13, v108
MZ 152,72,112
v_exp_f32 v110, v110
MZ 184,72,116
CV 126,108,109
v_add_f32 v13, v13, v109
MZ 188,76,116
v_exp_f32 v111, v111
MZ 156,76,112
buffer_load_dword v3, v15, s[96:99], s39 offen
s_add_u32 s39, s39, 1792
v_add_f32 v13, v13, v110
v_mfma_f32_16x16x32_bf16 v[96:99], v[16:19], v[160:163], 0
v_exp_f32 v80, v80
v_mfma_f32_16x16x32_bf16 v[104:107], v[16:19], v[176:179], 0
CV 127,110,111
v_add_f32 v13, v13, v111
v_mfma_f32_16x16x32_bf16 v[108:111], v[20:23], v[176:179], 0
v_exp_f32 v81, v81
v_mfma_f32_16x16x32_bf16 v[100:103], v[20:23], v[160:163], 0
v_add_f32 v4, v4, v80
MZ 192,48,120
v_exp_f32 v82, v82
MZ 224,48,124
CV 112,80,81
v_add_f32 v4, v4, v81
MZ 228,52,124
v_exp_f32 v83, v83
MZ 196,52,120
RD 48,14,24576
v_add_f32 v4, v4, v82
v_mfma_f32_16x16x32_bf16 v[96:99], v[24:27], v[164:167], v[96:99]
v_exp_f32 v84, v84
v_mfma_f32_16x16x32_bf16 v[104:107], v[24:27], v[180:183], v[104:107]
CV 113,82,83
v_add_f32 v4, v4, v83
v_mfma_f32_16x16x32_bf16 v[108:111], v[28:31], v[180:183], v[108:111]
v_exp_f32 v85, v85
v_mfma_f32_16x16x32_bf16 v[100:103], v[28:31], v[164:167], v[100:103]
RD 52,14,25600
v_add_f32 v4, v4, v84
MZ 200,56,120
v_exp_f32 v86, v86
MZ 232,56,124
CV 114,84,85
v_add_f32 v4, v4, v85
MZ 236,60,124
v_exp_f32 v87, v87
MZ 204,60,120
RD 56,14,26624
v_add_f32 v4, v4, v86
v_mfma_f32_16x16x32_bf16 v[96:99], v[32:35], v[168:171], v[96:99]
v_exp_f32 v88, v88
v_mfma_f32_16x16x32_bf16 v[104:107], v[32:35], v[184:187], v[104:107]
CV 115,86,87
v_add_f32 v4, v4, v87
v_mfma_f32_16x16x32_bf16 v[108:111], v[36:39], v[184:187], v[108:111]
v_exp_f32 v89, v89
v_mfma_f32_16x16x32_bf16 v[100:103], v[36:39], v[168:171], v[100:103]
RD 60,14,27648
v_add_f32 v5, v5, v88
MZ 208,64,120
v_exp_f32 v90, v90
MZ 240,64,124
CV 116,88,89
v_add_f32 v5, v5, v89
MZ 244,68,124
v_exp_f32 v91, v91
MZ 212,68,120
RD 64,14,28672
v_add_f32 v5, v5, v90
v_mfma_f32_16x16x32_bf16 v[96:99], v[40:43], v[172:175], v[96:99]
v_exp_f32 v92, v92
v_mfma_f32_16x16x32_bf16 v[104:107], v[40:43], v[188:191], v[104:107]
CV 117,90,91
v_add_f32 v5, v5, v91
v_mfma_f32_16x16x32_bf16 v[108:111], v[44:47], v[188:191], v[108:111]
v_exp_f32 v93, v93
v_mfma_f32_16x16x32_bf16 v[100:103], v[44:47], v[172:175], v[100:103]
RD 68,14,29696
v_add_f32 v5, v5, v92
MZ 216,72,120
v_exp_f32 v94, v94
MZ 248,72,124
CV 118,92,93
v_add_f32 v5, v5, v93
MZ 252,76,124
v_exp_f32 v95, v95
MZ 220,76,120
RD 72,14,30720
RD 76,14,31744
v_add_f32 v5, v5, v94
s_waitcnt lgkmcnt(2)
v_mfma_f32_16x16x32_bf16 v[80:83], v[16:19], v[192:195], 0
v_exp_f32 v96, v96
v_mfma_f32_16x16x32_bf16 v[88:91], v[16:19], v[208:211], 0
CV 119,94,95
v_add_f32 v5, v5, v95
v_mfma_f32_16x16x32_bf16 v[92:95], v[20:23], v[208:211], 0
v_exp_f32 v97, v97
v_mfma_f32_16x16x32_bf16 v[84:87], v[20:23], v[192:195], 0
v_add_f32 v6, v6, v96
MA 0,48,112
v_exp_f32 v98, v98
MA 32,48,116
CV 120,96,97
v_add_f32 v6, v6, v97
MA 36,52,116
v_exp_f32 v99, v99
MA 4,52,112
v_add_f32 v6, v6, v98
v_mfma_f32_16x16x32_bf16 v[80:83], v[24:27], v[196:199], v[80:83]
v_exp_f32 v100, v100
v_mfma_f32_16x16x32_bf16 v[88:91], v[24:27], v[212:215], v[88:91]
CV 121,98,99
v_add_f32 v6, v6, v99
v_mfma_f32_16x16x32_bf16 v[92:95], v[28:31], v[212:215], v[92:95]
v_exp_f32 v101, v101
v_mfma_f32_16x16x32_bf16 v[84:87], v[28:31], v[196:199], v[84:87]
v_add_f32 v6, v6, v100
MA 8,56,112
v_exp_f32 v102, v102
MA 40,56,116
CV 122,100,101
v_add_f32 v6, v6, v101
MA 44,60,116
v_exp_f32 v103, v103
MA 12,60,112
s_waitcnt lgkmcnt(0)
v_add_f32 v6, v6, v102
v_mfma_f32_16x16x32_bf16 v[80:83], v[32:35], v[200:203], v[80:83]
v_exp_f32 v104, v104
v_mfma_f32_16x16x32_bf16 v[88:91], v[32:35], v[216:219], v[88:91]
CV 123,102,103
v_add_f32 v6, v6, v103
v_mfma_f32_16x16x32_bf16 v[92:95], v[36:39], v[216:219], v[92:95]
v_exp_f32 v105, v105
v_mfma_f32_16x16x32_bf16 v[84:87], v[36:39], v[200:203], v[84:87]
v_add_f32 v7, v7, v104
MA 16,64,112
v_exp_f32 v106, v106
MA 48,64,116
CV 124,104,105
v_add_f32 v7, v7, v105
MA 52,68,116
v_exp_f32 v107, v107
MA 20,68,112
v_add_f32 v7, v7, v106
v_mfma_f32_16x16x32_bf16 v[80:83], v[40:43], v[204:207], v[80:83]
v_exp_f32 v108, v108
v_mfma_f32_16x16x32_bf16 v[88:91], v[40:43], v[220:223], v[88:91]
CV 125,106,107
v_add_f32 v7, v7, v107
v_mfma_f32_16x16x32_bf16 v[92:95], v[44:47], v[220:223], v[92:95]
v_exp_f32 v109, v109
v_mfma_f32_16x16x32_bf16 v[84:87], v[44:47], v[204:207], v[84:87]
v_add_f32 v7, v7, v108
MA 24,72,112
v_exp_f32 v110, v110
MA 56,72,116
CV 126,108,109
v_add_f32 v7, v7, v109
MA 60,76,116
v_exp_f32 v111, v111
MA 28,76,112
v_add_f32 v7, v7, v110
v_mfma_f32_16x16x32_bf16 v[96:99], v[16:19], v[224:227], 0
v_exp_f32 v80, v80
v_mfma_f32_16x16x32_bf16 v[104:107], v[16:19], v[240:243], 0
CV 127,110,111
v_add_f32 v7, v7, v111
v_mfma_f32_16x16x32_bf16 v[108:111], v[20:23], v[240:243], 0
v_exp_f32 v81, v81
v_mfma_f32_16x16x32_bf16 v[100:103], v[20:23], v[224:227], 0
RD 16,14,32768
v_add_f32 v8, v8, v80
MA 64,48,120
v_exp_f32 v82, v82
MA 96,48,124
CV 112,80,81
v_add_f32 v8, v8, v81
MA 100,52,124
v_exp_f32 v83, v83
MA 68,52,120
RD 20,14,33792
v_add_f32 v8, v8, v82
v_mfma_f32_16x16x32_bf16 v[96:99], v[24:27], v[228:231], v[96:99]
v_exp_f32 v84, v84
v_mfma_f32_16x16x32_bf16 v[104:107], v[24:27], v[244:247], v[104:107]
CV 113,82,83
v_add_f32 v8, v8, v83
v_mfma_f32_16x16x32_bf16 v[108:111], v[28:31], v[244:247], v[108:111]
v_exp_f32 v85, v85
v_mfma_f32_16x16x32_bf16 v[100:103], v[28:31], v[228:231], v[100:103]
RD 24,14,34816
v_add_f32 v8, v8, v84
MA 72,56,120
v_exp_f32 v86, v86
MA 104,56,124
CV 114,84,85
v_add_f32 v8, v8, v85
MA 108,60,124
v_exp_f32 v87, v87
MA 76,60,120
RD 28,14,35840
v_add_f32 v8, v8, v86
v_mfma_f32_16x16x32_bf16 v[96:99], v[32:35], v[232:235], v[96:99]
v_exp_f32 v88, v88
v_mfma_f32_16x16x32_bf16 v[104:107], v[32:35], v[248:251], v[104:107]
CV 115,86,87
v_add_f32 v8, v8, v87
v_mfma_f32_16x16x32_bf16 v[108:111], v[36:39], v[248:251], v[108:111]
v_exp_f32 v89, v89
v_mfma_f32_16x16x32_bf16 v[100:103], v[36:39], v[232:235], v[100:103]
RD 32,14,36864
v_add_f32 v9, v9, v88
MA 80,64,120
v_exp_f32 v90, v90
MA 112,64,124
CV 116,88,89
v_add_f32 v9, v9, v89
MA 116,68,124
v_exp_f32 v91, v91
MA 84,68,120
RD 36,14,37888
v_add_f32 v9, v9, v90
v_mfma_f32_16x16x32_bf16 v[96:99], v[40:43], v[236:239], v[96:99]
v_exp_f32 v92, v92
v_mfma_f32_16x16x32_bf16 v[104:107], v[40:43], v[252:255], v[104:107]
CV 117,90,91
v_add_f32 v9, v9, v91
v_mfma_f32_16x16x32_bf16 v[108:111], v[44:47], v[252:255], v[108:111]
v_exp_f32 v93, v93
v_mfma_f32_16x16x32_bf16 v[100:103], v[44:47], v[236:239], v[100:103]
RD 40,14,38912
v_add_f32 v9, v9, v92
MA 88,72,120
v_exp_f32 v94, v94
MA 120,72,124
CV 118,92,93
v_add_f32 v9, v9, v93
MA 124,76,124
v_exp_f32 v95, v95
MA 92,76,120
RD 44,14,39936
v_add_f32 v9, v9, v94
s_waitcnt lgkmcnt(2)
v_mfma_f32_16x16x32_bf16 v[80:83], v[16:19], v[128:131], 0
v_exp_f32 v96, v96
v_mfma_f32_16x16x32_bf16 v[88:91], v[16:19], v[144:147], 0
CV 119,94,95
v_add_f32 v9, v9, v95
v_mfma_f32_16x16x32_bf16 v[92:95], v[20:23], v[144:147], 0
v_exp_f32 v97, v97
v_mfma_f32_16x16x32_bf16 v[84:87], v[20:23], v[128:131], 0
v_add_f32 v10, v10, v96
MA 128,48,112
v_exp_f32 v98, v98
MA 160,48,116
CV 120,96,97
v_add_f32 v10, v10, v97
MA 164,52,116
v_exp_f32 v99, v99
MA 132,52,112
v_add_f32 v10, v10, v98
v_mfma_f32_16x16x32_bf16 v[80:83], v[24:27], v[132:135], v[80:83]
v_exp_f32 v100, v100
v_mfma_f32_16x16x32_bf16 v[88:91], v[24:27], v[148:151], v[88:91]
CV 121,98,99
v_add_f32 v10, v10, v99
v_mfma_f32_16x16x32_bf16 v[92:95], v[28:31], v[148:151], v[92:95]
v_exp_f32 v101, v101
v_mfma_f32_16x16x32_bf16 v[84:87], v[28:31], v[132:135], v[84:87]
v_add_f32 v10, v10, v100
MA 136,56,112
v_exp_f32 v102, v102
MA 168,56,116
CV 122,100,101
v_add_f32 v10, v10, v101
MA 172,60,116
v_exp_f32 v103, v103
MA 140,60,112
s_waitcnt lgkmcnt(0)
v_add_f32 v10, v10, v102
v_mfma_f32_16x16x32_bf16 v[80:83], v[32:35], v[136:139], v[80:83]
v_exp_f32 v104, v104
v_mfma_f32_16x16x32_bf16 v[88:91], v[32:35], v[152:155], v[88:91]
CV 123,102,103
v_add_f32 v10, v10, v103
v_mfma_f32_16x16x32_bf16 v[92:95], v[36:39], v[152:155], v[92:95]
v_exp_f32 v105, v105
v_mfma_f32_16x16x32_bf16 v[84:87], v[36:39], v[136:139], v[84:87]
v_add_f32 v13, v13, v104
MA 144,64,112
v_exp_f32 v106, v106
MA 176,64,116
CV 124,104,105
v_add_f32 v13, v13, v105
MA 180,68,116
v_exp_f32 v107, v107
MA 148,68,112
v_add_f32 v13, v13, v106
v_mfma_f32_16x16x32_bf16 v[80:83], v[40:43], v[140:143], v[80:83]
v_exp_f32 v108, v108
v_mfma_f32_16x16x32_bf16 v[88:91], v[40:43], v[156:159], v[88:91]
CV 125,106,107
v_add_f32 v13, v13, v107
v_mfma_f32_16x16x32_bf16 v[92:95], v[44:47], v[156:159], v[92:95]
v_exp_f32 v109, v109
v_mfma_f32_16x16x32_bf16 v[84:87], v[44:47], v[140:143], v[84:87]
v_add_f32 v13, v13, v108
MA 152,72,112
v_exp_f32 v110, v110
MA 184,72,116
CV 126,108,109
v_add_f32 v13, v13, v109
MA 188,76,116
v_exp_f32 v111, v111
MA 156,76,112
buffer_load_dword v3, v15, s[96:99], s39 offen
s_add_u32 s39, s39, 1792
v_add_f32 v13, v13, v110
v_mfma_f32_16x16x32_bf16 v[96:99], v[16:19], v[160:163], 0
v_exp_f32 v80, v80
v_mfma_f32_16x16x32_bf16 v[104:107], v[16:19], v[176:179], 0
CV 127,110,111
v_add_f32 v13, v13, v111
v_mfma_f32_16x16x32_bf16 v[108:111], v[20:23], v[176:179], 0
v_exp_f32 v81, v81
v_mfma_f32_16x16x32_bf16 v[100:103], v[20:23], v[160:163], 0
v_add_f32 v4, v4, v80
MA 192,48,120
v_exp_f32 v82, v82
MA 224,48,124
CV 112,80,81
v_add_f32 v4, v4, v81
MA 228,52,124
v_exp_f32 v83, v83
MA 196,52,120
RD 48,14,40960
v_add_f32 v4, v4, v82
v_mfma_f32_16x16x32_bf16 v[96:99], v[24:27], v[164:167], v[96:99]
v_exp_f32 v84, v84
v_mfma_f32_16x16x32_bf16 v[104:107], v[24:27], v[180:183], v[104:107]
CV 113,82,83
v_add_f32 v4, v4, v83
v_mfma_f32_16x16x32_bf16 v[108:111], v[28:31], v[180:183], v[108:111]
v_exp_f32 v85, v85
v_mfma_f32_16x16x32_bf16 v[100:103], v[28:31], v[164:167], v[100:103]
RD 52,14,41984
v_add_f32 v4, v4, v84
MA 200,56,120
v_exp_f32 v86, v86
MA 232,56,124
CV 114,84,85
v_add_f32 v4, v4, v85
MA 236,60,124
v_exp_f32 v87, v87
MA 204,60,120
RD 56,14,43008
v_add_f32 v4, v4, v86
v_mfma_f32_16x16x32_bf16 v[96:99], v[32:35], v[168:171], v[96:99]
v_exp_f32 v88, v88
v_mfma_f32_16x16x32_bf16 v[104:107], v[32:35], v[184:187], v[104:107]
CV 115,86,87
v_add_f32 v4, v4, v87
v_mfma_f32_16x16x32_bf16 v[108:111], v[36:39], v[184:187], v[108:111]
v_exp_f32 v89, v89
v_mfma_f32_16x16x32_bf16 v[100:103], v[36:39], v[168:171], v[100:103]
RD 60,14,44032
v_add_f32 v5, v5, v88
MA 208,64,120
v_exp_f32 v90, v90
MA 240,64,124
CV 116,88,89
v_add_f32 v5, v5, v89
MA 244,68,124
v_exp_f32 v91, v91
MA 212,68,120
RD 64,14,45056
v_add_f32 v5, v5, v90
v_mfma_f32_16x16x32_bf16 v[96:99], v[40:43], v[172:175], v[96:99]
v_exp_f32 v92, v92
v_mfma_f32_16x16x32_bf16 v[104:107], v[40:43], v[188:191], v[104:107]
CV 117,90,91
v_add_f32 v5, v5, v91
v_mfma_f32_16x16x32_bf16 v[108:111], v[44:47], v[188:191], v[108:111]
v_exp_f32 v93, v93
v_mfma_f32_16x16x32_bf16 v[100:103], v[44:47], v[172:175], v[100:103]
RD 68,14,46080
v_add_f32 v5, v5, v92
MA 216,72,120
v_exp_f32 v94, v94
MA 248,72,124
CV 118,92,93
v_add_f32 v5, v5, v93
MA 252,76,124
v_exp_f32 v95, v95
MA 220,76,120
RD 72,14,47104
RD 76,14,48128
v_add_f32 v5, v5, v94
s_waitcnt vmcnt(16) lgkmcnt(2)
s_barrier
v_mfma_f32_16x16x32_bf16 v[80:83], v[16:19], v[192:195], 0
v_exp_f32 v96, v96
v_mfma_f32_16x16x32_bf16 v[88:91], v[16:19], v[208:211], 0
CV 119,94,95
v_add_f32 v5, v5, v95
v_mfma_f32_16x16x32_bf16 v[92:95], v[20:23], v[208:211], 0
v_exp_f32 v97, v97
v_mfma_f32_16x16x32_bf16 v[84:87], v[20:23], v[192:195], 0
s_add_u32 m0, s36, 65536
s_nop 0
buffer_load_dwordx4 v12, s[24:27], s34 offen sc1 lds
v_add_f32 v6, v6, v96
MA 0,48,112
v_exp_f32 v98, v98
MA 32,48,116
CV 120,96,97
v_add_f32 v6, v6, v97
MA 36,52,116
v_exp_f32 v99, v99
MA 4,52,112
v_add_f32 v6, v6, v98
v_mfma_f32_16x16x32_bf16 v[80:83], v[24:27], v[196:199], v[80:83]
v_exp_f32 v100, v100
v_mfma_f32_16x16x32_bf16 v[88:91], v[24:27], v[212:215], v[88:91]
CV 121,98,99
v_add_f32 v6, v6, v99
v_mfma_f32_16x16x32_bf16 v[92:95], v[28:31], v[212:215], v[92:95]
v_exp_f32 v101, v101
v_mfma_f32_16x16x32_bf16 v[84:87], v[28:31], v[196:199], v[84:87]
buffer_load_dwordx4 v12, s[24:27], s34 offen offset:1024 sc1 lds
v_add_f32 v6, v6, v100
MA 8,56,112
v_exp_f32 v102, v102
MA 40,56,116
CV 122,100,101
v_add_f32 v6, v6, v101
MA 44,60,116
v_exp_f32 v103, v103
MA 12,60,112
s_waitcnt lgkmcnt(0)
v_add_f32 v6, v6, v102
v_mfma_f32_16x16x32_bf16 v[80:83], v[32:35], v[200:203], v[80:83]
v_exp_f32 v104, v104
v_mfma_f32_16x16x32_bf16 v[88:91], v[32:35], v[216:219], v[88:91]
CV 123,102,103
v_add_f32 v6, v6, v103
v_mfma_f32_16x16x32_bf16 v[92:95], v[36:39], v[216:219], v[92:95]
v_exp_f32 v105, v105
v_mfma_f32_16x16x32_bf16 v[84:87], v[36:39], v[200:203], v[84:87]
buffer_load_dwordx4 v12, s[24:27], s34 offen offset:2048 sc1 lds
v_add_f32 v7, v7, v104
MA 16,64,112
v_exp_f32 v106, v106
MA 48,64,116
CV 124,104,105
v_add_f32 v7, v7, v105
MA 52,68,116
v_exp_f32 v107, v107
MA 20,68,112
v_add_f32 v7, v7, v106
v_mfma_f32_16x16x32_bf16 v[80:83], v[40:43], v[204:207], v[80:83]
v_exp_f32 v108, v108
v_mfma_f32_16x16x32_bf16 v[88:91], v[40:43], v[220:223], v[88:91]
CV 125,106,107
v_add_f32 v7, v7, v107
v_mfma_f32_16x16x32_bf16 v[92:95], v[44:47], v[220:223], v[92:95]
v_exp_f32 v109, v109
v_mfma_f32_16x16x32_bf16 v[84:87], v[44:47], v[204:207], v[84:87]
buffer_load_dwordx4 v12, s[24:27], s34 offen offset:3072 sc1 lds
s_mov_b32 s34, 0x4000
v_add_f32 v7, v7, v108
MA 24,72,112
v_exp_f32 v110, v110
MA 56,72,116
CV 126,108,109
v_add_f32 v7, v7, v109
MA 60,76,116
v_exp_f32 v111, v111
MA 28,76,112
v_add_f32 v7, v7, v110
v_mfma_f32_16x16x32_bf16 v[96:99], v[16:19], v[224:227], 0
v_exp_f32 v80, v80
v_mfma_f32_16x16x32_bf16 v[104:107], v[16:19], v[240:243], 0
CV 127,110,111
v_add_f32 v7, v7, v111
v_mfma_f32_16x16x32_bf16 v[108:111], v[20:23], v[240:243], 0
v_exp_f32 v81, v81
v_mfma_f32_16x16x32_bf16 v[100:103], v[20:23], v[224:227], 0
RD 16,14,49152
v_add_f32 v8, v8, v80
MA 64,48,120
v_exp_f32 v82, v82
MA 96,48,124
CV 112,80,81
v_add_f32 v8, v8, v81
MA 100,52,124
v_exp_f32 v83, v83
MA 68,52,120
RD 20,14,50176
v_add_f32 v8, v8, v82
v_mfma_f32_16x16x32_bf16 v[96:99], v[24:27], v[228:231], v[96:99]
v_exp_f32 v84, v84
v_mfma_f32_16x16x32_bf16 v[104:107], v[24:27], v[244:247], v[104:107]
CV 113,82,83
v_add_f32 v8, v8, v83
v_mfma_f32_16x16x32_bf16 v[108:111], v[28:31], v[244:247], v[108:111]
v_exp_f32 v85, v85
v_mfma_f32_16x16x32_bf16 v[100:103], v[28:31], v[228:231], v[100:103]
RD 24,14,51200
v_add_f32 v8, v8, v84
MA 72,56,120
v_exp_f32 v86, v86
MA 104,56,124
CV 114,84,85
v_add_f32 v8, v8, v85
MA 108,60,124
v_exp_f32 v87, v87
MA 76,60,120
RD 28,14,52224
v_add_f32 v8, v8, v86
v_mfma_f32_16x16x32_bf16 v[96:99], v[32:35], v[232:235], v[96:99]
v_exp_f32 v88, v88
v_mfma_f32_16x16x32_bf16 v[104:107], v[32:35], v[248:251], v[104:107]
CV 115,86,87
v_add_f32 v8, v8, v87
v_mfma_f32_16x16x32_bf16 v[108:111], v[36:39], v[248:251], v[108:111]
v_exp_f32 v89, v89
v_mfma_f32_16x16x32_bf16 v[100:103], v[36:39], v[232:235], v[100:103]
RD 32,14,53248
v_add_f32 v9, v9, v88
MA 80,64,120
v_exp_f32 v90, v90
MA 112,64,124
CV 116,88,89
v_add_f32 v9, v9, v89
MA 116,68,124
v_exp_f32 v91, v91
MA 84,68,120
RD 36,14,54272
v_add_f32 v9, v9, v90
v_mfma_f32_16x16x32_bf16 v[96:99], v[40:43], v[236:239], v[96:99]
v_exp_f32 v92, v92
v_mfma_f32_16x16x32_bf16 v[104:107], v[40:43], v[252:255], v[104:107]
CV 117,90,91
v_add_f32 v9, v9, v91
v_mfma_f32_16x16x32_bf16 v[108:111], v[44:47], v[252:255], v[108:111]
v_exp_f32 v93, v93
v_mfma_f32_16x16x32_bf16 v[100:103], v[44:47], v[236:239], v[100:103]
RD 40,14,55296
v_add_f32 v9, v9, v92
MA 88,72,120
v_exp_f32 v94, v94
MA 120,72,124
CV 118,92,93
v_add_f32 v9, v9, v93
MA 124,76,124
v_exp_f32 v95, v95
MA 92,76,120
RD 44,14,56320
v_add_f32 v9, v9, v94
s_waitcnt lgkmcnt(2)
v_mfma_f32_16x16x32_bf16 v[80:83], v[16:19], v[128:131], 0
v_exp_f32 v96, v96
v_mfma_f32_16x16x32_bf16 v[88:91], v[16:19], v[144:147], 0
CV 119,94,95
v_add_f32 v9, v9, v95
v_mfma_f32_16x16x32_bf16 v[92:95], v[20:23], v[144:147], 0
v_exp_f32 v97, v97
v_mfma_f32_16x16x32_bf16 v[84:87], v[20:23], v[128:131], 0
s_add_u32 m0, s36, 81920
s_nop 0
buffer_load_dwordx4 v12, s[24:27], s34 offen sc1 lds
v_add_f32 v10, v10, v96
MA 128,48,112
v_exp_f32 v98, v98
MA 160,48,116
CV 120,96,97
v_add_f32 v10, v10, v97
s_getpc_b64 s[62:63]
L_ct4:
MA 164,52,116
v_exp_f32 v99, v99
MA 132,52,112
v_add_f32 v10, v10, v98
v_mfma_f32_16x16x32_bf16 v[80:83], v[24:27], v[132:135], v[80:83]
v_exp_f32 v100, v100
v_mfma_f32_16x16x32_bf16 v[88:91], v[24:27], v[148:151], v[88:91]
CV 121,98,99
v_add_f32 v10, v10, v99
v_lshlrev_b32 v0, 7, v1
v_mfma_f32_16x16x32_bf16 v[92:95], v[28:31], v[148:151], v[92:95]
v_exp_f32 v101, v101
v_mfma_f32_16x16x32_bf16 v[84:87], v[28:31], v[132:135], v[84:87]
buffer_load_dwordx4 v12, s[24:27], s34 offen offset:1024 sc1 lds
v_add_f32 v10, v10, v100
MA 136,56,112
v_exp_f32 v102, v102
MA 168,56,116
CV 122,100,101
v_add_f32 v10, v10, v101
v_add_u32 v0, 2048, v0
MA 172,60,116
v_exp_f32 v103, v103
MA 140,60,112
s_waitcnt lgkmcnt(0)
v_add_f32 v10, v10, v102
v_mfma_f32_16x16x32_bf16 v[80:83], v[32:35], v[136:139], v[80:83]
v_exp_f32 v104, v104
v_mfma_f32_16x16x32_bf16 v[88:91], v[32:35], v[152:155], v[88:91]
CV 123,102,103
v_add_f32 v10, v10, v103
v_min_u32 v0, L_code_end-L_ct4-4, v0
v_mfma_f32_16x16x32_bf16 v[92:95], v[36:39], v[152:155], v[92:95]
v_exp_f32 v105, v105
v_mfma_f32_16x16x32_bf16 v[84:87], v[36:39], v[136:139], v[84:87]
buffer_load_dwordx4 v12, s[24:27], s34 offen offset:2048 sc1 lds
v_add_f32 v13, v13, v104
MA 144,64,112
v_exp_f32 v106, v106
MA 176,64,116
global_load_dword v3, v0, s[62:63]
CV 124,104,105
v_add_f32 v13, v13, v105
MA 180,68,116
v_exp_f32 v107, v107
MA 148,68,112
v_add_f32 v13, v13, v106
v_mfma_f32_16x16x32_bf16 v[80:83], v[40:43], v[140:143], v[80:83]
v_exp_f32 v108, v108
v_mfma_f32_16x16x32_bf16 v[88:91], v[40:43], v[156:159], v[88:91]
CV 125,106,107
v_add_f32 v13, v13, v107
v_mfma_f32_16x16x32_bf16 v[92:95], v[44:47], v[156:159], v[92:95]
v_exp_f32 v109, v109
v_mfma_f32_16x16x32_bf16 v[84:87], v[44:47], v[140:143], v[84:87]
buffer_load_dwordx4 v12, s[24:27], s34 offen offset:3072 sc1 lds
s_mov_b32 s34, 0x8000
v_add_f32 v13, v13, v108
MA 152,72,112
v_exp_f32 v110, v110
MA 184,72,116
CV 126,108,109
v_add_f32 v13, v13, v109
MA 188,76,116
v_exp_f32 v111, v111
MA 156,76,112
buffer_load_dword v3, v15, s[96:99], s39 offen
s_add_u32 s39, s39, 1792
v_add_f32 v13, v13, v110
v_mfma_f32_16x16x32_bf16 v[96:99], v[16:19], v[160:163], 0
v_exp_f32 v80, v80
v_mfma_f32_16x16x32_bf16 v[104:107], v[16:19], v[176:179], 0
CV 127,110,111
v_add_f32 v13, v13, v111
v_mfma_f32_16x16x32_bf16 v[108:111], v[20:23], v[176:179], 0
v_exp_f32 v81, v81
v_mfma_f32_16x16x32_bf16 v[100:103], v[20:23], v[160:163], 0
v_add_f32 v4, v4, v80
MA 192,48,120
v_exp_f32 v82, v82
MA 224,48,124
CV 112,80,81
v_add_f32 v4, v4, v81
MA 228,52,124
v_exp_f32 v83, v83
MA 196,52,120
RD 48,14,57344
v_add_f32 v4, v4, v82
v_mfma_f32_16x16x32_bf16 v[96:99], v[24:27], v[164:167], v[96:99]
v_exp_f32 v84, v84
v_mfma_f32_16x16x32_bf16 v[104:107], v[24:27], v[180:183], v[104:107]
CV 113,82,83
v_add_f32 v4, v4, v83
v_mfma_f32_16x16x32_bf16 v[108:111], v[28:31], v[180:183], v[108:111]
v_exp_f32 v85, v85
v_mfma_f32_16x16x32_bf16 v[100:103], v[28:31], v[164:167], v[100:103]
RD 52,14,58368
v_add_f32 v4, v4, v84
MA 200,56,120
v_exp_f32 v86, v86
MA 232,56,124
CV 114,84,85
v_add_f32 v4, v4, v85
MA 236,60,124
v_exp_f32 v87, v87
MA 204,60,120
RD 56,14,59392
v_add_f32 v4, v4, v86
v_mfma_f32_16x16x32_bf16 v[96:99], v[32:35], v[168:171], v[96:99]
v_exp_f32 v88, v88
v_mfma_f32_16x16x32_bf16 v[104:107], v[32:35], v[184:187], v[104:107]
CV 115,86,87
v_add_f32 v4, v4, v87
v_mfma_f32_16x16x32_bf16 v[108:111], v[36:39], v[184:187], v[108:111]
v_exp_f32 v89, v89
v_mfma_f32_16x16x32_bf16 v[100:103], v[36:39], v[168:171], v[100:103]
RD 60,14,60416
v_add_f32 v5, v5, v88
MA 208,64,120
v_exp_f32 v90, v90
MA 240,64,124
CV 116,88,89
v_add_f32 v5, v5, v89
MA 244,68,124
v_exp_f32 v91, v91
MA 212,68,120
RD 64,14,61440
v_add_f32 v5, v5, v90
v_mfma_f32_16x16x32_bf16 v[96:99], v[40:43], v[172:175], v[96:99]
v_exp_f32 v92, v92
v_mfma_f32_16x16x32_bf16 v[104:107], v[40:43], v[188:191], v[104:107]
CV 117,90,91
v_add_f32 v5, v5, v91
v_mfma_f32_16x16x32_bf16 v[108:111], v[44:47], v[188:191], v[108:111]
v_exp_f32 v93, v93
v_mfma_f32_16x16x32_bf16 v[100:103], v[44:47], v[172:175], v[100:103]
RD 68,14,62464
v_add_f32 v5, v5, v92
MA 216,72,120
v_exp_f32 v94, v94
MA 248,72,124
CV 118,92,93
v_add_f32 v5, v5, v93
MA 252,76,124
v_exp_f32 v95, v95
MA 220,76,120
RD 72,14,63488
RD 76,14,64512
v_add_f32 v5, v5, v94
s_waitcnt lgkmcnt(2)
v_mfma_f32_16x16x32_bf16 v[80:83], v[16:19], v[192:195], 0
v_exp_f32 v96, v96
v_mfma_f32_16x16x32_bf16 v[88:91], v[16:19], v[208:211], 0
CV 119,94,95
v_add_f32 v5, v5, v95
v_mfma_f32_16x16x32_bf16 v[92:95], v[20:23], v[208:211], 0
v_exp_f32 v97, v97
v_mfma_f32_16x16x32_bf16 v[84:87], v[20:23], v[192:195], 0
v_add_f32 v6, v6, v96
MA 0,48,112
v_exp_f32 v98, v98
MA 32,48,116
CV 120,96,97
v_add_f32 v6, v6, v97
MA 36,52,116
v_exp_f32 v99, v99
MA 4,52,112
v_add_f32 v6, v6, v98
v_mfma_f32_16x16x32_bf16 v[80:83], v[24:27], v[196:199], v[80:83]
v_exp_f32 v100, v100
v_mfma_f32_16x16x32_bf16 v[88:91], v[24:27], v[212:215], v[88:91]
CV 121,98,99
v_add_f32 v6, v6, v99
v_mfma_f32_16x16x32_bf16 v[92:95], v[28:31], v[212:215], v[92:95]
v_exp_f32 v101, v101
v_mfma_f32_16x16x32_bf16 v[84:87], v[28:31], v[196:199], v[84:87]
v_add_f32 v6, v6, v100
MA 8,56,112
v_exp_f32 v102, v102
MA 40,56,116
CV 122,100,101
v_add_f32 v6, v6, v101
MA 44,60,116
v_exp_f32 v103, v103
MA 12,60,112
s_waitcnt lgkmcnt(0)
v_add_f32 v6, v6, v102
v_mfma_f32_16x16x32_bf16 v[80:83], v[32:35], v[200:203], v[80:83]
v_exp_f32 v104, v104
v_mfma_f32_16x16x32_bf16 v[88:91], v[32:35], v[216:219], v[88:91]
CV 123,102,103
v_add_f32 v6, v6, v103
v_mfma_f32_16x16x32_bf16 v[92:95], v[36:39], v[216:219], v[92:95]
v_exp_f32 v105, v105
v_mfma_f32_16x16x32_bf16 v[84:87], v[36:39], v[200:203], v[84:87]
v_add_f32 v7, v7, v104
MA 16,64,112
v_exp_f32 v106, v106
MA 48,64,116
CV 124,104,105
v_add_f32 v7, v7, v105
MA 52,68,116
v_exp_f32 v107, v107
MA 20,68,112
v_add_f32 v7, v7, v106
v_mfma_f32_16x16x32_bf16 v[80:83], v[40:43], v[204:207], v[80:83]
v_exp_f32 v108, v108
v_mfma_f32_16x16x32_bf16 v[88:91], v[40:43], v[220:223], v[88:91]
CV 125,106,107
v_add_f32 v7, v7, v107
v_mfma_f32_16x16x32_bf16 v[92:95], v[44:47], v[220:223], v[92:95]
v_exp_f32 v109, v109
v_mfma_f32_16x16x32_bf16 v[84:87], v[44:47], v[204:207], v[84:87]
v_add_f32 v7, v7, v108
MA 24,72,112
v_exp_f32 v110, v110
MA 56,72,116
CV 126,108,109
v_add_f32 v7, v7, v109
MA 60,76,116
v_exp_f32 v111, v111
MA 28,76,112
v_add_f32 v7, v7, v110
v_mfma_f32_16x16x32_bf16 v[96:99], v[16:19], v[224:227], 0
v_exp_f32 v80, v80
v_mfma_f32_16x16x32_bf16 v[104:107], v[16:19], v[240:243], 0
CV 127,110,111
v_add_f32 v7, v7, v111
v_mfma_f32_16x16x32_bf16 v[108:111], v[20:23], v[240:243], 0
v_exp_f32 v81, v81
v_mfma_f32_16x16x32_bf16 v[100:103], v[20:23], v[224:227], 0
RD 16,11,0
v_add_f32 v8, v8, v80
MA 64,48,120
v_exp_f32 v82, v82
MA 96,48,124
CV 112,80,81
v_add_f32 v8, v8, v81
MA 100,52,124
v_exp_f32 v83, v83
MA 68,52,120
RD 20,11,1024
v_add_f32 v8, v8, v82
v_mfma_f32_16x16x32_bf16 v[96:99], v[24:27], v[228:231], v[96:99]
v_exp_f32 v84, v84
v_mfma_f32_16x16x32_bf16 v[104:107], v[24:27], v[244:247], v[104:107]
CV 113,82,83
v_add_f32 v8, v8, v83
v_mfma_f32_16x16x32_bf16 v[108:111], v[28:31], v[244:247], v[108:111]
v_exp_f32 v85, v85
v_mfma_f32_16x16x32_bf16 v[100:103], v[28:31], v[228:231], v[100:103]
RD 24,11,2048
v_add_f32 v8, v8, v84
MA 72,56,120
v_exp_f32 v86, v86
MA 104,56,124
CV 114,84,85
v_add_f32 v8, v8, v85
MA 108,60,124
v_exp_f32 v87, v87
MA 76,60,120
RD 28,11,3072
v_add_f32 v8, v8, v86
v_mfma_f32_16x16x32_bf16 v[96:99], v[32:35], v[232:235], v[96:99]
v_exp_f32 v88, v88
v_mfma_f32_16x16x32_bf16 v[104:107], v[32:35], v[248:251], v[104:107]
CV 115,86,87
v_add_f32 v8, v8, v87
v_mfma_f32_16x16x32_bf16 v[108:111], v[36:39], v[248:251], v[108:111]
v_exp_f32 v89, v89
v_mfma_f32_16x16x32_bf16 v[100:103], v[36:39], v[232:235], v[100:103]
RD 32,11,4096
v_add_f32 v9, v9, v88
MA 80,64,120
v_exp_f32 v90, v90
MA 112,64,124
CV 116,88,89
v_add_f32 v9, v9, v89
MA 116,68,124
v_exp_f32 v91, v91
MA 84,68,120
RD 36,11,5120
v_add_f32 v9, v9, v90
v_mfma_f32_16x16x32_bf16 v[96:99], v[40:43], v[236:239], v[96:99]
v_exp_f32 v92, v92
v_mfma_f32_16x16x32_bf16 v[104:107], v[40:43], v[252:255], v[104:107]
CV 117,90,91
v_add_f32 v9, v9, v91
v_mfma_f32_16x16x32_bf16 v[108:111], v[44:47], v[252:255], v[108:111]
v_exp_f32 v93, v93
v_mfma_f32_16x16x32_bf16 v[100:103], v[44:47], v[236:239], v[100:103]
RD 40,11,6144
v_add_f32 v9, v9, v92
MA 88,72,120
v_exp_f32 v94, v94
MA 120,72,124
CV 118,92,93
v_add_f32 v9, v9, v93
MA 124,76,124
v_exp_f32 v95, v95
MA 92,76,120
RD 44,11,7168
v_add_f32 v9, v9, v94
s_waitcnt lgkmcnt(2)
v_mfma_f32_16x16x32_bf16 v[80:83], v[16:19], v[128:131], 0
v_exp_f32 v96, v96
v_mfma_f32_16x16x32_bf16 v[88:91], v[16:19], v[144:147], 0
CV 119,94,95
v_add_f32 v9, v9, v95
v_mfma_f32_16x16x32_bf16 v[92:95], v[20:23], v[144:147], 0
v_exp_f32 v97, v97
v_mfma_f32_16x16x32_bf16 v[84:87], v[20:23], v[128:131], 0
v_add_f32 v10, v10, v96
MA 128,48,112
v_exp_f32 v98, v98
MA 160,48,116
CV 120,96,97
v_add_f32 v10, v10, v97
MA 164,52,116
v_exp_f32 v99, v99
MA 132,52,112
v_add_f32 v10, v10, v98
v_mfma_f32_16x16x32_bf16 v[80:83], v[24:27], v[132:135], v[80:83]
v_exp_f32 v100, v100
v_mfma_f32_16x16x32_bf16 v[88:91], v[24:27], v[148:151], v[88:91]
CV 121,98,99
v_add_f32 v10, v10, v99
v_mfma_f32_16x16x32_bf16 v[92:95], v[28:31], v[148:151], v[92:95]
v_exp_f32 v101, v101
v_mfma_f32_16x16x32_bf16 v[84:87], v[28:31], v[132:135], v[84:87]
v_add_f32 v10, v10, v100
MA 136,56,112
v_exp_f32 v102, v102
MA 168,56,116
CV 122,100,101
v_add_f32 v10, v10, v101
MA 172,60,116
v_exp_f32 v103, v103
MA 140,60,112
s_waitcnt lgkmcnt(0)
v_add_f32 v10, v10, v102
v_mfma_f32_16x16x32_bf16 v[80:83], v[32:35], v[136:139], v[80:83]
v_exp_f32 v104, v104
v_mfma_f32_16x16x32_bf16 v[88:91], v[32:35], v[152:155], v[88:91]
CV 123,102,103
v_add_f32 v10, v10, v103
v_mfma_f32_16x16x32_bf16 v[92:95], v[36:39], v[152:155], v[92:95]
v_exp_f32 v105, v105
v_mfma_f32_16x16x32_bf16 v[84:87], v[36:39], v[136:139], v[84:87]
v_add_f32 v13, v13, v104
MA 144,64,112
v_exp_f32 v106, v106
MA 176,64,116
CV 124,104,105
v_add_f32 v13, v13, v105
MA 180,68,116
v_exp_f32 v107, v107
MA 148,68,112
v_add_f32 v13, v13, v106
v_mfma_f32_16x16x32_bf16 v[80:83], v[40:43], v[140:143], v[80:83]
v_exp_f32 v108, v108
v_mfma_f32_16x16x32_bf16 v[88:91], v[40:43], v[156:159], v[88:91]
CV 125,106,107
v_add_f32 v13, v13, v107
v_mfma_f32_16x16x32_bf16 v[92:95], v[44:47], v[156:159], v[92:95]
v_exp_f32 v109, v109
v_mfma_f32_16x16x32_bf16 v[84:87], v[44:47], v[140:143], v[84:87]
v_add_f32 v13, v13, v108
MA 152,72,112
v_exp_f32 v110, v110
MA 184,72,116
CV 126,108,109
v_add_f32 v13, v13, v109
MA 188,76,116
v_exp_f32 v111, v111
MA 156,76,112
buffer_load_dword v3, v15, s[96:99], s39 offen
s_add_u32 s39, s39, 1792
v_add_f32 v13, v13, v110
v_mfma_f32_16x16x32_bf16 v[96:99], v[16:19], v[160:163], 0
v_exp_f32 v80, v80
v_mfma_f32_16x16x32_bf16 v[104:107], v[16:19], v[176:179], 0
CV 127,110,111
v_add_f32 v13, v13, v111
v_mfma_f32_16x16x32_bf16 v[108:111], v[20:23], v[176:179], 0
v_exp_f32 v81, v81
v_mfma_f32_16x16x32_bf16 v[100:103], v[20:23], v[160:163], 0
v_add_f32 v4, v4, v80
MA 192,48,120
v_exp_f32 v82, v82
MA 224,48,124
CV 112,80,81
v_add_f32 v4, v4, v81
MA 228,52,124
v_exp_f32 v83, v83
MA 196,52,120
RD 48,11,8192
v_add_f32 v4, v4, v82
v_mfma_f32_16x16x32_bf16 v[96:99], v[24:27], v[164:167], v[96:99]
v_exp_f32 v84, v84
v_mfma_f32_16x16x32_bf16 v[104:107], v[24:27], v[180:183], v[104:107]
CV 113,82,83
v_add_f32 v4, v4, v83
v_mfma_f32_16x16x32_bf16 v[108:111], v[28:31], v[180:183], v[108:111]
v_exp_f32 v85, v85
v_mfma_f32_16x16x32_bf16 v[100:103], v[28:31], v[164:167], v[100:103]
RD 52,11,9216
v_add_f32 v4, v4, v84
MA 200,56,120
v_exp_f32 v86, v86
MA 232,56,124
CV 114,84,85
v_add_f32 v4, v4, v85
MA 236,60,124
v_exp_f32 v87, v87
MA 204,60,120
RD 56,11,10240
v_add_f32 v4, v4, v86
v_mfma_f32_16x16x32_bf16 v[96:99], v[32:35], v[168:171], v[96:99]
v_exp_f32 v88, v88
v_mfma_f32_16x16x32_bf16 v[104:107], v[32:35], v[184:187], v[104:107]
CV 115,86,87
v_add_f32 v4, v4, v87
v_mfma_f32_16x16x32_bf16 v[108:111], v[36:39], v[184:187], v[108:111]
v_exp_f32 v89, v89
v_mfma_f32_16x16x32_bf16 v[100:103], v[36:39], v[168:171], v[100:103]
RD 60,11,11264
v_add_f32 v5, v5, v88
MA 208,64,120
v_exp_f32 v90, v90
MA 240,64,124
CV 116,88,89
v_add_f32 v5, v5, v89
MA 244,68,124
v_exp_f32 v91, v91
MA 212,68,120
RD 64,11,12288
v_add_f32 v5, v5, v90
v_mfma_f32_16x16x32_bf16 v[96:99], v[40:43], v[172:175], v[96:99]
v_exp_f32 v92, v92
v_mfma_f32_16x16x32_bf16 v[104:107], v[40:43], v[188:191], v[104:107]
CV 117,90,91
v_add_f32 v5, v5, v91
v_mfma_f32_16x16x32_bf16 v[108:111], v[44:47], v[188:191], v[108:111]
v_exp_f32 v93, v93
v_mfma_f32_16x16x32_bf16 v[100:103], v[44:47], v[172:175], v[100:103]
RD 68,11,13312
v_add_f32 v5, v5, v92
MA 216,72,120
v_exp_f32 v94, v94
MA 248,72,124
CV 118,92,93
v_add_f32 v5, v5, v93
MA 252,76,124
v_exp_f32 v95, v95
MA 220,76,120
RD 72,11,14336
RD 76,11,15360
v_add_f32 v5, v5, v94
s_waitcnt vmcnt(17) lgkmcnt(2)
s_barrier
v_mfma_f32_16x16x32_bf16 v[80:83], v[16:19], v[192:195], 0
v_exp_f32 v96, v96
v_mfma_f32_16x16x32_bf16 v[88:91], v[16:19], v[208:211], 0
CV 119,94,95
v_add_f32 v5, v5, v95
v_mfma_f32_16x16x32_bf16 v[92:95], v[20:23], v[208:211], 0
v_exp_f32 v97, v97
v_mfma_f32_16x16x32_bf16 v[84:87], v[20:23], v[192:195], 0
s_add_u32 m0, s36, 98304
s_nop 0
buffer_load_dwordx4 v12, s[24:27], s34 offen sc1 lds
v_add_f32 v6, v6, v96
MA 0,48,112
v_exp_f32 v98, v98
MA 32,48,116
CV 120,96,97
v_add_f32 v6, v6, v97
MA 36,52,116
v_exp_f32 v99, v99
MA 4,52,112
v_add_f32 v6, v6, v98
v_mfma_f32_16x16x32_bf16 v[80:83], v[24:27], v[196:199], v[80:83]
v_exp_f32 v100, v100
v_mfma_f32_16x16x32_bf16 v[88:91], v[24:27], v[212:215], v[88:91]
CV 121,98,99
v_add_f32 v6, v6, v99
v_mfma_f32_16x16x32_bf16 v[92:95], v[28:31], v[212:215], v[92:95]
v_exp_f32 v101, v101
v_mfma_f32_16x16x32_bf16 v[84:87], v[28:31], v[196:199], v[84:87]
buffer_load_dwordx4 v12, s[24:27], s34 offen offset:1024 sc1 lds
v_add_f32 v6, v6, v100
MA 8,56,112
v_exp_f32 v102, v102
MA 40,56,116
CV 122,100,101
v_add_f32 v6, v6, v101
MA 44,60,116
v_exp_f32 v103, v103
MA 12,60,112
s_waitcnt lgkmcnt(0)
v_add_f32 v6, v6, v102
v_mfma_f32_16x16x32_bf16 v[80:83], v[32:35], v[200:203], v[80:83]
v_exp_f32 v104, v104
v_mfma_f32_16x16x32_bf16 v[88:91], v[32:35], v[216:219], v[88:91]
CV 123,102,103
v_add_f32 v6, v6, v103
v_mfma_f32_16x16x32_bf16 v[92:95], v[36:39], v[216:219], v[92:95]
v_exp_f32 v105, v105
v_mfma_f32_16x16x32_bf16 v[84:87], v[36:39], v[200:203], v[84:87]
buffer_load_dwordx4 v12, s[24:27], s34 offen offset:2048 sc1 lds
v_add_f32 v7, v7, v104
MA 16,64,112
v_exp_f32 v106, v106
MA 48,64,116
CV 124,104,105
v_add_f32 v7, v7, v105
MA 52,68,116
v_exp_f32 v107, v107
MA 20,68,112
v_add_f32 v7, v7, v106
v_mfma_f32_16x16x32_bf16 v[80:83], v[40:43], v[204:207], v[80:83]
v_exp_f32 v108, v108
v_mfma_f32_16x16x32_bf16 v[88:91], v[40:43], v[220:223], v[88:91]
CV 125,106,107
v_add_f32 v7, v7, v107
v_mfma_f32_16x16x32_bf16 v[92:95], v[44:47], v[220:223], v[92:95]
v_exp_f32 v109, v109
v_mfma_f32_16x16x32_bf16 v[84:87], v[44:47], v[204:207], v[84:87]
buffer_load_dwordx4 v12, s[24:27], s34 offen offset:3072 sc1 lds
s_mov_b32 s34, 0xc000
v_add_f32 v7, v7, v108
MA 24,72,112
v_exp_f32 v110, v110
MA 56,72,116
CV 126,108,109
v_add_f32 v7, v7, v109
MA 60,76,116
v_exp_f32 v111, v111
MA 28,76,112
v_add_f32 v7, v7, v110
v_mfma_f32_16x16x32_bf16 v[96:99], v[16:19], v[224:227], 0
v_exp_f32 v80, v80
v_mfma_f32_16x16x32_bf16 v[104:107], v[16:19], v[240:243], 0
CV 127,110,111
v_add_f32 v7, v7, v111
v_mfma_f32_16x16x32_bf16 v[108:111], v[20:23], v[240:243], 0
v_exp_f32 v81, v81
v_mfma_f32_16x16x32_bf16 v[100:103], v[20:23], v[224:227], 0
RD 16,11,16384
v_add_f32 v8, v8, v80
MA 64,48,120
v_exp_f32 v82, v82
MA 96,48,124
CV 112,80,81
v_add_f32 v8, v8, v81
MA 100,52,124
v_exp_f32 v83, v83
MA 68,52,120
RD 20,11,17408
v_add_f32 v8, v8, v82
v_mfma_f32_16x16x32_bf16 v[96:99], v[24:27], v[228:231], v[96:99]
v_exp_f32 v84, v84
v_mfma_f32_16x16x32_bf16 v[104:107], v[24:27], v[244:247], v[104:107]
CV 113,82,83
v_add_f32 v8, v8, v83
v_mfma_f32_16x16x32_bf16 v[108:111], v[28:31], v[244:247], v[108:111]
v_exp_f32 v85, v85
v_mfma_f32_16x16x32_bf16 v[100:103], v[28:31], v[228:231], v[100:103]
RD 24,11,18432
v_add_f32 v8, v8, v84
MA 72,56,120
v_exp_f32 v86, v86
MA 104,56,124
CV 114,84,85
v_add_f32 v8, v8, v85
MA 108,60,124
v_exp_f32 v87, v87
MA 76,60,120
RD 28,11,19456
v_add_f32 v8, v8, v86
v_mfma_f32_16x16x32_bf16 v[96:99], v[32:35], v[232:235], v[96:99]
v_exp_f32 v88, v88
v_mfma_f32_16x16x32_bf16 v[104:107], v[32:35], v[248:251], v[104:107]
CV 115,86,87
v_add_f32 v8, v8, v87
v_mfma_f32_16x16x32_bf16 v[108:111], v[36:39], v[248:251], v[108:111]
v_exp_f32 v89, v89
v_mfma_f32_16x16x32_bf16 v[100:103], v[36:39], v[232:235], v[100:103]
RD 32,11,20480
v_add_f32 v9, v9, v88
MA 80,64,120
v_exp_f32 v90, v90
MA 112,64,124
CV 116,88,89
v_add_f32 v9, v9, v89
MA 116,68,124
v_exp_f32 v91, v91
MA 84,68,120
RD 36,11,21504
v_add_f32 v9, v9, v90
v_mfma_f32_16x16x32_bf16 v[96:99], v[40:43], v[236:239], v[96:99]
v_exp_f32 v92, v92
v_mfma_f32_16x16x32_bf16 v[104:107], v[40:43], v[252:255], v[104:107]
CV 117,90,91
v_add_f32 v9, v9, v91
v_mfma_f32_16x16x32_bf16 v[108:111], v[44:47], v[252:255], v[108:111]
v_exp_f32 v93, v93
v_mfma_f32_16x16x32_bf16 v[100:103], v[44:47], v[236:239], v[100:103]
RD 40,11,22528
v_add_f32 v9, v9, v92
MA 88,72,120
v_exp_f32 v94, v94
MA 120,72,124
CV 118,92,93
v_add_f32 v9, v9, v93
MA 124,76,124
v_exp_f32 v95, v95
MA 92,76,120
RD 44,11,23552
v_add_f32 v9, v9, v94
s_waitcnt lgkmcnt(2)
v_mfma_f32_16x16x32_bf16 v[80:83], v[16:19], v[128:131], 0
v_exp_f32 v96, v96
v_mfma_f32_16x16x32_bf16 v[88:91], v[16:19], v[144:147], 0
CV 119,94,95
v_add_f32 v9, v9, v95
v_mfma_f32_16x16x32_bf16 v[92:95], v[20:23], v[144:147], 0
v_exp_f32 v97, v97
v_mfma_f32_16x16x32_bf16 v[84:87], v[20:23], v[128:131], 0
s_add_u32 m0, s36, 114688
s_nop 0
buffer_load_dwordx4 v12, s[24:27], s34 offen sc1 lds
v_add_f32 v10, v10, v96
MA 128,48,112
v_exp_f32 v98, v98
MA 160,48,116
CV 120,96,97
v_add_f32 v10, v10, v97
MA 164,52,116
v_exp_f32 v99, v99
MA 132,52,112
v_add_f32 v10, v10, v98
v_mfma_f32_16x16x32_bf16 v[80:83], v[24:27], v[132:135], v[80:83]
v_exp_f32 v100, v100
v_mfma_f32_16x16x32_bf16 v[88:91], v[24:27], v[148:151], v[88:91]
CV 121,98,99
v_add_f32 v10, v10, v99
v_mfma_f32_16x16x32_bf16 v[92:95], v[28:31], v[148:151], v[92:95]
v_exp_f32 v101, v101
v_mfma_f32_16x16x32_bf16 v[84:87], v[28:31], v[132:135], v[84:87]
buffer_load_dwordx4 v12, s[24:27], s34 offen offset:1024 sc1 lds
v_add_f32 v10, v10, v100
MA 136,56,112
v_exp_f32 v102, v102
MA 168,56,116
CV 122,100,101
v_add_f32 v10, v10, v101
MA 172,60,116
v_exp_f32 v103, v103
MA 140,60,112
s_waitcnt lgkmcnt(0)
v_add_f32 v10, v10, v102
v_mfma_f32_16x16x32_bf16 v[80:83], v[32:35], v[136:139], v[80:83]
v_exp_f32 v104, v104
v_mfma_f32_16x16x32_bf16 v[88:91], v[32:35], v[152:155], v[88:91]
CV 123,102,103
v_add_f32 v10, v10, v103
v_mfma_f32_16x16x32_bf16 v[92:95], v[36:39], v[152:155], v[92:95]
v_exp_f32 v105, v105
v_mfma_f32_16x16x32_bf16 v[84:87], v[36:39], v[136:139], v[84:87]
buffer_load_dwordx4 v12, s[24:27], s34 offen offset:2048 sc1 lds
v_add_f32 v13, v13, v104
MA 144,64,112
v_exp_f32 v106, v106
MA 176,64,116
CV 124,104,105
v_add_f32 v13, v13, v105
MA 180,68,116
v_exp_f32 v107, v107
MA 148,68,112
v_add_f32 v13, v13, v106
v_mfma_f32_16x16x32_bf16 v[80:83], v[40:43], v[140:143], v[80:83]
v_exp_f32 v108, v108
v_mfma_f32_16x16x32_bf16 v[88:91], v[40:43], v[156:159], v[88:91]
CV 125,106,107
v_add_f32 v13, v13, v107
v_mfma_f32_16x16x32_bf16 v[92:95], v[44:47], v[156:159], v[92:95]
v_exp_f32 v109, v109
v_mfma_f32_16x16x32_bf16 v[84:87], v[44:47], v[140:143], v[84:87]
buffer_load_dwordx4 v12, s[24:27], s34 offen offset:3072 sc1 lds
s_mov_b32 s34, 0x10000
v_add_f32 v13, v13, v108
MA 152,72,112
v_exp_f32 v110, v110
MA 184,72,116
CV 126,108,109
v_add_f32 v13, v13, v109
MA 188,76,116
v_exp_f32 v111, v111
MA 156,76,112
buffer_load_dword v3, v15, s[96:99], s39 offen
s_add_u32 s39, s39, 1792
v_add_f32 v13, v13, v110
v_mfma_f32_16x16x32_bf16 v[96:99], v[16:19], v[160:163], 0
v_exp_f32 v80, v80
v_mfma_f32_16x16x32_bf16 v[104:107], v[16:19], v[176:179], 0
CV 127,110,111
v_add_f32 v13, v13, v111
v_mfma_f32_16x16x32_bf16 v[108:111], v[20:23], v[176:179], 0
v_exp_f32 v81, v81
v_mfma_f32_16x16x32_bf16 v[100:103], v[20:23], v[160:163], 0
v_add_f32 v4, v4, v80
MA 192,48,120
v_exp_f32 v82, v82
MA 224,48,124
CV 112,80,81
v_add_f32 v4, v4, v81
MA 228,52,124
v_exp_f32 v83, v83
MA 196,52,120
RD 48,11,24576
v_add_f32 v4, v4, v82
v_mfma_f32_16x16x32_bf16 v[96:99], v[24:27], v[164:167], v[96:99]
v_exp_f32 v84, v84
v_mfma_f32_16x16x32_bf16 v[104:107], v[24:27], v[180:183], v[104:107]
CV 113,82,83
v_add_f32 v4, v4, v83
v_mfma_f32_16x16x32_bf16 v[108:111], v[28:31], v[180:183], v[108:111]
v_exp_f32 v85, v85
v_mfma_f32_16x16x32_bf16 v[100:103], v[28:31], v[164:167], v[100:103]
RD 52,11,25600
v_add_f32 v4, v4, v84
MA 200,56,120
v_exp_f32 v86, v86
MA 232,56,124
CV 114,84,85
v_add_f32 v4, v4, v85
MA 236,60,124
v_exp_f32 v87, v87
MA 204,60,120
RD 56,11,26624
v_add_f32 v4, v4, v86
v_mfma_f32_16x16x32_bf16 v[96:99], v[32:35], v[168:171], v[96:99]
v_exp_f32 v88, v88
v_mfma_f32_16x16x32_bf16 v[104:107], v[32:35], v[184:187], v[104:107]
CV 115,86,87
v_add_f32 v4, v4, v87
v_mfma_f32_16x16x32_bf16 v[108:111], v[36:39], v[184:187], v[108:111]
v_exp_f32 v89, v89
v_mfma_f32_16x16x32_bf16 v[100:103], v[36:39], v[168:171], v[100:103]
RD 60,11,27648
v_add_f32 v5, v5, v88
MA 208,64,120
v_exp_f32 v90, v90
MA 240,64,124
CV 116,88,89
v_add_f32 v5, v5, v89
MA 244,68,124
v_exp_f32 v91, v91
MA 212,68,120
RD 64,11,28672
v_add_f32 v5, v5, v90
v_mfma_f32_16x16x32_bf16 v[96:99], v[40:43], v[172:175], v[96:99]
v_exp_f32 v92, v92
v_mfma_f32_16x16x32_bf16 v[104:107], v[40:43], v[188:191], v[104:107]
CV 117,90,91
v_add_f32 v5, v5, v91
v_mfma_f32_16x16x32_bf16 v[108:111], v[44:47], v[188:191], v[108:111]
v_exp_f32 v93, v93
v_mfma_f32_16x16x32_bf16 v[100:103], v[44:47], v[172:175], v[100:103]
RD 68,11,29696
v_add_f32 v5, v5, v92
MA 216,72,120
v_exp_f32 v94, v94
MA 248,72,124
CV 118,92,93
v_add_f32 v5, v5, v93
MA 252,76,124
v_exp_f32 v95, v95
MA 220,76,120
RD 72,11,30720
RD 76,11,31744
v_add_f32 v5, v5, v94
s_waitcnt lgkmcnt(2)
v_mfma_f32_16x16x32_bf16 v[80:83], v[16:19], v[192:195], 0
v_exp_f32 v96, v96
v_mfma_f32_16x16x32_bf16 v[88:91], v[16:19], v[208:211], 0
CV 119,94,95
v_add_f32 v5, v5, v95
v_mfma_f32_16x16x32_bf16 v[92:95], v[20:23], v[208:211], 0
v_exp_f32 v97, v97
v_mfma_f32_16x16x32_bf16 v[84:87], v[20:23], v[192:195], 0
v_add_f32 v6, v6, v96
MA 0,48,112
v_exp_f32 v98, v98
MA 32,48,116
CV 120,96,97
v_add_f32 v6, v6, v97
MA 36,52,116
v_exp_f32 v99, v99
MA 4,52,112
v_add_f32 v6, v6, v98
v_mfma_f32_16x16x32_bf16 v[80:83], v[24:27], v[196:199], v[80:83]
v_exp_f32 v100, v100
v_mfma_f32_16x16x32_bf16 v[88:91], v[24:27], v[212:215], v[88:91]
CV 121,98,99
v_add_f32 v6, v6, v99
v_mfma_f32_16x16x32_bf16 v[92:95], v[28:31], v[212:215], v[92:95]
v_exp_f32 v101, v101
v_mfma_f32_16x16x32_bf16 v[84:87], v[28:31], v[196:199], v[84:87]
v_add_f32 v6, v6, v100
MA 8,56,112
v_exp_f32 v102, v102
MA 40,56,116
CV 122,100,101
v_add_f32 v6, v6, v101
MA 44,60,116
v_exp_f32 v103, v103
MA 12,60,112
s_waitcnt lgkmcnt(0)
v_add_f32 v6, v6, v102
v_mfma_f32_16x16x32_bf16 v[80:83], v[32:35], v[200:203], v[80:83]
v_exp_f32 v104, v104
v_mfma_f32_16x16x32_bf16 v[88:91], v[32:35], v[216:219], v[88:91]
CV 123,102,103
v_add_f32 v6, v6, v103
v_mfma_f32_16x16x32_bf16 v[92:95], v[36:39], v[216:219], v[92:95]
v_exp_f32 v105, v105
v_mfma_f32_16x16x32_bf16 v[84:87], v[36:39], v[200:203], v[84:87]
v_add_f32 v7, v7, v104
MA 16,64,112
v_exp_f32 v106, v106
MA 48,64,116
CV 124,104,105
v_add_f32 v7, v7, v105
MA 52,68,116
v_exp_f32 v107, v107
MA 20,68,112
v_add_f32 v7, v7, v106
v_mfma_f32_16x16x32_bf16 v[80:83], v[40:43], v[204:207], v[80:83]
v_exp_f32 v108, v108
v_mfma_f32_16x16x32_bf16 v[88:91], v[40:43], v[220:223], v[88:91]
CV 125,106,107
v_add_f32 v7, v7, v107
v_mfma_f32_16x16x32_bf16 v[92:95], v[44:47], v[220:223], v[92:95]
v_exp_f32 v109, v109
v_mfma_f32_16x16x32_bf16 v[84:87], v[44:47], v[204:207], v[84:87]
v_add_f32 v7, v7, v108
MA 24,72,112
v_exp_f32 v110, v110
MA 56,72,116
CV 126,108,109
v_add_f32 v7, v7, v109
MA 60,76,116
v_exp_f32 v111, v111
MA 28,76,112
v_add_f32 v7, v7, v110
v_mfma_f32_16x16x32_bf16 v[96:99], v[16:19], v[224:227], 0
v_exp_f32 v80, v80
v_mfma_f32_16x16x32_bf16 v[104:107], v[16:19], v[240:243], 0
CV 127,110,111
v_add_f32 v7, v7, v111
v_mfma_f32_16x16x32_bf16 v[108:111], v[20:23], v[240:243], 0
v_exp_f32 v81, v81
v_mfma_f32_16x16x32_bf16 v[100:103], v[20:23], v[224:227], 0
RD 16,11,32768
v_add_f32 v8, v8, v80
MA 64,48,120
v_exp_f32 v82, v82
MA 96,48,124
CV 112,80,81
v_add_f32 v8, v8, v81
MA 100,52,124
v_exp_f32 v83, v83
MA 68,52,120
RD 20,11,33792
v_add_f32 v8, v8, v82
v_mfma_f32_16x16x32_bf16 v[96:99], v[24:27], v[228:231], v[96:99]
v_exp_f32 v84, v84
v_mfma_f32_16x16x32_bf16 v[104:107], v[24:27], v[244:247], v[104:107]
CV 113,82,83
v_add_f32 v8, v8, v83
v_mfma_f32_16x16x32_bf16 v[108:111], v[28:31], v[244:247], v[108:111]
v_exp_f32 v85, v85
v_mfma_f32_16x16x32_bf16 v[100:103], v[28:31], v[228:231], v[100:103]
RD 24,11,34816
v_add_f32 v8, v8, v84
MA 72,56,120
v_exp_f32 v86, v86
MA 104,56,124
CV 114,84,85
v_add_f32 v8, v8, v85
MA 108,60,124
v_exp_f32 v87, v87
MA 76,60,120
RD 28,11,35840
v_add_f32 v8, v8, v86
v_mfma_f32_16x16x32_bf16 v[96:99], v[32:35], v[232:235], v[96:99]
v_exp_f32 v88, v88
v_mfma_f32_16x16x32_bf16 v[104:107], v[32:35], v[248:251], v[104:107]
CV 115,86,87
v_add_f32 v8, v8, v87
v_mfma_f32_16x16x32_bf16 v[108:111], v[36:39], v[248:251], v[108:111]
v_exp_f32 v89, v89
v_mfma_f32_16x16x32_bf16 v[100:103], v[36:39], v[232:235], v[100:103]
RD 32,11,36864
v_add_f32 v9, v9, v88
MA 80,64,120
v_exp_f32 v90, v90
MA 112,64,124
CV 116,88,89
v_add_f32 v9, v9, v89
MA 116,68,124
v_exp_f32 v91, v91
MA 84,68,120
RD 36,11,37888
v_add_f32 v9, v9, v90
v_mfma_f32_16x16x32_bf16 v[96:99], v[40:43], v[236:239], v[96:99]
v_exp_f32 v92, v92
v_mfma_f32_16x16x32_bf16 v[104:107], v[40:43], v[252:255], v[104:107]
CV 117,90,91
v_add_f32 v9, v9, v91
v_mfma_f32_16x16x32_bf16 v[108:111], v[44:47], v[252:255], v[108:111]
v_exp_f32 v93, v93
v_mfma_f32_16x16x32_bf16 v[100:103], v[44:47], v[236:239], v[100:103]
RD 40,11,38912
v_add_f32 v9, v9, v92
MA 88,72,120
v_exp_f32 v94, v94
MA 120,72,124
CV 118,92,93
v_add_f32 v9, v9, v93
MA 124,76,124
v_exp_f32 v95, v95
MA 92,76,120
RD 44,11,39936
v_add_f32 v9, v9, v94
s_waitcnt lgkmcnt(2)
v_mfma_f32_16x16x32_bf16 v[80:83], v[16:19], v[128:131], 0
v_exp_f32 v96, v96
v_mfma_f32_16x16x32_bf16 v[88:91], v[16:19], v[144:147], 0
CV 119,94,95
v_add_f32 v9, v9, v95
v_mfma_f32_16x16x32_bf16 v[92:95], v[20:23], v[144:147], 0
v_exp_f32 v97, v97
v_mfma_f32_16x16x32_bf16 v[84:87], v[20:23], v[128:131], 0
v_add_f32 v10, v10, v96
MA 128,48,112
v_exp_f32 v98, v98
MA 160,48,116
CV 120,96,97
v_add_f32 v10, v10, v97
s_getpc_b64 s[62:63]
L_ct5:
MA 164,52,116
v_exp_f32 v99, v99
MA 132,52,112
v_add_f32 v10, v10, v98
v_mfma_f32_16x16x32_bf16 v[80:83], v[24:27], v[132:135], v[80:83]
v_exp_f32 v100, v100
v_mfma_f32_16x16x32_bf16 v[88:91], v[24:27], v[148:151], v[88:91]
CV 121,98,99
v_add_f32 v10, v10, v99
v_lshlrev_b32 v0, 7, v1
v_mfma_f32_16x16x32_bf16 v[92:95], v[28:31], v[148:151], v[92:95]
v_exp_f32 v101, v101
v_mfma_f32_16x16x32_bf16 v[84:87], v[28:31], v[132:135], v[84:87]
v_add_f32 v10, v10, v100
MA 136,56,112
v_exp_f32 v102, v102
MA 168,56,116
CV 122,100,101
v_add_f32 v10, v10, v101
v_add_u32 v0, 2048, v0
MA 172,60,116
v_exp_f32 v103, v103
MA 140,60,112
s_waitcnt lgkmcnt(0)
v_add_f32 v10, v10, v102
v_mfma_f32_16x16x32_bf16 v[80:83], v[32:35], v[136:139], v[80:83]
v_exp_f32 v104, v104
v_mfma_f32_16x16x32_bf16 v[88:91], v[32:35], v[152:155], v[88:91]
CV 123,102,103
v_add_f32 v10, v10, v103
v_min_u32 v0, L_code_end-L_ct5-4, v0
v_mfma_f32_16x16x32_bf16 v[92:95], v[36:39], v[152:155], v[92:95]
v_exp_f32 v105, v105
v_mfma_f32_16x16x32_bf16 v[84:87], v[36:39], v[136:139], v[84:87]
v_add_f32 v13, v13, v104
MA 144,64,112
v_exp_f32 v106, v106
MA 176,64,116
global_load_dword v3, v0, s[62:63]
CV 124,104,105
v_add_f32 v13, v13, v105
MA 180,68,116
v_exp_f32 v107, v107
MA 148,68,112
v_add_f32 v13, v13, v106
v_mfma_f32_16x16x32_bf16 v[80:83], v[40:43], v[140:143], v[80:83]
v_exp_f32 v108, v108
v_mfma_f32_16x16x32_bf16 v[88:91], v[40:43], v[156:159], v[88:91]
CV 125,106,107
v_add_f32 v13, v13, v107
v_mfma_f32_16x16x32_bf16 v[92:95], v[44:47], v[156:159], v[92:95]
v_exp_f32 v109, v109
v_mfma_f32_16x16x32_bf16 v[84:87], v[44:47], v[140:143], v[84:87]
v_add_f32 v13, v13, v108
MA 152,72,112
v_exp_f32 v110, v110
MA 184,72,116
CV 126,108,109
v_add_f32 v13, v13, v109
MA 188,76,116
v_exp_f32 v111, v111
MA 156,76,112
buffer_load_dword v3, v15, s[96:99], s39 offen
s_add_u32 s39, s39, 1792
v_add_f32 v13, v13, v110
v_mfma_f32_16x16x32_bf16 v[96:99], v[16:19], v[160:163], 0
v_exp_f32 v80, v80
v_mfma_f32_16x16x32_bf16 v[104:107], v[16:19], v[176:179], 0
CV 127,110,111
v_add_f32 v13, v13, v111
v_mfma_f32_16x16x32_bf16 v[108:111], v[20:23], v[176:179], 0
v_exp_f32 v81, v81
v_mfma_f32_16x16x32_bf16 v[100:103], v[20:23], v[160:163], 0
v_add_f32 v4, v4, v80
MA 192,48,120
v_exp_f32 v82, v82
MA 224,48,124
CV 112,80,81
v_add_f32 v4, v4, v81
MA 228,52,124
v_exp_f32 v83, v83
MA 196,52,120
RD 48,11,40960
v_add_f32 v4, v4, v82
v_mfma_f32_16x16x32_bf16 v[96:99], v[24:27], v[164:167], v[96:99]
v_exp_f32 v84, v84
v_mfma_f32_16x16x32_bf16 v[104:107], v[24:27], v[180:183], v[104:107]
CV 113,82,83
v_add_f32 v4, v4, v83
v_mfma_f32_16x16x32_bf16 v[108:111], v[28:31], v[180:183], v[108:111]
v_exp_f32 v85, v85
v_mfma_f32_16x16x32_bf16 v[100:103], v[28:31], v[164:167], v[100:103]
RD 52,11,41984
v_add_f32 v4, v4, v84
MA 200,56,120
v_exp_f32 v86, v86
MA 232,56,124
CV 114,84,85
v_add_f32 v4, v4, v85
MA 236,60,124
v_exp_f32 v87, v87
MA 204,60,120
RD 56,11,43008
v_add_f32 v4, v4, v86
v_mfma_f32_16x16x32_bf16 v[96:99], v[32:35], v[168:171], v[96:99]
v_exp_f32 v88, v88
v_mfma_f32_16x16x32_bf16 v[104:107], v[32:35], v[184:187], v[104:107]
CV 115,86,87
v_add_f32 v4, v4, v87
v_mfma_f32_16x16x32_bf16 v[108:111], v[36:39], v[184:187], v[108:111]
v_exp_f32 v89, v89
v_mfma_f32_16x16x32_bf16 v[100:103], v[36:39], v[168:171], v[100:103]
RD 60,11,44032
v_add_f32 v5, v5, v88
MA 208,64,120
v_exp_f32 v90, v90
MA 240,64,124
CV 116,88,89
v_add_f32 v5, v5, v89
MA 244,68,124
v_exp_f32 v91, v91
MA 212,68,120
RD 64,11,45056
v_add_f32 v5, v5, v90
v_mfma_f32_16x16x32_bf16 v[96:99], v[40:43], v[172:175], v[96:99]
v_exp_f32 v92, v92
v_mfma_f32_16x16x32_bf16 v[104:107], v[40:43], v[188:191], v[104:107]
CV 117,90,91
v_add_f32 v5, v5, v91
v_mfma_f32_16x16x32_bf16 v[108:111], v[44:47], v[188:191], v[108:111]
v_exp_f32 v93, v93
v_mfma_f32_16x16x32_bf16 v[100:103], v[44:47], v[172:175], v[100:103]
RD 68,11,46080
v_add_f32 v5, v5, v92
MA 216,72,120
v_exp_f32 v94, v94
MA 248,72,124
CV 118,92,93
v_add_f32 v5, v5, v93
MA 252,76,124
v_exp_f32 v95, v95
MA 220,76,120
RD 72,11,47104
RD 76,11,48128
v_add_f32 v5, v5, v94
s_waitcnt vmcnt(13) lgkmcnt(2)
s_barrier
v_mfma_f32_16x16x32_bf16 v[80:83], v[16:19], v[192:195], 0
v_exp_f32 v96, v96
v_mfma_f32_16x16x32_bf16 v[88:91], v[16:19], v[208:211], 0
CV 119,94,95
v_add_f32 v5, v5, v95
v_mfma_f32_16x16x32_bf16 v[92:95], v[20:23], v[208:211], 0
v_exp_f32 v97, v97
v_mfma_f32_16x16x32_bf16 v[84:87], v[20:23], v[192:195], 0
s_add_u32 m0, s36, 0
s_nop 0
buffer_load_dwordx4 v12, s[24:27], s34 offen sc1 lds
v_add_f32 v6, v6, v96
MA 0,48,112
v_exp_f32 v98, v98
MA 32,48,116
CV 120,96,97
v_add_f32 v6, v6, v97
MA 36,52,116
v_exp_f32 v99, v99
MA 4,52,112
v_add_f32 v6, v6, v98
v_mfma_f32_16x16x32_bf16 v[80:83], v[24:27], v[196:199], v[80:83]
v_exp_f32 v100, v100
v_mfma_f32_16x16x32_bf16 v[88:91], v[24:27], v[212:215], v[88:91]
CV 121,98,99
v_add_f32 v6, v6, v99
v_mfma_f32_16x16x32_bf16 v[92:95], v[28:31], v[212:215], v[92:95]
v_exp_f32 v101, v101
v_mfma_f32_16x16x32_bf16 v[84:87], v[28:31], v[196:199], v[84:87]
buffer_load_dwordx4 v12, s[24:27], s34 offen offset:1024 sc1 lds
v_add_f32 v6, v6, v100
MA 8,56,112
v_exp_f32 v102, v102
MA 40,56,116
CV 122,100,101
v_add_f32 v6, v6, v101
MA 44,60,116
v_exp_f32 v103, v103
MA 12,60,112
s_waitcnt lgkmcnt(0)
v_add_f32 v6, v6, v102
v_mfma_f32_16x16x32_bf16 v[80:83], v[32:35], v[200:203], v[80:83]
v_exp_f32 v104, v104
v_mfma_f32_16x16x32_bf16 v[88:91], v[32:35], v[216:219], v[88:91]
CV 123,102,103
v_add_f32 v6, v6, v103
v_mfma_f32_16x16x32_bf16 v[92:95], v[36:39], v[216:219], v[92:95]
v_exp_f32 v105, v105
v_mfma_f32_16x16x32_bf16 v[84:87], v[36:39], v[200:203], v[84:87]
buffer_load_dwordx4 v12, s[24:27], s34 offen offset:2048 sc1 lds
v_add_f32 v7, v7, v104
MA 16,64,112
v_exp_f32 v106, v106
MA 48,64,116
CV 124,104,105
v_add_f32 v7, v7, v105
MA 52,68,116
v_exp_f32 v107, v107
MA 20,68,112
v_add_f32 v7, v7, v106
v_mfma_f32_16x16x32_bf16 v[80:83], v[40:43], v[204:207], v[80:83]
v_exp_f32 v108, v108
v_mfma_f32_16x16x32_bf16 v[88:91], v[40:43], v[220:223], v[88:91]
CV 125,106,107
v_add_f32 v7, v7, v107
v_mfma_f32_16x16x32_bf16 v[92:95], v[44:47], v[220:223], v[92:95]
v_exp_f32 v109, v109
v_mfma_f32_16x16x32_bf16 v[84:87], v[44:47], v[204:207], v[84:87]
buffer_load_dwordx4 v12, s[24:27], s34 offen offset:3072 sc1 lds
s_mov_b32 s34, 0x14000
v_add_f32 v7, v7, v108
MA 24,72,112
v_exp_f32 v110, v110
MA 56,72,116
CV 126,108,109
v_add_f32 v7, v7, v109
MA 60,76,116
v_exp_f32 v111, v111
MA 28,76,112
v_add_f32 v7, v7, v110
v_mfma_f32_16x16x32_bf16 v[96:99], v[16:19], v[224:227], 0
v_exp_f32 v80, v80
v_mfma_f32_16x16x32_bf16 v[104:107], v[16:19], v[240:243], 0
CV 127,110,111
v_add_f32 v7, v7, v111
v_mfma_f32_16x16x32_bf16 v[108:111], v[20:23], v[240:243], 0
v_exp_f32 v81, v81
v_mfma_f32_16x16x32_bf16 v[100:103], v[20:23], v[224:227], 0
RD 16,11,49152
v_add_f32 v8, v8, v80
MA 64,48,120
v_exp_f32 v82, v82
MA 96,48,124
CV 112,80,81
v_add_f32 v8, v8, v81
MA 100,52,124
v_exp_f32 v83, v83
MA 68,52,120
RD 20,11,50176
v_add_f32 v8, v8, v82
v_mfma_f32_16x16x32_bf16 v[96:99], v[24:27], v[228:231], v[96:99]
v_exp_f32 v84, v84
v_mfma_f32_16x16x32_bf16 v[104:107], v[24:27], v[244:247], v[104:107]
CV 113,82,83
v_add_f32 v8, v8, v83
v_mfma_f32_16x16x32_bf16 v[108:111], v[28:31], v[244:247], v[108:111]
v_exp_f32 v85, v85
v_mfma_f32_16x16x32_bf16 v[100:103], v[28:31], v[228:231], v[100:103]
RD 24,11,51200
v_add_f32 v8, v8, v84
MA 72,56,120
v_exp_f32 v86, v86
MA 104,56,124
CV 114,84,85
v_add_f32 v8, v8, v85
MA 108,60,124
v_exp_f32 v87, v87
MA 76,60,120
RD 28,11,52224
v_add_f32 v8, v8, v86
v_mfma_f32_16x16x32_bf16 v[96:99], v[32:35], v[232:235], v[96:99]
v_exp_f32 v88, v88
v_mfma_f32_16x16x32_bf16 v[104:107], v[32:35], v[248:251], v[104:107]
CV 115,86,87
v_add_f32 v8, v8, v87
v_mfma_f32_16x16x32_bf16 v[108:111], v[36:39], v[248:251], v[108:111]
v_exp_f32 v89, v89
v_mfma_f32_16x16x32_bf16 v[100:103], v[36:39], v[232:235], v[100:103]
RD 32,11,53248
v_add_f32 v9, v9, v88
MA 80,64,120
v_exp_f32 v90, v90
MA 112,64,124
CV 116,88,89
v_add_f32 v9, v9, v89
MA 116,68,124
v_exp_f32 v91, v91
MA 84,68,120
RD 36,11,54272
v_add_f32 v9, v9, v90
v_mfma_f32_16x16x32_bf16 v[96:99], v[40:43], v[236:239], v[96:99]
v_exp_f32 v92, v92
v_mfma_f32_16x16x32_bf16 v[104:107], v[40:43], v[252:255], v[104:107]
CV 117,90,91
v_add_f32 v9, v9, v91
v_mfma_f32_16x16x32_bf16 v[108:111], v[44:47], v[252:255], v[108:111]
v_exp_f32 v93, v93
v_mfma_f32_16x16x32_bf16 v[100:103], v[44:47], v[236:239], v[100:103]
RD 40,11,55296
v_add_f32 v9, v9, v92
MA 88,72,120
v_exp_f32 v94, v94
MA 120,72,124
CV 118,92,93
v_add_f32 v9, v9, v93
MA 124,76,124
v_exp_f32 v95, v95
MA 92,76,120
RD 44,11,56320
v_add_f32 v9, v9, v94
s_waitcnt lgkmcnt(2)
v_mfma_f32_16x16x32_bf16 v[80:83], v[16:19], v[128:131], 0
v_exp_f32 v96, v96
v_mfma_f32_16x16x32_bf16 v[88:91], v[16:19], v[144:147], 0
CV 119,94,95
v_add_f32 v9, v9, v95
v_mfma_f32_16x16x32_bf16 v[92:95], v[20:23], v[144:147], 0
v_exp_f32 v97, v97
v_mfma_f32_16x16x32_bf16 v[84:87], v[20:23], v[128:131], 0
s_add_u32 m0, s36, 16384
s_nop 0
buffer_load_dwordx4 v12, s[24:27], s34 offen sc1 lds
v_add_f32 v10, v10, v96
MA 128,48,112
v_exp_f32 v98, v98
MA 160,48,116
CV 120,96,97
v_add_f32 v10, v10, v97
MA 164,52,116
v_exp_f32 v99, v99
MA 132,52,112
v_add_f32 v10, v10, v98
v_mfma_f32_16x16x32_bf16 v[80:83], v[24:27], v[132:135], v[80:83]
v_exp_f32 v100, v100
v_mfma_f32_16x16x32_bf16 v[88:91], v[24:27], v[148:151], v[88:91]
CV 121,98,99
v_add_f32 v10, v10, v99
v_mfma_f32_16x16x32_bf16 v[92:95], v[28:31], v[148:151], v[92:95]
v_exp_f32 v101, v101
v_mfma_f32_16x16x32_bf16 v[84:87], v[28:31], v[132:135], v[84:87]
buffer_load_dwordx4 v12, s[24:27], s34 offen offset:1024 sc1 lds
v_add_f32 v10, v10, v100
MA 136,56,112
v_exp_f32 v102, v102
MA 168,56,116
CV 122,100,101
v_add_f32 v10, v10, v101
MA 172,60,116
v_exp_f32 v103, v103
MA 140,60,112
s_waitcnt lgkmcnt(0)
v_add_f32 v10, v10, v102
v_mfma_f32_16x16x32_bf16 v[80:83], v[32:35], v[136:139], v[80:83]
v_exp_f32 v104, v104
v_mfma_f32_16x16x32_bf16 v[88:91], v[32:35], v[152:155], v[88:91]
CV 123,102,103
v_add_f32 v10, v10, v103
v_mfma_f32_16x16x32_bf16 v[92:95], v[36:39], v[152:155], v[92:95]
v_exp_f32 v105, v105
v_mfma_f32_16x16x32_bf16 v[84:87], v[36:39], v[136:139], v[84:87]
buffer_load_dwordx4 v12, s[24:27], s34 offen offset:2048 sc1 lds
v_add_f32 v13, v13, v104
MA 144,64,112
v_exp_f32 v106, v106
MA 176,64,116
CV 124,104,105
v_add_f32 v13, v13, v105
MA 180,68,116
v_exp_f32 v107, v107
MA 148,68,112
v_add_f32 v13, v13, v106
v_mfma_f32_16x16x32_bf16 v[80:83], v[40:43], v[140:143], v[80:83]
v_exp_f32 v108, v108
v_mfma_f32_16x16x32_bf16 v[88:91], v[40:43], v[156:159], v[88:91]
CV 125,106,107
v_add_f32 v13, v13, v107
v_mfma_f32_16x16x32_bf16 v[92:95], v[44:47], v[156:159], v[92:95]
v_exp_f32 v109, v109
v_mfma_f32_16x16x32_bf16 v[84:87], v[44:47], v[140:143], v[84:87]
buffer_load_dwordx4 v12, s[24:27], s34 offen offset:3072 sc1 lds
s_mov_b32 s34, 0x18000
v_add_f32 v13, v13, v108
MA 152,72,112
v_exp_f32 v110, v110
MA 184,72,116
CV 126,108,109
v_add_f32 v13, v13, v109
MA 188,76,116
v_exp_f32 v111, v111
MA 156,76,112
buffer_load_dword v3, v15, s[96:99], s39 offen
s_add_u32 s39, s39, 1792
v_add_f32 v13, v13, v110
v_mfma_f32_16x16x32_bf16 v[96:99], v[16:19], v[160:163], 0
v_exp_f32 v80, v80
v_mfma_f32_16x16x32_bf16 v[104:107], v[16:19], v[176:179], 0
CV 127,110,111
v_add_f32 v13, v13, v111
v_mfma_f32_16x16x32_bf16 v[108:111], v[20:23], v[176:179], 0
v_exp_f32 v81, v81
v_mfma_f32_16x16x32_bf16 v[100:103], v[20:23], v[160:163], 0
v_add_f32 v4, v4, v80
MA 192,48,120
v_exp_f32 v82, v82
MA 224,48,124
CV 112,80,81
v_add_f32 v4, v4, v81
MA 228,52,124
v_exp_f32 v83, v83
MA 196,52,120
RD 48,11,57344
v_add_f32 v4, v4, v82
v_mfma_f32_16x16x32_bf16 v[96:99], v[24:27], v[164:167], v[96:99]
v_exp_f32 v84, v84
v_mfma_f32_16x16x32_bf16 v[104:107], v[24:27], v[180:183], v[104:107]
CV 113,82,83
v_add_f32 v4, v4, v83
v_mfma_f32_16x16x32_bf16 v[108:111], v[28:31], v[180:183], v[108:111]
v_exp_f32 v85, v85
v_mfma_f32_16x16x32_bf16 v[100:103], v[28:31], v[164:167], v[100:103]
RD 52,11,58368
v_add_f32 v4, v4, v84
MA 200,56,120
v_exp_f32 v86, v86
MA 232,56,124
CV 114,84,85
v_add_f32 v4, v4, v85
MA 236,60,124
v_exp_f32 v87, v87
MA 204,60,120
RD 56,11,59392
v_add_f32 v4, v4, v86
v_mfma_f32_16x16x32_bf16 v[96:99], v[32:35], v[168:171], v[96:99]
v_exp_f32 v88, v88
v_mfma_f32_16x16x32_bf16 v[104:107], v[32:35], v[184:187], v[104:107]
CV 115,86,87
v_add_f32 v4, v4, v87
v_mfma_f32_16x16x32_bf16 v[108:111], v[36:39], v[184:187], v[108:111]
v_exp_f32 v89, v89
v_mfma_f32_16x16x32_bf16 v[100:103], v[36:39], v[168:171], v[100:103]
RD 60,11,60416
v_add_f32 v5, v5, v88
MA 208,64,120
v_exp_f32 v90, v90
MA 240,64,124
CV 116,88,89
v_add_f32 v5, v5, v89
MA 244,68,124
v_exp_f32 v91, v91
MA 212,68,120
RD 64,11,61440
v_add_f32 v5, v5, v90
v_mfma_f32_16x16x32_bf16 v[96:99], v[40:43], v[172:175], v[96:99]
v_exp_f32 v92, v92
v_mfma_f32_16x16x32_bf16 v[104:107], v[40:43], v[188:191], v[104:107]
CV 117,90,91
v_add_f32 v5, v5, v91
v_mfma_f32_16x16x32_bf16 v[108:111], v[44:47], v[188:191], v[108:111]
v_exp_f32 v93, v93
v_mfma_f32_16x16x32_bf16 v[100:103], v[44:47], v[172:175], v[100:103]
RD 68,11,62464
v_add_f32 v5, v5, v92
MA 216,72,120
v_exp_f32 v94, v94
MA 248,72,124
CV 118,92,93
v_add_f32 v5, v5, v93
MA 252,76,124
v_exp_f32 v95, v95
MA 220,76,120
RD 72,11,63488
RD 76,11,64512
v_add_f32 v5, v5, v94
s_waitcnt lgkmcnt(2)
v_mfma_f32_16x16x32_bf16 v[80:83], v[16:19], v[192:195], 0
v_exp_f32 v96, v96
v_mfma_f32_16x16x32_bf16 v[88:91], v[16:19], v[208:211], 0
CV 119,94,95
v_add_f32 v5, v5, v95
v_mfma_f32_16x16x32_bf16 v[92:95], v[20:23], v[208:211], 0
v_exp_f32 v97, v97
v_mfma_f32_16x16x32_bf16 v[84:87], v[20:23], v[192:195], 0
v_add_f32 v6, v6, v96
MA 0,48,112
v_exp_f32 v98, v98
MA 32,48,116
CV 120,96,97
v_add_f32 v6, v6, v97
MA 36,52,116
v_exp_f32 v99, v99
MA 4,52,112
v_add_f32 v6, v6, v98
v_mfma_f32_16x16x32_bf16 v[80:83], v[24:27], v[196:199], v[80:83]
v_exp_f32 v100, v100
v_mfma_f32_16x16x32_bf16 v[88:91], v[24:27], v[212:215], v[88:91]
CV 121,98,99
v_add_f32 v6, v6, v99
v_mfma_f32_16x16x32_bf16 v[92:95], v[28:31], v[212:215], v[92:95]
v_exp_f32 v101, v101
v_mfma_f32_16x16x32_bf16 v[84:87], v[28:31], v[196:199], v[84:87]
v_add_f32 v6, v6, v100
MA 8,56,112
v_exp_f32 v102, v102
MA 40,56,116
CV 122,100,101
v_add_f32 v6, v6, v101
MA 44,60,116
v_exp_f32 v103, v103
MA 12,60,112
s_waitcnt lgkmcnt(0)
v_add_f32 v6, v6, v102
v_mfma_f32_16x16x32_bf16 v[80:83], v[32:35], v[200:203], v[80:83]
v_exp_f32 v104, v104
v_mfma_f32_16x16x32_bf16 v[88:91], v[32:35], v[216:219], v[88:91]
CV 123,102,103
v_add_f32 v6, v6, v103
v_mfma_f32_16x16x32_bf16 v[92:95], v[36:39], v[216:219], v[92:95]
v_exp_f32 v105, v105
v_mfma_f32_16x16x32_bf16 v[84:87], v[36:39], v[200:203], v[84:87]
v_add_f32 v7, v7, v104
MA 16,64,112
v_exp_f32 v106, v106
MA 48,64,116
CV 124,104,105
v_add_f32 v7, v7, v105
MA 52,68,116
v_exp_f32 v107, v107
MA 20,68,112
v_add_f32 v7, v7, v106
v_mfma_f32_16x16x32_bf16 v[80:83], v[40:43], v[204:207], v[80:83]
v_exp_f32 v108, v108
v_mfma_f32_16x16x32_bf16 v[88:91], v[40:43], v[220:223], v[88:91]
CV 125,106,107
v_add_f32 v7, v7, v107
v_mfma_f32_16x16x32_bf16 v[92:95], v[44:47], v[220:223], v[92:95]
v_exp_f32 v109, v109
v_mfma_f32_16x16x32_bf16 v[84:87], v[44:47], v[204:207], v[84:87]
v_add_f32 v7, v7, v108
MA 24,72,112
v_exp_f32 v110, v110
MA 56,72,116
CV 126,108,109
v_add_f32 v7, v7, v109
MA 60,76,116
v_exp_f32 v111, v111
MA 28,76,112
v_add_f32 v7, v7, v110
v_mfma_f32_16x16x32_bf16 v[96:99], v[16:19], v[224:227], 0
v_exp_f32 v80, v80
v_mfma_f32_16x16x32_bf16 v[104:107], v[16:19], v[240:243], 0
CV 127,110,111
v_add_f32 v7, v7, v111
v_mfma_f32_16x16x32_bf16 v[108:111], v[20:23], v[240:243], 0
v_exp_f32 v81, v81
v_mfma_f32_16x16x32_bf16 v[100:103], v[20:23], v[224:227], 0
RD 16,14,0
v_add_f32 v8, v8, v80
MA 64,48,120
v_exp_f32 v82, v82
MA 96,48,124
CV 112,80,81
v_add_f32 v8, v8, v81
MA 100,52,124
v_exp_f32 v83, v83
MA 68,52,120
RD 20,14,1024
v_add_f32 v8, v8, v82
v_mfma_f32_16x16x32_bf16 v[96:99], v[24:27], v[228:231], v[96:99]
v_exp_f32 v84, v84
v_mfma_f32_16x16x32_bf16 v[104:107], v[24:27], v[244:247], v[104:107]
CV 113,82,83
v_add_f32 v8, v8, v83
v_mfma_f32_16x16x32_bf16 v[108:111], v[28:31], v[244:247], v[108:111]
v_exp_f32 v85, v85
v_mfma_f32_16x16x32_bf16 v[100:103], v[28:31], v[228:231], v[100:103]
RD 24,14,2048
v_add_f32 v8, v8, v84
MA 72,56,120
v_exp_f32 v86, v86
MA 104,56,124
CV 114,84,85
v_add_f32 v8, v8, v85
MA 108,60,124
v_exp_f32 v87, v87
MA 76,60,120
RD 28,14,3072
v_add_f32 v8, v8, v86
v_mfma_f32_16x16x32_bf16 v[96:99], v[32:35], v[232:235], v[96:99]
v_exp_f32 v88, v88
v_mfma_f32_16x16x32_bf16 v[104:107], v[32:35], v[248:251], v[104:107]
CV 115,86,87
v_add_f32 v8, v8, v87
v_mfma_f32_16x16x32_bf16 v[108:111], v[36:39], v[248:251], v[108:111]
v_exp_f32 v89, v89
v_mfma_f32_16x16x32_bf16 v[100:103], v[36:39], v[232:235], v[100:103]
RD 32,14,4096
v_add_f32 v9, v9, v88
MA 80,64,120
v_exp_f32 v90, v90
MA 112,64,124
CV 116,88,89
v_add_f32 v9, v9, v89
MA 116,68,124
v_exp_f32 v91, v91
MA 84,68,120
RD 36,14,5120
v_add_f32 v9, v9, v90
v_mfma_f32_16x16x32_bf16 v[96:99], v[40:43], v[236:239], v[96:99]
v_exp_f32 v92, v92
v_mfma_f32_16x16x32_bf16 v[104:107], v[40:43], v[252:255], v[104:107]
CV 117,90,91
v_add_f32 v9, v9, v91
v_mfma_f32_16x16x32_bf16 v[108:111], v[44:47], v[252:255], v[108:111]
v_exp_f32 v93, v93
v_mfma_f32_16x16x32_bf16 v[100:103], v[44:47], v[236:239], v[100:103]
RD 40,14,6144
v_add_f32 v9, v9, v92
MA 88,72,120
v_exp_f32 v94, v94
MA 120,72,124
CV 118,92,93
v_add_f32 v9, v9, v93
MA 124,76,124
v_exp_f32 v95, v95
MA 92,76,120
RD 44,14,7168
v_add_f32 v9, v9, v94
s_waitcnt lgkmcnt(2)
v_mfma_f32_16x16x32_bf16 v[80:83], v[16:19], v[192:195], 0
v_exp_f32 v96, v96
v_mfma_f32_16x16x32_bf16 v[88:91], v[16:19], v[208:211], 0
CV 119,94,95
v_add_f32 v9, v9, v95
v_mfma_f32_16x16x32_bf16 v[92:95], v[20:23], v[208:211], 0
v_exp_f32 v97, v97
v_mfma_f32_16x16x32_bf16 v[84:87], v[20:23], v[192:195], 0
v_add_f32 v10, v10, v96
s_nop 1
v_permlane32_swap_b32 v4, v6
v_permlane32_swap_b32 v5, v7
MA 128,48,112
v_exp_f32 v98, v98
MA 160,48,116
CV 120,96,97
v_add_f32 v10, v10, v97
MA 164,52,116
v_exp_f32 v99, v99
MA 132,52,112
v_add_f32 v10, v10, v98
v_add_f32 v4, v4, v6
v_add_f32 v5, v5, v7
s_nop 1
v_permlane16_swap_b32 v4, v5
s_nop 0
v_add_f32 v4, v4, v5
v_mfma_f32_16x16x32_bf16 v[80:83], v[24:27], v[196:199], v[80:83]
v_exp_f32 v100, v100
v_mfma_f32_16x16x32_bf16 v[88:91], v[24:27], v[212:215], v[88:91]
CV 121,98,99
v_add_f32 v10, v10, v99
v_mfma_f32_16x16x32_bf16 v[92:95], v[28:31], v[212:215], v[92:95]
v_exp_f32 v101, v101
v_mfma_f32_16x16x32_bf16 v[84:87], v[28:31], v[196:199], v[84:87]
v_add_f32 v10, v10, v100
v_cmp_nle_f32 vcc, 0x1f800000, v4
s_mov_b64 s[60:61], vcc
v_cmp_nge_f32 vcc, 0x5f800000, v4
s_or_b64 s[60:61], s[60:61], vcc
s_cmp_lg_u64 s[60:61], 0
s_cbranch_scc1 L_a_spill
L_a_spilled:
v_rcp_f32 v4, v4
v_lshlrev_b32 v184, 4, v1
v_mov_b32 v176, v4
MA 136,56,112
v_exp_f32 v102, v102
v_mov_b32 v180, v4
s_nop 1
v_permlane32_swap_b32 v176, v180
MA 168,56,116
CV 122,100,101
v_add_f32 v10, v10, v101
s_nop 0
v_mov_b32 v178, v176
MA 172,60,116
v_exp_f32 v103, v103
v_mov_b32 v182, v180
MA 140,60,112
s_waitcnt lgkmcnt(0)
v_add_f32 v10, v10, v102
s_nop 1
v_permlane16_swap_b32 v176, v178
v_mfma_f32_16x16x32_bf16 v[80:83], v[32:35], v[200:203], v[80:83]
v_exp_f32 v104, v104
v_mfma_f32_16x16x32_bf16 v[88:91], v[32:35], v[216:219], v[88:91]
CV 123,102,103
v_add_f32 v10, v10, v103
v_mfma_f32_16x16x32_bf16 v[92:95], v[36:39], v[216:219], v[92:95]
v_exp_f32 v105, v105
v_mfma_f32_16x16x32_bf16 v[84:87], v[36:39], v[200:203], v[84:87]
v_add_f32 v13, v13, v104
v_permlane16_swap_b32 v180, v182
s_lshl_b32 s4, s10, 2
s_lshl_b32 s15, s13, 4
s_add_u32 s4, s4, s15
s_mul_i32 s4, s4, 133248
s_lshl_b32 s15, s14, 13
s_add_u32 s4, s4, s15
MA 144,64,112
v_exp_f32 v106, v106
MA 176,64,116
CV 124,104,105
v_add_f32 v13, v13, v105
MA 180,68,116
v_exp_f32 v107, v107
MA 148,68,112
v_add_f32 v13, v13, v106
s_lshl_b32 s5, s13, 2
s_add_u32 s5, s5, s10
s_lshl_b32 s5, s5, 4
s_add_u32 s5, s5, s14
s_lshl_b32 s5, s5, 6
s_add_u32 s5, s5, 466944
AR 128,0
AR 129,1
v_mfma_f32_16x16x32_bf16 v[80:83], v[40:43], v[204:207], v[80:83]
v_exp_f32 v108, v108
v_mfma_f32_16x16x32_bf16 v[88:91], v[40:43], v[220:223], v[88:91]
CV 125,106,107
v_add_f32 v13, v13, v107
v_mfma_f32_16x16x32_bf16 v[92:95], v[44:47], v[220:223], v[92:95]
v_exp_f32 v109, v109
v_mfma_f32_16x16x32_bf16 v[84:87], v[44:47], v[204:207], v[84:87]
v_add_f32 v13, v13, v108
AR 130,2
AR 131,3
AR 132,4
AR 133,5
MA 152,72,112
v_exp_f32 v110, v110
AR 134,6
MA 184,72,116
CV 126,108,109
v_add_f32 v13, v13, v109
AR 135,7
MA 188,76,116
v_exp_f32 v111, v111
v_mul_f32 v128, v128, v176
MA 156,76,112
buffer_load_dword v3, v15, s[96:99], s39 offen
s_add_u32 s39, s39, 1792
v_add_f32 v13, v13, v110
v_mfma_f32_16x16x32_bf16 v[96:99], v[16:19], v[224:227], 0
v_exp_f32 v80, v80
v_mul_f32 v129, v129, v176
v_mul_f32 v130, v130, v176
v_mfma_f32_16x16x32_bf16 v[104:107], v[16:19], v[240:243], 0
RD 16,14,16384
CV 127,110,111
v_add_f32 v13, v13, v111
v_mul_f32 v131, v131, v176
v_mul_f32 v132, v132, v176
v_mfma_f32_16x16x32_bf16 v[108:111], v[20:23], v[240:243], 0
v_exp_f32 v81, v81
v_mul_f32 v133, v133, v176
v_mul_f32 v134, v134, v176
v_mfma_f32_16x16x32_bf16 v[100:103], v[20:23], v[224:227], 0
RD 20,14,17408
v_add_f32 v8, v8, v80
v_mul_f32 v135, v135, v176
CV 136,128,129
MA 192,48,120
v_exp_f32 v82, v82
CV 137,130,131
MA 224,48,124
RD 48,14,8192
CV 112,80,81
v_add_f32 v8, v8, v81
CV 138,132,133
CV 139,134,135
MA 228,52,124
v_exp_f32 v83, v83
MA 196,52,120
buffer_store_dwordx4 v[136:139], v184, s[28:31], s4 offen sc1
RD 52,14,9216
v_add_f32 v8, v8, v82
AR 140,8
AR 141,9
AR 142,10
v_mfma_f32_16x16x32_bf16 v[96:99], v[24:27], v[228:231], v[96:99]
v_exp_f32 v84, v84
AR 143,11
v_mfma_f32_16x16x32_bf16 v[104:107], v[24:27], v[244:247], v[104:107]
RD 24,14,18432
CV 113,82,83
v_add_f32 v8, v8, v83
AR 144,12
AR 145,13
v_mfma_f32_16x16x32_bf16 v[108:111], v[28:31], v[244:247], v[108:111]
v_exp_f32 v85, v85
AR 146,14
AR 147,15
v_mfma_f32_16x16x32_bf16 v[100:103], v[28:31], v[228:231], v[100:103]
RD 28,14,19456
v_add_f32 v8, v8, v84
v_mul_f32 v140, v140, v176
v_mul_f32 v141, v141, v176
MA 200,56,120
v_exp_f32 v86, v86
v_mul_f32 v142, v142, v176
v_mul_f32 v143, v143, v176
MA 232,56,124
RD 56,14,10240
CV 114,84,85
v_add_f32 v8, v8, v85
v_mul_f32 v144, v144, v176
MA 236,60,124
v_exp_f32 v87, v87
v_mul_f32 v145, v145, v176
v_mul_f32 v146, v146, v176
MA 204,60,120
RD 60,14,11264
v_add_f32 v8, v8, v86
v_mul_f32 v147, v147, v176
CV 148,140,141
v_mfma_f32_16x16x32_bf16 v[96:99], v[32:35], v[232:235], v[96:99]
v_exp_f32 v88, v88
CV 149,142,143
CV 150,144,145
v_mfma_f32_16x16x32_bf16 v[104:107], v[32:35], v[248:251], v[104:107]
RD 32,14,20480
CV 115,86,87
v_add_f32 v8, v8, v87
CV 151,146,147
v_mfma_f32_16x16x32_bf16 v[108:111], v[36:39], v[248:251], v[108:111]
v_exp_f32 v89, v89
v_mfma_f32_16x16x32_bf16 v[100:103], v[36:39], v[232:235], v[100:103]
buffer_store_dwordx4 v[148:151], v184, s[28:31], s4 offen offset:1024 sc1
RD 36,14,21504
v_add_f32 v9, v9, v88
AR 152,16
AR 153,17
AR 154,18
MA 208,64,120
v_exp_f32 v90, v90
AR 155,19
AR 156,20
MA 240,64,124
RD 64,14,12288
CV 116,88,89
v_add_f32 v9, v9, v89
AR 157,21
AR 158,22
MA 244,68,124
v_exp_f32 v91, v91
AR 159,23
MA 212,68,120
RD 68,14,13312
v_add_f32 v9, v9, v90
v_mul_f32 v152, v152, v176
v_mul_f32 v153, v153, v176
v_mfma_f32_16x16x32_bf16 v[96:99], v[40:43], v[236:239], v[96:99]
v_exp_f32 v92, v92
v_mul_f32 v154, v154, v176
v_mul_f32 v155, v155, v176
v_mfma_f32_16x16x32_bf16 v[104:107], v[40:43], v[252:255], v[104:107]
RD 40,14,22528
CV 117,90,91
v_add_f32 v9, v9, v91
v_mul_f32 v156, v156, v176
v_mul_f32 v157, v157, v176
v_mfma_f32_16x16x32_bf16 v[108:111], v[44:47], v[252:255], v[108:111]
v_exp_f32 v93, v93
v_mul_f32 v158, v158, v176
v_mfma_f32_16x16x32_bf16 v[100:103], v[44:47], v[236:239], v[100:103]
RD 44,14,23552
v_add_f32 v9, v9, v92
v_mul_f32 v159, v159, v176
CV 160,152,153
MA 216,72,120
v_exp_f32 v94, v94
CV 161,154,155
CV 162,156,157
MA 248,72,124
RD 72,14,14336
CV 118,92,93
v_add_f32 v9, v9, v93
CV 163,158,159
MA 252,76,124
buffer_store_dwordx4 v[160:163], v184, s[28:31], s4 offen offset:2048 sc1
v_exp_f32 v95, v95
AR 164,24
MA 220,76,120
RD 76,14,15360
v_add_f32 v9, v9, v94
s_waitcnt vmcnt(16) lgkmcnt(4)
s_barrier
v_mfma_f32_16x16x32_bf16 v[80:83], v[16:19], v[192:195], 0
v_exp_f32 v96, v96
AR 165,25
AR 166,26
v_mfma_f32_16x16x32_bf16 v[88:91], v[16:19], v[208:211], 0
CV 119,94,95
v_add_f32 v9, v9, v95
AR 167,27
AR 168,28
v_mfma_f32_16x16x32_bf16 v[92:95], v[20:23], v[208:211], 0
v_exp_f32 v97, v97
AR 169,29
AR 170,30
v_mfma_f32_16x16x32_bf16 v[84:87], v[20:23], v[192:195], 0
s_add_u32 m0, s36, 32768
s_nop 0
buffer_load_dwordx4 v12, s[24:27], s34 offen sc1 lds
v_add_f32 v10, v10, v96
AR 171,31
v_mul_f32 v164, v164, v176
MA 128,48,112
v_exp_f32 v98, v98
MA 160,48,116
CV 120,96,97
v_add_f32 v10, v10, v97
MA 164,52,116
v_exp_f32 v99, v99
MA 132,52,112
v_add_f32 v10, v10, v98
v_mul_f32 v165, v165, v176
v_mul_f32 v166, v166, v176
v_mul_f32 v167, v167, v176
v_mul_f32 v168, v168, v176
v_mul_f32 v169, v169, v176
v_mul_f32 v170, v170, v176
v_mul_f32 v171, v171, v176
v_mfma_f32_16x16x32_bf16 v[80:83], v[24:27], v[196:199], v[80:83]
v_exp_f32 v100, v100
CV 172,164,165
v_mfma_f32_16x16x32_bf16 v[88:91], v[24:27], v[212:215], v[88:91]
CV 121,98,99
v_add_f32 v10, v10, v99
CV 173,166,167
CV 174,168,169
v_mfma_f32_16x16x32_bf16 v[92:95], v[28:31], v[212:215], v[92:95]
v_exp_f32 v101, v101
CV 175,170,171
v_mfma_f32_16x16x32_bf16 v[84:87], v[28:31], v[196:199], v[84:87]
buffer_store_dwordx4 v[172:175], v184, s[28:31], s4 offen offset:3072 sc1
buffer_load_dwordx4 v12, s[24:27], s34 offen offset:1024 sc1 lds
v_add_f32 v10, v10, v100
s_add_u32 s4, s4, 133248
AR 128,32
MA 136,56,112
v_exp_f32 v102, v102
AR 129,33
AR 130,34
MA 168,56,116
CV 122,100,101
v_add_f32 v10, v10, v101
AR 131,35
MA 172,60,116
v_exp_f32 v103, v103
AR 132,36
AR 133,37
MA 140,60,112
s_waitcnt lgkmcnt(0)
v_add_f32 v10, v10, v102
AR 134,38
AR 135,39
v_mfma_f32_16x16x32_bf16 v[80:83], v[32:35], v[200:203], v[80:83]
v_exp_f32 v104, v104
v_mul_f32 v128, v128, v178
v_mul_f32 v129, v129, v178
v_mfma_f32_16x16x32_bf16 v[88:91], v[32:35], v[216:219], v[88:91]
CV 123,102,103
v_add_f32 v10, v10, v103
v_mul_f32 v130, v130, v178
v_mfma_f32_16x16x32_bf16 v[92:95], v[36:39], v[216:219], v[92:95]
v_exp_f32 v105, v105
v_mul_f32 v131, v131, v178
v_mul_f32 v132, v132, v178
v_mfma_f32_16x16x32_bf16 v[84:87], v[36:39], v[200:203], v[84:87]
buffer_load_dwordx4 v12, s[24:27], s34 offen offset:2048 sc1 lds
v_add_f32 v13, v13, v104
v_mul_f32 v133, v133, v178
v_mul_f32 v134, v134, v178
MA 144,64,112
v_exp_f32 v106, v106
MA 176,64,116
CV 124,104,105
v_add_f32 v13, v13, v105
MA 180,68,116
v_exp_f32 v107, v107
MA 148,68,112
v_add_f32 v13, v13, v106
v_mul_f32 v135, v135, v178
CV 136,128,129
CV 137,130,131
CV 138,132,133
CV 139,134,135
v_mfma_f32_16x16x32_bf16 v[80:83], v[40:43], v[204:207], v[80:83]
buffer_store_dwordx4 v[136:139], v184, s[28:31], s4 offen sc1
v_exp_f32 v108, v108
AR 140,40
AR 141,41
AR 142,42
v_mfma_f32_16x16x32_bf16 v[88:91], v[40:43], v[220:223], v[88:91]
CV 125,106,107
v_add_f32 v13, v13, v107
AR 143,43
AR 144,44
v_mfma_f32_16x16x32_bf16 v[92:95], v[44:47], v[220:223], v[92:95]
v_exp_f32 v109, v109
AR 145,45
v_mfma_f32_16x16x32_bf16 v[84:87], v[44:47], v[204:207], v[84:87]
buffer_load_dwordx4 v12, s[24:27], s34 offen offset:3072 sc1 lds
s_mov_b32 s34, 0x1c000
v_add_f32 v13, v13, v108
AR 146,46
AR 147,47
MA 152,72,112
v_exp_f32 v110, v110
v_mul_f32 v140, v140, v178
v_mul_f32 v141, v141, v178
MA 184,72,116
CV 126,108,109
v_add_f32 v13, v13, v109
v_mul_f32 v142, v142, v178
v_mul_f32 v143, v143, v178
MA 188,76,116
v_exp_f32 v111, v111
v_mul_f32 v144, v144, v178
MA 156,76,112
v_add_f32 v13, v13, v110
v_mfma_f32_16x16x32_bf16 v[96:99], v[16:19], v[224:227], 0
v_exp_f32 v80, v80
v_mul_f32 v145, v145, v178
v_mul_f32 v146, v146, v178
v_mfma_f32_16x16x32_bf16 v[104:107], v[16:19], v[240:243], 0
RD 16,14,32768
CV 127,110,111
v_add_f32 v13, v13, v111
v_mul_f32 v147, v147, v178
CV 148,140,141
v_mfma_f32_16x16x32_bf16 v[108:111], v[20:23], v[240:243], 0
v_exp_f32 v81, v81
CV 149,142,143
CV 150,144,145
v_mfma_f32_16x16x32_bf16 v[100:103], v[20:23], v[224:227], 0
RD 20,14,33792
v_add_f32 v8, v8, v80
CV 151,146,147
MA 192,48,120
buffer_store_dwordx4 v[148:151], v184, s[28:31], s4 offen offset:1024 sc1
v_exp_f32 v82, v82
AR 152,48
MA 224,48,124
RD 48,14,24576
CV 112,80,81
v_add_f32 v8, v8, v81
AR 153,49
AR 154,50
MA 228,52,124
v_exp_f32 v83, v83
AR 155,51
AR 156,52
MA 196,52,120
RD 52,14,25600
v_add_f32 v8, v8, v82
AR 157,53
AR 158,54
v_mfma_f32_16x16x32_bf16 v[96:99], v[24:27], v[228:231], v[96:99]
v_exp_f32 v84, v84
AR 159,55
v_mfma_f32_16x16x32_bf16 v[104:107], v[24:27], v[244:247], v[104:107]
RD 24,14,34816
CV 113,82,83
v_add_f32 v8, v8, v83
v_mul_f32 v152, v152, v178
v_mul_f32 v153, v153, v178
v_mfma_f32_16x16x32_bf16 v[108:111], v[28:31], v[244:247], v[108:111]
v_exp_f32 v85, v85
v_mul_f32 v154, v154, v178
v_mul_f32 v155, v155, v178
v_mfma_f32_16x16x32_bf16 v[100:103], v[28:31], v[228:231], v[100:103]
RD 28,14,35840
v_add_f32 v8, v8, v84
v_mul_f32 v156, v156, v178
v_mul_f32 v157, v157, v178
MA 200,56,120
v_exp_f32 v86, v86
v_mul_f32 v158, v158, v178
v_mul_f32 v159, v159, v178
MA 232,56,124
RD 56,14,26624
CV 114,84,85
v_add_f32 v8, v8, v85
CV 160,152,153
MA 236,60,124
v_exp_f32 v87, v87
CV 161,154,155
CV 162,156,157
MA 204,60,120
RD 60,14,27648
v_add_f32 v8, v8, v86
CV 163,158,159
v_mfma_f32_16x16x32_bf16 v[96:99], v[32:35], v[232:235], v[96:99]
buffer_store_dwordx4 v[160:163], v184, s[28:31], s4 offen offset:2048 sc1
v_exp_f32 v88, v88
AR 164,56
AR 165,57
v_mfma_f32_16x16x32_bf16 v[104:107], v[32:35], v[248:251], v[104:107]
RD 32,14,36864
CV 115,86,87
v_add_f32 v8, v8, v87
AR 166,58
v_mfma_f32_16x16x32_bf16 v[108:111], v[36:39], v[248:251], v[108:111]
v_exp_f32 v89, v89
AR 167,59
AR 168,60
v_mfma_f32_16x16x32_bf16 v[100:103], v[36:39], v[232:235], v[100:103]
RD 36,14,37888
v_add_f32 v9, v9, v88
AR 169,61
AR 170,62
MA 208,64,120
v_exp_f32 v90, v90
AR 171,63
v_mul_f32 v164, v164, v178
MA 240,64,124
RD 64,14,28672
CV 116,88,89
v_add_f32 v9, v9, v89
v_mul_f32 v165, v165, v178
v_mul_f32 v166, v166, v178
MA 244,68,124
v_exp_f32 v91, v91
v_mul_f32 v167, v167, v178
MA 212,68,120
RD 68,14,29696
v_add_f32 v9, v9, v90
v_mul_f32 v168, v168, v178
v_mul_f32 v169, v169, v178
v_mfma_f32_16x16x32_bf16 v[96:99], v[40:43], v[236:239], v[96:99]
v_exp_f32 v92, v92
v_mul_f32 v170, v170, v178
v_mul_f32 v171, v171, v178
v_mfma_f32_16x16x32_bf16 v[104:107], v[40:43], v[252:255], v[104:107]
RD 40,14,38912
CV 117,90,91
v_add_f32 v9, v9, v91
CV 172,164,165
CV 173,166,167
v_mfma_f32_16x16x32_bf16 v[108:111], v[44:47], v[252:255], v[108:111]
v_exp_f32 v93, v93
CV 174,168,169
v_mfma_f32_16x16x32_bf16 v[100:103], v[44:47], v[236:239], v[100:103]
RD 44,14,39936
v_add_f32 v9, v9, v92
CV 175,170,171
MA 216,72,120
buffer_store_dwordx4 v[172:175], v184, s[28:31], s4 offen offset:3072 sc1
v_exp_f32 v94, v94
s_add_u32 s4, s4, 133248
AR 128,64
MA 248,72,124
RD 72,14,30720
CV 118,92,93
v_add_f32 v9, v9, v93
AR 129,65
AR 130,66
MA 252,76,124
v_exp_f32 v95, v95
AR 131,67
MA 220,76,120
RD 76,14,31744
v_add_f32 v9, v9, v94
s_waitcnt lgkmcnt(4)
v_mfma_f32_16x16x32_bf16 v[80:83], v[16:19], v[192:195], 0
v_exp_f32 v96, v96
AR 132,68
AR 133,69
v_mfma_f32_16x16x32_bf16 v[88:91], v[16:19], v[208:211], 0
CV 119,94,95
v_add_f32 v9, v9, v95
AR 134,70
AR 135,71
v_mfma_f32_16x16x32_bf16 v[92:95], v[20:23], v[208:211], 0
v_exp_f32 v97, v97
v_mul_f32 v128, v128, v180
v_mul_f32 v129, v129, v180
v_mfma_f32_16x16x32_bf16 v[84:87], v[20:23], v[192:195], 0
s_add_u32 m0, s36, 49152
s_nop 0
buffer_load_dwordx4 v12, s[24:27], s34 offen sc1 lds
v_add_f32 v10, v10, v96
v_mul_f32 v130, v130, v180
v_mul_f32 v131, v131, v180
MA 128,48,112
v_exp_f32 v98, v98
MA 160,48,116
CV 120,96,97
v_add_f32 v10, v10, v97
s_getpc_b64 s[62:63]
L_ct6:
MA 164,52,116
v_exp_f32 v99, v99
MA 132,52,112
v_add_f32 v10, v10, v98
v_mul_f32 v132, v132, v180
v_mul_f32 v133, v133, v180
v_mul_f32 v134, v134, v180
v_mul_f32 v135, v135, v180
CV 136,128,129
CV 137,130,131
CV 138,132,133
v_mfma_f32_16x16x32_bf16 v[80:83], v[24:27], v[196:199], v[80:83]
v_exp_f32 v100, v100
CV 139,134,135
v_mfma_f32_16x16x32_bf16 v[88:91], v[24:27], v[212:215], v[88:91]
CV 121,98,99
v_add_f32 v10, v10, v99
v_lshlrev_b32 v0, 7, v1
v_mfma_f32_16x16x32_bf16 v[92:95], v[28:31], v[212:215], v[92:95]
buffer_store_dwordx4 v[136:139], v184, s[28:31], s4 offen sc1
v_exp_f32 v101, v101
AR 140,72
AR 141,73
AR 142,74
v_mfma_f32_16x16x32_bf16 v[84:87], v[28:31], v[196:199], v[84:87]
buffer_load_dwordx4 v12, s[24:27], s34 offen offset:1024 sc1 lds
v_add_f32 v10, v10, v100
AR 143,75
AR 144,76
MA 136,56,112
v_exp_f32 v102, v102
AR 145,77
AR 146,78
MA 168,56,116
CV 122,100,101
v_add_f32 v10, v10, v101
v_add_u32 v0, 2048, v0
AR 147,79
MA 172,60,116
v_exp_f32 v103, v103
v_mul_f32 v140, v140, v180
v_mul_f32 v141, v141, v180
MA 140,60,112
s_waitcnt lgkmcnt(0)
v_add_f32 v10, v10, v102
v_mul_f32 v142, v142, v180
v_mul_f32 v143, v143, v180
v_mfma_f32_16x16x32_bf16 v[80:83], v[32:35], v[200:203], v[80:83]
v_exp_f32 v104, v104
v_mul_f32 v144, v144, v180
v_mul_f32 v145, v145, v180
v_mfma_f32_16x16x32_bf16 v[88:91], v[32:35], v[216:219], v[88:91]
CV 123,102,103
v_add_f32 v10, v10, v103
v_min_u32 v0, L_code_end-L_ct6-4, v0
v_mul_f32 v146, v146, v180
v_mfma_f32_16x16x32_bf16 v[92:95], v[36:39], v[216:219], v[92:95]
v_exp_f32 v105, v105
v_mul_f32 v147, v147, v180
CV 148,140,141
v_mfma_f32_16x16x32_bf16 v[84:87], v[36:39], v[200:203], v[84:87]
buffer_load_dwordx4 v12, s[24:27], s34 offen offset:2048 sc1 lds
v_add_f32 v13, v13, v104
CV 149,142,143
CV 150,144,145
MA 144,64,112
v_exp_f32 v106, v106
MA 176,64,116
global_load_dword v3, v0, s[62:63]
CV 124,104,105
v_add_f32 v13, v13, v105
MA 180,68,116
v_exp_f32 v107, v107
MA 148,68,112
v_add_f32 v13, v13, v106
CV 151,146,147
v_mfma_f32_16x16x32_bf16 v[80:83], v[40:43], v[204:207], v[80:83]
buffer_store_dwordx4 v[148:151], v184, s[28:31], s4 offen offset:1024 sc1
v_exp_f32 v108, v108
AR 152,80
AR 153,81
AR 154,82
AR 155,83
AR 156,84
AR 157,85
AR 158,86
v_mfma_f32_16x16x32_bf16 v[88:91], v[40:43], v[220:223], v[88:91]
CV 125,106,107
v_add_f32 v13, v13, v107
AR 159,87
v_mul_f32 v152, v152, v180
v_mfma_f32_16x16x32_bf16 v[92:95], v[44:47], v[220:223], v[92:95]
v_exp_f32 v109, v109
v_mul_f32 v153, v153, v180
v_mfma_f32_16x16x32_bf16 v[84:87], v[44:47], v[204:207], v[84:87]
buffer_load_dwordx4 v12, s[24:27], s34 offen offset:3072 sc1 lds
s_mov_b32 s34, 0x20000
v_add_f32 v13, v13, v108
v_mul_f32 v154, v154, v180
v_mul_f32 v155, v155, v180
MA 152,72,112
v_exp_f32 v110, v110
v_mul_f32 v156, v156, v180
v_mul_f32 v157, v157, v180
MA 184,72,116
CV 126,108,109
v_add_f32 v13, v13, v109
v_mul_f32 v158, v158, v180
v_mul_f32 v159, v159, v180
MA 188,76,116
v_exp_f32 v111, v111
CV 160,152,153
MA 156,76,112
buffer_load_dword v3, v15, s[96:99], s39 offen
s_add_u32 s39, s39, 1792
v_add_f32 v13, v13, v110
v_mfma_f32_16x16x32_bf16 v[96:99], v[16:19], v[224:227], 0
v_exp_f32 v80, v80
CV 161,154,155
CV 162,156,157
v_mfma_f32_16x16x32_bf16 v[104:107], v[16:19], v[240:243], 0
RD 16,14,49152
CV 127,110,111
v_add_f32 v13, v13, v111
CV 163,158,159
v_mfma_f32_16x16x32_bf16 v[108:111], v[20:23], v[240:243], 0
buffer_store_dwordx4 v[160:163], v184, s[28:31], s4 offen offset:2048 sc1
v_exp_f32 v81, v81
AR 164,88
AR 165,89
v_mfma_f32_16x16x32_bf16 v[100:103], v[20:23], v[224:227], 0
RD 20,14,50176
v_add_f32 v8, v8, v80
AR 166,90
AR 167,91
MA 192,48,120
v_exp_f32 v82, v82
AR 168,92
MA 224,48,124
RD 48,14,40960
CV 112,80,81
v_add_f32 v8, v8, v81
AR 169,93
AR 170,94
MA 228,52,124
v_exp_f32 v83, v83
AR 171,95
v_mul_f32 v164, v164, v180
MA 196,52,120
RD 52,14,41984
v_add_f32 v8, v8, v82
v_mul_f32 v165, v165, v180
v_mul_f32 v166, v166, v180
v_mfma_f32_16x16x32_bf16 v[96:99], v[24:27], v[228:231], v[96:99]
v_exp_f32 v84, v84
v_mul_f32 v167, v167, v180
v_mfma_f32_16x16x32_bf16 v[104:107], v[24:27], v[244:247], v[104:107]
RD 24,14,51200
CV 113,82,83
v_add_f32 v8, v8, v83
v_mul_f32 v168, v168, v180
v_mul_f32 v169, v169, v180
v_mfma_f32_16x16x32_bf16 v[108:111], v[28:31], v[244:247], v[108:111]
v_exp_f32 v85, v85
v_mul_f32 v170, v170, v180
v_mul_f32 v171, v171, v180
v_mfma_f32_16x16x32_bf16 v[100:103], v[28:31], v[228:231], v[100:103]
RD 28,14,52224
v_add_f32 v8, v8, v84
CV 172,164,165
CV 173,166,167
MA 200,56,120
v_exp_f32 v86, v86
CV 174,168,169
CV 175,170,171
MA 232,56,124
RD 56,14,43008
CV 114,84,85
v_add_f32 v8, v8, v85
MA 236,60,124
buffer_store_dwordx4 v[172:175], v184, s[28:31], s4 offen offset:3072 sc1
v_exp_f32 v87, v87
s_add_u32 s4, s4, 133248
AR 128,96
MA 204,60,120
RD 60,14,44032
v_add_f32 v8, v8, v86
AR 129,97
AR 130,98
v_mfma_f32_16x16x32_bf16 v[96:99], v[32:35], v[232:235], v[96:99]
v_exp_f32 v88, v88
AR 131,99
AR 132,100
v_mfma_f32_16x16x32_bf16 v[104:107], v[32:35], v[248:251], v[104:107]
RD 32,14,53248
CV 115,86,87
v_add_f32 v8, v8, v87
AR 133,101
v_mfma_f32_16x16x32_bf16 v[108:111], v[36:39], v[248:251], v[108:111]
v_exp_f32 v89, v89
AR 134,102
AR 135,103
v_mfma_f32_16x16x32_bf16 v[100:103], v[36:39], v[232:235], v[100:103]
RD 36,14,54272
v_add_f32 v9, v9, v88
v_mul_f32 v128, v128, v182
v_mul_f32 v129, v129, v182
MA 208,64,120
v_exp_f32 v90, v90
v_mul_f32 v130, v130, v182
v_mul_f32 v131, v131, v182
MA 240,64,124
RD 64,14,45056
CV 116,88,89
v_add_f32 v9, v9, v89
v_mul_f32 v132, v132, v182
v_mul_f32 v133, v133, v182
MA 244,68,124
v_exp_f32 v91, v91
v_mul_f32 v134, v134, v182
MA 212,68,120
RD 68,14,46080
v_add_f32 v9, v9, v90
v_mul_f32 v135, v135, v182
CV 136,128,129
v_mfma_f32_16x16x32_bf16 v[96:99], v[40:43], v[236:239], v[96:99]
v_exp_f32 v92, v92
CV 137,130,131
CV 138,132,133
v_mfma_f32_16x16x32_bf16 v[104:107], v[40:43], v[252:255], v[104:107]
RD 40,14,55296
CV 117,90,91
v_add_f32 v9, v9, v91
CV 139,134,135
v_mfma_f32_16x16x32_bf16 v[108:111], v[44:47], v[252:255], v[108:111]
buffer_store_dwordx4 v[136:139], v184, s[28:31], s4 offen sc1
v_exp_f32 v93, v93
AR 140,104
v_mfma_f32_16x16x32_bf16 v[100:103], v[44:47], v[236:239], v[100:103]
RD 44,14,56320
v_add_f32 v9, v9, v92
AR 141,105
AR 142,106
MA 216,72,120
v_exp_f32 v94, v94
AR 143,107
AR 144,108
MA 248,72,124
RD 72,14,47104
CV 118,92,93
v_add_f32 v9, v9, v93
AR 145,109
AR 146,110
MA 252,76,124
v_exp_f32 v95, v95
AR 147,111
MA 220,76,120
RD 76,14,48128
v_add_f32 v9, v9, v94
s_waitcnt vmcnt(25) lgkmcnt(4)
s_barrier
v_mfma_f32_16x16x32_bf16 v[80:83], v[16:19], v[192:195], 0
v_exp_f32 v96, v96
v_mfma_f32_16x16x32_bf16 v[88:91], v[16:19], v[208:211], 0
CV 119,94,95
v_add_f32 v9, v9, v95
v_mfma_f32_16x16x32_bf16 v[92:95], v[20:23], v[208:211], 0
v_exp_f32 v97, v97
v_mfma_f32_16x16x32_bf16 v[84:87], v[20:23], v[192:195], 0
v_add_f32 v10, v10, v96
v_mul_f32 v140, v140, v182
v_mul_f32 v141, v141, v182
v_mul_f32 v142, v142, v182
v_mul_f32 v143, v143, v182
v_mul_f32 v144, v144, v182
v_mul_f32 v145, v145, v182
v_mul_f32 v146, v146, v182
v_mul_f32 v147, v147, v182
MA 128,48,112
v_exp_f32 v98, v98
MA 160,48,116
CV 120,96,97
v_add_f32 v10, v10, v97
MA 164,52,116
v_exp_f32 v99, v99
MA 132,52,112
v_add_f32 v10, v10, v98
CV 148,140,141
CV 149,142,143
CV 150,144,145
CV 151,146,147
v_mfma_f32_16x16x32_bf16 v[80:83], v[24:27], v[196:199], v[80:83]
buffer_store_dwordx4 v[148:151], v184, s[28:31], s4 offen offset:1024 sc1
v_exp_f32 v100, v100
v_mfma_f32_16x16x32_bf16 v[88:91], v[24:27], v[212:215], v[88:91]
CV 121,98,99
v_add_f32 v10, v10, v99
v_mfma_f32_16x16x32_bf16 v[92:95], v[28:31], v[212:215], v[92:95]
v_exp_f32 v101, v101
v_mfma_f32_16x16x32_bf16 v[84:87], v[28:31], v[196:199], v[84:87]
v_add_f32 v10, v10, v100
AR 152,112
AR 153,113
AR 154,114
AR 155,115
AR 156,116
AR 157,117
AR 158,118
AR 159,119
v_mul_f32 v152, v152, v182
MA 136,56,112
v_exp_f32 v102, v102
v_mul_f32 v153, v153, v182
v_mul_f32 v154, v154, v182
MA 168,56,116
CV 122,100,101
v_add_f32 v10, v10, v101
v_mul_f32 v155, v155, v182
MA 172,60,116
v_exp_f32 v103, v103
v_mul_f32 v156, v156, v182
v_mul_f32 v157, v157, v182
MA 140,60,112
s_waitcnt lgkmcnt(0)
v_add_f32 v10, v10, v102
v_mul_f32 v158, v158, v182
v_mul_f32 v159, v159, v182
v_mfma_f32_16x16x32_bf16 v[80:83], v[32:35], v[200:203], v[80:83]
v_exp_f32 v104, v104
v_mfma_f32_16x16x32_bf16 v[88:91], v[32:35], v[216:219], v[88:91]
CV 123,102,103
v_add_f32 v10, v10, v103
v_mfma_f32_16x16x32_bf16 v[92:95], v[36:39], v[216:219], v[92:95]
v_exp_f32 v105, v105
v_mfma_f32_16x16x32_bf16 v[84:87], v[36:39], v[200:203], v[84:87]
v_add_f32 v13, v13, v104
CV 160,152,153
CV 161,154,155
CV 162,156,157
CV 163,158,159
MA 144,64,112
buffer_store_dwordx4 v[160:163], v184, s[28:31], s4 offen offset:2048 sc1
v_exp_f32 v106, v106
MA 176,64,116
CV 124,104,105
v_add_f32 v13, v13, v105
MA 180,68,116
v_exp_f32 v107, v107
MA 148,68,112
v_add_f32 v13, v13, v106
AR 164,120
AR 165,121
AR 166,122
AR 167,123
AR 168,124
AR 169,125
AR 170,126
AR 171,127
v_mul_f32 v164, v164, v182
v_mfma_f32_16x16x32_bf16 v[80:83], v[40:43], v[204:207], v[80:83]
v_exp_f32 v108, v108
v_mfma_f32_16x16x32_bf16 v[88:91], v[40:43], v[220:223], v[88:91]
CV 125,106,107
v_add_f32 v13, v13, v107
v_mfma_f32_16x16x32_bf16 v[92:95], v[44:47], v[220:223], v[92:95]
v_exp_f32 v109, v109
v_mfma_f32_16x16x32_bf16 v[84:87], v[44:47], v[204:207], v[84:87]
v_add_f32 v13, v13, v108
v_mul_f32 v165, v165, v182
v_mul_f32 v166, v166, v182
v_mul_f32 v167, v167, v182
v_mul_f32 v168, v168, v182
v_mul_f32 v169, v169, v182
v_mul_f32 v170, v170, v182
v_mul_f32 v171, v171, v182
MA 152,72,112
v_exp_f32 v110, v110
CV 172,164,165
CV 173,166,167
MA 184,72,116
CV 126,108,109
v_add_f32 v13, v13, v109
CV 174,168,169
CV 175,170,171
MA 188,76,116
buffer_store_dwordx4 v[172:175], v184, s[28:31], s4 offen offset:3072 sc1
v_exp_f32 v111, v111
MA 156,76,112
v_add_f32 v13, v13, v110
v_mfma_f32_16x16x32_bf16 v[96:99], v[16:19], v[224:227], 0
v_exp_f32 v80, v80
v_mfma_f32_16x16x32_bf16 v[104:107], v[16:19], v[240:243], 0
RD 16,11,0
CV 127,110,111
v_add_f32 v13, v13, v111
v_mfma_f32_16x16x32_bf16 v[108:111], v[20:23], v[240:243], 0
v_exp_f32 v81, v81
v_mfma_f32_16x16x32_bf16 v[100:103], v[20:23], v[224:227], 0
RD 20,11,1024
v_add_f32 v8, v8, v80
MA 192,48,120
v_exp_f32 v82, v82
MA 224,48,124
RD 48,14,57344
CV 112,80,81
v_add_f32 v8, v8, v81
MA 228,52,124
v_exp_f32 v83, v83
MA 196,52,120
RD 52,14,58368
v_add_f32 v8, v8, v82
v_mfma_f32_16x16x32_bf16 v[96:99], v[24:27], v[228:231], v[96:99]
v_exp_f32 v84, v84
v_mfma_f32_16x16x32_bf16 v[104:107], v[24:27], v[244:247], v[104:107]
RD 24,11,2048
CV 113,82,83
v_add_f32 v8, v8, v83
v_mfma_f32_16x16x32_bf16 v[108:111], v[28:31], v[244:247], v[108:111]
v_exp_f32 v85, v85
v_mfma_f32_16x16x32_bf16 v[100:103], v[28:31], v[228:231], v[100:103]
RD 28,11,3072
v_add_f32 v8, v8, v84
MA 200,56,120
v_exp_f32 v86, v86
MA 232,56,124
RD 56,14,59392
CV 114,84,85
v_add_f32 v8, v8, v85
MA 236,60,124
v_exp_f32 v87, v87
MA 204,60,120
RD 60,14,60416
v_add_f32 v8, v8, v86
v_mfma_f32_16x16x32_bf16 v[96:99], v[32:35], v[232:235], v[96:99]
v_exp_f32 v88, v88
v_mfma_f32_16x16x32_bf16 v[104:107], v[32:35], v[248:251], v[104:107]
RD 32,11,4096
CV 115,86,87
v_add_f32 v8, v8, v87
v_mfma_f32_16x16x32_bf16 v[108:111], v[36:39], v[248:251], v[108:111]
v_exp_f32 v89, v89
v_mfma_f32_16x16x32_bf16 v[100:103], v[36:39], v[232:235], v[100:103]
RD 36,11,5120
v_add_f32 v9, v9, v88
MA 208,64,120
v_exp_f32 v90, v90
MA 240,64,124
RD 64,14,61440
CV 116,88,89
v_add_f32 v9, v9, v89
MA 244,68,124
v_exp_f32 v91, v91
MA 212,68,120
RD 68,14,62464
v_add_f32 v9, v9, v90
v_mfma_f32_16x16x32_bf16 v[96:99], v[40:43], v[236:239], v[96:99]
v_exp_f32 v92, v92
v_mfma_f32_16x16x32_bf16 v[104:107], v[40:43], v[252:255], v[104:107]
RD 40,11,6144
CV 117,90,91
v_add_f32 v9, v9, v91
v_mfma_f32_16x16x32_bf16 v[108:111], v[44:47], v[252:255], v[108:111]
v_exp_f32 v93, v93
v_mfma_f32_16x16x32_bf16 v[100:103], v[44:47], v[236:239], v[100:103]
RD 44,11,7168
v_add_f32 v9, v9, v92
MA 216,72,120
v_exp_f32 v94, v94
MA 248,72,124
RD 72,14,63488
CV 118,92,93
v_add_f32 v9, v9, v93
MA 252,76,124
v_exp_f32 v95, v95
MA 220,76,120
RD 76,14,64512
v_add_f32 v9, v9, v94
s_waitcnt lgkmcnt(4)
s_waitcnt vmcnt(0)
s_cmp_lg_u32 s58, 0
s_cselect_b32 s3, 598080, s5
v_mov_b32 v2, s100
s_mov_b64 exec, 1
buffer_store_dword v2, off, s[48:51], s3 sc1
s_mov_b64 exec, -1
v_mfma_f32_16x16x32_bf16 v[80:83], v[16:19], v[192:195], 0
v_exp_f32 v96, v96
v_mfma_f32_16x16x32_bf16 v[88:91], v[16:19], v[208:211], 0
CV 119,94,95
v_add_f32 v9, v9, v95
v_mfma_f32_16x16x32_bf16 v[92:95], v[20:23], v[208:211], 0
v_exp_f32 v97, v97
v_mfma_f32_16x16x32_bf16 v[84:87], v[20:23], v[192:195], 0
v_add_f32 v10, v10, v96
MA 128,48,112
v_exp_f32 v98, v98
MA 160,48,116
CV 120,96,97
v_add_f32 v10, v10, v97
MA 164,52,116
v_exp_f32 v99, v99
MA 132,52,112
v_add_f32 v10, v10, v98
v_mfma_f32_16x16x32_bf16 v[80:83], v[24:27], v[196:199], v[80:83]
v_exp_f32 v100, v100
v_mfma_f32_16x16x32_bf16 v[88:91], v[24:27], v[212:215], v[88:91]
CV 121,98,99
v_add_f32 v10, v10, v99
v_mfma_f32_16x16x32_bf16 v[92:95], v[28:31], v[212:215], v[92:95]
v_exp_f32 v101, v101
v_mfma_f32_16x16x32_bf16 v[84:87], v[28:31], v[196:199], v[84:87]
v_add_f32 v10, v10, v100
MA 136,56,112
v_exp_f32 v102, v102
MA 168,56,116
CV 122,100,101
v_add_f32 v10, v10, v101
MA 172,60,116
v_exp_f32 v103, v103
MA 140,60,112
s_waitcnt lgkmcnt(0)
v_add_f32 v10, v10, v102
v_mfma_f32_16x16x32_bf16 v[80:83], v[32:35], v[200:203], v[80:83]
v_exp_f32 v104, v104
v_mfma_f32_16x16x32_bf16 v[88:91], v[32:35], v[216:219], v[88:91]
CV 123,102,103
v_add_f32 v10, v10, v103
v_mfma_f32_16x16x32_bf16 v[92:95], v[36:39], v[216:219], v[92:95]
v_exp_f32 v105, v105
v_mfma_f32_16x16x32_bf16 v[84:87], v[36:39], v[200:203], v[84:87]
v_add_f32 v13, v13, v104
MA 144,64,112
v_exp_f32 v106, v106
MA 176,64,116
CV 124,104,105
v_add_f32 v13, v13, v105
MA 180,68,116
v_exp_f32 v107, v107
MA 148,68,112
v_add_f32 v13, v13, v106
v_mfma_f32_16x16x32_bf16 v[80:83], v[40:43], v[204:207], v[80:83]
v_exp_f32 v108, v108
v_mfma_f32_16x16x32_bf16 v[88:91], v[40:43], v[220:223], v[88:91]
CV 125,106,107
v_add_f32 v13, v13, v107
v_mfma_f32_16x16x32_bf16 v[92:95], v[44:47], v[220:223], v[92:95]
v_exp_f32 v109, v109
v_mfma_f32_16x16x32_bf16 v[84:87], v[44:47], v[204:207], v[84:87]
v_add_f32 v13, v13, v108
MA 152,72,112
v_exp_f32 v110, v110
MA 184,72,116
CV 126,108,109
v_add_f32 v13, v13, v109
MA 188,76,116
v_exp_f32 v111, v111
MA 156,76,112
buffer_load_dword v3, v15, s[96:99], s39 offen
s_add_u32 s39, s39, 1792
v_add_f32 v13, v13, v110
v_mfma_f32_16x16x32_bf16 v[96:99], v[16:19], v[224:227], 0
v_exp_f32 v80, v80
v_mfma_f32_16x16x32_bf16 v[104:107], v[16:19], v[240:243], 0
RD 16,11,16384
CV 127,110,111
v_add_f32 v13, v13, v111
v_mfma_f32_16x16x32_bf16 v[108:111], v[20:23], v[240:243], 0
v_exp_f32 v81, v81
v_mfma_f32_16x16x32_bf16 v[100:103], v[20:23], v[224:227], 0
RD 20,11,17408
v_add_f32 v8, v8, v80
MA 192,48,120
v_exp_f32 v82, v82
MA 224,48,124
RD 48,11,8192
CV 112,80,81
v_add_f32 v8, v8, v81
MA 228,52,124
v_exp_f32 v83, v83
MA 196,52,120
RD 52,11,9216
v_add_f32 v8, v8, v82
v_mfma_f32_16x16x32_bf16 v[96:99], v[24:27], v[228:231], v[96:99]
v_exp_f32 v84, v84
v_mfma_f32_16x16x32_bf16 v[104:107], v[24:27], v[244:247], v[104:107]
RD 24,11,18432
CV 113,82,83
v_add_f32 v8, v8, v83
v_mfma_f32_16x16x32_bf16 v[108:111], v[28:31], v[244:247], v[108:111]
v_exp_f32 v85, v85
v_mfma_f32_16x16x32_bf16 v[100:103], v[28:31], v[228:231], v[100:103]
RD 28,11,19456
v_add_f32 v8, v8, v84
MA 200,56,120
v_exp_f32 v86, v86
MA 232,56,124
RD 56,11,10240
CV 114,84,85
v_add_f32 v8, v8, v85
MA 236,60,124
v_exp_f32 v87, v87
MA 204,60,120
RD 60,11,11264
v_add_f32 v8, v8, v86
v_mfma_f32_16x16x32_bf16 v[96:99], v[32:35], v[232:235], v[96:99]
v_exp_f32 v88, v88
v_mfma_f32_16x16x32_bf16 v[104:107], v[32:35], v[248:251], v[104:107]
RD 32,11,20480
CV 115,86,87
v_add_f32 v8, v8, v87
v_mfma_f32_16x16x32_bf16 v[108:111], v[36:39], v[248:251], v[108:111]
v_exp_f32 v89, v89
v_mfma_f32_16x16x32_bf16 v[100:103], v[36:39], v[232:235], v[100:103]
RD 36,11,21504
v_add_f32 v9, v9, v88
MA 208,64,120
v_exp_f32 v90, v90
MA 240,64,124
RD 64,11,12288
CV 116,88,89
v_add_f32 v9, v9, v89
MA 244,68,124
v_exp_f32 v91, v91
MA 212,68,120
RD 68,11,13312
v_add_f32 v9, v9, v90
v_mfma_f32_16x16x32_bf16 v[96:99], v[40:43], v[236:239], v[96:99]
v_exp_f32 v92, v92
v_mfma_f32_16x16x32_bf16 v[104:107], v[40:43], v[252:255], v[104:107]
RD 40,11,22528
CV 117,90,91
v_add_f32 v9, v9, v91
v_mfma_f32_16x16x32_bf16 v[108:111], v[44:47], v[252:255], v[108:111]
v_exp_f32 v93, v93
v_mfma_f32_16x16x32_bf16 v[100:103], v[44:47], v[236:239], v[100:103]
RD 44,11,23552
v_add_f32 v9, v9, v92
MA 216,72,120
v_exp_f32 v94, v94
MA 248,72,124
RD 72,11,14336
CV 118,92,93
v_add_f32 v9, v9, v93
MA 252,76,124
v_exp_f32 v95, v95
MA 220,76,120
RD 76,11,15360
v_add_f32 v9, v9, v94
s_waitcnt vmcnt(9) lgkmcnt(4)
s_barrier
v_mfma_f32_16x16x32_bf16 v[80:83], v[16:19], v[192:195], 0
v_exp_f32 v96, v96
v_mfma_f32_16x16x32_bf16 v[88:91], v[16:19], v[208:211], 0
CV 119,94,95
v_add_f32 v9, v9, v95
v_mfma_f32_16x16x32_bf16 v[92:95], v[20:23], v[208:211], 0
v_exp_f32 v97, v97
v_mfma_f32_16x16x32_bf16 v[84:87], v[20:23], v[192:195], 0
v_add_f32 v10, v10, v96
s_bfe_u32 s52, s11, 0x10001
MA 128,48,112
v_exp_f32 v98, v98
MA 160,48,116
CV 120,96,97
v_add_f32 v10, v10, v97
MA 164,52,116
v_exp_f32 v99, v99
MA 132,52,112
v_add_f32 v10, v10, v98
s_lshl_b32 s52, s52, 2
s_and_b32 s15, s12, 3
s_add_u32 s52, s52, s15
s_lshr_b32 s53, s11, 2
v_mfma_f32_16x16x32_bf16 v[80:83], v[24:27], v[196:199], v[80:83]
v_exp_f32 v100, v100
v_mfma_f32_16x16x32_bf16 v[88:91], v[24:27], v[212:215], v[88:91]
CV 121,98,99
v_add_f32 v10, v10, v99
v_mfma_f32_16x16x32_bf16 v[92:95], v[28:31], v[212:215], v[92:95]
v_exp_f32 v101, v101
v_mfma_f32_16x16x32_bf16 v[84:87], v[28:31], v[196:199], v[84:87]
v_add_f32 v10, v10, v100
s_lshl_b32 s53, s53, 2
s_bfe_u32 s15, s12, 0x20002
s_add_u32 s53, s53, s15
MA 136,56,112
v_exp_f32 v102, v102
s_and_b32 s11, s11, 1
MA 168,56,116
CV 122,100,101
v_add_f32 v10, v10, v101
s_lshl_b32 s15, s53, 8
MA 172,60,116
v_exp_f32 v103, v103
s_and_b32 s38, s10, 1
MA 140,60,112
s_waitcnt lgkmcnt(0)
v_add_f32 v10, v10, v102
s_lshl_b32 s38, s38, 12
v_mfma_f32_16x16x32_bf16 v[80:83], v[32:35], v[200:203], v[80:83]
v_exp_f32 v104, v104
v_mfma_f32_16x16x32_bf16 v[88:91], v[32:35], v[216:219], v[88:91]
CV 123,102,103
v_add_f32 v10, v10, v103
v_mfma_f32_16x16x32_bf16 v[92:95], v[36:39], v[216:219], v[92:95]
v_exp_f32 v105, v105
v_mfma_f32_16x16x32_bf16 v[84:87], v[36:39], v[200:203], v[84:87]
v_add_f32 v13, v13, v104
s_add_u32 s15, s15, s38
v_and_b32 v12, 15, v1
v_lshlrev_b32 v12, 4, v12
MA 144,64,112
v_exp_f32 v106, v106
MA 176,64,116
CV 124,104,105
v_add_f32 v13, v13, v105
MA 180,68,116
v_exp_f32 v107, v107
MA 148,68,112
v_add_f32 v13, v13, v106
v_add_u32 v12, s15, v12
v_lshrrev_b32 v132, 5, v1
v_bfe_u32 v2, v1, 4, 1
v_mfma_f32_16x16x32_bf16 v[80:83], v[40:43], v[204:207], v[80:83]
v_exp_f32 v108, v108
v_mfma_f32_16x16x32_bf16 v[88:91], v[40:43], v[220:223], v[88:91]
CV 125,106,107
v_add_f32 v13, v13, v107
v_mfma_f32_16x16x32_bf16 v[92:95], v[44:47], v[220:223], v[92:95]
v_exp_f32 v109, v109
v_mfma_f32_16x16x32_bf16 v[84:87], v[44:47], v[204:207], v[84:87]
v_add_f32 v13, v13, v108
s_lshr_b32 s38, s10, 1
s_lshl_b32 s15, s38, 13
v_lshl_add_u32 v128, v132, 14, v12
v_lshl_add_u32 v128, v2, 15, v128
MA 152,72,112
v_exp_f32 v110, v110
v_add_u32 v128, s15, v128
MA 184,72,116
CV 126,108,109
v_add_f32 v13, v13, v109
v_add_u32 v129, 992, v128
MA 188,76,116
v_exp_f32 v111, v111
MA 156,76,112
v_add_f32 v13, v13, v110
v_mfma_f32_16x16x32_bf16 v[96:99], v[16:19], v[224:227], 0
v_exp_f32 v80, v80
s_mul_i32 s32, s11, 3145728
v_mfma_f32_16x16x32_bf16 v[104:107], v[16:19], v[240:243], 0
RD 16,11,32768
CV 127,110,111
v_add_f32 v13, v13, v111
v_mfma_f32_16x16x32_bf16 v[108:111], v[20:23], v[240:243], 0
v_exp_f32 v81, v81
s_mov_b32 s16, s6
v_mfma_f32_16x16x32_bf16 v[100:103], v[20:23], v[224:227], 0
RD 20,11,33792
v_add_f32 v8, v8, v80
MA 192,48,120
v_exp_f32 v82, v82
MA 224,48,124
RD 48,11,24576
CV 112,80,81
v_add_f32 v8, v8, v81
s_mov_b32 s17, s7
MA 228,52,124
v_exp_f32 v83, v83
MA 196,52,120
RD 52,11,25600
v_add_f32 v8, v8, v82
s_mov_b32 s18, 0x800000
v_mfma_f32_16x16x32_bf16 v[96:99], v[24:27], v[228:231], v[96:99]
v_exp_f32 v84, v84
v_mfma_f32_16x16x32_bf16 v[104:107], v[24:27], v[244:247], v[104:107]
RD 24,11,34816
CV 113,82,83
v_add_f32 v8, v8, v83
v_mfma_f32_16x16x32_bf16 v[108:111], v[28:31], v[244:247], v[108:111]
v_exp_f32 v85, v85
s_mov_b32 s19, 0x00020000
v_mfma_f32_16x16x32_bf16 v[100:103], v[28:31], v[228:231], v[100:103]
RD 28,11,35840
v_add_f32 v8, v8, v84
MA 200,56,120
v_exp_f32 v86, v86
s_mul_i32 s6, s11, 0
MA 232,56,124
RD 56,11,26624
CV 114,84,85
v_add_f32 v8, v8, v85
MA 236,60,124
v_exp_f32 v87, v87
MA 204,60,120
RD 60,11,27648
v_add_f32 v8, v8, v86
s_add_i32 s6, s6, -39
v_mfma_f32_16x16x32_bf16 v[96:99], v[32:35], v[232:235], v[96:99]
v_exp_f32 v88, v88
v_mfma_f32_16x16x32_bf16 v[104:107], v[32:35], v[248:251], v[104:107]
RD 32,11,36864
CV 115,86,87
v_add_f32 v8, v8, v87
v_mfma_f32_16x16x32_bf16 v[108:111], v[36:39], v[248:251], v[108:111]
v_exp_f32 v89, v89
s_lshl_b32 s7, s6, 10
v_mfma_f32_16x16x32_bf16 v[100:103], v[36:39], v[232:235], v[100:103]
RD 36,11,37888
v_add_f32 v9, v9, v88
MA 208,64,120
v_exp_f32 v90, v90
s_lshl_b32 s6, s6, 16
MA 240,64,124
RD 64,11,28672
CV 116,88,89
v_add_f32 v9, v9, v89
MA 244,68,124
v_exp_f32 v91, v91
MA 212,68,120
RD 68,11,29696
v_add_f32 v9, v9, v90
s_mov_b32 s40, s6
v_mfma_f32_16x16x32_bf16 v[96:99], v[40:43], v[236:239], v[96:99]
v_exp_f32 v92, v92
v_mfma_f32_16x16x32_bf16 v[104:107], v[40:43], v[252:255], v[104:107]
RD 40,11,38912
CV 117,90,91
v_add_f32 v9, v9, v91
s_mov_b32 s41, s7
v_mfma_f32_16x16x32_bf16 v[108:111], v[44:47], v[252:255], v[108:111]
v_exp_f32 v93, v93
v_mfma_f32_16x16x32_bf16 v[100:103], v[44:47], v[236:239], v[100:103]
RD 44,11,39936
v_add_f32 v9, v9, v92
MA 216,72,120
v_exp_f32 v94, v94
s_mov_b32 s6, 327680
MA 248,72,124
RD 72,11,30720
CV 118,92,93
v_add_f32 v9, v9, v93
MA 252,76,124
v_exp_f32 v95, v95
MA 220,76,120
RD 76,11,31744
v_add_f32 v9, v9, v94
s_waitcnt lgkmcnt(4)
v_mfma_f32_16x16x32_bf16 v[80:83], v[16:19], v[192:195], 0
v_exp_f32 v96, v96
v_mfma_f32_16x16x32_bf16 v[88:91], v[16:19], v[208:211], 0
CV 119,94,95
v_add_f32 v9, v9, v95
v_mfma_f32_16x16x32_bf16 v[92:95], v[20:23], v[208:211], 0
v_exp_f32 v97, v97
v_mfma_f32_16x16x32_bf16 v[84:87], v[20:23], v[192:195], 0
v_add_f32 v10, v10, v96
s_mov_b32 s7, 5120
s_mul_i32 s38, s10, 2112
v_and_b32 v130, 15, v1
MA 128,48,112
v_exp_f32 v98, v98
MA 160,48,116
CV 120,96,97
v_add_f32 v10, v10, v97
MA 164,52,116
v_exp_f32 v99, v99
MA 132,52,112
v_add_f32 v10, v10, v98
v_lshlrev_b32 v15, 6, v130
v_lshlrev_b32 v130, 4, v130
v_lshrrev_b32 v12, 4, v1
v_mfma_f32_16x16x32_bf16 v[80:83], v[24:27], v[196:199], v[80:83]
v_exp_f32 v100, v100
v_mfma_f32_16x16x32_bf16 v[88:91], v[24:27], v[212:215], v[88:91]
CV 121,98,99
v_add_f32 v10, v10, v99
v_mfma_f32_16x16x32_bf16 v[92:95], v[28:31], v[212:215], v[92:95]
v_exp_f32 v101, v101
v_mfma_f32_16x16x32_bf16 v[84:87], v[28:31], v[196:199], v[84:87]
v_add_f32 v10, v10, v100
v_lshl_add_u32 v130, v12, 9, v130
v_bfe_u32 v12, v1, 2, 3
v_mul_u32_u24 v131, 1056, v12
MA 136,56,112
v_exp_f32 v102, v102
v_lshrrev_b32 v12, 5, v1
MA 168,56,116
CV 122,100,101
v_add_f32 v10, v10, v101
MA 172,60,116
v_exp_f32 v103, v103
v_lshl_add_u32 v131, v12, 9, v131
MA 140,60,112
s_waitcnt lgkmcnt(0)
v_add_f32 v10, v10, v102
v_and_b32 v12, 3, v1
v_mfma_f32_16x16x32_bf16 v[80:83], v[32:35], v[200:203], v[80:83]
v_exp_f32 v104, v104
v_mfma_f32_16x16x32_bf16 v[88:91], v[32:35], v[216:219], v[88:91]
CV 123,102,103
v_add_f32 v10, v10, v103
v_mfma_f32_16x16x32_bf16 v[92:95], v[36:39], v[216:219], v[92:95]
v_exp_f32 v105, v105
v_mfma_f32_16x16x32_bf16 v[84:87], v[36:39], v[200:203], v[84:87]
v_add_f32 v13, v13, v104
v_lshl_add_u32 v131, v12, 3, v131
v_lshlrev_b32 v0, 4, v1
s_add_u32 s20, s8, 0x800000
s_addc_u32 s21, s9, 0
MA 144,64,112
v_exp_f32 v106, v106
MA 176,64,116
CV 124,104,105
v_add_f32 v13, v13, v105
MA 180,68,116
v_exp_f32 v107, v107
MA 148,68,112
v_add_f32 v13, v13, v106
s_mov_b32 s22, 0x1044000
s_mov_b32 s23, 0x00020000
v_add_u32 v130, 133248, v0
v_mfma_f32_16x16x32_bf16 v[80:83], v[40:43], v[204:207], v[80:83]
v_exp_f32 v108, v108
v_mfma_f32_16x16x32_bf16 v[88:91], v[40:43], v[220:223], v[88:91]
CV 125,106,107
v_add_f32 v13, v13, v107
v_mfma_f32_16x16x32_bf16 v[92:95], v[44:47], v[220:223], v[92:95]
v_exp_f32 v109, v109
v_mfma_f32_16x16x32_bf16 v[84:87], v[44:47], v[204:207], v[84:87]
v_add_f32 v13, v13, v108
s_add_u32 s44, s8, 0x8800000
s_addc_u32 s45, s9, 0
s_mov_b32 s46, 0x800000
MA 152,72,112
v_exp_f32 v110, v110
s_mov_b32 s47, 0x00020000
MA 184,72,116
CV 126,108,109
v_add_f32 v13, v13, v109
s_lshl_b32 s15, s52, 2
MA 188,76,116
v_exp_f32 v111, v111
MA 156,76,112
v_add_f32 v13, v13, v110
v_mfma_f32_16x16x32_bf16 v[96:99], v[16:19], v[224:227], 0
v_exp_f32 v80, v80
s_add_u32 s15, s15, s10
v_mfma_f32_16x16x32_bf16 v[104:107], v[16:19], v[240:243], 0
RD 16,11,49152
CV 127,110,111
v_add_f32 v13, v13, v111
v_mfma_f32_16x16x32_bf16 v[108:111], v[20:23], v[240:243], 0
v_exp_f32 v81, v81
s_lshl_b32 s39, s15, 10
v_mfma_f32_16x16x32_bf16 v[100:103], v[20:23], v[224:227], 0
RD 20,11,50176
v_add_f32 v8, v8, v80
MA 192,48,120
v_exp_f32 v82, v82
MA 224,48,124
RD 48,11,40960
CV 112,80,81
v_add_f32 v8, v8, v81
s_add_u32 s54, s39, 368640
MA 228,52,124
v_exp_f32 v83, v83
MA 196,52,120
RD 52,11,41984
v_add_f32 v8, v8, v82
s_add_u32 s55, s39, 401408
v_mfma_f32_16x16x32_bf16 v[96:99], v[24:27], v[228:231], v[96:99]
v_exp_f32 v84, v84
v_mfma_f32_16x16x32_bf16 v[104:107], v[24:27], v[244:247], v[104:107]
RD 24,11,51200
CV 113,82,83
v_add_f32 v8, v8, v83
v_mfma_f32_16x16x32_bf16 v[108:111], v[28:31], v[244:247], v[108:111]
v_exp_f32 v85, v85
s_add_u32 s59, s39, 466944
v_mfma_f32_16x16x32_bf16 v[100:103], v[28:31], v[228:231], v[100:103]
RD 28,11,52224
v_add_f32 v8, v8, v84
MA 200,56,120
v_exp_f32 v86, v86
s_lshl_b32 s15, s15, 1
MA 232,56,124
RD 56,11,43008
CV 114,84,85
v_add_f32 v8, v8, v85
MA 236,60,124
v_exp_f32 v87, v87
MA 204,60,120
RD 60,11,44032
v_add_f32 v8, v8, v86
s_mul_i32 s33, s15, 266496
v_mfma_f32_16x16x32_bf16 v[96:99], v[32:35], v[232:235], v[96:99]
v_exp_f32 v88, v88
v_mfma_f32_16x16x32_bf16 v[104:107], v[32:35], v[248:251], v[104:107]
RD 32,11,53248
CV 115,86,87
v_add_f32 v8, v8, v87
v_mfma_f32_16x16x32_bf16 v[108:111], v[36:39], v[248:251], v[108:111]
v_exp_f32 v89, v89
s_mul_i32 s35, s11, 49152
v_mfma_f32_16x16x32_bf16 v[100:103], v[36:39], v[232:235], v[100:103]
RD 36,11,54272
v_add_f32 v9, v9, v88
MA 208,64,120
v_exp_f32 v90, v90
s_add_u32 s33, s33, s35
MA 240,64,124
RD 64,11,45056
CV 116,88,89
v_add_f32 v9, v9, v89
MA 244,68,124
v_exp_f32 v91, v91
MA 212,68,120
RD 68,11,46080
v_add_f32 v9, v9, v90
s_add_u32 s35, s33, 266496
v_mfma_f32_16x16x32_bf16 v[96:99], v[40:43], v[236:239], v[96:99]
v_exp_f32 v92, v92
v_mfma_f32_16x16x32_bf16 v[104:107], v[40:43], v[252:255], v[104:107]
RD 40,11,55296
CV 117,90,91
v_add_f32 v9, v9, v91
s_lshl_b32 s39, s52, 1
v_mfma_f32_16x16x32_bf16 v[108:111], v[44:47], v[252:255], v[108:111]
v_exp_f32 v93, v93
v_mfma_f32_16x16x32_bf16 v[100:103], v[44:47], v[236:239], v[100:103]
RD 44,11,56320
v_add_f32 v9, v9, v92
MA 216,72,120
v_exp_f32 v94, v94
s_lshr_b32 s15, s10, 1
MA 248,72,124
RD 72,11,47104
CV 118,92,93
v_add_f32 v9, v9, v93
MA 252,76,124
v_exp_f32 v95, v95
MA 220,76,120
RD 76,11,48128
v_add_f32 v9, v9, v94
s_waitcnt vmcnt(9) lgkmcnt(4)
s_barrier
v_mfma_f32_16x16x32_bf16 v[80:83], v[16:19], v[192:195], 0
v_exp_f32 v96, v96
v_mfma_f32_16x16x32_bf16 v[88:91], v[16:19], v[208:211], 0
CV 119,94,95
v_add_f32 v9, v9, v95
v_mfma_f32_16x16x32_bf16 v[92:95], v[20:23], v[208:211], 0
v_exp_f32 v97, v97
v_mfma_f32_16x16x32_bf16 v[84:87], v[20:23], v[192:195], 0
v_add_f32 v10, v10, v96
s_add_u32 s39, s39, s15
s_lshl_b32 s39, s39, 3
MA 128,48,112
v_exp_f32 v98, v98
MA 160,48,116
CV 120,96,97
v_add_f32 v10, v10, v97
MA 164,52,116
v_exp_f32 v99, v99
MA 132,52,112
v_add_f32 v10, v10, v98
s_add_u32 s39, s39, s53
s_lshl_b32 s39, s39, 1
v_mfma_f32_16x16x32_bf16 v[80:83], v[24:27], v[196:199], v[80:83]
v_exp_f32 v100, v100
v_mfma_f32_16x16x32_bf16 v[88:91], v[24:27], v[212:215], v[88:91]
CV 121,98,99
v_add_f32 v10, v10, v99
v_mfma_f32_16x16x32_bf16 v[92:95], v[28:31], v[212:215], v[92:95]
v_exp_f32 v101, v101
v_mfma_f32_16x16x32_bf16 v[84:87], v[28:31], v[196:199], v[84:87]
v_add_f32 v10, v10, v100
s_add_u32 s39, s39, s11
s_lshl_b32 s39, s39, 1
MA 136,56,112
v_exp_f32 v102, v102
s_and_b32 s15, s10, 1
MA 168,56,116
CV 122,100,101
v_add_f32 v10, v10, v101
MA 172,60,116
v_exp_f32 v103, v103
s_add_u32 s39, s39, s15
MA 140,60,112
s_waitcnt lgkmcnt(0)
v_add_f32 v10, v10, v102
v_mfma_f32_16x16x32_bf16 v[80:83], v[32:35], v[200:203], v[80:83]
v_exp_f32 v104, v104
v_mfma_f32_16x16x32_bf16 v[88:91], v[32:35], v[216:219], v[88:91]
CV 123,102,103
v_add_f32 v10, v10, v103
v_mfma_f32_16x16x32_bf16 v[92:95], v[36:39], v[216:219], v[92:95]
v_exp_f32 v105, v105
v_mfma_f32_16x16x32_bf16 v[84:87], v[36:39], v[200:203], v[84:87]
v_add_f32 v13, v13, v104
s_lshl_b32 s62, s39, 14
s_lshl_b32 s63, s39, 6
MA 144,64,112
v_exp_f32 v106, v106
MA 176,64,116
CV 124,104,105
v_add_f32 v13, v13, v105
MA 180,68,116
v_exp_f32 v107, v107
MA 148,68,112
v_add_f32 v13, v13, v106
s_add_u32 s63, s63, 434176
s_lshl_b32 s101, s13, 2
s_add_u32 s101, s101, s10
v_mfma_f32_16x16x32_bf16 v[80:83], v[40:43], v[204:207], v[80:83]
v_exp_f32 v108, v108
v_mfma_f32_16x16x32_bf16 v[88:91], v[40:43], v[220:223], v[88:91]
CV 125,106,107
v_add_f32 v13, v13, v107
v_mfma_f32_16x16x32_bf16 v[92:95], v[44:47], v[220:223], v[92:95]
v_exp_f32 v109, v109
v_mfma_f32_16x16x32_bf16 v[84:87], v[44:47], v[204:207], v[84:87]
v_add_f32 v13, v13, v108
s_lshl_b32 s101, s101, 4
s_add_u32 s101, s101, s14
s_lshl_b32 s101, s101, 6
s_add_u32 s101, s101, 368640
MA 152,72,112
v_exp_f32 v110, v110
MA 184,72,116
buffer_load_dword v12, v15, s[48:51], s59 offen sc1
CV 126,108,109
v_add_f32 v13, v13, v109
MA 188,76,116
v_exp_f32 v111, v111
MA 156,76,112
v_add_f32 v13, v13, v110
v_mfma_f32_16x16x32_bf16 v[96:99], v[16:19], v[224:227], 0
v_exp_f32 v80, v80
v_mfma_f32_16x16x32_bf16 v[104:107], v[16:19], v[240:243], 0
CV 127,110,111
v_add_f32 v13, v13, v111
v_mfma_f32_16x16x32_bf16 v[108:111], v[20:23], v[240:243], 0
v_exp_f32 v81, v81
v_mfma_f32_16x16x32_bf16 v[100:103], v[20:23], v[224:227], 0
v_add_f32 v8, v8, v80
MA 192,48,120
v_exp_f32 v82, v82
MA 224,48,124
CV 112,80,81
v_add_f32 v8, v8, v81
MA 228,52,124
v_exp_f32 v83, v83
MA 196,52,120
RD 48,11,57344
v_add_f32 v8, v8, v82
v_mfma_f32_16x16x32_bf16 v[96:99], v[24:27], v[228:231], v[96:99]
v_exp_f32 v84, v84
v_mfma_f32_16x16x32_bf16 v[104:107], v[24:27], v[244:247], v[104:107]
CV 113,82,83
v_add_f32 v8, v8, v83
v_mfma_f32_16x16x32_bf16 v[108:111], v[28:31], v[244:247], v[108:111]
v_exp_f32 v85, v85
v_mfma_f32_16x16x32_bf16 v[100:103], v[28:31], v[228:231], v[100:103]
RD 52,11,58368
v_add_f32 v8, v8, v84
MA 200,56,120
v_exp_f32 v86, v86
MA 232,56,124
CV 114,84,85
v_add_f32 v8, v8, v85
MA 236,60,124
v_exp_f32 v87, v87
MA 204,60,120
RD 56,11,59392
v_add_f32 v8, v8, v86
v_mfma_f32_16x16x32_bf16 v[96:99], v[32:35], v[232:235], v[96:99]
v_exp_f32 v88, v88
v_mfma_f32_16x16x32_bf16 v[104:107], v[32:35], v[248:251], v[104:107]
CV 115,86,87
v_add_f32 v8, v8, v87
v_mfma_f32_16x16x32_bf16 v[108:111], v[36:39], v[248:251], v[108:111]
v_exp_f32 v89, v89
v_mfma_f32_16x16x32_bf16 v[100:103], v[36:39], v[232:235], v[100:103]
RD 60,11,60416
v_add_f32 v9, v9, v88
MA 208,64,120
v_exp_f32 v90, v90
MA 240,64,124
CV 116,88,89
v_add_f32 v9, v9, v89
MA 244,68,124
v_exp_f32 v91, v91
MA 212,68,120
RD 64,11,61440
v_add_f32 v9, v9, v90
v_mfma_f32_16x16x32_bf16 v[96:99], v[40:43], v[236:239], v[96:99]
v_exp_f32 v92, v92
v_mfma_f32_16x16x32_bf16 v[104:107], v[40:43], v[252:255], v[104:107]
CV 117,90,91
v_add_f32 v9, v9, v91
v_mfma_f32_16x16x32_bf16 v[108:111], v[44:47], v[252:255], v[108:111]
v_exp_f32 v93, v93
v_mfma_f32_16x16x32_bf16 v[100:103], v[44:47], v[236:239], v[100:103]
RD 68,11,62464
v_add_f32 v9, v9, v92
MA 216,72,120
v_exp_f32 v94, v94
MA 248,72,124
CV 118,92,93
v_add_f32 v9, v9, v93
MA 252,76,124
v_exp_f32 v95, v95
MA 220,76,120
RD 72,11,63488
RD 76,11,64512
v_add_f32 v9, v9, v94
s_waitcnt lgkmcnt(0)
CV 119,94,95
v_add_f32 v9, v9, v95
s_nop 1
MA 128,48,112
v_exp_f32 v96, v96
v_exp_f32 v97, v97
MA 160,48,116
v_exp_f32 v98, v98
v_add_f32 v10, v10, v96
v_add_f32 v10, v10, v97
v_exp_f32 v99, v99
MA 164,52,116
CV 120,96,97
v_add_f32 v10, v10, v98
v_exp_f32 v100, v100
MA 132,52,112
s_add_u32 m0, s38, 0
CV 121,98,99
v_add_f32 v10, v10, v99
v_exp_f32 v101, v101
MA 136,56,112
v_exp_f32 v102, v102
v_add_f32 v10, v10, v100
CV 122,100,101
MA 168,56,116
buffer_load_dwordx4 v128, s[16:19], s32 offen lds
v_exp_f32 v103, v103
v_add_f32 v10, v10, v101
MA 172,60,116
buffer_load_dwordx4 v129, s[16:19], s32 offen offset:1056 lds
s_add_u32 s32, s32, 65536
v_add_f32 v10, v10, v102
v_exp_f32 v104, v104
MA 140,60,112
s_add_u32 m0, s38, 8448
CV 123,102,103
v_add_f32 v10, v10, v103
v_exp_f32 v105, v105
MA 144,64,112
buffer_load_dwordx4 v128, s[16:19], s32 offen lds
v_exp_f32 v106, v106
v_add_f32 v13, v13, v104
MA 176,64,116
buffer_load_dwordx4 v129, s[16:19], s32 offen offset:1056 lds
s_add_u32 s32, s32, 65536
CV 124,104,105
v_exp_f32 v107, v107
MA 180,68,116
s_add_u32 m0, s38, 16896
v_add_f32 v13, v13, v105
v_add_f32 v13, v13, v106
MA 148,68,112
buffer_load_dwordx4 v128, s[16:19], s32 offen lds
v_exp_f32 v108, v108
CV 125,106,107
v_add_f32 v13, v13, v107
MA 152,72,112
buffer_load_dwordx4 v129, s[16:19], s32 offen offset:1056 lds
s_add_u32 s32, s32, 65536
v_exp_f32 v109, v109
MA 184,72,116
s_add_u32 m0, s38, 25344
v_exp_f32 v110, v110
v_add_f32 v13, v13, v108
CV 126,108,109
MA 188,76,116
buffer_load_dwordx4 v128, s[16:19], s32 offen lds
buffer_load_dwordx4 v129, s[16:19], s32 offen offset:1056 lds
s_add_u32 s32, s32, s6
v_exp_f32 v111, v111
MA 156,76,112
v_add_f32 v13, v13, v109
v_add_f32 v13, v13, v110
CV 127,110,111
v_add_f32 v13, v13, v111
s_nop 1
MA 192,48,120
MA 224,48,124
MA 228,52,124
MA 196,52,120
MA 200,56,120
MA 232,56,124
MA 236,60,124
MA 204,60,120
MA 208,64,120
MA 240,64,124
MA 244,68,124
MA 212,68,120
MA 216,72,120
MA 248,72,124
MA 252,76,124
MA 220,76,120
s_nop 1
v_permlane32_swap_b32 v8, v10
v_permlane32_swap_b32 v9, v13
v_add_f32 v8, v8, v10
v_add_f32 v9, v9, v13
s_nop 1
v_permlane16_swap_b32 v8, v9
s_nop 0
v_add_f32 v8, v8, v9
v_cmp_nle_f32 vcc, 0x1f800000, v8
s_mov_b64 s[60:61], vcc
v_cmp_nge_f32 vcc, 0x5f800000, v8
s_or_b64 s[60:61], s[60:61], vcc
s_or_b32 s60, s60, s58
s_cmp_lg_u64 s[60:61], 0
s_cbranch_scc1 L_a_fallback
L_a_final:
s_waitcnt vmcnt(8)
v_cmp_ne_u32 vcc, s100, v12
s_cbranch_vccnz L_a_eslow
L_a_eok:
buffer_load_dwordx4 v[144:147], v0, s[20:23], s33 offen sc1
buffer_load_dwordx4 v[148:151], v130, s[20:23], s33 offen sc1
s_add_u32 s33, s33, 1024
buffer_load_dwordx4 v[152:155], v0, s[20:23], s35 offen sc1
buffer_load_dwordx4 v[156:159], v130, s[20:23], s35 offen sc1
s_add_u32 s35, s35, 1024
buffer_load_dwordx4 v[160:163], v0, s[20:23], s33 offen sc1
buffer_load_dwordx4 v[164:167], v130, s[20:23], s33 offen sc1
s_add_u32 s33, s33, 1024
buffer_load_dwordx4 v[168:171], v0, s[20:23], s35 offen sc1
buffer_load_dwordx4 v[172:175], v130, s[20:23], s35 offen sc1
s_add_u32 s35, s35, 1024
buffer_load_dwordx4 v[176:179], v0, s[20:23], s33 offen sc1
buffer_load_dwordx4 v[180:183], v130, s[20:23], s33 offen sc1
s_add_u32 s33, s33, 1024
buffer_load_dwordx4 v[184:187], v0, s[20:23], s35 offen sc1
buffer_load_dwordx4 v[188:191], v130, s[20:23], s35 offen sc1
s_add_u32 s35, s35, 1024
buffer_load_dwordx4 v[192:195], v0, s[20:23], s33 offen sc1
buffer_load_dwordx4 v[196:199], v130, s[20:23], s33 offen sc1
s_add_u32 s33, s33, s7
buffer_load_dwordx4 v[200:203], v0, s[20:23], s35 offen sc1
buffer_load_dwordx4 v[204:207], v130, s[20:23], s35 offen sc1
s_add_u32 s35, s35, s7
v_rcp_f32 v8, v8
v_lshlrev_b32 v24, 4, v1
v_mov_b32 v16, v8
v_mov_b32 v20, v8
s_nop 1
v_permlane32_swap_b32 v16, v20
s_nop 0
v_mov_b32 v18, v16
v_mov_b32 v22, v20
s_nop 1
v_permlane16_swap_b32 v16, v18
v_permlane16_swap_b32 v20, v22
s_lshl_b32 s4, s10, 2
s_lshl_b32 s15, s13, 4
s_add_u32 s4, s4, s15
s_mul_i32 s4, s4, 133248
s_lshl_b32 s15, s14, 13
s_add_u32 s4, s4, s15
s_add_u32 s4, s4, 4096
AR 32,128
AR 33,129
AR 34,130
AR 35,131
AR 36,132
AR 37,133
AR 38,134
AR 39,135
v_pk_mul_f32 v[32:33], v[32:33], v[16:17] op_sel_hi:[1,0]
v_pk_mul_f32 v[34:35], v[34:35], v[16:17] op_sel_hi:[1,0]
v_pk_mul_f32 v[36:37], v[36:37], v[16:17] op_sel_hi:[1,0]
v_pk_mul_f32 v[38:39], v[38:39], v[16:17] op_sel_hi:[1,0]
CV 40,32,33
CV 41,34,35
CV 42,36,37
CV 43,38,39
buffer_store_dwordx4 v[40:43], v24, s[28:31], s4 offen sc1
AR 48,136
AR 49,137
AR 50,138
AR 51,139
AR 52,140
AR 53,141
AR 54,142
AR 55,143
v_pk_mul_f32 v[48:49], v[48:49], v[16:17] op_sel_hi:[1,0]
v_pk_mul_f32 v[50:51], v[50:51], v[16:17] op_sel_hi:[1,0]
v_pk_mul_f32 v[52:53], v[52:53], v[16:17] op_sel_hi:[1,0]
v_pk_mul_f32 v[54:55], v[54:55], v[16:17] op_sel_hi:[1,0]
CV 56,48,49
CV 57,50,51
CV 58,52,53
CV 59,54,55
buffer_store_dwordx4 v[56:59], v24, s[28:31], s4 offen offset:1024 sc1
AR 64,144
AR 65,145
AR 66,146
AR 67,147
AR 68,148
AR 69,149
AR 70,150
AR 71,151
v_pk_mul_f32 v[64:65], v[64:65], v[16:17] op_sel_hi:[1,0]
v_pk_mul_f32 v[66:67], v[66:67], v[16:17] op_sel_hi:[1,0]
v_pk_mul_f32 v[68:69], v[68:69], v[16:17] op_sel_hi:[1,0]
v_pk_mul_f32 v[70:71], v[70:71], v[16:17] op_sel_hi:[1,0]
CV 72,64,65
CV 73,66,67
CV 74,68,69
CV 75,70,71
buffer_store_dwordx4 v[72:75], v24, s[28:31], s4 offen offset:2048 sc1
AR 80,152
AR 81,153
AR 82,154
AR 83,155
AR 84,156
AR 85,157
AR 86,158
AR 87,159
v_pk_mul_f32 v[80:81], v[80:81], v[16:17] op_sel_hi:[1,0]
v_pk_mul_f32 v[82:83], v[82:83], v[16:17] op_sel_hi:[1,0]
v_pk_mul_f32 v[84:85], v[84:85], v[16:17] op_sel_hi:[1,0]
v_pk_mul_f32 v[86:87], v[86:87], v[16:17] op_sel_hi:[1,0]
CV 88,80,81
CV 89,82,83
CV 90,84,85
CV 91,86,87
buffer_store_dwordx4 v[88:91], v24, s[28:31], s4 offen offset:3072 sc1
s_add_u32 s4, s4, 133248
AR 32,160
AR 33,161
AR 34,162
AR 35,163
AR 36,164
AR 37,165
AR 38,166
AR 39,167
v_pk_mul_f32 v[32:33], v[32:33], v[18:19] op_sel_hi:[1,0]
v_pk_mul_f32 v[34:35], v[34:35], v[18:19] op_sel_hi:[1,0]
v_pk_mul_f32 v[36:37], v[36:37], v[18:19] op_sel_hi:[1,0]
v_pk_mul_f32 v[38:39], v[38:39], v[18:19] op_sel_hi:[1,0]
CV 40,32,33
CV 41,34,35
CV 42,36,37
CV 43,38,39
buffer_store_dwordx4 v[40:43], v24, s[28:31], s4 offen sc1
AR 48,168
AR 49,169
AR 50,170
AR 51,171
AR 52,172
AR 53,173
AR 54,174
AR 55,175
v_pk_mul_f32 v[48:49], v[48:49], v[18:19] op_sel_hi:[1,0]
v_pk_mul_f32 v[50:51], v[50:51], v[18:19] op_sel_hi:[1,0]
v_pk_mul_f32 v[52:53], v[52:53], v[18:19] op_sel_hi:[1,0]
v_pk_mul_f32 v[54:55], v[54:55], v[18:19] op_sel_hi:[1,0]
CV 56,48,49
CV 57,50,51
CV 58,52,53
CV 59,54,55
buffer_store_dwordx4 v[56:59], v24, s[28:31], s4 offen offset:1024 sc1
AR 64,176
AR 65,177
AR 66,178
AR 67,179
AR 68,180
AR 69,181
AR 70,182
AR 71,183
v_pk_mul_f32 v[64:65], v[64:65], v[18:19] op_sel_hi:[1,0]
v_pk_mul_f32 v[66:67], v[66:67], v[18:19] op_sel_hi:[1,0]
v_pk_mul_f32 v[68:69], v[68:69], v[18:19] op_sel_hi:[1,0]
v_pk_mul_f32 v[70:71], v[70:71], v[18:19] op_sel_hi:[1,0]
CV 72,64,65
CV 73,66,67
CV 74,68,69
CV 75,70,71
buffer_store_dwordx4 v[72:75], v24, s[28:31], s4 offen offset:2048 sc1
AR 80,184
AR 81,185
AR 82,186
AR 83,187
AR 84,188
AR 85,189
AR 86,190
AR 87,191
v_pk_mul_f32 v[80:81], v[80:81], v[18:19] op_sel_hi:[1,0]
v_pk_mul_f32 v[82:83], v[82:83], v[18:19] op_sel_hi:[1,0]
v_pk_mul_f32 v[84:85], v[84:85], v[18:19] op_sel_hi:[1,0]
v_pk_mul_f32 v[86:87], v[86:87], v[18:19] op_sel_hi:[1,0]
CV 88,80,81
CV 89,82,83
CV 90,84,85
CV 91,86,87
buffer_store_dwordx4 v[88:91], v24, s[28:31], s4 offen offset:3072 sc1
s_add_u32 s4, s4, 133248
AR 32,192
AR 33,193
AR 34,194
AR 35,195
AR 36,196
AR 37,197
AR 38,198
AR 39,199
v_pk_mul_f32 v[32:33], v[32:33], v[20:21] op_sel_hi:[1,0]
v_pk_mul_f32 v[34:35], v[34:35], v[20:21] op_sel_hi:[1,0]
v_pk_mul_f32 v[36:37], v[36:37], v[20:21] op_sel_hi:[1,0]
v_pk_mul_f32 v[38:39], v[38:39], v[20:21] op_sel_hi:[1,0]
CV 40,32,33
CV 41,34,35
CV 42,36,37
CV 43,38,39
buffer_store_dwordx4 v[40:43], v24, s[28:31], s4 offen sc1
AR 48,200
AR 49,201
AR 50,202
AR 51,203
AR 52,204
AR 53,205
AR 54,206
AR 55,207
v_pk_mul_f32 v[48:49], v[48:49], v[20:21] op_sel_hi:[1,0]
v_pk_mul_f32 v[50:51], v[50:51], v[20:21] op_sel_hi:[1,0]
v_pk_mul_f32 v[52:53], v[52:53], v[20:21] op_sel_hi:[1,0]
v_pk_mul_f32 v[54:55], v[54:55], v[20:21] op_sel_hi:[1,0]
CV 56,48,49
CV 57,50,51
CV 58,52,53
CV 59,54,55
buffer_store_dwordx4 v[56:59], v24, s[28:31], s4 offen offset:1024 sc1
AR 64,208
AR 65,209
AR 66,210
AR 67,211
AR 68,212
AR 69,213
AR 70,214
AR 71,215
v_pk_mul_f32 v[64:65], v[64:65], v[20:21] op_sel_hi:[1,0]
v_pk_mul_f32 v[66:67], v[66:67], v[20:21] op_sel_hi:[1,0]
v_pk_mul_f32 v[68:69], v[68:69], v[20:21] op_sel_hi:[1,0]
v_pk_mul_f32 v[70:71], v[70:71], v[20:21] op_sel_hi:[1,0]
CV 72,64,65
CV 73,66,67
CV 74,68,69
CV 75,70,71
buffer_store_dwordx4 v[72:75], v24, s[28:31], s4 offen offset:2048 sc1
AR 80,216
AR 81,217
AR 82,218
AR 83,219
AR 84,220
AR 85,221
AR 86,222
AR 87,223
v_pk_mul_f32 v[80:81], v[80:81], v[20:21] op_sel_hi:[1,0]
v_pk_mul_f32 v[82:83], v[82:83], v[20:21] op_sel_hi:[1,0]
v_pk_mul_f32 v[84:85], v[84:85], v[20:21] op_sel_hi:[1,0]
v_pk_mul_f32 v[86:87], v[86:87], v[20:21] op_sel_hi:[1,0]
CV 88,80,81
CV 89,82,83
CV 90,84,85
CV 91,86,87
buffer_store_dwordx4 v[88:91], v24, s[28:31], s4 offen offset:3072 sc1
s_add_u32 s4, s4, 133248
AR 32,224
AR 33,225
AR 34,226
AR 35,227
AR 36,228
AR 37,229
AR 38,230
AR 39,231
v_pk_mul_f32 v[32:33], v[32:33], v[22:23] op_sel_hi:[1,0]
v_pk_mul_f32 v[34:35], v[34:35], v[22:23] op_sel_hi:[1,0]
v_pk_mul_f32 v[36:37], v[36:37], v[22:23] op_sel_hi:[1,0]
v_pk_mul_f32 v[38:39], v[38:39], v[22:23] op_sel_hi:[1,0]
CV 40,32,33
CV 41,34,35
CV 42,36,37
CV 43,38,39
buffer_store_dwordx4 v[40:43], v24, s[28:31], s4 offen sc1
AR 48,232
AR 49,233
AR 50,234
AR 51,235
AR 52,236
AR 53,237
AR 54,238
AR 55,239
v_pk_mul_f32 v[48:49], v[48:49], v[22:23] op_sel_hi:[1,0]
v_pk_mul_f32 v[50:51], v[50:51], v[22:23] op_sel_hi:[1,0]
v_pk_mul_f32 v[52:53], v[52:53], v[22:23] op_sel_hi:[1,0]
v_pk_mul_f32 v[54:55], v[54:55], v[22:23] op_sel_hi:[1,0]
CV 56,48,49
CV 57,50,51
CV 58,52,53
CV 59,54,55
buffer_store_dwordx4 v[56:59], v24, s[28:31], s4 offen offset:1024 sc1
AR 64,240
AR 65,241
AR 66,242
AR 67,243
AR 68,244
AR 69,245
AR 70,246
AR 71,247
v_pk_mul_f32 v[64:65], v[64:65], v[22:23] op_sel_hi:[1,0]
v_pk_mul_f32 v[66:67], v[66:67], v[22:23] op_sel_hi:[1,0]
v_pk_mul_f32 v[68:69], v[68:69], v[22:23] op_sel_hi:[1,0]
v_pk_mul_f32 v[70:71], v[70:71], v[22:23] op_sel_hi:[1,0]
CV 72,64,65
CV 73,66,67
CV 74,68,69
CV 75,70,71
buffer_store_dwordx4 v[72:75], v24, s[28:31], s4 offen offset:2048 sc1
AR 80,248
AR 81,249
AR 82,250
AR 83,251
AR 84,252
AR 85,253
AR 86,254
AR 87,255
v_pk_mul_f32 v[80:81], v[80:81], v[22:23] op_sel_hi:[1,0]
v_pk_mul_f32 v[82:83], v[82:83], v[22:23] op_sel_hi:[1,0]
v_pk_mul_f32 v[84:85], v[84:85], v[22:23] op_sel_hi:[1,0]
v_pk_mul_f32 v[86:87], v[86:87], v[22:23] op_sel_hi:[1,0]
CV 88,80,81
CV 89,82,83
CV 90,84,85
CV 91,86,87
buffer_store_dwordx4 v[88:91], v24, s[28:31], s4 offen offset:3072 sc1
s_waitcnt vmcnt(28)
s_barrier
TR 16,131,0
TR 18,131,256
TR 20,131,32
TR 22,131,288
TR 24,131,64
TR 26,131,320
TR 28,131,96
TR 30,131,352
TR 32,131,128
TR 34,131,384
TR 36,131,160
TR 38,131,416
TR 40,131,192
TR 42,131,448
TR 44,131,224
TR 46,131,480
s_waitcnt vmcnt(24) lgkmcnt(0)
s_barrier
MZ 0,16,144
TR 48,131,8448
s_add_u32 m0, s38, 33792
MZ 16,20,144
buffer_load_dwordx4 v128, s[16:19], s32 offen lds
MZ 20,20,148
TR 50,131,8704
MZ 4,16,148
TR 52,131,8480
buffer_load_dwordx4 v129, s[16:19], s32 offen offset:1056 lds
s_add_u32 s32, s32, 65536
MZ 8,16,152
TR 54,131,8736
MZ 24,20,152
TR 56,131,8512
MZ 28,20,156
buffer_load_dwordx4 v[208:211], v0, s[20:23], s33 offen sc1
MZ 12,16,156
TR 58,131,8768
MZ 44,24,156
TR 60,131,8544
buffer_load_dwordx4 v[212:215], v130, s[20:23], s33 offen sc1
s_add_u32 s33, s33, 1024
MZ 60,28,156
TR 62,131,8800
MZ 56,28,152
TR 64,131,8576
MZ 40,24,152
buffer_load_dwordx4 v[216:219], v0, s[20:23], s35 offen sc1
MZ 36,24,148
TR 66,131,8832
MZ 52,28,148
TR 68,131,8608
buffer_load_dwordx4 v[220:223], v130, s[20:23], s35 offen sc1
s_add_u32 s35, s35, 1024
MZ 48,28,144
TR 70,131,8864
MZ 32,24,144
TR 72,131,8640
s_add_u32 m0, s38, 42240
MZ 64,32,144
buffer_load_dwordx4 v128, s[16:19], s32 offen lds
MZ 80,36,144
TR 74,131,8896
MZ 84,36,148
TR 76,131,8672
buffer_load_dwordx4 v129, s[16:19], s32 offen offset:1056 lds
s_add_u32 s32, s32, 65536
MZ 68,32,148
TR 78,131,8928
MZ 72,32,152
MZ 88,36,152
buffer_load_dwordx4 v[224:227], v0, s[20:23], s33 offen sc1
MZ 92,36,156
MZ 76,32,156
buffer_load_dwordx4 v[228:231], v130, s[20:23], s33 offen sc1
s_add_u32 s33, s33, 1024
MZ 108,40,156
MZ 124,44,156
MZ 120,44,152
buffer_load_dwordx4 v[232:235], v0, s[20:23], s35 offen sc1
MZ 104,40,152
MZ 100,40,148
buffer_load_dwordx4 v[236:239], v130, s[20:23], s35 offen sc1
s_add_u32 s35, s35, 1024
MZ 116,44,148
MZ 112,44,144
MZ 96,40,144
s_waitcnt lgkmcnt(0)
MA 0,48,160
TR 16,131,16896
s_add_u32 m0, s38, 0
MA 16,52,160
buffer_load_dwordx4 v128, s[16:19], s32 offen lds
MA 20,52,164
TR 18,131,17152
MA 4,48,164
TR 20,131,16928
MA 8,48,168
TR 22,131,17184
MA 24,52,168
TR 24,131,16960
MA 28,52,172
buffer_load_dwordx4 v129, s[16:19], s32 offen offset:1056 lds
s_add_u32 s32, s32, 65536
MA 12,48,172
TR 26,131,17216
MA 44,56,172
TR 28,131,16992
MA 60,60,172
TR 30,131,17248
MA 56,60,168
TR 32,131,17024
MA 40,56,168
buffer_load_dwordx4 v[144:147], v0, s[20:23], s33 offen sc1
MA 36,56,164
TR 34,131,17280
MA 52,60,164
TR 36,131,17056
MA 48,60,160
TR 38,131,17312
MA 32,56,160
TR 40,131,17088
MA 64,64,160
buffer_load_dwordx4 v[148:151], v130, s[20:23], s33 offen sc1
s_add_u32 s33, s33, 1024
MA 80,68,160
TR 42,131,17344
MA 84,68,164
TR 44,131,17120
MA 68,64,164
TR 46,131,17376
MA 72,64,168
MA 88,68,168
buffer_load_dwordx4 v[152:155], v0, s[20:23], s35 offen sc1
MA 92,68,172
MA 76,64,172
MA 108,72,172
MA 124,76,172
MA 120,76,168
buffer_load_dwordx4 v[156:159], v130, s[20:23], s35 offen sc1
s_add_u32 s35, s35, 1024
MA 104,72,168
MA 100,72,164
MA 116,76,164
MA 112,76,160
MA 96,72,160
s_waitcnt vmcnt(12) lgkmcnt(0)
s_barrier
MA 0,16,176
TR 48,131,25344
s_add_u32 m0, s38, 8448
MA 16,20,176
buffer_load_dwordx4 v128, s[16:19], s32 offen lds
MA 20,20,180
TR 50,131,25600
MA 4,16,180
TR 52,131,25376
MA 8,16,184
TR 54,131,25632
MA 24,20,184
TR 56,131,25408
MA 28,20,188
buffer_load_dwordx4 v129, s[16:19], s32 offen offset:1056 lds
s_add_u32 s32, s32, s6
MA 12,16,188
TR 58,131,25664
MA 44,24,188
TR 60,131,25440
MA 60,28,188
TR 62,131,25696
MA 56,28,184
TR 64,131,25472
MA 40,24,184
buffer_load_dwordx4 v[160:163], v0, s[20:23], s33 offen sc1
MA 36,24,180
TR 66,131,25728
MA 52,28,180
TR 68,131,25504
MA 48,28,176
TR 70,131,25760
MA 32,24,176
TR 72,131,25536
MA 64,32,176
buffer_load_dwordx4 v[164:167], v130, s[20:23], s33 offen sc1
s_add_u32 s33, s33, s7
MA 80,36,176
TR 74,131,25792
MA 84,36,180
TR 76,131,25568
MA 68,32,180
TR 78,131,25824
MA 72,32,184
MA 88,36,184
buffer_load_dwordx4 v[168:171], v0, s[20:23], s35 offen sc1
MA 92,36,188
MA 76,32,188
MA 108,40,188
MA 124,44,188
MA 120,44,184
buffer_load_dwordx4 v[172:175], v130, s[20:23], s35 offen sc1
s_add_u32 s35, s35, s7
MA 104,40,184
MA 100,40,180
MA 116,44,180
MA 112,44,176
MA 96,40,176
s_waitcnt lgkmcnt(0)
MA 0,48,192
TR 16,131,33792
s_add_u32 m0, s38, 16896
MA 16,52,192
buffer_load_dwordx4 v128, s[16:19], s32 offen lds
MA 20,52,196
TR 18,131,34048
MA 4,48,196
TR 20,131,33824
MA 8,48,200
TR 22,131,34080
MA 24,52,200
TR 24,131,33856
MA 28,52,204
buffer_load_dwordx4 v129, s[16:19], s32 offen offset:1056 lds
s_add_u32 s32, s32, 65536
MA 12,48,204
TR 26,131,34112
MA 44,56,204
TR 28,131,33888
MA 60,60,204
TR 30,131,34144
MA 56,60,200
TR 32,131,33920
MA 40,56,200
buffer_load_dwordx4 v[176:179], v0, s[20:23], s33 offen sc1
MA 36,56,196
TR 34,131,34176
MA 52,60,196
TR 36,131,33952
MA 48,60,192
TR 38,131,34208
MA 32,56,192
TR 40,131,33984
MA 64,64,192
buffer_load_dwordx4 v[180:183], v130, s[20:23], s33 offen sc1
s_add_u32 s33, s33, 1024
MA 80,68,192
TR 42,131,34240
MA 84,68,196
TR 44,131,34016
MA 68,64,196
TR 46,131,34272
MA 72,64,200
MA 88,68,200
buffer_load_dwordx4 v[184:187], v0, s[20:23], s35 offen sc1
MA 92,68,204
MA 76,64,204
MA 108,72,204
MA 124,76,204
MA 120,76,200
buffer_load_dwordx4 v[188:191], v130, s[20:23], s35 offen sc1
s_add_u32 s35, s35, 1024
MA 104,72,200
MA 100,72,196
MA 116,76,196
MA 112,76,192
MA 96,72,192
s_waitcnt vmcnt(30)
v_mov_b32 v3, s100
s_mov_b64 exec, 1
buffer_store_dword v3, off, s[48:51], s101 sc1
s_mov_b64 exec, -1
s_waitcnt vmcnt(13) lgkmcnt(0)
s_barrier
MA 0,16,208
TR 48,131,42240
s_add_u32 m0, s38, 25344
MA 16,20,208
buffer_load_dwordx4 v128, s[16:19], s32 offen lds
MA 20,20,212
TR 50,131,42496
MA 4,16,212
TR 52,131,42272
MA 8,16,216
TR 54,131,42528
MA 24,20,216
TR 56,131,42304
MA 28,20,220
buffer_load_dwordx4 v129, s[16:19], s32 offen offset:1056 lds
s_add_u32 s32, s32, 65536
MA 12,16,220
TR 58,131,42560
MA 44,24,220
TR 60,131,42336
MA 60,28,220
TR 62,131,42592
MA 56,28,216
TR 64,131,42368
MA 40,24,216
buffer_load_dwordx4 v[192:195], v0, s[20:23], s33 offen sc1
MA 36,24,212
TR 66,131,42624
MA 52,28,212
TR 68,131,42400
MA 48,28,208
TR 70,131,42656
MA 32,24,208
TR 72,131,42432
MA 64,32,208
buffer_load_dwordx4 v[196:199], v130, s[20:23], s33 offen sc1
s_add_u32 s33, s33, 1024
MA 80,36,208
TR 74,131,42688
MA 84,36,212
TR 76,131,42464
MA 68,32,212
TR 78,131,42720
MA 72,32,216
MA 88,36,216
buffer_load_dwordx4 v[200:203], v0, s[20:23], s35 offen sc1
MA 92,36,220
MA 76,32,220
MA 108,40,220
MA 124,44,220
MA 120,44,216
buffer_load_dwordx4 v[204:207], v130, s[20:23], s35 offen sc1
s_add_u32 s35, s35, 1024
MA 104,40,216
MA 100,40,212
MA 116,44,212
MA 112,44,208
MA 96,40,208
s_waitcnt lgkmcnt(0)
MA 0,48,224
TR 16,131,0
s_add_u32 m0, s38, 33792
MA 16,52,224
buffer_load_dwordx4 v128, s[16:19], s32 offen lds
MA 20,52,228
TR 18,131,256
MA 4,48,228
TR 20,131,32
MA 8,48,232
TR 22,131,288
MA 24,52,232
TR 24,131,64
MA 28,52,236
buffer_load_dwordx4 v129, s[16:19], s32 offen offset:1056 lds
s_add_u32 s32, s32, 65536
MA 12,48,236
TR 26,131,320
MA 44,56,236
TR 28,131,96
MA 60,60,236
TR 30,131,352
MA 56,60,232
TR 32,131,128
MA 40,56,232
buffer_load_dwordx4 v[208:211], v0, s[20:23], s33 offen sc1
MA 36,56,228
TR 34,131,384
MA 52,60,228
TR 36,131,160
MA 48,60,224
TR 38,131,416
MA 32,56,224
TR 40,131,192
MA 64,64,224
buffer_load_dwordx4 v[212:215], v130, s[20:23], s33 offen sc1
s_add_u32 s33, s33, 1024
MA 80,68,224
TR 42,131,448
MA 84,68,228
TR 44,131,224
MA 68,64,228
TR 46,131,480
MA 72,64,232
MA 88,68,232
buffer_load_dwordx4 v[216:219], v0, s[20:23], s35 offen sc1
MA 92,68,236
MA 76,64,236
MA 108,72,236
MA 124,76,236
MA 120,76,232
buffer_load_dwordx4 v[220:223], v130, s[20:23], s35 offen sc1
s_add_u32 s35, s35, 1024
MA 104,72,232
MA 100,72,228
MA 116,76,228
MA 112,76,224
MA 96,72,224
s_mov_b32 s37, 3
.p2align 6
L_p1_0:
s_cmp_lg_u32 s37, 2
s_cbranch_scc1 L_p1_k18_0x
s_mov_b32 s6, s40
s_mov_b32 s7, s41
L_p1_k18_0x:
s_waitcnt vmcnt(12) lgkmcnt(0)
s_barrier
MA 0,16,144
TR 48,131,8448
s_add_u32 m0, s38, 42240
MA 16,20,144
buffer_load_dwordx4 v128, s[16:19], s32 offen lds
MA 20,20,148
TR 50,131,8704
MA 4,16,148
TR 52,131,8480
MA 8,16,152
TR 54,131,8736
MA 24,20,152
TR 56,131,8512
MA 28,20,156
buffer_load_dwordx4 v129, s[16:19], s32 offen offset:1056 lds
s_add_u32 s32, s32, s6
MA 12,16,156
TR 58,131,8768
MA 44,24,156
TR 60,131,8544
MA 60,28,156
TR 62,131,8800
MA 56,28,152
TR 64,131,8576
MA 40,24,152
buffer_load_dwordx4 v[224:227], v0, s[20:23], s33 offen sc1
MA 36,24,148
TR 66,131,8832
MA 52,28,148
TR 68,131,8608
MA 48,28,144
TR 70,131,8864
MA 32,24,144
TR 72,131,8640
MA 64,32,144
buffer_load_dwordx4 v[228:231], v130, s[20:23], s33 offen sc1
s_add_u32 s33, s33, s7
MA 80,36,144
TR 74,131,8896
MA 84,36,148
TR 76,131,8672
MA 68,32,148
TR 78,131,8928
MA 72,32,152
MA 88,36,152
buffer_load_dwordx4 v[232:235], v0, s[20:23], s35 offen sc1
MA 92,36,156
MA 76,32,156
MA 108,40,156
MA 124,44,156
MA 120,44,152
buffer_load_dwordx4 v[236:239], v130, s[20:23], s35 offen sc1
s_add_u32 s35, s35, s7
MA 104,40,152
MA 100,40,148
MA 116,44,148
MA 112,44,144
MA 96,40,144
s_cmp_lg_u32 s37, 2
s_cbranch_scc1 L_p1_k19_0x
s_waitcnt vmcnt(18)
v_cmp_ne_u32 vcc, s100, v3
s_cbranch_vccnz L_p1o_slow
L_p1o_ok:
L_p1_k19_0x:
s_cmp_lg_u32 s37, 2
s_cbranch_scc1 L_p1_k19_1x
s_mov_b32 s6, 327680
s_mov_b32 s7, 5120
L_p1_k19_1x:
s_waitcnt lgkmcnt(0)
MA 0,48,160
TR 16,131,16896
s_add_u32 m0, s38, 0
MA 16,52,160
buffer_load_dwordx4 v128, s[16:19], s32 offen lds
MA 20,52,164
TR 18,131,17152
MA 4,48,164
TR 20,131,16928
MA 8,48,168
TR 22,131,17184
MA 24,52,168
TR 24,131,16960
MA 28,52,172
buffer_load_dwordx4 v129, s[16:19], s32 offen offset:1056 lds
s_add_u32 s32, s32, 65536
MA 12,48,172
TR 26,131,17216
MA 44,56,172
TR 28,131,16992
MA 60,60,172
TR 30,131,17248
MA 56,60,168
TR 32,131,17024
MA 40,56,168
buffer_load_dwordx4 v[144:147], v0, s[20:23], s33 offen sc1
MA 36,56,164
TR 34,131,17280
MA 52,60,164
TR 36,131,17056
MA 48,60,160
TR 38,131,17312
MA 32,56,160
TR 40,131,17088
MA 64,64,160
buffer_load_dwordx4 v[148:151], v130, s[20:23], s33 offen sc1
s_add_u32 s33, s33, 1024
MA 80,68,160
TR 42,131,17344
MA 84,68,164
TR 44,131,17120
MA 68,64,164
TR 46,131,17376
MA 72,64,168
MA 88,68,168
buffer_load_dwordx4 v[152:155], v0, s[20:23], s35 offen sc1
MA 92,68,172
MA 76,64,172
MA 108,72,172
MA 124,76,172
MA 120,76,168
buffer_load_dwordx4 v[156:159], v130, s[20:23], s35 offen sc1
s_add_u32 s35, s35, 1024
MA 104,72,168
MA 100,72,164
MA 116,76,164
MA 112,76,160
MA 96,72,160
s_waitcnt vmcnt(12) lgkmcnt(0)
s_barrier
MA 0,16,176
TR 48,131,25344
s_add_u32 m0, s38, 8448
MA 16,20,176
buffer_load_dwordx4 v128, s[16:19], s32 offen lds
MA 20,20,180
TR 50,131,25600
MA 4,16,180
TR 52,131,25376
MA 8,16,184
TR 54,131,25632
MA 24,20,184
TR 56,131,25408
MA 28,20,188
buffer_load_dwordx4 v129, s[16:19], s32 offen offset:1056 lds
s_add_u32 s32, s32, 65536
MA 12,16,188
TR 58,131,25664
MA 44,24,188
TR 60,131,25440
MA 60,28,188
TR 62,131,25696
MA 56,28,184
TR 64,131,25472
MA 40,24,184
buffer_load_dwordx4 v[160:163], v0, s[20:23], s33 offen sc1
MA 36,24,180
TR 66,131,25728
MA 52,28,180
TR 68,131,25504
MA 48,28,176
TR 70,131,25760
MA 32,24,176
TR 72,131,25536
MA 64,32,176
buffer_load_dwordx4 v[164:167], v130, s[20:23], s33 offen sc1
s_add_u32 s33, s33, 1024
MA 80,36,176
TR 74,131,25792
MA 84,36,180
TR 76,131,25568
MA 68,32,180
TR 78,131,25824
MA 72,32,184
MA 88,36,184
buffer_load_dwordx4 v[168:171], v0, s[20:23], s35 offen sc1
MA 92,36,188
MA 76,32,188
MA 108,40,188
MA 124,44,188
MA 120,44,184
buffer_load_dwordx4 v[172:175], v130, s[20:23], s35 offen sc1
s_add_u32 s35, s35, 1024
MA 104,40,184
MA 100,40,180
MA 116,44,180
MA 112,44,176
MA 96,40,176
s_waitcnt lgkmcnt(0)
MA 0,48,192
TR 16,131,33792
s_add_u32 m0, s38, 16896
MA 16,52,192
buffer_load_dwordx4 v128, s[16:19], s32 offen lds
MA 20,52,196
TR 18,131,34048
MA 4,48,196
TR 20,131,33824
MA 8,48,200
TR 22,131,34080
MA 24,52,200
TR 24,131,33856
MA 28,52,204
buffer_load_dwordx4 v129, s[16:19], s32 offen offset:1056 lds
s_add_u32 s32, s32, 65536
MA 12,48,204
TR 26,131,34112
MA 44,56,204
TR 28,131,33888
MA 60,60,204
TR 30,131,34144
MA 56,60,200
TR 32,131,33920
MA 40,56,200
buffer_load_dwordx4 v[176:179], v0, s[20:23], s33 offen sc1
MA 36,56,196
TR 34,131,34176
MA 52,60,196
TR 36,131,33952
MA 48,60,192
TR 38,131,34208
MA 32,56,192
TR 40,131,33984
MA 64,64,192
buffer_load_dwordx4 v[180:183], v130, s[20:23], s33 offen sc1
s_add_u32 s33, s33, 1024
MA 80,68,192
TR 42,131,34240
MA 84,68,196
TR 44,131,34016
MA 68,64,196
TR 46,131,34272
MA 72,64,200
MA 88,68,200
buffer_load_dwordx4 v[184:187], v0, s[20:23], s35 offen sc1
MA 92,68,204
MA 76,64,204
MA 108,72,204
MA 124,76,204
MA 120,76,200
buffer_load_dwordx4 v[188:191], v130, s[20:23], s35 offen sc1
s_add_u32 s35, s35, 1024
MA 104,72,200
MA 100,72,196
MA 116,76,196
MA 112,76,192
MA 96,72,192
s_waitcnt vmcnt(12) lgkmcnt(0)
s_barrier
MA 0,16,208
TR 48,131,42240
s_add_u32 m0, s38, 25344
MA 16,20,208
buffer_load_dwordx4 v128, s[16:19], s32 offen lds
MA 20,20,212
TR 50,131,42496
MA 4,16,212
TR 52,131,42272
MA 8,16,216
TR 54,131,42528
MA 24,20,216
TR 56,131,42304
MA 28,20,220
buffer_load_dwordx4 v129, s[16:19], s32 offen offset:1056 lds
s_add_u32 s32, s32, s6
MA 12,16,220
TR 58,131,42560
MA 44,24,220
TR 60,131,42336
MA 60,28,220
TR 62,131,42592
MA 56,28,216
TR 64,131,42368
MA 40,24,216
buffer_load_dwordx4 v[192:195], v0, s[20:23], s33 offen sc1
MA 36,24,212
TR 66,131,42624
MA 52,28,212
TR 68,131,42400
MA 48,28,208
TR 70,131,42656
MA 32,24,208
TR 72,131,42432
MA 64,32,208
buffer_load_dwordx4 v[196:199], v130, s[20:23], s33 offen sc1
s_add_u32 s33, s33, s7
MA 80,36,208
TR 74,131,42688
MA 84,36,212
TR 76,131,42464
MA 68,32,212
TR 78,131,42720
MA 72,32,216
MA 88,36,216
buffer_load_dwordx4 v[200:203], v0, s[20:23], s35 offen sc1
MA 92,36,220
MA 76,32,220
MA 108,40,220
MA 124,44,220
MA 120,44,216
buffer_load_dwordx4 v[204:207], v130, s[20:23], s35 offen sc1
s_add_u32 s35, s35, s7
MA 104,40,216
MA 100,40,212
MA 116,44,212
MA 112,44,208
MA 96,40,208
s_waitcnt lgkmcnt(0)
MA 0,48,224
TR 16,131,0
s_add_u32 m0, s38, 33792
MA 16,52,224
buffer_load_dwordx4 v128, s[16:19], s32 offen lds
MA 20,52,228
TR 18,131,256
MA 4,48,228
TR 20,131,32
MA 8,48,232
TR 22,131,288
MA 24,52,232
TR 24,131,64
MA 28,52,236
buffer_load_dwordx4 v129, s[16:19], s32 offen offset:1056 lds
s_add_u32 s32, s32, 65536
MA 12,48,236
TR 26,131,320
MA 44,56,236
TR 28,131,96
MA 60,60,236
TR 30,131,352
MA 56,60,232
TR 32,131,128
MA 40,56,232
buffer_load_dwordx4 v[208:211], v0, s[20:23], s33 offen sc1
MA 36,56,228
TR 34,131,384
MA 52,60,228
TR 36,131,160
MA 48,60,224
TR 38,131,416
MA 32,56,224
TR 40,131,192
MA 64,64,224
buffer_load_dwordx4 v[212:215], v130, s[20:23], s33 offen sc1
s_add_u32 s33, s33, 1024
MA 80,68,224
TR 42,131,448
MA 84,68,228
TR 44,131,224
MA 68,64,228
TR 46,131,480
MA 72,64,232
MA 88,68,232
buffer_load_dwordx4 v[216:219], v0, s[20:23], s35 offen sc1
MA 92,68,236
MA 76,64,236
MA 108,72,236
MA 124,76,236
MA 120,76,232
buffer_load_dwordx4 v[220:223], v130, s[20:23], s35 offen sc1
s_add_u32 s35, s35, 1024
MA 104,72,232
MA 100,72,228
MA 116,76,228
MA 112,76,224
MA 96,72,224
s_waitcnt vmcnt(12) lgkmcnt(0)
s_barrier
MA 0,16,144
TR 48,131,8448
s_add_u32 m0, s38, 42240
MA 16,20,144
buffer_load_dwordx4 v128, s[16:19], s32 offen lds
MA 20,20,148
TR 50,131,8704
MA 4,16,148
TR 52,131,8480
MA 8,16,152
TR 54,131,8736
MA 24,20,152
TR 56,131,8512
MA 28,20,156
buffer_load_dwordx4 v129, s[16:19], s32 offen offset:1056 lds
s_add_u32 s32, s32, 65536
MA 12,16,156
TR 58,131,8768
MA 44,24,156
TR 60,131,8544
MA 60,28,156
TR 62,131,8800
MA 56,28,152
TR 64,131,8576
MA 40,24,152
buffer_load_dwordx4 v[224:227], v0, s[20:23], s33 offen sc1
MA 36,24,148
TR 66,131,8832
MA 52,28,148
TR 68,131,8608
MA 48,28,144
TR 70,131,8864
MA 32,24,144
TR 72,131,8640
MA 64,32,144
buffer_load_dwordx4 v[228:231], v130, s[20:23], s33 offen sc1
s_add_u32 s33, s33, 1024
MA 80,36,144
TR 74,131,8896
MA 84,36,148
TR 76,131,8672
MA 68,32,148
TR 78,131,8928
MA 72,32,152
MA 88,36,152
buffer_load_dwordx4 v[232:235], v0, s[20:23], s35 offen sc1
MA 92,36,156
MA 76,32,156
MA 108,40,156
MA 124,44,156
MA 120,44,152
buffer_load_dwordx4 v[236:239], v130, s[20:23], s35 offen sc1
s_add_u32 s35, s35, 1024
MA 104,40,152
MA 100,40,148
MA 116,44,148
MA 112,44,144
MA 96,40,144
s_waitcnt lgkmcnt(0)
MA 0,48,160
TR 16,131,16896
s_add_u32 m0, s38, 0
MA 16,52,160
buffer_load_dwordx4 v128, s[16:19], s32 offen lds
MA 20,52,164
TR 18,131,17152
MA 4,48,164
TR 20,131,16928
MA 8,48,168
TR 22,131,17184
MA 24,52,168
TR 24,131,16960
MA 28,52,172
buffer_load_dwordx4 v129, s[16:19], s32 offen offset:1056 lds
s_add_u32 s32, s32, 65536
MA 12,48,172
TR 26,131,17216
MA 44,56,172
TR 28,131,16992
MA 60,60,172
TR 30,131,17248
MA 56,60,168
TR 32,131,17024
MA 40,56,168
buffer_load_dwordx4 v[144:147], v0, s[20:23], s33 offen sc1
MA 36,56,164
TR 34,131,17280
MA 52,60,164
TR 36,131,17056
MA 48,60,160
TR 38,131,17312
MA 32,56,160
TR 40,131,17088
MA 64,64,160
buffer_load_dwordx4 v[148:151], v130, s[20:23], s33 offen sc1
s_add_u32 s33, s33, 1024
MA 80,68,160
TR 42,131,17344
MA 84,68,164
TR 44,131,17120
MA 68,64,164
TR 46,131,17376
MA 72,64,168
MA 88,68,168
buffer_load_dwordx4 v[152:155], v0, s[20:23], s35 offen sc1
MA 92,68,172
MA 76,64,172
MA 108,72,172
MA 124,76,172
MA 120,76,168
buffer_load_dwordx4 v[156:159], v130, s[20:23], s35 offen sc1
s_add_u32 s35, s35, 1024
MA 104,72,168
MA 100,72,164
MA 116,76,164
MA 112,76,160
MA 96,72,160
s_waitcnt vmcnt(12) lgkmcnt(0)
s_barrier
MA 0,16,176
TR 48,131,25344
s_add_u32 m0, s38, 8448
MA 16,20,176
buffer_load_dwordx4 v128, s[16:19], s32 offen lds
MA 20,20,180
TR 50,131,25600
MA 4,16,180
TR 52,131,25376
MA 8,16,184
TR 54,131,25632
MA 24,20,184
TR 56,131,25408
MA 28,20,188
buffer_load_dwordx4 v129, s[16:19], s32 offen offset:1056 lds
s_add_u32 s32, s32, s6
MA 12,16,188
TR 58,131,25664
MA 44,24,188
TR 60,131,25440
MA 60,28,188
TR 62,131,25696
MA 56,28,184
TR 64,131,25472
MA 40,24,184
buffer_load_dwordx4 v[160:163], v0, s[20:23], s33 offen sc1
MA 36,24,180
TR 66,131,25728
MA 52,28,180
TR 68,131,25504
MA 48,28,176
TR 70,131,25760
MA 32,24,176
TR 72,131,25536
MA 64,32,176
buffer_load_dwordx4 v[164:167], v130, s[20:23], s33 offen sc1
s_add_u32 s33, s33, s7
MA 80,36,176
TR 74,131,25792
MA 84,36,180
TR 76,131,25568
MA 68,32,180
TR 78,131,25824
MA 72,32,184
MA 88,36,184
buffer_load_dwordx4 v[168:171], v0, s[20:23], s35 offen sc1
MA 92,36,188
MA 76,32,188
MA 108,40,188
MA 124,44,188
MA 120,44,184
buffer_load_dwordx4 v[172:175], v130, s[20:23], s35 offen sc1
s_add_u32 s35, s35, s7
MA 104,40,184
MA 100,40,180
MA 116,44,180
MA 112,44,176
MA 96,40,176
s_waitcnt lgkmcnt(0)
MA 0,48,192
TR 16,131,33792
s_add_u32 m0, s38, 16896
MA 16,52,192
buffer_load_dwordx4 v128, s[16:19], s32 offen lds
MA 20,52,196
TR 18,131,34048
MA 4,48,196
TR 20,131,33824
MA 8,48,200
TR 22,131,34080
MA 24,52,200
TR 24,131,33856
MA 28,52,204
buffer_load_dwordx4 v129, s[16:19], s32 offen offset:1056 lds
s_add_u32 s32, s32, 65536
MA 12,48,204
TR 26,131,34112
MA 44,56,204
TR 28,131,33888
MA 60,60,204
TR 30,131,34144
MA 56,60,200
TR 32,131,33920
MA 40,56,200
buffer_load_dwordx4 v[176:179], v0, s[20:23], s33 offen sc1
MA 36,56,196
TR 34,131,34176
MA 52,60,196
TR 36,131,33952
MA 48,60,192
TR 38,131,34208
MA 32,56,192
TR 40,131,33984
MA 64,64,192
buffer_load_dwordx4 v[180:183], v130, s[20:23], s33 offen sc1
s_add_u32 s33, s33, 1024
MA 80,68,192
TR 42,131,34240
MA 84,68,196
TR 44,131,34016
MA 68,64,196
TR 46,131,34272
MA 72,64,200
MA 88,68,200
buffer_load_dwordx4 v[184:187], v0, s[20:23], s35 offen sc1
MA 92,68,204
MA 76,64,204
MA 108,72,204
MA 124,76,204
MA 120,76,200
buffer_load_dwordx4 v[188:191], v130, s[20:23], s35 offen sc1
s_add_u32 s35, s35, 1024
MA 104,72,200
MA 100,72,196
MA 116,76,196
MA 112,76,192
MA 96,72,192
s_cmp_lg_u32 s37, 3
s_cbranch_scc1 L_p1_k16_0x
buffer_load_dword v3, v15, s[48:51], s54 offen sc1
L_p1_k16_0x:
s_waitcnt vmcnt(12) lgkmcnt(0)
s_barrier
MA 0,16,208
TR 48,131,42240
s_add_u32 m0, s38, 25344
MA 16,20,208
buffer_load_dwordx4 v128, s[16:19], s32 offen lds
MA 20,20,212
TR 50,131,42496
MA 4,16,212
TR 52,131,42272
MA 8,16,216
TR 54,131,42528
MA 24,20,216
TR 56,131,42304
MA 28,20,220
buffer_load_dwordx4 v129, s[16:19], s32 offen offset:1056 lds
s_add_u32 s32, s32, 65536
MA 12,16,220
TR 58,131,42560
MA 44,24,220
TR 60,131,42336
MA 60,28,220
TR 62,131,42592
MA 56,28,216
TR 64,131,42368
MA 40,24,216
buffer_load_dwordx4 v[192:195], v0, s[20:23], s33 offen sc1
MA 36,24,212
TR 66,131,42624
MA 52,28,212
TR 68,131,42400
MA 48,28,208
TR 70,131,42656
MA 32,24,208
TR 72,131,42432
MA 64,32,208
buffer_load_dwordx4 v[196:199], v130, s[20:23], s33 offen sc1
s_add_u32 s33, s33, 1024
MA 80,36,208
TR 74,131,42688
MA 84,36,212
TR 76,131,42464
MA 68,32,212
TR 78,131,42720
MA 72,32,216
MA 88,36,216
buffer_load_dwordx4 v[200:203], v0, s[20:23], s35 offen sc1
MA 92,36,220
MA 76,32,220
MA 108,40,220
MA 124,44,220
MA 120,44,216
buffer_load_dwordx4 v[204:207], v130, s[20:23], s35 offen sc1
s_add_u32 s35, s35, 1024
MA 104,40,216
MA 100,40,212
MA 116,44,212
MA 112,44,208
MA 96,40,208
s_waitcnt lgkmcnt(0)
MA 0,48,224
TR 16,131,0
s_add_u32 m0, s38, 33792
MA 16,52,224
buffer_load_dwordx4 v128, s[16:19], s32 offen lds
MA 20,52,228
TR 18,131,256
MA 4,48,228
TR 20,131,32
MA 8,48,232
TR 22,131,288
MA 24,52,232
TR 24,131,64
MA 28,52,236
buffer_load_dwordx4 v129, s[16:19], s32 offen offset:1056 lds
s_add_u32 s32, s32, 65536
MA 12,48,236
TR 26,131,320
MA 44,56,236
TR 28,131,96
MA 60,60,236
TR 30,131,352
MA 56,60,232
TR 32,131,128
MA 40,56,232
buffer_load_dwordx4 v[208:211], v0, s[20:23], s33 offen sc1
MA 36,56,228
TR 34,131,384
MA 52,60,228
TR 36,131,160
MA 48,60,224
TR 38,131,416
MA 32,56,224
TR 40,131,192
MA 64,64,224
buffer_load_dwordx4 v[212:215], v130, s[20:23], s33 offen sc1
s_add_u32 s33, s33, 1024
MA 80,68,224
TR 42,131,448
MA 84,68,228
TR 44,131,224
MA 68,64,228
TR 46,131,480
MA 72,64,232
MA 88,68,232
buffer_load_dwordx4 v[216:219], v0, s[20:23], s35 offen sc1
MA 92,68,236
MA 76,64,236
MA 108,72,236
MA 124,76,236
MA 120,76,232
buffer_load_dwordx4 v[220:223], v130, s[20:23], s35 offen sc1
s_add_u32 s35, s35, 1024
MA 104,72,232
MA 100,72,228
MA 116,76,228
MA 112,76,224
MA 96,72,224
s_sub_u32 s37, s37, 1
s_cmp_lg_u32 s37, 0
s_cbranch_scc1 L_p1_0
s_waitcnt vmcnt(12) lgkmcnt(0)
s_barrier
MA 0,16,144
TR 48,131,8448
s_add_u32 m0, s38, 42240
MA 16,20,144
buffer_load_dwordx4 v128, s[16:19], s32 offen lds
MA 20,20,148
TR 50,131,8704
MA 4,16,148
TR 52,131,8480
MA 8,16,152
TR 54,131,8736
MA 24,20,152
TR 56,131,8512
MA 28,20,156
buffer_load_dwordx4 v129, s[16:19], s32 offen offset:1056 lds
s_add_u32 s32, s32, s6
MA 12,16,156
TR 58,131,8768
MA 44,24,156
TR 60,131,8544
MA 60,28,156
TR 62,131,8800
MA 56,28,152
TR 64,131,8576
MA 40,24,152
buffer_load_dwordx4 v[224:227], v0, s[20:23], s33 offen sc1
MA 36,24,148
TR 66,131,8832
MA 52,28,148
TR 68,131,8608
MA 48,28,144
TR 70,131,8864
MA 32,24,144
TR 72,131,8640
MA 64,32,144
buffer_load_dwordx4 v[228:231], v130, s[20:23], s33 offen sc1
s_add_u32 s33, s33, s7
MA 80,36,144
TR 74,131,8896
MA 84,36,148
TR 76,131,8672
MA 68,32,148
TR 78,131,8928
MA 72,32,152
MA 88,36,152
buffer_load_dwordx4 v[232:235], v0, s[20:23], s35 offen sc1
MA 92,36,156
MA 76,32,156
MA 108,40,156
MA 124,44,156
MA 120,44,152
buffer_load_dwordx4 v[236:239], v130, s[20:23], s35 offen sc1
s_add_u32 s35, s35, s7
MA 104,40,152
MA 100,40,148
MA 116,44,148
MA 112,44,144
MA 96,40,144
s_waitcnt lgkmcnt(0)
MA 0,48,160
TR 16,131,16896
MA 16,52,160
MA 20,52,164
TR 18,131,17152
MA 4,48,164
TR 20,131,16928
MA 8,48,168
TR 22,131,17184
MA 24,52,168
TR 24,131,16960
MA 28,52,172
MA 12,48,172
TR 26,131,17216
MA 44,56,172
TR 28,131,16992
MA 60,60,172
TR 30,131,17248
MA 56,60,168
TR 32,131,17024
MA 40,56,168
MA 36,56,164
TR 34,131,17280
MA 52,60,164
TR 36,131,17056
MA 48,60,160
TR 38,131,17312
MA 32,56,160
TR 40,131,17088
MA 64,64,160
MA 80,68,160
TR 42,131,17344
MA 84,68,164
TR 44,131,17120
MA 68,64,164
TR 46,131,17376
MA 72,64,168
MA 88,68,168
MA 92,68,172
MA 76,64,172
MA 108,72,172
MA 124,76,172
MA 120,76,168
MA 104,72,168
MA 100,72,164
MA 116,76,164
MA 112,76,160
MA 96,72,160
s_waitcnt vmcnt(6) lgkmcnt(0)
s_barrier
MA 0,16,176
TR 48,131,25344
MA 16,20,176
MA 20,20,180
TR 50,131,25600
MA 4,16,180
TR 52,131,25376
MA 8,16,184
TR 54,131,25632
MA 24,20,184
TR 56,131,25408
MA 28,20,188
MA 12,16,188
TR 58,131,25664
MA 44,24,188
TR 60,131,25440
MA 60,28,188
TR 62,131,25696
MA 56,28,184
TR 64,131,25472
MA 40,24,184
MA 36,24,180
TR 66,131,25728
MA 52,28,180
TR 68,131,25504
MA 48,28,176
TR 70,131,25760
MA 32,24,176
TR 72,131,25536
MA 64,32,176
MA 80,36,176
TR 74,131,25792
MA 84,36,180
TR 76,131,25568
MA 68,32,180
TR 78,131,25824
MA 72,32,184
MA 88,36,184
MA 92,36,188
MA 76,32,188
MA 108,40,188
MA 124,44,188
MA 120,44,184
MA 104,40,184
MA 100,40,180
MA 116,44,180
MA 112,44,176
MA 96,40,176
s_waitcnt lgkmcnt(0)
MA 0,48,192
TR 16,131,33792
MA 16,52,192
MA 20,52,196
TR 18,131,34048
MA 4,48,196
TR 20,131,33824
MA 8,48,200
TR 22,131,34080
MA 24,52,200
TR 24,131,33856
MA 28,52,204
MA 12,48,204
TR 26,131,34112
MA 44,56,204
TR 28,131,33888
MA 60,60,204
TR 30,131,34144
MA 56,60,200
TR 32,131,33920
MA 40,56,200
MA 36,56,196
TR 34,131,34176
MA 52,60,196
TR 36,131,33952
MA 48,60,192
TR 38,131,34208
MA 32,56,192
TR 40,131,33984
MA 64,64,192
MA 80,68,192
TR 42,131,34240
MA 84,68,196
TR 44,131,34016
MA 68,64,196
TR 46,131,34272
MA 72,64,200
MA 88,68,200
MA 92,68,204
MA 76,64,204
MA 108,72,204
MA 124,76,204
MA 120,76,200
MA 104,72,200
MA 100,72,196
MA 116,76,196
MA 112,76,192
MA 96,72,192
s_waitcnt vmcnt(0) lgkmcnt(0)
s_barrier
MA 0,16,208
TR 48,131,42240
MA 16,20,208
MA 20,20,212
TR 50,131,42496
MA 4,16,212
TR 52,131,42272
MA 8,16,216
TR 54,131,42528
MA 24,20,216
TR 56,131,42304
MA 28,20,220
MA 12,16,220
TR 58,131,42560
MA 44,24,220
TR 60,131,42336
MA 60,28,220
TR 62,131,42592
MA 56,28,216
TR 64,131,42368
MA 40,24,216
MA 36,24,212
TR 66,131,42624
MA 52,28,212
TR 68,131,42400
MA 48,28,208
TR 70,131,42656
MA 32,24,208
TR 72,131,42432
MA 64,32,208
MA 80,36,208
TR 74,131,42688
MA 84,36,212
TR 76,131,42464
MA 68,32,212
TR 78,131,42720
MA 72,32,216
MA 88,36,216
MA 92,36,220
MA 76,32,220
MA 108,40,220
MA 124,44,220
MA 120,44,216
MA 104,40,216
MA 100,40,212
MA 116,44,212
MA 112,44,208
MA 96,40,208
s_waitcnt lgkmcnt(0)
MA 0,48,224
MA 16,52,224
MA 20,52,228
MA 4,48,228
MA 8,48,232
MA 24,52,232
MA 28,52,236
MA 12,48,236
MA 44,56,236
MA 60,60,236
MA 56,60,232
MA 40,56,232
MA 36,56,228
MA 52,60,228
MA 48,60,224
MA 32,56,224
MA 64,64,224
MA 80,68,224
MA 84,68,228
MA 68,64,228
MA 72,64,232
MA 88,68,232
MA 92,68,236
MA 76,64,236
MA 108,72,236
MA 124,76,236
MA 120,76,232
MA 104,72,232
MA 100,72,228
MA 116,76,228
MA 112,76,224
MA 96,72,224
s_nop 7
AR 16,0
AR 17,1
AR 18,2
AR 19,3
AR 20,4
AR 21,5
AR 22,6
AR 23,7
CV 24,16,17
CV 25,18,19
CV 26,20,21
CV 27,22,23
buffer_store_dwordx4 v[24:27], v0, s[44:47], s62 offen sc1
AR 28,16
AR 29,17
AR 30,18
AR 31,19
AR 32,20
AR 33,21
AR 34,22
AR 35,23
CV 36,28,29
CV 37,30,31
CV 38,32,33
CV 39,34,35
buffer_store_dwordx4 v[36:39], v0, s[44:47], s62 offen offset:1024 sc1
AR 40,32
AR 41,33
AR 42,34
AR 43,35
AR 44,36
AR 45,37
AR 46,38
AR 47,39
CV 48,40,41
CV 49,42,43
CV 50,44,45
CV 51,46,47
buffer_store_dwordx4 v[48:51], v0, s[44:47], s62 offen offset:2048 sc1
AR 16,48
AR 17,49
AR 18,50
AR 19,51
AR 20,52
AR 21,53
AR 22,54
AR 23,55
CV 24,16,17
CV 25,18,19
CV 26,20,21
CV 27,22,23
buffer_store_dwordx4 v[24:27], v0, s[44:47], s62 offen offset:3072 sc1
s_add_u32 s62, s62, 4096
AR 28,64
AR 29,65
AR 30,66
AR 31,67
AR 32,68
AR 33,69
AR 34,70
AR 35,71
CV 36,28,29
CV 37,30,31
CV 38,32,33
CV 39,34,35
buffer_store_dwordx4 v[36:39], v0, s[44:47], s62 offen sc1
AR 40,80
AR 41,81
AR 42,82
AR 43,83
AR 44,84
AR 45,85
AR 46,86
AR 47,87
CV 48,40,41
CV 49,42,43
CV 50,44,45
CV 51,46,47
buffer_store_dwordx4 v[48:51], v0, s[44:47], s62 offen offset:1024 sc1
AR 16,96
AR 17,97
AR 18,98
AR 19,99
AR 20,100
AR 21,101
AR 22,102
AR 23,103
CV 24,16,17
CV 25,18,19
CV 26,20,21
CV 27,22,23
buffer_store_dwordx4 v[24:27], v0, s[44:47], s62 offen offset:2048 sc1
AR 28,112
AR 29,113
AR 30,114
AR 31,115
AR 32,116
AR 33,117
AR 34,118
AR 35,119
CV 36,28,29
CV 37,30,31
CV 38,32,33
CV 39,34,35
buffer_store_dwordx4 v[36:39], v0, s[44:47], s62 offen offset:3072 sc1
s_add_u32 s62, s62, 4096
AR 40,8
AR 41,9
AR 42,10
AR 43,11
AR 44,12
AR 45,13
AR 46,14
AR 47,15
CV 48,40,41
CV 49,42,43
CV 50,44,45
CV 51,46,47
buffer_store_dwordx4 v[48:51], v0, s[44:47], s62 offen sc1
AR 16,24
AR 17,25
AR 18,26
AR 19,27
AR 20,28
AR 21,29
AR 22,30
AR 23,31
CV 24,16,17
CV 25,18,19
CV 26,20,21
CV 27,22,23
buffer_store_dwordx4 v[24:27], v0, s[44:47], s62 offen offset:1024 sc1
AR 28,40
AR 29,41
AR 30,42
AR 31,43
AR 32,44
AR 33,45
AR 34,46
AR 35,47
CV 36,28,29
CV 37,30,31
CV 38,32,33
CV 39,34,35
buffer_store_dwordx4 v[36:39], v0, s[44:47], s62 offen offset:2048 sc1
AR 40,56
AR 41,57
AR 42,58
AR 43,59
AR 44,60
AR 45,61
AR 46,62
AR 47,63
CV 48,40,41
CV 49,42,43
CV 50,44,45
CV 51,46,47
buffer_store_dwordx4 v[48:51], v0, s[44:47], s62 offen offset:3072 sc1
s_add_u32 s62, s62, 4096
AR 16,72
AR 17,73
AR 18,74
AR 19,75
AR 20,76
AR 21,77
AR 22,78
AR 23,79
CV 24,16,17
CV 25,18,19
CV 26,20,21
CV 27,22,23
buffer_store_dwordx4 v[24:27], v0, s[44:47], s62 offen sc1
AR 28,88
AR 29,89
AR 30,90
AR 31,91
AR 32,92
AR 33,93
AR 34,94
AR 35,95
CV 36,28,29
CV 37,30,31
CV 38,32,33
CV 39,34,35
buffer_store_dwordx4 v[36:39], v0, s[44:47], s62 offen offset:1024 sc1
AR 40,104
AR 41,105
AR 42,106
AR 43,107
AR 44,108
AR 45,109
AR 46,110
AR 47,111
CV 48,40,41
CV 49,42,43
CV 50,44,45
CV 51,46,47
buffer_store_dwordx4 v[48:51], v0, s[44:47], s62 offen offset:2048 sc1
AR 16,120
AR 17,121
AR 18,122
AR 19,123
AR 20,124
AR 21,125
AR 22,126
AR 23,127
CV 24,16,17
CV 25,18,19
CV 26,20,21
CV 27,22,23
buffer_store_dwordx4 v[24:27], v0, s[44:47], s62 offen offset:3072 sc1
s_add_u32 s62, s62, 4096
s_waitcnt vmcnt(0)
v_mov_b32 v16, s100
s_mov_b64 exec, 1
buffer_store_dword v16, off, s[48:51], s63 sc1
s_mov_b64 exec, -1
s_endpgm
L_p1o_slow:
s_mov_b32 s61, s37
s_mov_b32 s37, 0
L_p1o_poll:
buffer_load_dword v3, v15, s[48:51], s54 offen sc1
s_waitcnt vmcnt(0)
v_cmp_ne_u32 vcc, s100, v3
s_add_u32 s37, s37, 1
s_cmp_ge_u32 s37, 65536
s_cbranch_scc1 L_p1o_poll_done
s_cbranch_vccnz L_p1o_poll
L_p1o_poll_done:
s_mov_b32 s37, s61
s_branch L_p1o_ok
L_a_eslow:
s_mov_b32 s37, 0
L_a_epoll:
buffer_load_dword v12, v15, s[48:51], s59 offen sc1
s_waitcnt vmcnt(0)
v_cmp_ne_u32 vcc, s100, v12
s_add_u32 s37, s37, 1
s_cmp_ge_u32 s37, 65536
s_cbranch_scc1 L_a_epoll_done
s_cbranch_vccnz L_a_epoll
L_a_epoll_done:
s_branch L_a_eok
L_a_spill:
s_add_u32 s20, s8, 0x8000000
s_addc_u32 s21, s9, 0
s_mov_b32 s22, 0x800000
s_mov_b32 s23, 0x00020000
s_and_b32 s58, s2, 127
s_lshl_b32 s58, s58, 2
s_add_u32 s58, s58, s10
s_lshl_b32 s58, s58, 14
v_lshlrev_b32 v2, 4, v1
buffer_store_dwordx4 v[128:131], v2, s[20:23], s58 offen offset:0
buffer_store_dwordx4 v[132:135], v2, s[20:23], s58 offen offset:1024
buffer_store_dwordx4 v[136:139], v2, s[20:23], s58 offen offset:2048
buffer_store_dwordx4 v[140:143], v2, s[20:23], s58 offen offset:3072
s_add_u32 s58, s58, 4096
buffer_store_dwordx4 v[144:147], v2, s[20:23], s58 offen offset:0
buffer_store_dwordx4 v[148:151], v2, s[20:23], s58 offen offset:1024
buffer_store_dwordx4 v[152:155], v2, s[20:23], s58 offen offset:2048
buffer_store_dwordx4 v[156:159], v2, s[20:23], s58 offen offset:3072
s_add_u32 s58, s58, 4096
buffer_store_dwordx4 v[160:163], v2, s[20:23], s58 offen offset:0
buffer_store_dwordx4 v[164:167], v2, s[20:23], s58 offen offset:1024
buffer_store_dwordx4 v[168:171], v2, s[20:23], s58 offen offset:2048
buffer_store_dwordx4 v[172:175], v2, s[20:23], s58 offen offset:3072
s_add_u32 s58, s58, 4096
buffer_store_dwordx4 v[176:179], v2, s[20:23], s58 offen offset:0
buffer_store_dwordx4 v[180:183], v2, s[20:23], s58 offen offset:1024
buffer_store_dwordx4 v[184:187], v2, s[20:23], s58 offen offset:2048
buffer_store_dwordx4 v[188:191], v2, s[20:23], s58 offen offset:3072
s_add_u32 s58, s58, 4096
s_waitcnt vmcnt(0)
s_branch L_a_spilled
L_a_kvslow:
s_mov_b32 s37, 0
L_a_kvpoll:
buffer_load_dword v242, v241, s[48:51], s61 offen sc1
s_waitcnt vmcnt(0)
v_cmp_ne_u32 vcc, s100, v242
s_add_u32 s37, s37, 1
s_cmp_ge_u32 s37, 65536
s_cbranch_scc1 L_a_kvpoll_done
s_cbranch_vccnz L_a_kvpoll
L_a_kvpoll_done:
s_branch L_a_kvok
L_a_fallback:
s_waitcnt vmcnt(0)
v_lshlrev_b32 v3, 4, v1
v_mov_b32 v144, 0xff800000
v_mov_b32 v145, 0xff800000
v_mov_b32 v146, 0xff800000
v_mov_b32 v147, 0xff800000
s_mov_b32 s37, 0
L_a_fbb1:
buffer_load_dwordx4 v[16:19], v3, s[24:27], s37 offen sc1
buffer_load_dwordx4 v[20:23], v3, s[24:27], s37 offen offset:1024 sc1
buffer_load_dwordx4 v[24:27], v3, s[24:27], s37 offen offset:2048 sc1
buffer_load_dwordx4 v[28:31], v3, s[24:27], s37 offen offset:3072 sc1
s_add_u32 s60, s37, 4096
buffer_load_dwordx4 v[32:35], v3, s[24:27], s60 offen sc1
buffer_load_dwordx4 v[36:39], v3, s[24:27], s60 offen offset:1024 sc1
buffer_load_dwordx4 v[40:43], v3, s[24:27], s60 offen offset:2048 sc1
buffer_load_dwordx4 v[44:47], v3, s[24:27], s60 offen offset:3072 sc1
s_waitcnt vmcnt(0)
v_mfma_f32_16x16x32_bf16 v[80:83], v[16:19], v[192:195], 0
v_mfma_f32_16x16x32_bf16 v[88:91], v[16:19], v[208:211], 0
v_mfma_f32_16x16x32_bf16 v[92:95], v[20:23], v[208:211], 0
v_mfma_f32_16x16x32_bf16 v[84:87], v[20:23], v[192:195], 0
v_mfma_f32_16x16x32_bf16 v[80:83], v[24:27], v[196:199], v[80:83]
v_mfma_f32_16x16x32_bf16 v[88:91], v[24:27], v[212:215], v[88:91]
v_mfma_f32_16x16x32_bf16 v[92:95], v[28:31], v[212:215], v[92:95]
v_mfma_f32_16x16x32_bf16 v[84:87], v[28:31], v[196:199], v[84:87]
v_mfma_f32_16x16x32_bf16 v[80:83], v[32:35], v[200:203], v[80:83]
v_mfma_f32_16x16x32_bf16 v[88:91], v[32:35], v[216:219], v[88:91]
v_mfma_f32_16x16x32_bf16 v[92:95], v[36:39], v[216:219], v[92:95]
v_mfma_f32_16x16x32_bf16 v[84:87], v[36:39], v[200:203], v[84:87]
v_mfma_f32_16x16x32_bf16 v[80:83], v[40:43], v[204:207], v[80:83]
v_mfma_f32_16x16x32_bf16 v[88:91], v[40:43], v[220:223], v[88:91]
v_mfma_f32_16x16x32_bf16 v[92:95], v[44:47], v[220:223], v[92:95]
v_mfma_f32_16x16x32_bf16 v[84:87], v[44:47], v[204:207], v[84:87]
s_nop 15
v_max3_f32 v144, v144, v80, v81
v_max3_f32 v144, v144, v82, v83
v_max3_f32 v144, v144, v84, v85
v_max3_f32 v144, v144, v86, v87
v_max3_f32 v145, v145, v88, v89
v_max3_f32 v145, v145, v90, v91
v_max3_f32 v145, v145, v92, v93
v_max3_f32 v145, v145, v94, v95
s_nop 1
v_mfma_f32_16x16x32_bf16 v[96:99], v[16:19], v[224:227], 0
v_mfma_f32_16x16x32_bf16 v[104:107], v[16:19], v[240:243], 0
v_mfma_f32_16x16x32_bf16 v[108:111], v[20:23], v[240:243], 0
v_mfma_f32_16x16x32_bf16 v[100:103], v[20:23], v[224:227], 0
v_mfma_f32_16x16x32_bf16 v[96:99], v[24:27], v[228:231], v[96:99]
v_mfma_f32_16x16x32_bf16 v[104:107], v[24:27], v[244:247], v[104:107]
v_mfma_f32_16x16x32_bf16 v[108:111], v[28:31], v[244:247], v[108:111]
v_mfma_f32_16x16x32_bf16 v[100:103], v[28:31], v[228:231], v[100:103]
v_mfma_f32_16x16x32_bf16 v[96:99], v[32:35], v[232:235], v[96:99]
v_mfma_f32_16x16x32_bf16 v[104:107], v[32:35], v[248:251], v[104:107]
v_mfma_f32_16x16x32_bf16 v[108:111], v[36:39], v[248:251], v[108:111]
v_mfma_f32_16x16x32_bf16 v[100:103], v[36:39], v[232:235], v[100:103]
v_mfma_f32_16x16x32_bf16 v[96:99], v[40:43], v[236:239], v[96:99]
v_mfma_f32_16x16x32_bf16 v[104:107], v[40:43], v[252:255], v[104:107]
v_mfma_f32_16x16x32_bf16 v[108:111], v[44:47], v[252:255], v[108:111]
v_mfma_f32_16x16x32_bf16 v[100:103], v[44:47], v[236:239], v[100:103]
s_nop 15
v_max3_f32 v146, v146, v96, v97
v_max3_f32 v146, v146, v98, v99
v_max3_f32 v146, v146, v100, v101
v_max3_f32 v146, v146, v102, v103
v_max3_f32 v147, v147, v104, v105
v_max3_f32 v147, v147, v106, v107
v_max3_f32 v147, v147, v108, v109
v_max3_f32 v147, v147, v110, v111
s_nop 1
s_add_u32 s37, s37, 0x4000
s_cmp_lg_u32 s37, 0x40000
s_cbranch_scc1 L_a_fbb1
v_mov_b32 v148, v144
v_mov_b32 v149, v145
v_mov_b32 v150, v146
v_mov_b32 v151, v147
s_nop 1
v_permlane16_swap_b32 v144, v148
v_permlane16_swap_b32 v145, v149
v_permlane16_swap_b32 v146, v150
v_permlane16_swap_b32 v147, v151
s_nop 1
v_max_f32 v144, v144, v148
v_max_f32 v145, v145, v149
v_max_f32 v146, v146, v150
v_max_f32 v147, v147, v151
v_mov_b32 v148, v144
v_mov_b32 v149, v145
v_mov_b32 v150, v146
v_mov_b32 v151, v147
s_nop 1
v_permlane32_swap_b32 v144, v148
v_permlane32_swap_b32 v145, v149
v_permlane32_swap_b32 v146, v150
v_permlane32_swap_b32 v147, v151
s_nop 1
v_max_f32 v144, v144, v148
v_max_f32 v145, v145, v149
v_max_f32 v146, v146, v150
v_max_f32 v147, v147, v151
v_mov_b32 v8, 0
v_mov_b32 v9, 0
v_mov_b32 v10, 0
v_mov_b32 v13, 0
AW 128,0
AW 129,0
AW 130,0
AW 131,0
AW 132,0
AW 133,0
AW 134,0
AW 135,0
AW 136,0
AW 137,0
AW 138,0
AW 139,0
AW 140,0
AW 141,0
AW 142,0
AW 143,0
AW 144,0
AW 145,0
AW 146,0
AW 147,0
AW 148,0
AW 149,0
AW 150,0
AW 151,0
AW 152,0
AW 153,0
AW 154,0
AW 155,0
AW 156,0
AW 157,0
AW 158,0
AW 159,0
AW 160,0
AW 161,0
AW 162,0
AW 163,0
AW 164,0
AW 165,0
AW 166,0
AW 167,0
AW 168,0
AW 169,0
AW 170,0
AW 171,0
AW 172,0
AW 173,0
AW 174,0
AW 175,0
AW 176,0
AW 177,0
AW 178,0
AW 179,0
AW 180,0
AW 181,0
AW 182,0
AW 183,0
AW 184,0
AW 185,0
AW 186,0
AW 187,0
AW 188,0
AW 189,0
AW 190,0
AW 191,0
AW 192,0
AW 193,0
AW 194,0
AW 195,0
AW 196,0
AW 197,0
AW 198,0
AW 199,0
AW 200,0
AW 201,0
AW 202,0
AW 203,0
AW 204,0
AW 205,0
AW 206,0
AW 207,0
AW 208,0
AW 209,0
AW 210,0
AW 211,0
AW 212,0
AW 213,0
AW 214,0
AW 215,0
AW 216,0
AW 217,0
AW 218,0
AW 219,0
AW 220,0
AW 221,0
AW 222,0
AW 223,0
AW 224,0
AW 225,0
AW 226,0
AW 227,0
AW 228,0
AW 229,0
AW 230,0
AW 231,0
AW 232,0
AW 233,0
AW 234,0
AW 235,0
AW 236,0
AW 237,0
AW 238,0
AW 239,0
AW 240,0
AW 241,0
AW 242,0
AW 243,0
AW 244,0
AW 245,0
AW 246,0
AW 247,0
AW 248,0
AW 249,0
AW 250,0
AW 251,0
AW 252,0
AW 253,0
AW 254,0
AW 255,0
s_mov_b32 s37, 0
L_a_fbb2:
buffer_load_dwordx4 v[16:19], v3, s[24:27], s37 offen sc1
buffer_load_dwordx4 v[20:23], v3, s[24:27], s37 offen offset:1024 sc1
buffer_load_dwordx4 v[24:27], v3, s[24:27], s37 offen offset:2048 sc1
buffer_load_dwordx4 v[28:31], v3, s[24:27], s37 offen offset:3072 sc1
s_add_u32 s60, s37, 4096
buffer_load_dwordx4 v[32:35], v3, s[24:27], s60 offen sc1
buffer_load_dwordx4 v[36:39], v3, s[24:27], s60 offen offset:1024 sc1
buffer_load_dwordx4 v[40:43], v3, s[24:27], s60 offen offset:2048 sc1
buffer_load_dwordx4 v[44:47], v3, s[24:27], s60 offen offset:3072 sc1
s_add_u32 s60, s37, 8192
buffer_load_dwordx4 v[48:51], v3, s[24:27], s60 offen sc1
buffer_load_dwordx4 v[52:55], v3, s[24:27], s60 offen offset:1024 sc1
buffer_load_dwordx4 v[56:59], v3, s[24:27], s60 offen offset:2048 sc1
buffer_load_dwordx4 v[60:63], v3, s[24:27], s60 offen offset:3072 sc1
s_add_u32 s60, s37, 12288
buffer_load_dwordx4 v[64:67], v3, s[24:27], s60 offen sc1
buffer_load_dwordx4 v[68:71], v3, s[24:27], s60 offen offset:1024 sc1
buffer_load_dwordx4 v[72:75], v3, s[24:27], s60 offen offset:2048 sc1
buffer_load_dwordx4 v[76:79], v3, s[24:27], s60 offen offset:3072 sc1
s_waitcnt vmcnt(0)
v_mfma_f32_16x16x32_bf16 v[80:83], v[16:19], v[192:195], 0
v_mfma_f32_16x16x32_bf16 v[88:91], v[16:19], v[208:211], 0
v_mfma_f32_16x16x32_bf16 v[92:95], v[20:23], v[208:211], 0
v_mfma_f32_16x16x32_bf16 v[84:87], v[20:23], v[192:195], 0
v_mfma_f32_16x16x32_bf16 v[80:83], v[24:27], v[196:199], v[80:83]
v_mfma_f32_16x16x32_bf16 v[88:91], v[24:27], v[212:215], v[88:91]
v_mfma_f32_16x16x32_bf16 v[92:95], v[28:31], v[212:215], v[92:95]
v_mfma_f32_16x16x32_bf16 v[84:87], v[28:31], v[196:199], v[84:87]
v_mfma_f32_16x16x32_bf16 v[80:83], v[32:35], v[200:203], v[80:83]
v_mfma_f32_16x16x32_bf16 v[88:91], v[32:35], v[216:219], v[88:91]
v_mfma_f32_16x16x32_bf16 v[92:95], v[36:39], v[216:219], v[92:95]
v_mfma_f32_16x16x32_bf16 v[84:87], v[36:39], v[200:203], v[84:87]
v_mfma_f32_16x16x32_bf16 v[80:83], v[40:43], v[204:207], v[80:83]
v_mfma_f32_16x16x32_bf16 v[88:91], v[40:43], v[220:223], v[88:91]
v_mfma_f32_16x16x32_bf16 v[92:95], v[44:47], v[220:223], v[92:95]
v_mfma_f32_16x16x32_bf16 v[84:87], v[44:47], v[204:207], v[84:87]
s_nop 15
v_sub_f32 v80, v80, v144
v_sub_f32 v81, v81, v144
v_sub_f32 v82, v82, v144
v_sub_f32 v83, v83, v144
v_sub_f32 v84, v84, v144
v_sub_f32 v85, v85, v144
v_sub_f32 v86, v86, v144
v_sub_f32 v87, v87, v144
v_sub_f32 v88, v88, v145
v_sub_f32 v89, v89, v145
v_sub_f32 v90, v90, v145
v_sub_f32 v91, v91, v145
v_sub_f32 v92, v92, v145
v_sub_f32 v93, v93, v145
v_sub_f32 v94, v94, v145
v_sub_f32 v95, v95, v145
v_exp_f32 v80, v80
v_exp_f32 v81, v81
v_exp_f32 v82, v82
v_add_f32 v8, v8, v80
v_add_f32 v8, v8, v81
v_exp_f32 v83, v83
CV 112,80,81
v_add_f32 v8, v8, v82
v_exp_f32 v84, v84
CV 113,82,83
v_add_f32 v8, v8, v83
v_exp_f32 v85, v85
v_exp_f32 v86, v86
v_add_f32 v8, v8, v84
CV 114,84,85
v_exp_f32 v87, v87
v_add_f32 v8, v8, v85
v_add_f32 v8, v8, v86
v_exp_f32 v88, v88
CV 115,86,87
v_add_f32 v8, v8, v87
v_exp_f32 v89, v89
v_exp_f32 v90, v90
v_add_f32 v9, v9, v88
CV 116,88,89
v_exp_f32 v91, v91
v_add_f32 v9, v9, v89
v_add_f32 v9, v9, v90
v_exp_f32 v92, v92
CV 117,90,91
v_add_f32 v9, v9, v91
v_exp_f32 v93, v93
v_exp_f32 v94, v94
v_add_f32 v9, v9, v92
CV 118,92,93
v_exp_f32 v95, v95
v_add_f32 v9, v9, v93
v_add_f32 v9, v9, v94
CV 119,94,95
v_add_f32 v9, v9, v95
s_nop 1
MA 128,48,112
MA 160,48,116
MA 164,52,116
MA 132,52,112
MA 136,56,112
MA 168,56,116
MA 172,60,116
MA 140,60,112
MA 144,64,112
MA 176,64,116
MA 180,68,116
MA 148,68,112
MA 152,72,112
MA 184,72,116
MA 188,76,116
MA 156,76,112
v_mfma_f32_16x16x32_bf16 v[96:99], v[16:19], v[224:227], 0
v_mfma_f32_16x16x32_bf16 v[104:107], v[16:19], v[240:243], 0
v_mfma_f32_16x16x32_bf16 v[108:111], v[20:23], v[240:243], 0
v_mfma_f32_16x16x32_bf16 v[100:103], v[20:23], v[224:227], 0
v_mfma_f32_16x16x32_bf16 v[96:99], v[24:27], v[228:231], v[96:99]
v_mfma_f32_16x16x32_bf16 v[104:107], v[24:27], v[244:247], v[104:107]
v_mfma_f32_16x16x32_bf16 v[108:111], v[28:31], v[244:247], v[108:111]
v_mfma_f32_16x16x32_bf16 v[100:103], v[28:31], v[228:231], v[100:103]
v_mfma_f32_16x16x32_bf16 v[96:99], v[32:35], v[232:235], v[96:99]
v_mfma_f32_16x16x32_bf16 v[104:107], v[32:35], v[248:251], v[104:107]
v_mfma_f32_16x16x32_bf16 v[108:111], v[36:39], v[248:251], v[108:111]
v_mfma_f32_16x16x32_bf16 v[100:103], v[36:39], v[232:235], v[100:103]
v_mfma_f32_16x16x32_bf16 v[96:99], v[40:43], v[236:239], v[96:99]
v_mfma_f32_16x16x32_bf16 v[104:107], v[40:43], v[252:255], v[104:107]
v_mfma_f32_16x16x32_bf16 v[108:111], v[44:47], v[252:255], v[108:111]
v_mfma_f32_16x16x32_bf16 v[100:103], v[44:47], v[236:239], v[100:103]
s_nop 15
v_sub_f32 v96, v96, v146
v_sub_f32 v97, v97, v146
v_sub_f32 v98, v98, v146
v_sub_f32 v99, v99, v146
v_sub_f32 v100, v100, v146
v_sub_f32 v101, v101, v146
v_sub_f32 v102, v102, v146
v_sub_f32 v103, v103, v146
v_sub_f32 v104, v104, v147
v_sub_f32 v105, v105, v147
v_sub_f32 v106, v106, v147
v_sub_f32 v107, v107, v147
v_sub_f32 v108, v108, v147
v_sub_f32 v109, v109, v147
v_sub_f32 v110, v110, v147
v_sub_f32 v111, v111, v147
v_exp_f32 v96, v96
v_exp_f32 v97, v97
v_exp_f32 v98, v98
v_add_f32 v10, v10, v96
v_add_f32 v10, v10, v97
v_exp_f32 v99, v99
CV 120,96,97
v_add_f32 v10, v10, v98
v_exp_f32 v100, v100
CV 121,98,99
v_add_f32 v10, v10, v99
v_exp_f32 v101, v101
v_exp_f32 v102, v102
v_add_f32 v10, v10, v100
CV 122,100,101
v_exp_f32 v103, v103
v_add_f32 v10, v10, v101
v_add_f32 v10, v10, v102
v_exp_f32 v104, v104
CV 123,102,103
v_add_f32 v10, v10, v103
v_exp_f32 v105, v105
v_exp_f32 v106, v106
v_add_f32 v13, v13, v104
CV 124,104,105
v_exp_f32 v107, v107
v_add_f32 v13, v13, v105
v_add_f32 v13, v13, v106
v_exp_f32 v108, v108
CV 125,106,107
v_add_f32 v13, v13, v107
v_exp_f32 v109, v109
v_exp_f32 v110, v110
v_add_f32 v13, v13, v108
CV 126,108,109
v_exp_f32 v111, v111
v_add_f32 v13, v13, v109
v_add_f32 v13, v13, v110
CV 127,110,111
v_add_f32 v13, v13, v111
s_nop 1
MA 192,48,120
MA 224,48,124
MA 228,52,124
MA 196,52,120
MA 200,56,120
MA 232,56,124
MA 236,60,124
MA 204,60,120
MA 208,64,120
MA 240,64,124
MA 244,68,124
MA 212,68,120
MA 216,72,120
MA 248,72,124
MA 252,76,124
MA 220,76,120
s_add_u32 s37, s37, 0x4000
s_cmp_lg_u32 s37, 0x40000
s_cbranch_scc1 L_a_fbb2
s_nop 1
v_permlane32_swap_b32 v8, v10
v_permlane32_swap_b32 v9, v13
v_add_f32 v8, v8, v10
v_add_f32 v9, v9, v13
s_nop 1
v_permlane16_swap_b32 v8, v9
s_nop 0
v_add_f32 v8, v8, v9
s_nop 7
s_cmp_eq_u32 s58, 0
s_cbranch_scc1 L_a_final
v_mov_b32 v200, v128
v_mov_b32 v201, v129
v_mov_b32 v202, v130
v_mov_b32 v203, v131
v_mov_b32 v204, v132
v_mov_b32 v205, v133
v_mov_b32 v206, v134
v_mov_b32 v207, v135
s_add_u32 s96, s8, 0x8000000
s_addc_u32 s97, s9, 0
s_mov_b32 s98, 0x800000
s_mov_b32 s99, 0x00020000
s_sub_u32 s58, s58, 16384
buffer_load_dwordx4 v[128:131], v3, s[96:99], s58 offen offset:0
buffer_load_dwordx4 v[132:135], v3, s[96:99], s58 offen offset:1024
buffer_load_dwordx4 v[136:139], v3, s[96:99], s58 offen offset:2048
buffer_load_dwordx4 v[140:143], v3, s[96:99], s58 offen offset:3072
s_add_u32 s58, s58, 4096
buffer_load_dwordx4 v[144:147], v3, s[96:99], s58 offen offset:0
buffer_load_dwordx4 v[148:151], v3, s[96:99], s58 offen offset:1024
buffer_load_dwordx4 v[152:155], v3, s[96:99], s58 offen offset:2048
buffer_load_dwordx4 v[156:159], v3, s[96:99], s58 offen offset:3072
s_add_u32 s58, s58, 4096
buffer_load_dwordx4 v[160:163], v3, s[96:99], s58 offen offset:0
buffer_load_dwordx4 v[164:167], v3, s[96:99], s58 offen offset:1024
buffer_load_dwordx4 v[168:171], v3, s[96:99], s58 offen offset:2048
buffer_load_dwordx4 v[172:175], v3, s[96:99], s58 offen offset:3072
s_add_u32 s58, s58, 4096
buffer_load_dwordx4 v[176:179], v3, s[96:99], s58 offen offset:0
buffer_load_dwordx4 v[180:183], v3, s[96:99], s58 offen offset:1024
buffer_load_dwordx4 v[184:187], v3, s[96:99], s58 offen offset:2048
buffer_load_dwordx4 v[188:191], v3, s[96:99], s58 offen offset:3072
s_add_u32 s58, s58, 4096
s_waitcnt vmcnt(0)
v_mov_b32 v192, 0xff800000
v_mov_b32 v193, 0xff800000
v_mov_b32 v194, 0xff800000
v_mov_b32 v195, 0xff800000
s_mov_b32 s37, 0
L_a_fba1:
buffer_load_dwordx4 v[16:19], v3, s[24:27], s37 offen sc1
buffer_load_dwordx4 v[20:23], v3, s[24:27], s37 offen offset:1024 sc1
buffer_load_dwordx4 v[24:27], v3, s[24:27], s37 offen offset:2048 sc1
buffer_load_dwordx4 v[28:31], v3, s[24:27], s37 offen offset:3072 sc1
s_add_u32 s60, s37, 4096
buffer_load_dwordx4 v[32:35], v3, s[24:27], s60 offen sc1
buffer_load_dwordx4 v[36:39], v3, s[24:27], s60 offen offset:1024 sc1
buffer_load_dwordx4 v[40:43], v3, s[24:27], s60 offen offset:2048 sc1
buffer_load_dwordx4 v[44:47], v3, s[24:27], s60 offen offset:3072 sc1
s_waitcnt vmcnt(0)
v_mfma_f32_16x16x32_bf16 v[80:83], v[16:19], v[128:131], 0
v_mfma_f32_16x16x32_bf16 v[88:91], v[16:19], v[144:147], 0
v_mfma_f32_16x16x32_bf16 v[92:95], v[20:23], v[144:147], 0
v_mfma_f32_16x16x32_bf16 v[84:87], v[20:23], v[128:131], 0
v_mfma_f32_16x16x32_bf16 v[80:83], v[24:27], v[132:135], v[80:83]
v_mfma_f32_16x16x32_bf16 v[88:91], v[24:27], v[148:151], v[88:91]
v_mfma_f32_16x16x32_bf16 v[92:95], v[28:31], v[148:151], v[92:95]
v_mfma_f32_16x16x32_bf16 v[84:87], v[28:31], v[132:135], v[84:87]
v_mfma_f32_16x16x32_bf16 v[80:83], v[32:35], v[136:139], v[80:83]
v_mfma_f32_16x16x32_bf16 v[88:91], v[32:35], v[152:155], v[88:91]
v_mfma_f32_16x16x32_bf16 v[92:95], v[36:39], v[152:155], v[92:95]
v_mfma_f32_16x16x32_bf16 v[84:87], v[36:39], v[136:139], v[84:87]
v_mfma_f32_16x16x32_bf16 v[80:83], v[40:43], v[140:143], v[80:83]
v_mfma_f32_16x16x32_bf16 v[88:91], v[40:43], v[156:159], v[88:91]
v_mfma_f32_16x16x32_bf16 v[92:95], v[44:47], v[156:159], v[92:95]
v_mfma_f32_16x16x32_bf16 v[84:87], v[44:47], v[140:143], v[84:87]
s_nop 15
v_max3_f32 v192, v192, v80, v81
v_max3_f32 v192, v192, v82, v83
v_max3_f32 v192, v192, v84, v85
v_max3_f32 v192, v192, v86, v87
v_max3_f32 v193, v193, v88, v89
v_max3_f32 v193, v193, v90, v91
v_max3_f32 v193, v193, v92, v93
v_max3_f32 v193, v193, v94, v95
s_nop 1
v_mfma_f32_16x16x32_bf16 v[96:99], v[16:19], v[160:163], 0
v_mfma_f32_16x16x32_bf16 v[104:107], v[16:19], v[176:179], 0
v_mfma_f32_16x16x32_bf16 v[108:111], v[20:23], v[176:179], 0
v_mfma_f32_16x16x32_bf16 v[100:103], v[20:23], v[160:163], 0
v_mfma_f32_16x16x32_bf16 v[96:99], v[24:27], v[164:167], v[96:99]
v_mfma_f32_16x16x32_bf16 v[104:107], v[24:27], v[180:183], v[104:107]
v_mfma_f32_16x16x32_bf16 v[108:111], v[28:31], v[180:183], v[108:111]
v_mfma_f32_16x16x32_bf16 v[100:103], v[28:31], v[164:167], v[100:103]
v_mfma_f32_16x16x32_bf16 v[96:99], v[32:35], v[168:171], v[96:99]
v_mfma_f32_16x16x32_bf16 v[104:107], v[32:35], v[184:187], v[104:107]
v_mfma_f32_16x16x32_bf16 v[108:111], v[36:39], v[184:187], v[108:111]
v_mfma_f32_16x16x32_bf16 v[100:103], v[36:39], v[168:171], v[100:103]
v_mfma_f32_16x16x32_bf16 v[96:99], v[40:43], v[172:175], v[96:99]
v_mfma_f32_16x16x32_bf16 v[104:107], v[40:43], v[188:191], v[104:107]
v_mfma_f32_16x16x32_bf16 v[108:111], v[44:47], v[188:191], v[108:111]
v_mfma_f32_16x16x32_bf16 v[100:103], v[44:47], v[172:175], v[100:103]
s_nop 15
v_max3_f32 v194, v194, v96, v97
v_max3_f32 v194, v194, v98, v99
v_max3_f32 v194, v194, v100, v101
v_max3_f32 v194, v194, v102, v103
v_max3_f32 v195, v195, v104, v105
v_max3_f32 v195, v195, v106, v107
v_max3_f32 v195, v195, v108, v109
v_max3_f32 v195, v195, v110, v111
s_nop 1
s_add_u32 s37, s37, 0x4000
s_cmp_lg_u32 s37, 0x40000
s_cbranch_scc1 L_a_fba1
v_mov_b32 v196, v192
v_mov_b32 v197, v193
v_mov_b32 v198, v194
v_mov_b32 v199, v195
s_nop 1
v_permlane16_swap_b32 v192, v196
v_permlane16_swap_b32 v193, v197
v_permlane16_swap_b32 v194, v198
v_permlane16_swap_b32 v195, v199
s_nop 1
v_max_f32 v192, v192, v196
v_max_f32 v193, v193, v197
v_max_f32 v194, v194, v198
v_max_f32 v195, v195, v199
v_mov_b32 v196, v192
v_mov_b32 v197, v193
v_mov_b32 v198, v194
v_mov_b32 v199, v195
s_nop 1
v_permlane32_swap_b32 v192, v196
v_permlane32_swap_b32 v193, v197
v_permlane32_swap_b32 v194, v198
v_permlane32_swap_b32 v195, v199
s_nop 1
v_max_f32 v192, v192, v196
v_max_f32 v193, v193, v197
v_max_f32 v194, v194, v198
v_max_f32 v195, v195, v199
v_mov_b32 v4, 0
v_mov_b32 v5, 0
v_mov_b32 v6, 0
v_mov_b32 v7, 0
AW 0,0
AW 1,0
AW 2,0
AW 3,0
AW 4,0
AW 5,0
AW 6,0
AW 7,0
AW 8,0
AW 9,0
AW 10,0
AW 11,0
AW 12,0
AW 13,0
AW 14,0
AW 15,0
AW 16,0
AW 17,0
AW 18,0
AW 19,0
AW 20,0
AW 21,0
AW 22,0
AW 23,0
AW 24,0
AW 25,0
AW 26,0
AW 27,0
AW 28,0
AW 29,0
AW 30,0
AW 31,0
AW 32,0
AW 33,0
AW 34,0
AW 35,0
AW 36,0
AW 37,0
AW 38,0
AW 39,0
AW 40,0
AW 41,0
AW 42,0
AW 43,0
AW 44,0
AW 45,0
AW 46,0
AW 47,0
AW 48,0
AW 49,0
AW 50,0
AW 51,0
AW 52,0
AW 53,0
AW 54,0
AW 55,0
AW 56,0
AW 57,0
AW 58,0
AW 59,0
AW 60,0
AW 61,0
AW 62,0
AW 63,0
AW 64,0
AW 65,0
AW 66,0
AW 67,0
AW 68,0
AW 69,0
AW 70,0
AW 71,0
AW 72,0
AW 73,0
AW 74,0
AW 75,0
AW 76,0
AW 77,0
AW 78,0
AW 79,0
AW 80,0
AW 81,0
AW 82,0
AW 83,0
AW 84,0
AW 85,0
AW 86,0
AW 87,0
AW 88,0
AW 89,0
AW 90,0
AW 91,0
AW 92,0
AW 93,0
AW 94,0
AW 95,0
AW 96,0
AW 97,0
AW 98,0
AW 99,0
AW 100,0
AW 101,0
AW 102,0
AW 103,0
AW 104,0
AW 105,0
AW 106,0
AW 107,0
AW 108,0
AW 109,0
AW 110,0
AW 111,0
AW 112,0
AW 113,0
AW 114,0
AW 115,0
AW 116,0
AW 117,0
AW 118,0
AW 119,0
AW 120,0
AW 121,0
AW 122,0
AW 123,0
AW 124,0
AW 125,0
AW 126,0
AW 127,0
s_mov_b32 s37, 0
L_a_fba2:
buffer_load_dwordx4 v[16:19], v3, s[24:27], s37 offen sc1
buffer_load_dwordx4 v[20:23], v3, s[24:27], s37 offen offset:1024 sc1
buffer_load_dwordx4 v[24:27], v3, s[24:27], s37 offen offset:2048 sc1
buffer_load_dwordx4 v[28:31], v3, s[24:27], s37 offen offset:3072 sc1
s_add_u32 s60, s37, 4096
buffer_load_dwordx4 v[32:35], v3, s[24:27], s60 offen sc1
buffer_load_dwordx4 v[36:39], v3, s[24:27], s60 offen offset:1024 sc1
buffer_load_dwordx4 v[40:43], v3, s[24:27], s60 offen offset:2048 sc1
buffer_load_dwordx4 v[44:47], v3, s[24:27], s60 offen offset:3072 sc1
s_add_u32 s60, s37, 8192
buffer_load_dwordx4 v[48:51], v3, s[24:27], s60 offen sc1
buffer_load_dwordx4 v[52:55], v3, s[24:27], s60 offen offset:1024 sc1
buffer_load_dwordx4 v[56:59], v3, s[24:27], s60 offen offset:2048 sc1
buffer_load_dwordx4 v[60:63], v3, s[24:27], s60 offen offset:3072 sc1
s_add_u32 s60, s37, 12288
buffer_load_dwordx4 v[64:67], v3, s[24:27], s60 offen sc1
buffer_load_dwordx4 v[68:71], v3, s[24:27], s60 offen offset:1024 sc1
buffer_load_dwordx4 v[72:75], v3, s[24:27], s60 offen offset:2048 sc1
buffer_load_dwordx4 v[76:79], v3, s[24:27], s60 offen offset:3072 sc1
s_waitcnt vmcnt(0)
v_mfma_f32_16x16x32_bf16 v[80:83], v[16:19], v[128:131], 0
v_mfma_f32_16x16x32_bf16 v[88:91], v[16:19], v[144:147], 0
v_mfma_f32_16x16x32_bf16 v[92:95], v[20:23], v[144:147], 0
v_mfma_f32_16x16x32_bf16 v[84:87], v[20:23], v[128:131], 0
v_mfma_f32_16x16x32_bf16 v[80:83], v[24:27], v[132:135], v[80:83]
v_mfma_f32_16x16x32_bf16 v[88:91], v[24:27], v[148:151], v[88:91]
v_mfma_f32_16x16x32_bf16 v[92:95], v[28:31], v[148:151], v[92:95]
v_mfma_f32_16x16x32_bf16 v[84:87], v[28:31], v[132:135], v[84:87]
v_mfma_f32_16x16x32_bf16 v[80:83], v[32:35], v[136:139], v[80:83]
v_mfma_f32_16x16x32_bf16 v[88:91], v[32:35], v[152:155], v[88:91]
v_mfma_f32_16x16x32_bf16 v[92:95], v[36:39], v[152:155], v[92:95]
v_mfma_f32_16x16x32_bf16 v[84:87], v[36:39], v[136:139], v[84:87]
v_mfma_f32_16x16x32_bf16 v[80:83], v[40:43], v[140:143], v[80:83]
v_mfma_f32_16x16x32_bf16 v[88:91], v[40:43], v[156:159], v[88:91]
v_mfma_f32_16x16x32_bf16 v[92:95], v[44:47], v[156:159], v[92:95]
v_mfma_f32_16x16x32_bf16 v[84:87], v[44:47], v[140:143], v[84:87]
s_nop 15
v_sub_f32 v80, v80, v192
v_sub_f32 v81, v81, v192
v_sub_f32 v82, v82, v192
v_sub_f32 v83, v83, v192
v_sub_f32 v84, v84, v192
v_sub_f32 v85, v85, v192
v_sub_f32 v86, v86, v192
v_sub_f32 v87, v87, v192
v_sub_f32 v88, v88, v193
v_sub_f32 v89, v89, v193
v_sub_f32 v90, v90, v193
v_sub_f32 v91, v91, v193
v_sub_f32 v92, v92, v193
v_sub_f32 v93, v93, v193
v_sub_f32 v94, v94, v193
v_sub_f32 v95, v95, v193
v_exp_f32 v80, v80
v_exp_f32 v81, v81
v_exp_f32 v82, v82
v_add_f32 v4, v4, v80
v_add_f32 v4, v4, v81
v_exp_f32 v83, v83
CV 112,80,81
v_add_f32 v4, v4, v82
v_exp_f32 v84, v84
CV 113,82,83
v_add_f32 v4, v4, v83
v_exp_f32 v85, v85
v_exp_f32 v86, v86
v_add_f32 v4, v4, v84
CV 114,84,85
v_exp_f32 v87, v87
v_add_f32 v4, v4, v85
v_add_f32 v4, v4, v86
v_exp_f32 v88, v88
CV 115,86,87
v_add_f32 v4, v4, v87
v_exp_f32 v89, v89
v_exp_f32 v90, v90
v_add_f32 v5, v5, v88
CV 116,88,89
v_exp_f32 v91, v91
v_add_f32 v5, v5, v89
v_add_f32 v5, v5, v90
v_exp_f32 v92, v92
CV 117,90,91
v_add_f32 v5, v5, v91
v_exp_f32 v93, v93
v_exp_f32 v94, v94
v_add_f32 v5, v5, v92
CV 118,92,93
v_exp_f32 v95, v95
v_add_f32 v5, v5, v93
v_add_f32 v5, v5, v94
CV 119,94,95
v_add_f32 v5, v5, v95
s_nop 1
MA 0,48,112
MA 32,48,116
MA 36,52,116
MA 4,52,112
MA 8,56,112
MA 40,56,116
MA 44,60,116
MA 12,60,112
MA 16,64,112
MA 48,64,116
MA 52,68,116
MA 20,68,112
MA 24,72,112
MA 56,72,116
MA 60,76,116
MA 28,76,112
v_mfma_f32_16x16x32_bf16 v[96:99], v[16:19], v[160:163], 0
v_mfma_f32_16x16x32_bf16 v[104:107], v[16:19], v[176:179], 0
v_mfma_f32_16x16x32_bf16 v[108:111], v[20:23], v[176:179], 0
v_mfma_f32_16x16x32_bf16 v[100:103], v[20:23], v[160:163], 0
v_mfma_f32_16x16x32_bf16 v[96:99], v[24:27], v[164:167], v[96:99]
v_mfma_f32_16x16x32_bf16 v[104:107], v[24:27], v[180:183], v[104:107]
v_mfma_f32_16x16x32_bf16 v[108:111], v[28:31], v[180:183], v[108:111]
v_mfma_f32_16x16x32_bf16 v[100:103], v[28:31], v[164:167], v[100:103]
v_mfma_f32_16x16x32_bf16 v[96:99], v[32:35], v[168:171], v[96:99]
v_mfma_f32_16x16x32_bf16 v[104:107], v[32:35], v[184:187], v[104:107]
v_mfma_f32_16x16x32_bf16 v[108:111], v[36:39], v[184:187], v[108:111]
v_mfma_f32_16x16x32_bf16 v[100:103], v[36:39], v[168:171], v[100:103]
v_mfma_f32_16x16x32_bf16 v[96:99], v[40:43], v[172:175], v[96:99]
v_mfma_f32_16x16x32_bf16 v[104:107], v[40:43], v[188:191], v[104:107]
v_mfma_f32_16x16x32_bf16 v[108:111], v[44:47], v[188:191], v[108:111]
v_mfma_f32_16x16x32_bf16 v[100:103], v[44:47], v[172:175], v[100:103]
s_nop 15
v_sub_f32 v96, v96, v194
v_sub_f32 v97, v97, v194
v_sub_f32 v98, v98, v194
v_sub_f32 v99, v99, v194
v_sub_f32 v100, v100, v194
v_sub_f32 v101, v101, v194
v_sub_f32 v102, v102, v194
v_sub_f32 v103, v103, v194
v_sub_f32 v104, v104, v195
v_sub_f32 v105, v105, v195
v_sub_f32 v106, v106, v195
v_sub_f32 v107, v107, v195
v_sub_f32 v108, v108, v195
v_sub_f32 v109, v109, v195
v_sub_f32 v110, v110, v195
v_sub_f32 v111, v111, v195
v_exp_f32 v96, v96
v_exp_f32 v97, v97
v_exp_f32 v98, v98
v_add_f32 v6, v6, v96
v_add_f32 v6, v6, v97
v_exp_f32 v99, v99
CV 120,96,97
v_add_f32 v6, v6, v98
v_exp_f32 v100, v100
CV 121,98,99
v_add_f32 v6, v6, v99
v_exp_f32 v101, v101
v_exp_f32 v102, v102
v_add_f32 v6, v6, v100
CV 122,100,101
v_exp_f32 v103, v103
v_add_f32 v6, v6, v101
v_add_f32 v6, v6, v102
v_exp_f32 v104, v104
CV 123,102,103
v_add_f32 v6, v6, v103
v_exp_f32 v105, v105
v_exp_f32 v106, v106
v_add_f32 v7, v7, v104
CV 124,104,105
v_exp_f32 v107, v107
v_add_f32 v7, v7, v105
v_add_f32 v7, v7, v106
v_exp_f32 v108, v108
CV 125,106,107
v_add_f32 v7, v7, v107
v_exp_f32 v109, v109
v_exp_f32 v110, v110
v_add_f32 v7, v7, v108
CV 126,108,109
v_exp_f32 v111, v111
v_add_f32 v7, v7, v109
v_add_f32 v7, v7, v110
CV 127,110,111
v_add_f32 v7, v7, v111
s_nop 1
MA 64,48,120
MA 96,48,124
MA 100,52,124
MA 68,52,120
MA 72,56,120
MA 104,56,124
MA 108,60,124
MA 76,60,120
MA 80,64,120
MA 112,64,124
MA 116,68,124
MA 84,68,120
MA 88,72,120
MA 120,72,124
MA 124,76,124
MA 92,76,120
s_add_u32 s37, s37, 0x4000
s_cmp_lg_u32 s37, 0x40000
s_cbranch_scc1 L_a_fba2
s_nop 1
v_permlane32_swap_b32 v4, v6
v_permlane32_swap_b32 v5, v7
v_add_f32 v4, v4, v6
v_add_f32 v5, v5, v7
s_nop 1
v_permlane16_swap_b32 v4, v5
s_nop 0
v_add_f32 v4, v4, v5
s_nop 7
v_mov_b32 v128, v200
v_mov_b32 v129, v201
v_mov_b32 v130, v202
v_mov_b32 v131, v203
v_mov_b32 v132, v204
v_mov_b32 v133, v205
v_mov_b32 v134, v206
v_mov_b32 v135, v207
v_rcp_f32 v4, v4
v_lshlrev_b32 v24, 4, v1
v_mov_b32 v16, v4
v_mov_b32 v20, v4
s_nop 1
v_permlane32_swap_b32 v16, v20
s_nop 0
v_mov_b32 v18, v16
v_mov_b32 v22, v20
s_nop 1
v_permlane16_swap_b32 v16, v18
v_permlane16_swap_b32 v20, v22
s_lshl_b32 s4, s10, 2
s_lshl_b32 s15, s13, 4
s_add_u32 s4, s4, s15
s_mul_i32 s4, s4, 133248
s_lshl_b32 s15, s14, 13
s_add_u32 s4, s4, s15
AR 32,0
AR 33,1
AR 34,2
AR 35,3
AR 36,4
AR 37,5
AR 38,6
AR 39,7
v_pk_mul_f32 v[32:33], v[32:33], v[16:17] op_sel_hi:[1,0]
v_pk_mul_f32 v[34:35], v[34:35], v[16:17] op_sel_hi:[1,0]
v_pk_mul_f32 v[36:37], v[36:37], v[16:17] op_sel_hi:[1,0]
v_pk_mul_f32 v[38:39], v[38:39], v[16:17] op_sel_hi:[1,0]
CV 40,32,33
CV 41,34,35
CV 42,36,37
CV 43,38,39
buffer_store_dwordx4 v[40:43], v24, s[28:31], s4 offen sc1
AR 48,8
AR 49,9
AR 50,10
AR 51,11
AR 52,12
AR 53,13
AR 54,14
AR 55,15
v_pk_mul_f32 v[48:49], v[48:49], v[16:17] op_sel_hi:[1,0]
v_pk_mul_f32 v[50:51], v[50:51], v[16:17] op_sel_hi:[1,0]
v_pk_mul_f32 v[52:53], v[52:53], v[16:17] op_sel_hi:[1,0]
v_pk_mul_f32 v[54:55], v[54:55], v[16:17] op_sel_hi:[1,0]
CV 56,48,49
CV 57,50,51
CV 58,52,53
CV 59,54,55
buffer_store_dwordx4 v[56:59], v24, s[28:31], s4 offen offset:1024 sc1
AR 64,16
AR 65,17
AR 66,18
AR 67,19
AR 68,20
AR 69,21
AR 70,22
AR 71,23
v_pk_mul_f32 v[64:65], v[64:65], v[16:17] op_sel_hi:[1,0]
v_pk_mul_f32 v[66:67], v[66:67], v[16:17] op_sel_hi:[1,0]
v_pk_mul_f32 v[68:69], v[68:69], v[16:17] op_sel_hi:[1,0]
v_pk_mul_f32 v[70:71], v[70:71], v[16:17] op_sel_hi:[1,0]
CV 72,64,65
CV 73,66,67
CV 74,68,69
CV 75,70,71
buffer_store_dwordx4 v[72:75], v24, s[28:31], s4 offen offset:2048 sc1
AR 80,24
AR 81,25
AR 82,26
AR 83,27
AR 84,28
AR 85,29
AR 86,30
AR 87,31
v_pk_mul_f32 v[80:81], v[80:81], v[16:17] op_sel_hi:[1,0]
v_pk_mul_f32 v[82:83], v[82:83], v[16:17] op_sel_hi:[1,0]
v_pk_mul_f32 v[84:85], v[84:85], v[16:17] op_sel_hi:[1,0]
v_pk_mul_f32 v[86:87], v[86:87], v[16:17] op_sel_hi:[1,0]
CV 88,80,81
CV 89,82,83
CV 90,84,85
CV 91,86,87
buffer_store_dwordx4 v[88:91], v24, s[28:31], s4 offen offset:3072 sc1
s_add_u32 s4, s4, 133248
AR 32,32
AR 33,33
AR 34,34
AR 35,35
AR 36,36
AR 37,37
AR 38,38
AR 39,39
v_pk_mul_f32 v[32:33], v[32:33], v[18:19] op_sel_hi:[1,0]
v_pk_mul_f32 v[34:35], v[34:35], v[18:19] op_sel_hi:[1,0]
v_pk_mul_f32 v[36:37], v[36:37], v[18:19] op_sel_hi:[1,0]
v_pk_mul_f32 v[38:39], v[38:39], v[18:19] op_sel_hi:[1,0]
CV 40,32,33
CV 41,34,35
CV 42,36,37
CV 43,38,39
buffer_store_dwordx4 v[40:43], v24, s[28:31], s4 offen sc1
AR 48,40
AR 49,41
AR 50,42
AR 51,43
AR 52,44
AR 53,45
AR 54,46
AR 55,47
v_pk_mul_f32 v[48:49], v[48:49], v[18:19] op_sel_hi:[1,0]
v_pk_mul_f32 v[50:51], v[50:51], v[18:19] op_sel_hi:[1,0]
v_pk_mul_f32 v[52:53], v[52:53], v[18:19] op_sel_hi:[1,0]
v_pk_mul_f32 v[54:55], v[54:55], v[18:19] op_sel_hi:[1,0]
CV 56,48,49
CV 57,50,51
CV 58,52,53
CV 59,54,55
buffer_store_dwordx4 v[56:59], v24, s[28:31], s4 offen offset:1024 sc1
AR 64,48
AR 65,49
AR 66,50
AR 67,51
AR 68,52
AR 69,53
AR 70,54
AR 71,55
v_pk_mul_f32 v[64:65], v[64:65], v[18:19] op_sel_hi:[1,0]
v_pk_mul_f32 v[66:67], v[66:67], v[18:19] op_sel_hi:[1,0]
v_pk_mul_f32 v[68:69], v[68:69], v[18:19] op_sel_hi:[1,0]
v_pk_mul_f32 v[70:71], v[70:71], v[18:19] op_sel_hi:[1,0]
CV 72,64,65
CV 73,66,67
CV 74,68,69
CV 75,70,71
buffer_store_dwordx4 v[72:75], v24, s[28:31], s4 offen offset:2048 sc1
AR 80,56
AR 81,57
AR 82,58
AR 83,59
AR 84,60
AR 85,61
AR 86,62
AR 87,63
v_pk_mul_f32 v[80:81], v[80:81], v[18:19] op_sel_hi:[1,0]
v_pk_mul_f32 v[82:83], v[82:83], v[18:19] op_sel_hi:[1,0]
v_pk_mul_f32 v[84:85], v[84:85], v[18:19] op_sel_hi:[1,0]
v_pk_mul_f32 v[86:87], v[86:87], v[18:19] op_sel_hi:[1,0]
CV 88,80,81
CV 89,82,83
CV 90,84,85
CV 91,86,87
buffer_store_dwordx4 v[88:91], v24, s[28:31], s4 offen offset:3072 sc1
s_add_u32 s4, s4, 133248
AR 32,64
AR 33,65
AR 34,66
AR 35,67
AR 36,68
AR 37,69
AR 38,70
AR 39,71
v_pk_mul_f32 v[32:33], v[32:33], v[20:21] op_sel_hi:[1,0]
v_pk_mul_f32 v[34:35], v[34:35], v[20:21] op_sel_hi:[1,0]
v_pk_mul_f32 v[36:37], v[36:37], v[20:21] op_sel_hi:[1,0]
v_pk_mul_f32 v[38:39], v[38:39], v[20:21] op_sel_hi:[1,0]
CV 40,32,33
CV 41,34,35
CV 42,36,37
CV 43,38,39
buffer_store_dwordx4 v[40:43], v24, s[28:31], s4 offen sc1
AR 48,72
AR 49,73
AR 50,74
AR 51,75
AR 52,76
AR 53,77
AR 54,78
AR 55,79
v_pk_mul_f32 v[48:49], v[48:49], v[20:21] op_sel_hi:[1,0]
v_pk_mul_f32 v[50:51], v[50:51], v[20:21] op_sel_hi:[1,0]
v_pk_mul_f32 v[52:53], v[52:53], v[20:21] op_sel_hi:[1,0]
v_pk_mul_f32 v[54:55], v[54:55], v[20:21] op_sel_hi:[1,0]
CV 56,48,49
CV 57,50,51
CV 58,52,53
CV 59,54,55
buffer_store_dwordx4 v[56:59], v24, s[28:31], s4 offen offset:1024 sc1
AR 64,80
AR 65,81
AR 66,82
AR 67,83
AR 68,84
AR 69,85
AR 70,86
AR 71,87
v_pk_mul_f32 v[64:65], v[64:65], v[20:21] op_sel_hi:[1,0]
v_pk_mul_f32 v[66:67], v[66:67], v[20:21] op_sel_hi:[1,0]
v_pk_mul_f32 v[68:69], v[68:69], v[20:21] op_sel_hi:[1,0]
v_pk_mul_f32 v[70:71], v[70:71], v[20:21] op_sel_hi:[1,0]
CV 72,64,65
CV 73,66,67
CV 74,68,69
CV 75,70,71
buffer_store_dwordx4 v[72:75], v24, s[28:31], s4 offen offset:2048 sc1
AR 80,88
AR 81,89
AR 82,90
AR 83,91
AR 84,92
AR 85,93
AR 86,94
AR 87,95
v_pk_mul_f32 v[80:81], v[80:81], v[20:21] op_sel_hi:[1,0]
v_pk_mul_f32 v[82:83], v[82:83], v[20:21] op_sel_hi:[1,0]
v_pk_mul_f32 v[84:85], v[84:85], v[20:21] op_sel_hi:[1,0]
v_pk_mul_f32 v[86:87], v[86:87], v[20:21] op_sel_hi:[1,0]
CV 88,80,81
CV 89,82,83
CV 90,84,85
CV 91,86,87
buffer_store_dwordx4 v[88:91], v24, s[28:31], s4 offen offset:3072 sc1
s_add_u32 s4, s4, 133248
AR 32,96
AR 33,97
AR 34,98
AR 35,99
AR 36,100
AR 37,101
AR 38,102
AR 39,103
v_pk_mul_f32 v[32:33], v[32:33], v[22:23] op_sel_hi:[1,0]
v_pk_mul_f32 v[34:35], v[34:35], v[22:23] op_sel_hi:[1,0]
v_pk_mul_f32 v[36:37], v[36:37], v[22:23] op_sel_hi:[1,0]
v_pk_mul_f32 v[38:39], v[38:39], v[22:23] op_sel_hi:[1,0]
CV 40,32,33
CV 41,34,35
CV 42,36,37
CV 43,38,39
buffer_store_dwordx4 v[40:43], v24, s[28:31], s4 offen sc1
AR 48,104
AR 49,105
AR 50,106
AR 51,107
AR 52,108
AR 53,109
AR 54,110
AR 55,111
v_pk_mul_f32 v[48:49], v[48:49], v[22:23] op_sel_hi:[1,0]
v_pk_mul_f32 v[50:51], v[50:51], v[22:23] op_sel_hi:[1,0]
v_pk_mul_f32 v[52:53], v[52:53], v[22:23] op_sel_hi:[1,0]
v_pk_mul_f32 v[54:55], v[54:55], v[22:23] op_sel_hi:[1,0]
CV 56,48,49
CV 57,50,51
CV 58,52,53
CV 59,54,55
buffer_store_dwordx4 v[56:59], v24, s[28:31], s4 offen offset:1024 sc1
AR 64,112
AR 65,113
AR 66,114
AR 67,115
AR 68,116
AR 69,117
AR 70,118
AR 71,119
v_pk_mul_f32 v[64:65], v[64:65], v[22:23] op_sel_hi:[1,0]
v_pk_mul_f32 v[66:67], v[66:67], v[22:23] op_sel_hi:[1,0]
v_pk_mul_f32 v[68:69], v[68:69], v[22:23] op_sel_hi:[1,0]
v_pk_mul_f32 v[70:71], v[70:71], v[22:23] op_sel_hi:[1,0]
CV 72,64,65
CV 73,66,67
CV 74,68,69
CV 75,70,71
buffer_store_dwordx4 v[72:75], v24, s[28:31], s4 offen offset:2048 sc1
AR 80,120
AR 81,121
AR 82,122
AR 83,123
AR 84,124
AR 85,125
AR 86,126
AR 87,127
v_pk_mul_f32 v[80:81], v[80:81], v[22:23] op_sel_hi:[1,0]
v_pk_mul_f32 v[82:83], v[82:83], v[22:23] op_sel_hi:[1,0]
v_pk_mul_f32 v[84:85], v[84:85], v[22:23] op_sel_hi:[1,0]
v_pk_mul_f32 v[86:87], v[86:87], v[22:23] op_sel_hi:[1,0]
CV 88,80,81
CV 89,82,83
CV 90,84,85
CV 91,86,87
buffer_store_dwordx4 v[88:91], v24, s[28:31], s4 offen offset:3072 sc1
s_waitcnt vmcnt(0)
v_mov_b32 v28, s100
s_mov_b64 exec, 1
buffer_store_dword v28, off, s[48:51], s5 sc1
s_mov_b64 exec, -1
s_branch L_a_final
L_end:
s_endpgm
L_path_b:
v_lshrrev_b32 v3, 5, v1
v_lshl_add_u32 v3, v3, 2, v2
v_mul_u32_u24 v4, 7168, v3
v_and_b32 v3, 31, v1
v_lshl_add_u32 v4, v3, 4, v4
s_mul_i32 s15, s14, 224
v_add_u32 v4, s15, v4
v_add_u32 v5, 3360, v4
v_cmp_lt_u32 vcc, 13, v3
s_nop 1
v_cndmask_b32 v4, v4, v5, vcc
v_mov_b32 v5, 0x40000000
v_cmp_lt_u32 vcc, 27, v3
s_nop 1
v_cndmask_b32 v4, v4, v5, vcc
v_add_u32 v5, 0xdbe0, v4
v_add_u32 v6, 0xdbe0, v5
v_add_u32 v7, 0xdbe0, v6
v_and_b32 v8, 15, v1
v_lshlrev_b32 v8, 4, v8
v_lshrrev_b32 v3, 4, v1
v_lshl_add_u32 v8, v3, 9, v8
v_lshl_add_u32 v8, v2, 12, v8
s_mov_b32 s32, 0
s_lshl_b32 s33, s13, 19
s_mul_i32 s35, s10, 4416
s_add_u32 m0, s35, 0
s_nop 0
buffer_load_dwordx4 v4, s[16:19], s32 offen lds
buffer_load_dwordx4 v5, s[16:19], s32 offen offset:1056 lds
buffer_load_dwordx4 v6, s[16:19], s32 offen offset:2112 lds
buffer_load_dwordx4 v7, s[16:19], s32 offen offset:3168 lds
s_add_u32 s32, s32, 0x38000
s_add_u32 m0, s35, 17664
s_nop 0
buffer_load_dwordx4 v4, s[16:19], s32 offen lds
buffer_load_dwordx4 v5, s[16:19], s32 offen offset:1056 lds
buffer_load_dwordx4 v6, s[16:19], s32 offen offset:2112 lds
buffer_load_dwordx4 v7, s[16:19], s32 offen offset:3168 lds
s_add_u32 s32, s32, 0x38000
v_lshlrev_b32 v19, 2, v0
v_mov_b32 v20, -1
s_lshl_b32 s3, s2, 10
buffer_store_dword v20, v19, s[48:51], s3 offen sc1
s_getpc_b64 s[96:97]
L_b_pc:
s_sub_u32 s96, s96, L_b_pc-L_code_begin
s_subb_u32 s97, s97, 0
s_lshl_b32 s15, s12, 2
s_add_u32 s15, s15, s10
s_lshl_b32 s15, s15, 4
v_and_b32 v22, 15, v1
v_add_u32 v22, s15, v22
v_lshlrev_b32 v22, 7, v22
v_min_u32 v22, L_code_end-L_code_begin-4, v22
global_load_dword v21, v22, s[96:97]
v_lshrrev_b32 v18, 2, v17
v_lshl_add_u32 v18, v2, 3, v18
v_lshlrev_b32 v18, 14, v18
v_and_b32 v17, 3, v17
v_lshl_add_u32 v18, v17, 9, v18
v_lshl_add_u32 v18, v16, 4, v18
s_lshr_b32 s3, s2, 5
s_lshl_b32 s3, s3, 19
s_bfe_u32 s15, s2, 0x30002
s_lshl_b32 s15, s15, 11
s_add_u32 s3, s3, s15
s_and_b32 s15, s2, 3
s_lshl_b32 s15, s15, 7
s_add_u32 s3, s3, s15
v_lshlrev_b32 v16, 3, v16
v_add_u32 v16, 163584, v16
v_lshl_add_u32 v17, v2, 6, v16
v_mov_b32 v120, 0
v_mov_b32 v121, 0
v_mov_b32 v122, 0
v_mov_b32 v123, 0
s_waitcnt vmcnt(14)
v_lshlrev_b32 v56, 16, v24
v_and_b32 v57, 0xffff0000, v24
v_lshlrev_b32 v58, 16, v25
v_and_b32 v59, 0xffff0000, v25
v_lshlrev_b32 v60, 16, v26
v_and_b32 v61, 0xffff0000, v26
v_lshlrev_b32 v62, 16, v27
v_and_b32 v63, 0xffff0000, v27
PD 120,120,56
v_pk_fma_f32 v[122:123], v[56:57], v[56:57], v[122:123]
PD 120,120,58
v_pk_fma_f32 v[122:123], v[58:59], v[58:59], v[122:123]
PD 120,120,60
v_pk_fma_f32 v[122:123], v[60:61], v[60:61], v[122:123]
PD 120,120,62
v_pk_fma_f32 v[122:123], v[62:63], v[62:63], v[122:123]
s_waitcnt vmcnt(13)
v_lshlrev_b32 v64, 16, v28
v_and_b32 v65, 0xffff0000, v28
v_lshlrev_b32 v66, 16, v29
v_and_b32 v67, 0xffff0000, v29
v_lshlrev_b32 v68, 16, v30
v_and_b32 v69, 0xffff0000, v30
v_lshlrev_b32 v70, 16, v31
v_and_b32 v71, 0xffff0000, v31
PD 120,120,64
v_pk_fma_f32 v[122:123], v[64:65], v[64:65], v[122:123]
PD 120,120,66
v_pk_fma_f32 v[122:123], v[66:67], v[66:67], v[122:123]
PD 120,120,68
v_pk_fma_f32 v[122:123], v[68:69], v[68:69], v[122:123]
PD 120,120,70
v_pk_fma_f32 v[122:123], v[70:71], v[70:71], v[122:123]
s_waitcnt vmcnt(12)
v_lshlrev_b32 v72, 16, v32
v_and_b32 v73, 0xffff0000, v32
v_lshlrev_b32 v74, 16, v33
v_and_b32 v75, 0xffff0000, v33
v_lshlrev_b32 v76, 16, v34
v_and_b32 v77, 0xffff0000, v34
v_lshlrev_b32 v78, 16, v35
v_and_b32 v79, 0xffff0000, v35
PD 120,120,72
v_pk_fma_f32 v[122:123], v[72:73], v[72:73], v[122:123]
PD 120,120,74
v_pk_fma_f32 v[122:123], v[74:75], v[74:75], v[122:123]
PD 120,120,76
v_pk_fma_f32 v[122:123], v[76:77], v[76:77], v[122:123]
PD 120,120,78
v_pk_fma_f32 v[122:123], v[78:79], v[78:79], v[122:123]
s_waitcnt vmcnt(11)
v_lshlrev_b32 v80, 16, v36
v_and_b32 v81, 0xffff0000, v36
v_lshlrev_b32 v82, 16, v37
v_and_b32 v83, 0xffff0000, v37
v_lshlrev_b32 v84, 16, v38
v_and_b32 v85, 0xffff0000, v38
v_lshlrev_b32 v86, 16, v39
v_and_b32 v87, 0xffff0000, v39
PD 120,120,80
v_pk_fma_f32 v[122:123], v[80:81], v[80:81], v[122:123]
PD 120,120,82
v_pk_fma_f32 v[122:123], v[82:83], v[82:83], v[122:123]
PD 120,120,84
v_pk_fma_f32 v[122:123], v[84:85], v[84:85], v[122:123]
PD 120,120,86
v_pk_fma_f32 v[122:123], v[86:87], v[86:87], v[122:123]
v_add_f32 v120, v120, v121
v_add_f32 v121, v122, v123
s_nop 1
v_add_f32_dpp v120, v120, v120 row_ror:8 row_mask:0xf bank_mask:0xf
v_add_f32_dpp v121, v121, v121 row_ror:8 row_mask:0xf bank_mask:0xf
v_mov_b32 v122, v120
v_mov_b32 v123, v121
s_nop 1
v_permlane16_swap_b32 v120, v122
v_permlane16_swap_b32 v121, v123
s_nop 1
PD 120,120,122
v_mov_b32 v122, v120
v_mov_b32 v123, v121
s_nop 1
v_permlane32_swap_b32 v120, v122
v_permlane32_swap_b32 v121, v123
s_nop 1
PD 120,120,122
ds_write_b64 v17, v[120:121]
s_waitcnt lgkmcnt(0)
s_barrier
ds_read_b64 v[120:121], v16 offset:0
ds_read_b64 v[122:123], v16 offset:64
ds_read_b64 v[124:125], v16 offset:128
ds_read_b64 v[126:127], v16 offset:192
s_waitcnt lgkmcnt(0)
PD 120,120,122
PD 124,124,126
PD 120,120,124
v_mul_f32 v120, 0x3a800000, v120
v_mul_f32 v121, 0x3a800000, v121
v_fma_f32 v121, -v120, v120, v121
v_max_f32 v121, 0, v121
CV 120,120,120
v_and_b32 v120, 0xffff0000, v120
CV 121,121,121
v_and_b32 v121, 0xffff0000, v121
v_add_f32 v121, 0x3727c5ac, v121
CV 121,121,121
v_and_b32 v121, 0xffff0000, v121
v_sqrt_f32 v121, v121
v_sub_f32 v120, 0, v120
CV 121,121,121
v_and_b32 v121, 0xffff0000, v121
v_rcp_f32 v121, v121
s_nop 0
v_pk_add_f32 v[56:57], v[56:57], v[120:121] op_sel_hi:[1,0]
v_pk_add_f32 v[58:59], v[58:59], v[120:121] op_sel_hi:[1,0]
v_pk_add_f32 v[60:61], v[60:61], v[120:121] op_sel_hi:[1,0]
v_pk_add_f32 v[62:63], v[62:63], v[120:121] op_sel_hi:[1,0]
CV 24,56,57
CV 25,58,59
CV 26,60,61
CV 27,62,63
v_lshlrev_b32 v56, 16, v24
v_and_b32 v57, 0xffff0000, v24
v_lshlrev_b32 v58, 16, v25
v_and_b32 v59, 0xffff0000, v25
v_lshlrev_b32 v60, 16, v26
v_and_b32 v61, 0xffff0000, v26
v_lshlrev_b32 v62, 16, v27
v_and_b32 v63, 0xffff0000, v27
v_pk_mul_f32 v[56:57], v[56:57], v[120:121] op_sel:[0,1] op_sel_hi:[1,1]
v_pk_mul_f32 v[58:59], v[58:59], v[120:121] op_sel:[0,1] op_sel_hi:[1,1]
v_pk_mul_f32 v[60:61], v[60:61], v[120:121] op_sel:[0,1] op_sel_hi:[1,1]
v_pk_mul_f32 v[62:63], v[62:63], v[120:121] op_sel:[0,1] op_sel_hi:[1,1]
CV 24,56,57
CV 25,58,59
CV 26,60,61
CV 27,62,63
buffer_store_dwordx4 v[24:27], v18, s[20:23], s3 offen sc1
s_add_u32 s3, s3, 0x8000
v_pk_add_f32 v[64:65], v[64:65], v[120:121] op_sel_hi:[1,0]
v_pk_add_f32 v[66:67], v[66:67], v[120:121] op_sel_hi:[1,0]
v_pk_add_f32 v[68:69], v[68:69], v[120:121] op_sel_hi:[1,0]
v_pk_add_f32 v[70:71], v[70:71], v[120:121] op_sel_hi:[1,0]
CV 28,64,65
CV 29,66,67
CV 30,68,69
CV 31,70,71
v_lshlrev_b32 v64, 16, v28
v_and_b32 v65, 0xffff0000, v28
v_lshlrev_b32 v66, 16, v29
v_and_b32 v67, 0xffff0000, v29
v_lshlrev_b32 v68, 16, v30
v_and_b32 v69, 0xffff0000, v30
v_lshlrev_b32 v70, 16, v31
v_and_b32 v71, 0xffff0000, v31
v_pk_mul_f32 v[64:65], v[64:65], v[120:121] op_sel:[0,1] op_sel_hi:[1,1]
v_pk_mul_f32 v[66:67], v[66:67], v[120:121] op_sel:[0,1] op_sel_hi:[1,1]
v_pk_mul_f32 v[68:69], v[68:69], v[120:121] op_sel:[0,1] op_sel_hi:[1,1]
v_pk_mul_f32 v[70:71], v[70:71], v[120:121] op_sel:[0,1] op_sel_hi:[1,1]
CV 28,64,65
CV 29,66,67
CV 30,68,69
CV 31,70,71
buffer_store_dwordx4 v[28:31], v18, s[20:23], s3 offen sc1
s_add_u32 s3, s3, 0x8000
v_pk_add_f32 v[72:73], v[72:73], v[120:121] op_sel_hi:[1,0]
v_pk_add_f32 v[74:75], v[74:75], v[120:121] op_sel_hi:[1,0]
v_pk_add_f32 v[76:77], v[76:77], v[120:121] op_sel_hi:[1,0]
v_pk_add_f32 v[78:79], v[78:79], v[120:121] op_sel_hi:[1,0]
CV 32,72,73
CV 33,74,75
CV 34,76,77
CV 35,78,79
v_lshlrev_b32 v72, 16, v32
v_and_b32 v73, 0xffff0000, v32
v_lshlrev_b32 v74, 16, v33
v_and_b32 v75, 0xffff0000, v33
v_lshlrev_b32 v76, 16, v34
v_and_b32 v77, 0xffff0000, v34
v_lshlrev_b32 v78, 16, v35
v_and_b32 v79, 0xffff0000, v35
v_pk_mul_f32 v[72:73], v[72:73], v[120:121] op_sel:[0,1] op_sel_hi:[1,1]
v_pk_mul_f32 v[74:75], v[74:75], v[120:121] op_sel:[0,1] op_sel_hi:[1,1]
v_pk_mul_f32 v[76:77], v[76:77], v[120:121] op_sel:[0,1] op_sel_hi:[1,1]
v_pk_mul_f32 v[78:79], v[78:79], v[120:121] op_sel:[0,1] op_sel_hi:[1,1]
CV 32,72,73
CV 33,74,75
CV 34,76,77
CV 35,78,79
buffer_store_dwordx4 v[32:35], v18, s[20:23], s3 offen sc1
s_add_u32 s3, s3, 0x8000
v_pk_add_f32 v[80:81], v[80:81], v[120:121] op_sel_hi:[1,0]
v_pk_add_f32 v[82:83], v[82:83], v[120:121] op_sel_hi:[1,0]
v_pk_add_f32 v[84:85], v[84:85], v[120:121] op_sel_hi:[1,0]
v_pk_add_f32 v[86:87], v[86:87], v[120:121] op_sel_hi:[1,0]
CV 36,80,81
CV 37,82,83
CV 38,84,85
CV 39,86,87
v_lshlrev_b32 v80, 16, v36
v_and_b32 v81, 0xffff0000, v36
v_lshlrev_b32 v82, 16, v37
v_and_b32 v83, 0xffff0000, v37
v_lshlrev_b32 v84, 16, v38
v_and_b32 v85, 0xffff0000, v38
v_lshlrev_b32 v86, 16, v39
v_and_b32 v87, 0xffff0000, v39
v_pk_mul_f32 v[80:81], v[80:81], v[120:121] op_sel:[0,1] op_sel_hi:[1,1]
v_pk_mul_f32 v[82:83], v[82:83], v[120:121] op_sel:[0,1] op_sel_hi:[1,1]
v_pk_mul_f32 v[84:85], v[84:85], v[120:121] op_sel:[0,1] op_sel_hi:[1,1]
v_pk_mul_f32 v[86:87], v[86:87], v[120:121] op_sel:[0,1] op_sel_hi:[1,1]
CV 36,80,81
CV 37,82,83
CV 38,84,85
CV 39,86,87
buffer_store_dwordx4 v[36:39], v18, s[20:23], s3 offen sc1
s_lshl_b32 s3, s2, 2
s_add_u32 s3, s3, s10
s_lshl_b32 s3, s3, 6
s_add_u32 s3, s3, 262144
s_waitcnt vmcnt(0)
v_readfirstlane_b32 s100, v240
s_nop 1
s_add_u32 s100, s100, 1
v_mov_b32 v16, s100
s_mov_b64 exec, 1
buffer_store_dword v16, off, s[48:51], s3 sc1
s_mov_b64 exec, -1
s_add_u32 m0, s35, 35328
s_nop 0
buffer_load_dwordx4 v4, s[16:19], s32 offen lds
buffer_load_dwordx4 v5, s[16:19], s32 offen offset:1056 lds
buffer_load_dwordx4 v6, s[16:19], s32 offen offset:2112 lds
buffer_load_dwordx4 v7, s[16:19], s32 offen offset:3168 lds
s_add_u32 s32, s32, 0x38000
s_add_u32 m0, s35, 52992
s_nop 0
buffer_load_dwordx4 v4, s[16:19], s32 offen lds
buffer_load_dwordx4 v5, s[16:19], s32 offen offset:1056 lds
buffer_load_dwordx4 v6, s[16:19], s32 offen offset:2112 lds
buffer_load_dwordx4 v7, s[16:19], s32 offen offset:3168 lds
s_add_u32 s32, s32, 0x38000
v_and_b32 v16, 31, v1
v_lshlrev_b32 v16, 6, v16
s_lshl_b32 s3, s13, 2
s_add_u32 s3, s3, s10
s_lshl_b32 s3, s3, 11
s_add_u32 s3, s3, 262144
s_mov_b32 s37, 0
L_b_pollx:
buffer_load_dword v17, v16, s[48:51], s3 offen sc1
s_waitcnt vmcnt(0)
v_cmp_ne_u32 vcc, s100, v17
s_add_u32 s37, s37, 1
s_cmp_ge_u32 s37, 65536
s_cbranch_scc1 L_b_pollx_done
s_cbranch_vccnz L_b_pollx
L_b_pollx_done:
buffer_load_dwordx4 v[128:131], v8, s[20:23], s33 offen sc1
buffer_load_dwordx4 v[132:135], v8, s[20:23], s33 offen offset:256 sc1
buffer_load_dwordx4 v[136:139], v8, s[20:23], s33 offen offset:2048 sc1
buffer_load_dwordx4 v[140:143], v8, s[20:23], s33 offen offset:2304 sc1
s_add_u32 s33, s33, 0x4000
buffer_load_dwordx4 v[144:147], v8, s[20:23], s33 offen sc1
buffer_load_dwordx4 v[148:151], v8, s[20:23], s33 offen offset:256 sc1
buffer_load_dwordx4 v[152:155], v8, s[20:23], s33 offen offset:2048 sc1
buffer_load_dwordx4 v[156:159], v8, s[20:23], s33 offen offset:2304 sc1
s_add_u32 s33, s33, 0x4000
buffer_load_dwordx4 v[160:163], v8, s[20:23], s33 offen sc1
buffer_load_dwordx4 v[164:167], v8, s[20:23], s33 offen offset:256 sc1
buffer_load_dwordx4 v[168:171], v8, s[20:23], s33 offen offset:2048 sc1
buffer_load_dwordx4 v[172:175], v8, s[20:23], s33 offen offset:2304 sc1
s_add_u32 s33, s33, 0x4000
v_bfe_u32 v3, v1, 2, 2
v_mul_u32_u24 v9, 4416, v3
v_lshrrev_b32 v3, 4, v1
v_mul_u32_u24 v3, 1056, v3
v_add_u32 v9, v9, v3
v_and_b32 v3, 3, v1
v_lshl_add_u32 v9, v3, 3, v9
v_add_u32 v10, 52992, v9
s_and_b32 s59, s2, 127
s_lshl_b32 s59, s59, 2
s_add_u32 s59, s59, s10
s_mul_i32 s59, s59, 896
s_add_u32 s59, s59, 1835008
v_lshlrev_b32 v243, 7, v1
v_cmp_lt_u32 vcc, 6, v1
v_mov_b32 v3, 0x40000000
s_nop 0
v_cndmask_b32 v246, v243, v3, vcc
v_cmp_lt_u32 vcc, 10, v1
s_and_b32 s58, s2, 127
s_lshl_b32 s58, s58, 2
s_add_u32 s58, s58, s10
s_lshl_b32 s58, s58, 14
v_cndmask_b32 v245, v243, v3, vcc
s_mov_b32 s44, s52
s_mov_b32 s45, s53
s_mov_b32 s46, 0x800000
s_mov_b32 s47, 0x00020000
s_mov_b32 s96, s54
s_mov_b32 s97, s55
s_mov_b32 s98, 0x1000
s_mov_b32 s99, 0x00020000
s_add_u32 s24, s8, 0x2000000
s_addc_u32 s25, s9, 0
s_mov_b32 s26, 0x700000
s_mov_b32 s27, 0x00020000
s_add_u32 s28, s8, 0x2800000
s_addc_u32 s29, s9, 0
s_mov_b32 s30, 0x728000
s_mov_b32 s31, 0x00020000
s_mov_b32 s60, 0xbdd2d3e8
s_mov_b32 s61, 0xc0135761
v_lshrrev_b32 v3, 3, v1
v_lshl_add_u32 v12, v2, 6, v3
v_lshlrev_b32 v12, 12, v12
v_bfe_u32 v3, v1, 4, 1
v_and_b32 v13, 7, v1
v_xor_b32 v3, v3, v13
v_xor_b32 v13, 6, v3
v_lshl_add_u32 v13, v13, 4, v12
v_lshl_add_u32 v12, v3, 4, v12
v_add_u32 v13, 31744, v13
v_add_u32 v14, 63488, v12
v_add_u32 v15, 63488, v13
s_lshl_b32 s5, s13, 20
s_lshl_b32 s4, s13, 9
s_or_b32 s62, s4, s5
s_add_u32 s63, s62, 131072
s_lshl_b32 s39, s10, 13
s_add_u32 s39, s39, 98304
s_waitcnt vmcnt(8)
s_barrier
TR 16,9,0
TR 18,9,512
TR 20,9,32
TR 22,9,544
TR 24,9,64
TR 26,9,576
TR 28,9,96
TR 30,9,608
TR 32,9,128
TR 34,9,640
TR 36,9,160
TR 38,9,672
TR 40,9,192
TR 42,9,704
TR 44,9,224
TR 46,9,736
TR 48,9,256
TR 50,9,768
TR 52,9,288
TR 54,9,800
TR 56,9,320
TR 58,9,832
TR 60,9,352
TR 62,9,864
TR 64,9,384
TR 66,9,896
TR 68,9,416
TR 70,9,928
s_waitcnt vmcnt(8) lgkmcnt(0)
s_barrier
MZ 0,16,128
TR 72,9,17664
MZ 16,20,128
TR 74,9,18176
MZ 20,20,132
buffer_load_dwordx4 v[176:179], v8, s[20:23], s33 offen sc1
MZ 4,16,132
TR 76,9,17696
MZ 8,16,136
TR 78,9,18208
MZ 24,20,136
MZ 28,20,140
TR 80,9,17728
MZ 12,16,140
TR 82,9,18240
MZ 44,24,140
buffer_load_dwordx4 v[180:183], v8, s[20:23], s33 offen offset:256 sc1
MZ 60,28,140
TR 84,9,17760
MZ 56,28,136
TR 86,9,18272
MZ 40,24,136
MZ 36,24,132
TR 88,9,17792
MZ 52,28,132
TR 90,9,18304
MZ 48,28,128
MZ 32,24,128
TR 92,9,17824
MZ 64,32,128
TR 94,9,18336
MZ 80,36,128
buffer_load_dwordx4 v[184:187], v8, s[20:23], s33 offen offset:2048 sc1
MZ 84,36,132
TR 96,9,17856
MZ 68,32,132
TR 98,9,18368
MZ 72,32,136
MZ 88,36,136
TR 100,9,17888
MZ 92,36,140
TR 102,9,18400
MZ 76,32,140
buffer_load_dwordx4 v[188:191], v8, s[20:23], s33 offen offset:2304 sc1
s_add_u32 s33, s33, 0x4000
MZ 108,40,140
TR 104,9,17920
MZ 124,44,140
TR 106,9,18432
MZ 120,44,136
MZ 104,40,136
TR 108,9,17952
MZ 100,40,132
TR 110,9,18464
MZ 116,44,132
MZ 112,44,128
TR 112,9,17984
MZ 96,40,128
TR 114,9,18496
MZ 128,48,128
s_add_u32 m0, s35, 0
MZ 144,52,128
TR 116,9,18016
MZ 148,52,132
TR 118,9,18528
MZ 132,48,132
MZ 136,48,136
TR 120,9,18048
MZ 152,52,136
TR 122,9,18560
MZ 156,52,140
MZ 140,48,140
TR 124,9,18080
MZ 172,56,140
TR 126,9,18592
MZ 188,60,140
buffer_load_dwordx4 v4, s[16:19], s32 offen lds
MZ 184,60,136
MZ 168,56,136
buffer_load_dwordx4 v5, s[16:19], s32 offen offset:1056 lds
MZ 164,56,132
MZ 180,60,132
MZ 176,60,128
buffer_load_dwordx4 v6, s[16:19], s32 offen offset:2112 lds
MZ 160,56,128
MZ 192,64,128
buffer_load_dwordx4 v7, s[16:19], s32 offen offset:3168 lds
s_add_u32 s32, s32, 0x38000
MZ 208,68,128
MZ 212,68,132
MZ 196,64,132
buffer_load_dword v244, v246, s[16:19], s59 offen
s_add_u32 s59, s59, 458752
MZ 200,64,136
MZ 216,68,136
MZ 220,68,140
MZ 204,64,140
s_waitcnt vmcnt(13) lgkmcnt(0)
s_barrier
MA 0,72,144
TR 16,9,35328
MA 16,76,144
TR 18,9,35840
MA 20,76,148
buffer_load_dwordx4 v[128:131], v8, s[20:23], s33 offen sc1
MA 4,72,148
TR 20,9,35360
MA 8,72,152
TR 22,9,35872
MA 24,76,152
MA 28,76,156
TR 24,9,35392
MA 12,72,156
TR 26,9,35904
MA 44,80,156
buffer_load_dwordx4 v[132:135], v8, s[20:23], s33 offen offset:256 sc1
MA 60,84,156
TR 28,9,35424
MA 56,84,152
TR 30,9,35936
MA 40,80,152
MA 36,80,148
TR 32,9,35456
MA 52,84,148
TR 34,9,35968
MA 48,84,144
MA 32,80,144
TR 36,9,35488
MA 64,88,144
TR 38,9,36000
MA 80,92,144
buffer_load_dwordx4 v[136:139], v8, s[20:23], s33 offen offset:2048 sc1
MA 84,92,148
TR 40,9,35520
MA 68,88,148
TR 42,9,36032
MA 72,88,152
MA 88,92,152
TR 44,9,35552
MA 92,92,156
TR 46,9,36064
MA 76,88,156
MA 108,96,156
TR 48,9,35584
MA 124,100,156
TR 50,9,36096
MA 120,100,152
buffer_load_dwordx4 v[140:143], v8, s[20:23], s33 offen offset:2304 sc1
s_add_u32 s33, s33, 0x4000
MA 104,96,152
TR 52,9,35616
MA 100,96,148
TR 54,9,36128
MA 116,100,148
MA 112,100,144
TR 56,9,35648
MA 96,96,144
TR 58,9,36160
MA 128,104,144
MA 144,108,144
TR 60,9,35680
MA 148,108,148
TR 62,9,36192
MA 132,104,148
s_add_u32 m0, s35, 17664
MA 136,104,152
TR 64,9,35712
MA 152,108,152
TR 66,9,36224
MA 156,108,156
MA 140,104,156
TR 68,9,35744
MA 172,112,156
TR 70,9,36256
MA 188,116,156
MA 184,116,152
buffer_load_dwordx4 v4, s[16:19], s32 offen lds
MA 168,112,152
MA 164,112,148
MA 180,116,148
buffer_load_dwordx4 v5, s[16:19], s32 offen offset:1056 lds
MA 176,116,144
MA 160,112,144
MA 192,120,144
buffer_load_dwordx4 v6, s[16:19], s32 offen offset:2112 lds
MA 208,124,144
MA 212,124,148
MA 196,120,148
buffer_load_dwordx4 v7, s[16:19], s32 offen offset:3168 lds
s_add_u32 s32, s32, 0x38000
MA 200,120,152
MA 216,124,152
MA 220,124,156
MA 204,120,156
s_waitcnt vmcnt(17) lgkmcnt(0)
s_barrier
MA 0,16,160
TR 72,10,0
MA 16,20,160
TR 74,10,512
MA 20,20,164
buffer_load_dwordx4 v[144:147], v8, s[20:23], s33 offen sc1
MA 4,16,164
TR 76,10,32
MA 8,16,168
TR 78,10,544
MA 24,20,168
MA 28,20,172
TR 80,10,64
MA 12,16,172
TR 82,10,576
MA 44,24,172
buffer_load_dwordx4 v[148:151], v8, s[20:23], s33 offen offset:256 sc1
MA 60,28,172
TR 84,10,96
MA 56,28,168
TR 86,10,608
MA 40,24,168
MA 36,24,164
TR 88,10,128
MA 52,28,164
TR 90,10,640
MA 48,28,160
MA 32,24,160
TR 92,10,160
MA 64,32,160
TR 94,10,672
MA 80,36,160
buffer_load_dwordx4 v[152:155], v8, s[20:23], s33 offen offset:2048 sc1
MA 84,36,164
TR 96,10,192
MA 68,32,164
TR 98,10,704
MA 72,32,168
MA 88,36,168
TR 100,10,224
MA 92,36,172
TR 102,10,736
MA 76,32,172
buffer_load_dwordx4 v[156:159], v8, s[20:23], s33 offen offset:2304 sc1
s_add_u32 s33, s33, 0x4000
MA 108,40,172
TR 104,10,256
MA 124,44,172
TR 106,10,768
MA 120,44,168
MA 104,40,168
TR 108,10,288
MA 100,40,164
TR 110,10,800
MA 116,44,164
MA 112,44,160
TR 112,10,320
MA 96,40,160
TR 114,10,832
MA 128,48,160
s_add_u32 m0, s35, 35328
MA 144,52,160
TR 116,10,352
MA 148,52,164
TR 118,10,864
MA 132,48,164
MA 136,48,168
TR 120,10,384
MA 152,52,168
TR 122,10,896
MA 156,52,172
MA 140,48,172
TR 124,10,416
MA 172,56,172
TR 126,10,928
MA 188,60,172
buffer_load_dwordx4 v4, s[16:19], s32 offen lds
MA 184,60,168
MA 168,56,168
buffer_load_dwordx4 v5, s[16:19], s32 offen offset:1056 lds
MA 164,56,164
MA 180,60,164
MA 176,60,160
buffer_load_dwordx4 v6, s[16:19], s32 offen offset:2112 lds
MA 160,56,160
MA 192,64,160
buffer_load_dwordx4 v7, s[16:19], s32 offen offset:3168 lds
s_add_u32 s32, s32, 0x38000
MA 208,68,160
MA 212,68,164
MA 196,64,164
buffer_load_dword v244, v246, s[16:19], s59 offen
s_add_u32 s59, s59, 458752
MA 200,64,168
MA 216,68,168
MA 220,68,172
MA 204,64,172
s_waitcnt vmcnt(18) lgkmcnt(0)
s_barrier
MA 0,72,176
TR 16,9,0
MA 16,76,176
TR 18,9,512
MA 20,76,180
buffer_load_dwordx4 v[160:163], v8, s[20:23], s33 offen sc1
MA 4,72,180
TR 20,9,32
MA 8,72,184
TR 22,9,544
MA 24,76,184
MA 28,76,188
TR 24,9,64
MA 12,72,188
TR 26,9,576
MA 44,80,188
buffer_load_dwordx4 v[164:167], v8, s[20:23], s33 offen offset:256 sc1
MA 60,84,188
TR 28,9,96
MA 56,84,184
TR 30,9,608
MA 40,80,184
MA 36,80,180
TR 32,9,128
MA 52,84,180
TR 34,9,640
MA 48,84,176
MA 32,80,176
TR 36,9,160
MA 64,88,176
TR 38,9,672
MA 80,92,176
buffer_load_dwordx4 v[168:171], v8, s[20:23], s33 offen offset:2048 sc1
MA 84,92,180
TR 40,9,192
MA 68,88,180
TR 42,9,704
MA 72,88,184
MA 88,92,184
TR 44,9,224
MA 92,92,188
TR 46,9,736
MA 76,88,188
MA 108,96,188
TR 48,9,256
MA 124,100,188
TR 50,9,768
MA 120,100,184
buffer_load_dwordx4 v[172:175], v8, s[20:23], s33 offen offset:2304 sc1
s_add_u32 s33, s33, 0x4000
MA 104,96,184
TR 52,9,288
MA 100,96,180
TR 54,9,800
MA 116,100,180
MA 112,100,176
TR 56,9,320
MA 96,96,176
TR 58,9,832
MA 128,104,176
MA 144,108,176
TR 60,9,352
MA 148,108,180
TR 62,9,864
MA 132,104,180
s_add_u32 m0, s35, 52992
MA 136,104,184
TR 64,9,384
MA 152,108,184
TR 66,9,896
MA 156,108,188
MA 140,104,188
TR 68,9,416
MA 172,112,188
TR 70,9,928
MA 188,116,188
MA 184,116,184
buffer_load_dwordx4 v4, s[16:19], s32 offen lds
MA 168,112,184
MA 164,112,180
MA 180,116,180
buffer_load_dwordx4 v5, s[16:19], s32 offen offset:1056 lds
MA 176,116,176
MA 160,112,176
MA 192,120,176
buffer_load_dwordx4 v6, s[16:19], s32 offen offset:2112 lds
MA 208,124,176
MA 212,124,180
MA 196,120,180
buffer_load_dwordx4 v7, s[16:19], s32 offen offset:3168 lds
s_add_u32 s32, s32, 0x38000
MA 200,120,184
MA 216,124,184
MA 220,124,188
MA 204,120,188
s_mov_b32 s37, 6
.p2align 6
L_b_z_0:
s_waitcnt vmcnt(17) lgkmcnt(0)
s_barrier
MA 0,16,128
TR 72,9,17664
MA 16,20,128
TR 74,9,18176
MA 20,20,132
buffer_load_dwordx4 v[176:179], v8, s[20:23], s33 offen sc1
MA 4,16,132
TR 76,9,17696
MA 8,16,136
TR 78,9,18208
MA 24,20,136
MA 28,20,140
TR 80,9,17728
MA 12,16,140
TR 82,9,18240
MA 44,24,140
buffer_load_dwordx4 v[180:183], v8, s[20:23], s33 offen offset:256 sc1
MA 60,28,140
TR 84,9,17760
MA 56,28,136
TR 86,9,18272
MA 40,24,136
MA 36,24,132
TR 88,9,17792
MA 52,28,132
TR 90,9,18304
MA 48,28,128
MA 32,24,128
TR 92,9,17824
MA 64,32,128
TR 94,9,18336
MA 80,36,128
buffer_load_dwordx4 v[184:187], v8, s[20:23], s33 offen offset:2048 sc1
MA 84,36,132
TR 96,9,17856
MA 68,32,132
TR 98,9,18368
MA 72,32,136
MA 88,36,136
TR 100,9,17888
MA 92,36,140
TR 102,9,18400
MA 76,32,140
buffer_load_dwordx4 v[188:191], v8, s[20:23], s33 offen offset:2304 sc1
s_add_u32 s33, s33, 0x4000
MA 108,40,140
TR 104,9,17920
MA 124,44,140
TR 106,9,18432
MA 120,44,136
MA 104,40,136
TR 108,9,17952
MA 100,40,132
TR 110,9,18464
MA 116,44,132
MA 112,44,128
TR 112,9,17984
MA 96,40,128
TR 114,9,18496
MA 128,48,128
s_add_u32 m0, s35, 0
MA 144,52,128
TR 116,9,18016
MA 148,52,132
TR 118,9,18528
MA 132,48,132
MA 136,48,136
TR 120,9,18048
MA 152,52,136
TR 122,9,18560
MA 156,52,140
MA 140,48,140
TR 124,9,18080
MA 172,56,140
TR 126,9,18592
MA 188,60,140
buffer_load_dwordx4 v4, s[16:19], s32 offen lds
MA 184,60,136
MA 168,56,136
buffer_load_dwordx4 v5, s[16:19], s32 offen offset:1056 lds
MA 164,56,132
MA 180,60,132
MA 176,60,128
buffer_load_dwordx4 v6, s[16:19], s32 offen offset:2112 lds
MA 160,56,128
MA 192,64,128
buffer_load_dwordx4 v7, s[16:19], s32 offen offset:3168 lds
s_add_u32 s32, s32, 0x38000
MA 208,68,128
MA 212,68,132
MA 196,64,132
buffer_load_dword v244, v246, s[16:19], s59 offen
s_add_u32 s59, s59, 458752
MA 200,64,136
MA 216,68,136
MA 220,68,140
MA 204,64,140
s_waitcnt vmcnt(18) lgkmcnt(0)
s_barrier
MA 0,72,144
TR 16,9,35328
MA 16,76,144
TR 18,9,35840
MA 20,76,148
buffer_load_dwordx4 v[128:131], v8, s[20:23], s33 offen sc1
MA 4,72,148
TR 20,9,35360
MA 8,72,152
TR 22,9,35872
MA 24,76,152
MA 28,76,156
TR 24,9,35392
MA 12,72,156
TR 26,9,35904
MA 44,80,156
buffer_load_dwordx4 v[132:135], v8, s[20:23], s33 offen offset:256 sc1
MA 60,84,156
TR 28,9,35424
MA 56,84,152
TR 30,9,35936
MA 40,80,152
MA 36,80,148
TR 32,9,35456
MA 52,84,148
TR 34,9,35968
MA 48,84,144
MA 32,80,144
TR 36,9,35488
MA 64,88,144
TR 38,9,36000
MA 80,92,144
buffer_load_dwordx4 v[136:139], v8, s[20:23], s33 offen offset:2048 sc1
MA 84,92,148
TR 40,9,35520
MA 68,88,148
TR 42,9,36032
MA 72,88,152
MA 88,92,152
TR 44,9,35552
MA 92,92,156
TR 46,9,36064
MA 76,88,156
MA 108,96,156
TR 48,9,35584
MA 124,100,156
TR 50,9,36096
MA 120,100,152
buffer_load_dwordx4 v[140:143], v8, s[20:23], s33 offen offset:2304 sc1
s_add_u32 s33, s33, 0x4000
MA 104,96,152
TR 52,9,35616
MA 100,96,148
TR 54,9,36128
MA 116,100,148
MA 112,100,144
TR 56,9,35648
MA 96,96,144
TR 58,9,36160
MA 128,104,144
MA 144,108,144
TR 60,9,35680
MA 148,108,148
TR 62,9,36192
MA 132,104,148
s_add_u32 m0, s35, 17664
MA 136,104,152
TR 64,9,35712
MA 152,108,152
TR 66,9,36224
MA 156,108,156
MA 140,104,156
TR 68,9,35744
MA 172,112,156
TR 70,9,36256
MA 188,116,156
MA 184,116,152
buffer_load_dwordx4 v4, s[16:19], s32 offen lds
MA 168,112,152
MA 164,112,148
MA 180,116,148
buffer_load_dwordx4 v5, s[16:19], s32 offen offset:1056 lds
MA 176,116,144
MA 160,112,144
MA 192,120,144
buffer_load_dwordx4 v6, s[16:19], s32 offen offset:2112 lds
MA 208,124,144
MA 212,124,148
MA 196,120,148
buffer_load_dwordx4 v7, s[16:19], s32 offen offset:3168 lds
s_add_u32 s32, s32, 0x38000
MA 200,120,152
MA 216,124,152
MA 220,124,156
MA 204,120,156
s_waitcnt vmcnt(17) lgkmcnt(0)
s_barrier
MA 0,16,160
TR 72,10,0
MA 16,20,160
TR 74,10,512
MA 20,20,164
buffer_load_dwordx4 v[144:147], v8, s[20:23], s33 offen sc1
MA 4,16,164
TR 76,10,32
MA 8,16,168
TR 78,10,544
MA 24,20,168
MA 28,20,172
TR 80,10,64
MA 12,16,172
TR 82,10,576
MA 44,24,172
buffer_load_dwordx4 v[148:151], v8, s[20:23], s33 offen offset:256 sc1
MA 60,28,172
TR 84,10,96
MA 56,28,168
TR 86,10,608
MA 40,24,168
MA 36,24,164
TR 88,10,128
MA 52,28,164
TR 90,10,640
MA 48,28,160
MA 32,24,160
TR 92,10,160
MA 64,32,160
TR 94,10,672
MA 80,36,160
buffer_load_dwordx4 v[152:155], v8, s[20:23], s33 offen offset:2048 sc1
MA 84,36,164
TR 96,10,192
MA 68,32,164
TR 98,10,704
MA 72,32,168
MA 88,36,168
TR 100,10,224
MA 92,36,172
TR 102,10,736
MA 76,32,172
buffer_load_dwordx4 v[156:159], v8, s[20:23], s33 offen offset:2304 sc1
s_add_u32 s33, s33, 0x4000
MA 108,40,172
TR 104,10,256
MA 124,44,172
TR 106,10,768
MA 120,44,168
MA 104,40,168
TR 108,10,288
MA 100,40,164
TR 110,10,800
MA 116,44,164
MA 112,44,160
TR 112,10,320
MA 96,40,160
TR 114,10,832
MA 128,48,160
s_add_u32 m0, s35, 35328
MA 144,52,160
TR 116,10,352
MA 148,52,164
TR 118,10,864
MA 132,48,164
MA 136,48,168
TR 120,10,384
MA 152,52,168
TR 122,10,896
MA 156,52,172
MA 140,48,172
TR 124,10,416
MA 172,56,172
TR 126,10,928
MA 188,60,172
buffer_load_dwordx4 v4, s[16:19], s32 offen lds
MA 184,60,168
MA 168,56,168
buffer_load_dwordx4 v5, s[16:19], s32 offen offset:1056 lds
MA 164,56,164
MA 180,60,164
MA 176,60,160
buffer_load_dwordx4 v6, s[16:19], s32 offen offset:2112 lds
MA 160,56,160
MA 192,64,160
buffer_load_dwordx4 v7, s[16:19], s32 offen offset:3168 lds
s_add_u32 s32, s32, 0x38000
MA 208,68,160
MA 212,68,164
MA 196,64,164
buffer_load_dword v244, v246, s[16:19], s59 offen
s_add_u32 s59, s59, 458752
MA 200,64,168
MA 216,68,168
MA 220,68,172
MA 204,64,172
s_waitcnt vmcnt(18) lgkmcnt(0)
s_barrier
MA 0,72,176
TR 16,9,0
MA 16,76,176
TR 18,9,512
MA 20,76,180
buffer_load_dwordx4 v[160:163], v8, s[20:23], s33 offen sc1
MA 4,72,180
TR 20,9,32
MA 8,72,184
TR 22,9,544
MA 24,76,184
MA 28,76,188
TR 24,9,64
MA 12,72,188
TR 26,9,576
MA 44,80,188
buffer_load_dwordx4 v[164:167], v8, s[20:23], s33 offen offset:256 sc1
MA 60,84,188
TR 28,9,96
MA 56,84,184
TR 30,9,608
MA 40,80,184
MA 36,80,180
TR 32,9,128
MA 52,84,180
TR 34,9,640
MA 48,84,176
MA 32,80,176
TR 36,9,160
MA 64,88,176
TR 38,9,672
MA 80,92,176
buffer_load_dwordx4 v[168:171], v8, s[20:23], s33 offen offset:2048 sc1
MA 84,92,180
TR 40,9,192
MA 68,88,180
TR 42,9,704
MA 72,88,184
MA 88,92,184
TR 44,9,224
MA 92,92,188
TR 46,9,736
MA 76,88,188
MA 108,96,188
TR 48,9,256
MA 124,100,188
TR 50,9,768
MA 120,100,184
buffer_load_dwordx4 v[172:175], v8, s[20:23], s33 offen offset:2304 sc1
s_add_u32 s33, s33, 0x4000
MA 104,96,184
TR 52,9,288
MA 100,96,180
TR 54,9,800
MA 116,100,180
MA 112,100,176
TR 56,9,320
MA 96,96,176
TR 58,9,832
MA 128,104,176
MA 144,108,176
TR 60,9,352
MA 148,108,180
TR 62,9,864
MA 132,104,180
s_add_u32 m0, s35, 52992
MA 136,104,184
TR 64,9,384
MA 152,108,184
TR 66,9,896
MA 156,108,188
MA 140,104,188
TR 68,9,416
MA 172,112,188
TR 70,9,928
MA 188,116,188
MA 184,116,184
buffer_load_dwordx4 v4, s[16:19], s32 offen lds
MA 168,112,184
MA 164,112,180
MA 180,116,180
buffer_load_dwordx4 v5, s[16:19], s32 offen offset:1056 lds
MA 176,116,176
MA 160,112,176
MA 192,120,176
buffer_load_dwordx4 v6, s[16:19], s32 offen offset:2112 lds
MA 208,124,176
MA 212,124,180
MA 196,120,180
buffer_load_dwordx4 v7, s[16:19], s32 offen offset:3168 lds
s_add_u32 s32, s32, 0x38000
MA 200,120,184
MA 216,124,184
MA 220,124,188
MA 204,120,188
s_sub_u32 s37, s37, 1
s_cmp_lg_u32 s37, 0
s_cbranch_scc1 L_b_z_0
s_waitcnt vmcnt(17) lgkmcnt(0)
s_barrier
MA 0,16,128
TR 72,9,17664
MA 16,20,128
TR 74,9,18176
MA 20,20,132
buffer_load_dwordx4 v[176:179], v8, s[20:23], s33 offen sc1
MA 4,16,132
TR 76,9,17696
MA 8,16,136
TR 78,9,18208
MA 24,20,136
MA 28,20,140
TR 80,9,17728
MA 12,16,140
TR 82,9,18240
MA 44,24,140
MA 60,28,140
TR 84,9,17760
MA 56,28,136
TR 86,9,18272
MA 40,24,136
buffer_load_dwordx4 v[180:183], v8, s[20:23], s33 offen offset:256 sc1
MA 36,24,132
TR 88,9,17792
MA 52,28,132
TR 90,9,18304
MA 48,28,128
MA 32,24,128
TR 92,9,17824
MA 64,32,128
TR 94,9,18336
MA 80,36,128
MA 84,36,132
TR 96,9,17856
MA 68,32,132
TR 98,9,18368
MA 72,32,136
buffer_load_dwordx4 v[184:187], v8, s[20:23], s33 offen offset:2048 sc1
MA 88,36,136
TR 100,9,17888
MA 92,36,140
TR 102,9,18400
MA 76,32,140
MA 108,40,140
TR 104,9,17920
MA 124,44,140
TR 106,9,18432
MA 120,44,136
MA 104,40,136
TR 108,9,17952
MA 100,40,132
TR 110,9,18464
MA 116,44,132
buffer_load_dwordx4 v[188:191], v8, s[20:23], s33 offen offset:2304 sc1
s_add_u32 s33, s33, 0x4000
MA 112,44,128
TR 112,9,17984
MA 96,40,128
TR 114,9,18496
MA 128,48,128
MA 144,52,128
TR 116,9,18016
MA 148,52,132
TR 118,9,18528
MA 132,48,132
MA 136,48,136
TR 120,9,18048
MA 152,52,136
TR 122,9,18560
MA 156,52,140
MA 140,48,140
TR 124,9,18080
MA 172,56,140
TR 126,9,18592
MA 188,60,140
s_getpc_b64 s[36:37]
L_ct7:
s_add_u32 s36, s36, L_b_gelu-L_ct7
s_addc_u32 s37, s37, 0
MA 184,60,136
MA 168,56,136
MA 164,56,132
v_lshlrev_b32 v247, 7, v0
MA 180,60,132
MA 176,60,128
MA 160,56,128
v_min_u32 v247, L_b_hepi-L_b_gelu-4, v247
MA 192,64,128
MA 208,68,128
MA 212,68,132
global_load_dword v244, v247, s[36:37]
MA 196,64,132
MA 200,64,136
MA 216,68,136
MA 220,68,140
MA 204,64,140
s_waitcnt vmcnt(14) lgkmcnt(0)
s_barrier
MA 0,72,144
TR 16,9,35328
MA 16,76,144
TR 18,9,35840
MA 20,76,148
s_add_u32 m0, s39, 0
MA 4,72,148
TR 20,9,35360
MA 8,72,152
TR 22,9,35872
MA 24,76,152
buffer_load_dwordx4 v12, s[44:47], s62 offen lds
MA 28,76,156
TR 24,9,35392
MA 12,72,156
TR 26,9,35904
MA 44,80,156
MA 60,84,156
TR 28,9,35424
MA 56,84,152
TR 30,9,35936
MA 40,80,152
buffer_load_dwordx4 v13, s[44:47], s62 offen offset:1024 lds
MA 36,80,148
TR 32,9,35456
MA 52,84,148
TR 34,9,35968
MA 48,84,144
MA 32,80,144
TR 36,9,35488
MA 64,88,144
TR 38,9,36000
MA 80,92,144
buffer_load_dwordx4 v14, s[44:47], s62 offen offset:2048 lds
MA 84,92,148
TR 40,9,35520
MA 68,88,148
TR 42,9,36032
MA 72,88,152
MA 88,92,152
TR 44,9,35552
MA 92,92,156
TR 46,9,36064
MA 76,88,156
buffer_load_dwordx4 v15, s[44:47], s62 offen offset:3072 lds
MA 108,96,156
TR 48,9,35584
MA 124,100,156
TR 50,9,36096
MA 120,100,152
MA 104,96,152
TR 52,9,35616
MA 100,96,148
TR 54,9,36128
MA 116,100,148
s_add_u32 m0, s39, 4096
MA 112,100,144
TR 56,9,35648
MA 96,96,144
TR 58,9,36160
MA 128,104,144
MA 144,108,144
TR 60,9,35680
MA 148,108,148
TR 62,9,36192
MA 132,104,148
buffer_load_dwordx4 v12, s[44:47], s63 offen lds
MA 136,104,152
TR 64,9,35712
MA 152,108,152
TR 66,9,36224
MA 156,108,156
MA 140,104,156
TR 68,9,35744
MA 172,112,156
TR 70,9,36256
MA 188,116,156
buffer_load_dwordx4 v13, s[44:47], s63 offen offset:1024 lds
MA 184,116,152
buffer_load_dwordx4 v14, s[44:47], s63 offen offset:2048 lds
MA 168,112,152
MA 164,112,148
buffer_load_dwordx4 v15, s[44:47], s63 offen offset:3072 lds
MA 180,116,148
MA 176,116,144
s_add_u32 s4, s4, 128
s_and_b32 s4, s4, 0xfff
MA 160,112,144
MA 192,120,144
s_or_b32 s62, s4, s5
s_add_u32 s63, s62, 131072
MA 208,124,144
MA 212,124,148
s_add_u32 s39, s39, 32768
s_cmp_ge_u32 s39, 163840
MA 196,120,148
MA 200,120,152
s_cselect_b32 s15, 98304, 0
s_sub_u32 s39, s39, s15
MA 216,124,152
MA 220,124,156
MA 204,120,156
s_waitcnt vmcnt(13) lgkmcnt(0)
s_barrier
MA 0,16,160
TR 72,10,0
MA 16,20,160
TR 74,10,512
MA 20,20,164
s_add_u32 m0, s39, 0
MA 4,16,164
TR 76,10,32
MA 8,16,168
TR 78,10,544
MA 24,20,168
buffer_load_dwordx4 v12, s[44:47], s62 offen lds
MA 28,20,172
TR 80,10,64
MA 12,16,172
TR 82,10,576
MA 44,24,172
MA 60,28,172
TR 84,10,96
MA 56,28,168
TR 86,10,608
MA 40,24,168
buffer_load_dwordx4 v13, s[44:47], s62 offen offset:1024 lds
MA 36,24,164
TR 88,10,128
MA 52,28,164
TR 90,10,640
MA 48,28,160
MA 32,24,160
TR 92,10,160
MA 64,32,160
TR 94,10,672
MA 80,36,160
buffer_load_dwordx4 v14, s[44:47], s62 offen offset:2048 lds
MA 84,36,164
TR 96,10,192
MA 68,32,164
TR 98,10,704
MA 72,32,168
MA 88,36,168
TR 100,10,224
MA 92,36,172
TR 102,10,736
MA 76,32,172
buffer_load_dwordx4 v15, s[44:47], s62 offen offset:3072 lds
MA 108,40,172
TR 104,10,256
MA 124,44,172
TR 106,10,768
MA 120,44,168
MA 104,40,168
TR 108,10,288
MA 100,40,164
TR 110,10,800
MA 116,44,164
s_add_u32 m0, s39, 4096
MA 112,44,160
TR 112,10,320
MA 96,40,160
TR 114,10,832
MA 128,48,160
MA 144,52,160
TR 116,10,352
MA 148,52,164
TR 118,10,864
MA 132,48,164
buffer_load_dwordx4 v12, s[44:47], s63 offen lds
MA 136,48,168
TR 120,10,384
MA 152,52,168
TR 122,10,896
MA 156,52,172
MA 140,48,172
TR 124,10,416
MA 172,56,172
TR 126,10,928
MA 188,60,172
buffer_load_dwordx4 v13, s[44:47], s63 offen offset:1024 lds
MA 184,60,168
buffer_load_dwordx4 v14, s[44:47], s63 offen offset:2048 lds
MA 168,56,168
MA 164,56,164
buffer_load_dwordx4 v15, s[44:47], s63 offen offset:3072 lds
MA 180,60,164
MA 176,60,160
s_add_u32 s4, s4, 128
s_and_b32 s4, s4, 0xfff
MA 160,56,160
MA 192,64,160
s_or_b32 s62, s4, s5
s_add_u32 s63, s62, 131072
MA 208,68,160
MA 212,68,164
s_add_u32 s39, s39, 32768
s_cmp_ge_u32 s39, 163840
MA 196,64,164
MA 200,64,168
s_cselect_b32 s15, 98304, 0
s_sub_u32 s39, s39, s15
MA 216,68,168
MA 220,68,172
MA 204,64,172
s_waitcnt vmcnt(17) lgkmcnt(0)
s_barrier
MA 0,72,176
MA 16,76,176
MA 20,76,180
s_add_u32 m0, s39, 0
MA 4,72,180
MA 8,72,184
MA 24,76,184
buffer_load_dwordx4 v12, s[44:47], s62 offen lds
MA 28,76,188
MA 12,72,188
MA 44,80,188
MA 60,84,188
buffer_load_dwordx4 v13, s[44:47], s62 offen offset:1024 lds
MA 56,84,184
MA 40,80,184
MA 36,80,180
MA 52,84,180
buffer_load_dwordx4 v14, s[44:47], s62 offen offset:2048 lds
MA 48,84,176
MA 32,80,176
MA 64,88,176
buffer_load_dwordx4 v15, s[44:47], s62 offen offset:3072 lds
MA 80,92,176
MA 84,92,180
MA 68,88,180
MA 72,88,184
s_add_u32 m0, s39, 4096
MA 88,92,184
MA 92,92,188
MA 76,88,188
MA 108,96,188
buffer_load_dwordx4 v12, s[44:47], s63 offen lds
MA 124,100,188
MA 120,100,184
MA 104,96,184
MA 100,96,180
buffer_load_dwordx4 v13, s[44:47], s63 offen offset:1024 lds
MA 116,100,180
MA 112,100,176
MA 96,96,176
buffer_load_dwordx4 v14, s[44:47], s63 offen offset:2048 lds
MA 128,104,176
MA 144,108,176
MA 148,108,180
MA 132,104,180
buffer_load_dwordx4 v15, s[44:47], s63 offen offset:3072 lds
MA 136,104,184
MA 152,108,184
MA 156,108,188
MA 140,104,188
s_add_u32 s4, s4, 128
s_and_b32 s4, s4, 0xfff
MA 172,112,188
MA 188,116,188
MA 184,116,184
s_or_b32 s62, s4, s5
s_add_u32 s63, s62, 131072
MA 168,112,184
MA 164,112,180
MA 180,116,180
MA 176,116,176
s_add_u32 s39, s39, 32768
s_cmp_ge_u32 s39, 163840
MA 160,112,176
MA 192,120,176
MA 208,124,176
MA 212,124,180
s_cselect_b32 s15, 98304, 0
s_sub_u32 s39, s39, s15
MA 196,120,180
MA 200,120,184
MA 216,124,184
MA 220,124,188
MA 204,120,188
L_b_gelu:
v_and_b32 v3, 15, v1
v_lshl_add_u32 v3, v2, 6, v3
v_lshlrev_b32 v3, 1, v3
s_lshl_b32 s15, s13, 9
buffer_load_ushort v4, v3, s[96:99], s15 offen offset:0
buffer_load_ushort v5, v3, s[96:99], s15 offen offset:32
buffer_load_ushort v6, v3, s[96:99], s15 offen offset:64
buffer_load_ushort v7, v3, s[96:99], s15 offen offset:96
v_mov_b32 v144, 0
v_mov_b32 v145, 0
v_mov_b32 v146, 0
v_mov_b32 v147, 0
v_mov_b32 v148, 0
v_mov_b32 v149, 0
v_mov_b32 v150, 0
v_mov_b32 v151, 0
v_mov_b32 v152, 0
v_mov_b32 v153, 0
v_mov_b32 v154, 0
v_mov_b32 v155, 0
v_mov_b32 v156, 0
v_mov_b32 v157, 0
v_mov_b32 v158, 0
v_mov_b32 v159, 0
AR 16,112
AR 17,113
AR 18,114
AR 19,115
AR 20,116
AR 21,117
AR 22,118
AR 23,119
PM 128,16,16
PM 130,18,18
PM 132,20,20
PM 134,22,22
v_pk_fma_f32 v[128:129], v[128:129], s[60:61], s[60:61] op_sel:[0,0,1] op_sel_hi:[1,0,1]
v_pk_fma_f32 v[130:131], v[130:131], s[60:61], s[60:61] op_sel:[0,0,1] op_sel_hi:[1,0,1]
v_pk_fma_f32 v[132:133], v[132:133], s[60:61], s[60:61] op_sel:[0,0,1] op_sel_hi:[1,0,1]
v_pk_fma_f32 v[134:135], v[134:135], s[60:61], s[60:61] op_sel:[0,0,1] op_sel_hi:[1,0,1]
PM 128,128,16
PM 130,130,18
PM 132,132,20
PM 134,134,22
v_exp_f32 v128, v128
v_exp_f32 v129, v129
v_exp_f32 v130, v130
v_exp_f32 v131, v131
v_exp_f32 v132, v132
v_exp_f32 v133, v133
v_exp_f32 v134, v134
v_exp_f32 v135, v135
v_pk_add_f32 v[128:129], v[128:129], 1.0 op_sel_hi:[1,0]
v_pk_add_f32 v[130:131], v[130:131], 1.0 op_sel_hi:[1,0]
v_pk_add_f32 v[132:133], v[132:133], 1.0 op_sel_hi:[1,0]
v_pk_add_f32 v[134:135], v[134:135], 1.0 op_sel_hi:[1,0]
v_rcp_f32 v128, v128
v_rcp_f32 v129, v129
v_rcp_f32 v130, v130
v_rcp_f32 v131, v131
v_rcp_f32 v132, v132
v_rcp_f32 v133, v133
v_rcp_f32 v134, v134
v_rcp_f32 v135, v135
PM 16,16,128
PM 18,18,130
PM 20,20,132
PM 22,22,134
PD 144,144,16
v_pk_fma_f32 v[146:147], v[16:17], v[16:17], v[146:147]
PD 148,148,20
v_pk_fma_f32 v[150:151], v[20:21], v[20:21], v[150:151]
PD 144,144,18
v_pk_fma_f32 v[146:147], v[18:19], v[18:19], v[146:147]
PD 148,148,22
v_pk_fma_f32 v[150:151], v[22:23], v[22:23], v[150:151]
AR 24,120
AR 25,121
AR 26,122
AR 27,123
AR 28,124
AR 29,125
AR 30,126
AR 31,127
PM 128,24,24
PM 130,26,26
PM 132,28,28
PM 134,30,30
v_pk_fma_f32 v[128:129], v[128:129], s[60:61], s[60:61] op_sel:[0,0,1] op_sel_hi:[1,0,1]
v_pk_fma_f32 v[130:131], v[130:131], s[60:61], s[60:61] op_sel:[0,0,1] op_sel_hi:[1,0,1]
v_pk_fma_f32 v[132:133], v[132:133], s[60:61], s[60:61] op_sel:[0,0,1] op_sel_hi:[1,0,1]
v_pk_fma_f32 v[134:135], v[134:135], s[60:61], s[60:61] op_sel:[0,0,1] op_sel_hi:[1,0,1]
PM 128,128,24
PM 130,130,26
PM 132,132,28
PM 134,134,30
v_exp_f32 v128, v128
v_exp_f32 v129, v129
v_exp_f32 v130, v130
v_exp_f32 v131, v131
v_exp_f32 v132, v132
v_exp_f32 v133, v133
v_exp_f32 v134, v134
v_exp_f32 v135, v135
v_pk_add_f32 v[128:129], v[128:129], 1.0 op_sel_hi:[1,0]
v_pk_add_f32 v[130:131], v[130:131], 1.0 op_sel_hi:[1,0]
v_pk_add_f32 v[132:133], v[132:133], 1.0 op_sel_hi:[1,0]
v_pk_add_f32 v[134:135], v[134:135], 1.0 op_sel_hi:[1,0]
v_rcp_f32 v128, v128
v_rcp_f32 v129, v129
v_rcp_f32 v130, v130
v_rcp_f32 v131, v131
v_rcp_f32 v132, v132
v_rcp_f32 v133, v133
v_rcp_f32 v134, v134
v_rcp_f32 v135, v135
PM 24,24,128
PM 26,26,130
PM 28,28,132
PM 30,30,134
PD 152,152,24
v_pk_fma_f32 v[154:155], v[24:25], v[24:25], v[154:155]
PD 156,156,28
v_pk_fma_f32 v[158:159], v[28:29], v[28:29], v[158:159]
PD 152,152,26
v_pk_fma_f32 v[154:155], v[26:27], v[26:27], v[154:155]
PD 156,156,30
v_pk_fma_f32 v[158:159], v[30:31], v[30:31], v[158:159]
AR 32,128
AR 33,129
AR 34,130
AR 35,131
AR 36,132
AR 37,133
AR 38,134
AR 39,135
PM 128,32,32
PM 130,34,34
PM 132,36,36
PM 134,38,38
v_pk_fma_f32 v[128:129], v[128:129], s[60:61], s[60:61] op_sel:[0,0,1] op_sel_hi:[1,0,1]
v_pk_fma_f32 v[130:131], v[130:131], s[60:61], s[60:61] op_sel:[0,0,1] op_sel_hi:[1,0,1]
v_pk_fma_f32 v[132:133], v[132:133], s[60:61], s[60:61] op_sel:[0,0,1] op_sel_hi:[1,0,1]
v_pk_fma_f32 v[134:135], v[134:135], s[60:61], s[60:61] op_sel:[0,0,1] op_sel_hi:[1,0,1]
PM 128,128,32
PM 130,130,34
PM 132,132,36
PM 134,134,38
v_exp_f32 v128, v128
v_exp_f32 v129, v129
v_exp_f32 v130, v130
v_exp_f32 v131, v131
v_exp_f32 v132, v132
v_exp_f32 v133, v133
v_exp_f32 v134, v134
v_exp_f32 v135, v135
v_pk_add_f32 v[128:129], v[128:129], 1.0 op_sel_hi:[1,0]
v_pk_add_f32 v[130:131], v[130:131], 1.0 op_sel_hi:[1,0]
v_pk_add_f32 v[132:133], v[132:133], 1.0 op_sel_hi:[1,0]
v_pk_add_f32 v[134:135], v[134:135], 1.0 op_sel_hi:[1,0]
v_rcp_f32 v128, v128
v_rcp_f32 v129, v129
v_rcp_f32 v130, v130
v_rcp_f32 v131, v131
v_rcp_f32 v132, v132
v_rcp_f32 v133, v133
v_rcp_f32 v134, v134
v_rcp_f32 v135, v135
PM 32,32,128
PM 34,34,130
PM 36,36,132
PM 38,38,134
PD 144,144,32
v_pk_fma_f32 v[146:147], v[32:33], v[32:33], v[146:147]
PD 148,148,36
v_pk_fma_f32 v[150:151], v[36:37], v[36:37], v[150:151]
PD 144,144,34
v_pk_fma_f32 v[146:147], v[34:35], v[34:35], v[146:147]
PD 148,148,38
v_pk_fma_f32 v[150:151], v[38:39], v[38:39], v[150:151]
AR 40,136
AR 41,137
AR 42,138
AR 43,139
AR 44,140
AR 45,141
AR 46,142
AR 47,143
PM 128,40,40
PM 130,42,42
PM 132,44,44
PM 134,46,46
v_pk_fma_f32 v[128:129], v[128:129], s[60:61], s[60:61] op_sel:[0,0,1] op_sel_hi:[1,0,1]
v_pk_fma_f32 v[130:131], v[130:131], s[60:61], s[60:61] op_sel:[0,0,1] op_sel_hi:[1,0,1]
v_pk_fma_f32 v[132:133], v[132:133], s[60:61], s[60:61] op_sel:[0,0,1] op_sel_hi:[1,0,1]
v_pk_fma_f32 v[134:135], v[134:135], s[60:61], s[60:61] op_sel:[0,0,1] op_sel_hi:[1,0,1]
PM 128,128,40
PM 130,130,42
PM 132,132,44
PM 134,134,46
v_exp_f32 v128, v128
v_exp_f32 v129, v129
v_exp_f32 v130, v130
v_exp_f32 v131, v131
v_exp_f32 v132, v132
v_exp_f32 v133, v133
v_exp_f32 v134, v134
v_exp_f32 v135, v135
v_pk_add_f32 v[128:129], v[128:129], 1.0 op_sel_hi:[1,0]
v_pk_add_f32 v[130:131], v[130:131], 1.0 op_sel_hi:[1,0]
v_pk_add_f32 v[132:133], v[132:133], 1.0 op_sel_hi:[1,0]
v_pk_add_f32 v[134:135], v[134:135], 1.0 op_sel_hi:[1,0]
v_rcp_f32 v128, v128
v_rcp_f32 v129, v129
v_rcp_f32 v130, v130
v_rcp_f32 v131, v131
v_rcp_f32 v132, v132
v_rcp_f32 v133, v133
v_rcp_f32 v134, v134
v_rcp_f32 v135, v135
PM 40,40,128
PM 42,42,130
PM 44,44,132
PM 46,46,134
PD 152,152,40
v_pk_fma_f32 v[154:155], v[40:41], v[40:41], v[154:155]
PD 156,156,44
v_pk_fma_f32 v[158:159], v[44:45], v[44:45], v[158:159]
PD 152,152,42
v_pk_fma_f32 v[154:155], v[42:43], v[42:43], v[154:155]
PD 156,156,46
v_pk_fma_f32 v[158:159], v[46:47], v[46:47], v[158:159]
AR 48,144
AR 49,145
AR 50,146
AR 51,147
AR 52,148
AR 53,149
AR 54,150
AR 55,151
PM 128,48,48
PM 130,50,50
PM 132,52,52
PM 134,54,54
v_pk_fma_f32 v[128:129], v[128:129], s[60:61], s[60:61] op_sel:[0,0,1] op_sel_hi:[1,0,1]
v_pk_fma_f32 v[130:131], v[130:131], s[60:61], s[60:61] op_sel:[0,0,1] op_sel_hi:[1,0,1]
v_pk_fma_f32 v[132:133], v[132:133], s[60:61], s[60:61] op_sel:[0,0,1] op_sel_hi:[1,0,1]
v_pk_fma_f32 v[134:135], v[134:135], s[60:61], s[60:61] op_sel:[0,0,1] op_sel_hi:[1,0,1]
PM 128,128,48
PM 130,130,50
PM 132,132,52
PM 134,134,54
v_exp_f32 v128, v128
v_exp_f32 v129, v129
v_exp_f32 v130, v130
v_exp_f32 v131, v131
v_exp_f32 v132, v132
v_exp_f32 v133, v133
v_exp_f32 v134, v134
v_exp_f32 v135, v135
v_pk_add_f32 v[128:129], v[128:129], 1.0 op_sel_hi:[1,0]
v_pk_add_f32 v[130:131], v[130:131], 1.0 op_sel_hi:[1,0]
v_pk_add_f32 v[132:133], v[132:133], 1.0 op_sel_hi:[1,0]
v_pk_add_f32 v[134:135], v[134:135], 1.0 op_sel_hi:[1,0]
v_rcp_f32 v128, v128
v_rcp_f32 v129, v129
v_rcp_f32 v130, v130
v_rcp_f32 v131, v131
v_rcp_f32 v132, v132
v_rcp_f32 v133, v133
v_rcp_f32 v134, v134
v_rcp_f32 v135, v135
PM 48,48,128
PM 50,50,130
PM 52,52,132
PM 54,54,134
PD 144,144,48
v_pk_fma_f32 v[146:147], v[48:49], v[48:49], v[146:147]
PD 148,148,52
v_pk_fma_f32 v[150:151], v[52:53], v[52:53], v[150:151]
PD 144,144,50
v_pk_fma_f32 v[146:147], v[50:51], v[50:51], v[146:147]
PD 148,148,54
v_pk_fma_f32 v[150:151], v[54:55], v[54:55], v[150:151]
AR 56,152
AR 57,153
AR 58,154
AR 59,155
AR 60,156
AR 61,157
AR 62,158
AR 63,159
PM 128,56,56
PM 130,58,58
PM 132,60,60
PM 134,62,62
v_pk_fma_f32 v[128:129], v[128:129], s[60:61], s[60:61] op_sel:[0,0,1] op_sel_hi:[1,0,1]
v_pk_fma_f32 v[130:131], v[130:131], s[60:61], s[60:61] op_sel:[0,0,1] op_sel_hi:[1,0,1]
v_pk_fma_f32 v[132:133], v[132:133], s[60:61], s[60:61] op_sel:[0,0,1] op_sel_hi:[1,0,1]
v_pk_fma_f32 v[134:135], v[134:135], s[60:61], s[60:61] op_sel:[0,0,1] op_sel_hi:[1,0,1]
PM 128,128,56
PM 130,130,58
PM 132,132,60
PM 134,134,62
v_exp_f32 v128, v128
v_exp_f32 v129, v129
v_exp_f32 v130, v130
v_exp_f32 v131, v131
v_exp_f32 v132, v132
v_exp_f32 v133, v133
v_exp_f32 v134, v134
v_exp_f32 v135, v135
v_pk_add_f32 v[128:129], v[128:129], 1.0 op_sel_hi:[1,0]
v_pk_add_f32 v[130:131], v[130:131], 1.0 op_sel_hi:[1,0]
v_pk_add_f32 v[132:133], v[132:133], 1.0 op_sel_hi:[1,0]
v_pk_add_f32 v[134:135], v[134:135], 1.0 op_sel_hi:[1,0]
v_rcp_f32 v128, v128
v_rcp_f32 v129, v129
v_rcp_f32 v130, v130
v_rcp_f32 v131, v131
v_rcp_f32 v132, v132
v_rcp_f32 v133, v133
v_rcp_f32 v134, v134
v_rcp_f32 v135, v135
PM 56,56,128
PM 58,58,130
PM 60,60,132
PM 62,62,134
PD 152,152,56
v_pk_fma_f32 v[154:155], v[56:57], v[56:57], v[154:155]
PD 156,156,60
v_pk_fma_f32 v[158:159], v[60:61], v[60:61], v[158:159]
PD 152,152,58
v_pk_fma_f32 v[154:155], v[58:59], v[58:59], v[154:155]
PD 156,156,62
v_pk_fma_f32 v[158:159], v[62:63], v[62:63], v[158:159]
AR 64,160
AR 65,161
AR 66,162
AR 67,163
AR 68,164
AR 69,165
AR 70,166
AR 71,167
PM 128,64,64
PM 130,66,66
PM 132,68,68
PM 134,70,70
v_pk_fma_f32 v[128:129], v[128:129], s[60:61], s[60:61] op_sel:[0,0,1] op_sel_hi:[1,0,1]
v_pk_fma_f32 v[130:131], v[130:131], s[60:61], s[60:61] op_sel:[0,0,1] op_sel_hi:[1,0,1]
v_pk_fma_f32 v[132:133], v[132:133], s[60:61], s[60:61] op_sel:[0,0,1] op_sel_hi:[1,0,1]
v_pk_fma_f32 v[134:135], v[134:135], s[60:61], s[60:61] op_sel:[0,0,1] op_sel_hi:[1,0,1]
PM 128,128,64
PM 130,130,66
PM 132,132,68
PM 134,134,70
v_exp_f32 v128, v128
v_exp_f32 v129, v129
v_exp_f32 v130, v130
v_exp_f32 v131, v131
v_exp_f32 v132, v132
v_exp_f32 v133, v133
v_exp_f32 v134, v134
v_exp_f32 v135, v135
v_pk_add_f32 v[128:129], v[128:129], 1.0 op_sel_hi:[1,0]
v_pk_add_f32 v[130:131], v[130:131], 1.0 op_sel_hi:[1,0]
v_pk_add_f32 v[132:133], v[132:133], 1.0 op_sel_hi:[1,0]
v_pk_add_f32 v[134:135], v[134:135], 1.0 op_sel_hi:[1,0]
v_rcp_f32 v128, v128
v_rcp_f32 v129, v129
v_rcp_f32 v130, v130
v_rcp_f32 v131, v131
v_rcp_f32 v132, v132
v_rcp_f32 v133, v133
v_rcp_f32 v134, v134
v_rcp_f32 v135, v135
PM 64,64,128
PM 66,66,130
PM 68,68,132
PM 70,70,134
PD 144,144,64
v_pk_fma_f32 v[146:147], v[64:65], v[64:65], v[146:147]
PD 148,148,68
v_pk_fma_f32 v[150:151], v[68:69], v[68:69], v[150:151]
PD 144,144,66
v_pk_fma_f32 v[146:147], v[66:67], v[66:67], v[146:147]
PD 148,148,70
v_pk_fma_f32 v[150:151], v[70:71], v[70:71], v[150:151]
AR 72,168
AR 73,169
AR 74,170
AR 75,171
AR 76,172
AR 77,173
AR 78,174
AR 79,175
PM 128,72,72
PM 130,74,74
PM 132,76,76
PM 134,78,78
v_pk_fma_f32 v[128:129], v[128:129], s[60:61], s[60:61] op_sel:[0,0,1] op_sel_hi:[1,0,1]
v_pk_fma_f32 v[130:131], v[130:131], s[60:61], s[60:61] op_sel:[0,0,1] op_sel_hi:[1,0,1]
v_pk_fma_f32 v[132:133], v[132:133], s[60:61], s[60:61] op_sel:[0,0,1] op_sel_hi:[1,0,1]
v_pk_fma_f32 v[134:135], v[134:135], s[60:61], s[60:61] op_sel:[0,0,1] op_sel_hi:[1,0,1]
PM 128,128,72
PM 130,130,74
PM 132,132,76
PM 134,134,78
v_exp_f32 v128, v128
v_exp_f32 v129, v129
v_exp_f32 v130, v130
v_exp_f32 v131, v131
v_exp_f32 v132, v132
v_exp_f32 v133, v133
v_exp_f32 v134, v134
v_exp_f32 v135, v135
v_pk_add_f32 v[128:129], v[128:129], 1.0 op_sel_hi:[1,0]
v_pk_add_f32 v[130:131], v[130:131], 1.0 op_sel_hi:[1,0]
v_pk_add_f32 v[132:133], v[132:133], 1.0 op_sel_hi:[1,0]
v_pk_add_f32 v[134:135], v[134:135], 1.0 op_sel_hi:[1,0]
v_rcp_f32 v128, v128
v_rcp_f32 v129, v129
v_rcp_f32 v130, v130
v_rcp_f32 v131, v131
v_rcp_f32 v132, v132
v_rcp_f32 v133, v133
v_rcp_f32 v134, v134
v_rcp_f32 v135, v135
PM 72,72,128
PM 74,74,130
PM 76,76,132
PM 78,78,134
PD 152,152,72
v_pk_fma_f32 v[154:155], v[72:73], v[72:73], v[154:155]
PD 156,156,76
v_pk_fma_f32 v[158:159], v[76:77], v[76:77], v[158:159]
PD 152,152,74
v_pk_fma_f32 v[154:155], v[74:75], v[74:75], v[154:155]
PD 156,156,78
v_pk_fma_f32 v[158:159], v[78:79], v[78:79], v[158:159]
AR 80,176
AR 81,177
AR 82,178
AR 83,179
AR 84,180
AR 85,181
AR 86,182
AR 87,183
PM 128,80,80
PM 130,82,82
PM 132,84,84
PM 134,86,86
v_pk_fma_f32 v[128:129], v[128:129], s[60:61], s[60:61] op_sel:[0,0,1] op_sel_hi:[1,0,1]
v_pk_fma_f32 v[130:131], v[130:131], s[60:61], s[60:61] op_sel:[0,0,1] op_sel_hi:[1,0,1]
v_pk_fma_f32 v[132:133], v[132:133], s[60:61], s[60:61] op_sel:[0,0,1] op_sel_hi:[1,0,1]
v_pk_fma_f32 v[134:135], v[134:135], s[60:61], s[60:61] op_sel:[0,0,1] op_sel_hi:[1,0,1]
PM 128,128,80
PM 130,130,82
PM 132,132,84
PM 134,134,86
v_exp_f32 v128, v128
v_exp_f32 v129, v129
v_exp_f32 v130, v130
v_exp_f32 v131, v131
v_exp_f32 v132, v132
v_exp_f32 v133, v133
v_exp_f32 v134, v134
v_exp_f32 v135, v135
v_pk_add_f32 v[128:129], v[128:129], 1.0 op_sel_hi:[1,0]
v_pk_add_f32 v[130:131], v[130:131], 1.0 op_sel_hi:[1,0]
v_pk_add_f32 v[132:133], v[132:133], 1.0 op_sel_hi:[1,0]
v_pk_add_f32 v[134:135], v[134:135], 1.0 op_sel_hi:[1,0]
v_rcp_f32 v128, v128
v_rcp_f32 v129, v129
v_rcp_f32 v130, v130
v_rcp_f32 v131, v131
v_rcp_f32 v132, v132
v_rcp_f32 v133, v133
v_rcp_f32 v134, v134
v_rcp_f32 v135, v135
PM 80,80,128
PM 82,82,130
PM 84,84,132
PM 86,86,134
PD 144,144,80
v_pk_fma_f32 v[146:147], v[80:81], v[80:81], v[146:147]
PD 148,148,84
v_pk_fma_f32 v[150:151], v[84:85], v[84:85], v[150:151]
PD 144,144,82
v_pk_fma_f32 v[146:147], v[82:83], v[82:83], v[146:147]
PD 148,148,86
v_pk_fma_f32 v[150:151], v[86:87], v[86:87], v[150:151]
AR 88,184
AR 89,185
AR 90,186
AR 91,187
AR 92,188
AR 93,189
AR 94,190
AR 95,191
PM 128,88,88
PM 130,90,90
PM 132,92,92
PM 134,94,94
v_pk_fma_f32 v[128:129], v[128:129], s[60:61], s[60:61] op_sel:[0,0,1] op_sel_hi:[1,0,1]
v_pk_fma_f32 v[130:131], v[130:131], s[60:61], s[60:61] op_sel:[0,0,1] op_sel_hi:[1,0,1]
v_pk_fma_f32 v[132:133], v[132:133], s[60:61], s[60:61] op_sel:[0,0,1] op_sel_hi:[1,0,1]
v_pk_fma_f32 v[134:135], v[134:135], s[60:61], s[60:61] op_sel:[0,0,1] op_sel_hi:[1,0,1]
PM 128,128,88
PM 130,130,90
PM 132,132,92
PM 134,134,94
v_exp_f32 v128, v128
v_exp_f32 v129, v129
v_exp_f32 v130, v130
v_exp_f32 v131, v131
v_exp_f32 v132, v132
v_exp_f32 v133, v133
v_exp_f32 v134, v134
v_exp_f32 v135, v135
v_pk_add_f32 v[128:129], v[128:129], 1.0 op_sel_hi:[1,0]
v_pk_add_f32 v[130:131], v[130:131], 1.0 op_sel_hi:[1,0]
v_pk_add_f32 v[132:133], v[132:133], 1.0 op_sel_hi:[1,0]
v_pk_add_f32 v[134:135], v[134:135], 1.0 op_sel_hi:[1,0]
v_rcp_f32 v128, v128
v_rcp_f32 v129, v129
v_rcp_f32 v130, v130
v_rcp_f32 v131, v131
v_rcp_f32 v132, v132
v_rcp_f32 v133, v133
v_rcp_f32 v134, v134
v_rcp_f32 v135, v135
PM 88,88,128
PM 90,90,130
PM 92,92,132
PM 94,94,134
PD 152,152,88
v_pk_fma_f32 v[154:155], v[88:89], v[88:89], v[154:155]
PD 156,156,92
v_pk_fma_f32 v[158:159], v[92:93], v[92:93], v[158:159]
PD 152,152,90
v_pk_fma_f32 v[154:155], v[90:91], v[90:91], v[154:155]
PD 156,156,94
v_pk_fma_f32 v[158:159], v[94:95], v[94:95], v[158:159]
AR 96,192
AR 97,193
AR 98,194
AR 99,195
AR 100,196
AR 101,197
AR 102,198
AR 103,199
PM 128,96,96
PM 130,98,98
PM 132,100,100
PM 134,102,102
v_pk_fma_f32 v[128:129], v[128:129], s[60:61], s[60:61] op_sel:[0,0,1] op_sel_hi:[1,0,1]
v_pk_fma_f32 v[130:131], v[130:131], s[60:61], s[60:61] op_sel:[0,0,1] op_sel_hi:[1,0,1]
v_pk_fma_f32 v[132:133], v[132:133], s[60:61], s[60:61] op_sel:[0,0,1] op_sel_hi:[1,0,1]
v_pk_fma_f32 v[134:135], v[134:135], s[60:61], s[60:61] op_sel:[0,0,1] op_sel_hi:[1,0,1]
PM 128,128,96
PM 130,130,98
PM 132,132,100
PM 134,134,102
v_exp_f32 v128, v128
v_exp_f32 v129, v129
v_exp_f32 v130, v130
v_exp_f32 v131, v131
v_exp_f32 v132, v132
v_exp_f32 v133, v133
v_exp_f32 v134, v134
v_exp_f32 v135, v135
v_pk_add_f32 v[128:129], v[128:129], 1.0 op_sel_hi:[1,0]
v_pk_add_f32 v[130:131], v[130:131], 1.0 op_sel_hi:[1,0]
v_pk_add_f32 v[132:133], v[132:133], 1.0 op_sel_hi:[1,0]
v_pk_add_f32 v[134:135], v[134:135], 1.0 op_sel_hi:[1,0]
v_rcp_f32 v128, v128
v_rcp_f32 v129, v129
v_rcp_f32 v130, v130
v_rcp_f32 v131, v131
v_rcp_f32 v132, v132
v_rcp_f32 v133, v133
v_rcp_f32 v134, v134
v_rcp_f32 v135, v135
PM 96,96,128
PM 98,98,130
PM 100,100,132
PM 102,102,134
PD 144,144,96
v_pk_fma_f32 v[146:147], v[96:97], v[96:97], v[146:147]
PD 148,148,100
v_pk_fma_f32 v[150:151], v[100:101], v[100:101], v[150:151]
PD 144,144,98
v_pk_fma_f32 v[146:147], v[98:99], v[98:99], v[146:147]
PD 148,148,102
v_pk_fma_f32 v[150:151], v[102:103], v[102:103], v[150:151]
AR 104,200
AR 105,201
AR 106,202
AR 107,203
AR 108,204
AR 109,205
AR 110,206
AR 111,207
PM 128,104,104
PM 130,106,106
PM 132,108,108
PM 134,110,110
v_pk_fma_f32 v[128:129], v[128:129], s[60:61], s[60:61] op_sel:[0,0,1] op_sel_hi:[1,0,1]
v_pk_fma_f32 v[130:131], v[130:131], s[60:61], s[60:61] op_sel:[0,0,1] op_sel_hi:[1,0,1]
v_pk_fma_f32 v[132:133], v[132:133], s[60:61], s[60:61] op_sel:[0,0,1] op_sel_hi:[1,0,1]
v_pk_fma_f32 v[134:135], v[134:135], s[60:61], s[60:61] op_sel:[0,0,1] op_sel_hi:[1,0,1]
PM 128,128,104
PM 130,130,106
PM 132,132,108
PM 134,134,110
v_exp_f32 v128, v128
v_exp_f32 v129, v129
v_exp_f32 v130, v130
v_exp_f32 v131, v131
v_exp_f32 v132, v132
v_exp_f32 v133, v133
v_exp_f32 v134, v134
v_exp_f32 v135, v135
v_pk_add_f32 v[128:129], v[128:129], 1.0 op_sel_hi:[1,0]
v_pk_add_f32 v[130:131], v[130:131], 1.0 op_sel_hi:[1,0]
v_pk_add_f32 v[132:133], v[132:133], 1.0 op_sel_hi:[1,0]
v_pk_add_f32 v[134:135], v[134:135], 1.0 op_sel_hi:[1,0]
v_rcp_f32 v128, v128
v_rcp_f32 v129, v129
v_rcp_f32 v130, v130
v_rcp_f32 v131, v131
v_rcp_f32 v132, v132
v_rcp_f32 v133, v133
v_rcp_f32 v134, v134
v_rcp_f32 v135, v135
PM 104,104,128
PM 106,106,130
PM 108,108,132
PM 110,110,134
PD 152,152,104
v_pk_fma_f32 v[154:155], v[104:105], v[104:105], v[154:155]
PD 156,156,108
v_pk_fma_f32 v[158:159], v[108:109], v[108:109], v[158:159]
PD 152,152,106
v_pk_fma_f32 v[154:155], v[106:107], v[106:107], v[154:155]
PD 156,156,110
v_pk_fma_f32 v[158:159], v[110:111], v[110:111], v[158:159]
AR 112,208
AR 113,209
AR 114,210
AR 115,211
AR 116,212
AR 117,213
AR 118,214
AR 119,215
PM 128,112,112
PM 130,114,114
PM 132,116,116
PM 134,118,118
v_pk_fma_f32 v[128:129], v[128:129], s[60:61], s[60:61] op_sel:[0,0,1] op_sel_hi:[1,0,1]
v_pk_fma_f32 v[130:131], v[130:131], s[60:61], s[60:61] op_sel:[0,0,1] op_sel_hi:[1,0,1]
v_pk_fma_f32 v[132:133], v[132:133], s[60:61], s[60:61] op_sel:[0,0,1] op_sel_hi:[1,0,1]
v_pk_fma_f32 v[134:135], v[134:135], s[60:61], s[60:61] op_sel:[0,0,1] op_sel_hi:[1,0,1]
PM 128,128,112
PM 130,130,114
PM 132,132,116
PM 134,134,118
v_exp_f32 v128, v128
v_exp_f32 v129, v129
v_exp_f32 v130, v130
v_exp_f32 v131, v131
v_exp_f32 v132, v132
v_exp_f32 v133, v133
v_exp_f32 v134, v134
v_exp_f32 v135, v135
v_pk_add_f32 v[128:129], v[128:129], 1.0 op_sel_hi:[1,0]
v_pk_add_f32 v[130:131], v[130:131], 1.0 op_sel_hi:[1,0]
v_pk_add_f32 v[132:133], v[132:133], 1.0 op_sel_hi:[1,0]
v_pk_add_f32 v[134:135], v[134:135], 1.0 op_sel_hi:[1,0]
v_rcp_f32 v128, v128
v_rcp_f32 v129, v129
v_rcp_f32 v130, v130
v_rcp_f32 v131, v131
v_rcp_f32 v132, v132
v_rcp_f32 v133, v133
v_rcp_f32 v134, v134
v_rcp_f32 v135, v135
PM 112,112,128
PM 114,114,130
PM 116,116,132
PM 118,118,134
PD 144,144,112
v_pk_fma_f32 v[146:147], v[112:113], v[112:113], v[146:147]
PD 148,148,116
v_pk_fma_f32 v[150:151], v[116:117], v[116:117], v[150:151]
PD 144,144,114
v_pk_fma_f32 v[146:147], v[114:115], v[114:115], v[146:147]
PD 148,148,118
v_pk_fma_f32 v[150:151], v[118:119], v[118:119], v[150:151]
AR 120,216
AR 121,217
AR 122,218
AR 123,219
AR 124,220
AR 125,221
AR 126,222
AR 127,223
PM 128,120,120
PM 130,122,122
PM 132,124,124
PM 134,126,126
v_pk_fma_f32 v[128:129], v[128:129], s[60:61], s[60:61] op_sel:[0,0,1] op_sel_hi:[1,0,1]
v_pk_fma_f32 v[130:131], v[130:131], s[60:61], s[60:61] op_sel:[0,0,1] op_sel_hi:[1,0,1]
v_pk_fma_f32 v[132:133], v[132:133], s[60:61], s[60:61] op_sel:[0,0,1] op_sel_hi:[1,0,1]
v_pk_fma_f32 v[134:135], v[134:135], s[60:61], s[60:61] op_sel:[0,0,1] op_sel_hi:[1,0,1]
PM 128,128,120
PM 130,130,122
PM 132,132,124
PM 134,134,126
v_exp_f32 v128, v128
v_exp_f32 v129, v129
v_exp_f32 v130, v130
v_exp_f32 v131, v131
v_exp_f32 v132, v132
v_exp_f32 v133, v133
v_exp_f32 v134, v134
v_exp_f32 v135, v135
v_pk_add_f32 v[128:129], v[128:129], 1.0 op_sel_hi:[1,0]
v_pk_add_f32 v[130:131], v[130:131], 1.0 op_sel_hi:[1,0]
v_pk_add_f32 v[132:133], v[132:133], 1.0 op_sel_hi:[1,0]
v_pk_add_f32 v[134:135], v[134:135], 1.0 op_sel_hi:[1,0]
v_rcp_f32 v128, v128
v_rcp_f32 v129, v129
v_rcp_f32 v130, v130
v_rcp_f32 v131, v131
v_rcp_f32 v132, v132
v_rcp_f32 v133, v133
v_rcp_f32 v134, v134
v_rcp_f32 v135, v135
PM 120,120,128
PM 122,122,130
PM 124,124,132
PM 126,126,134
PD 152,152,120
v_pk_fma_f32 v[154:155], v[120:121], v[120:121], v[154:155]
PD 156,156,124
v_pk_fma_f32 v[158:159], v[124:125], v[124:125], v[158:159]
PD 152,152,122
v_pk_fma_f32 v[154:155], v[122:123], v[122:123], v[154:155]
PD 156,156,126
v_pk_fma_f32 v[158:159], v[126:127], v[126:127], v[158:159]
v_add_f32 v144, v144, v145
v_add_f32 v146, v146, v147
v_add_f32 v148, v148, v149
v_add_f32 v150, v150, v151
v_add_f32 v152, v152, v153
v_add_f32 v154, v154, v155
v_add_f32 v156, v156, v157
v_add_f32 v158, v158, v159
s_nop 1
v_permlane32_swap_b32 v144, v152
v_permlane32_swap_b32 v148, v156
v_permlane32_swap_b32 v146, v154
v_permlane32_swap_b32 v150, v158
s_nop 1
v_add_f32 v144, v144, v152
v_add_f32 v148, v148, v156
v_add_f32 v146, v146, v154
v_add_f32 v150, v150, v158
s_nop 1
v_permlane16_swap_b32 v144, v148
v_permlane16_swap_b32 v146, v150
s_nop 1
v_add_f32 v132, v144, v148
v_add_f32 v133, v146, v150
v_lshlrev_b32 v10, 3, v0
s_lshl_b32 s34, s13, 15
s_lshl_b32 s15, s14, 11
s_add_u32 s15, s15, s34
buffer_store_dwordx2 v[132:133], v10, s[48:51], s15 offen sc1
s_waitcnt vmcnt(1)
v_lshlrev_b32 v4, 16, v4
v_lshlrev_b32 v5, 16, v5
v_lshlrev_b32 v6, 16, v6
v_lshlrev_b32 v7, 16, v7
AW 112,v4
AW 113,v4
AW 114,v4
AW 115,v4
AW 116,v5
AW 117,v5
AW 118,v5
AW 119,v5
AW 120,v6
AW 121,v6
AW 122,v6
AW 123,v6
AW 124,v7
AW 125,v7
AW 126,v7
AW 127,v7
AW 128,v4
AW 129,v4
AW 130,v4
AW 131,v4
AW 132,v5
AW 133,v5
AW 134,v5
AW 135,v5
AW 136,v6
AW 137,v6
AW 138,v6
AW 139,v6
AW 140,v7
AW 141,v7
AW 142,v7
AW 143,v7
AW 144,v4
AW 145,v4
AW 146,v4
AW 147,v4
AW 148,v5
AW 149,v5
AW 150,v5
AW 151,v5
AW 152,v6
AW 153,v6
AW 154,v6
AW 155,v6
AW 156,v7
AW 157,v7
AW 158,v7
AW 159,v7
AW 160,v4
AW 161,v4
AW 162,v4
AW 163,v4
AW 164,v5
AW 165,v5
AW 166,v5
AW 167,v5
AW 168,v6
AW 169,v6
AW 170,v6
AW 171,v6
AW 172,v7
AW 173,v7
AW 174,v7
AW 175,v7
AW 176,v4
AW 177,v4
AW 178,v4
AW 179,v4
AW 180,v5
AW 181,v5
AW 182,v5
AW 183,v5
AW 184,v6
AW 185,v6
AW 186,v6
AW 187,v6
AW 188,v7
AW 189,v7
AW 190,v7
AW 191,v7
AW 192,v4
AW 193,v4
AW 194,v4
AW 195,v4
AW 196,v5
AW 197,v5
AW 198,v5
AW 199,v5
AW 200,v6
AW 201,v6
AW 202,v6
AW 203,v6
AW 204,v7
AW 205,v7
AW 206,v7
AW 207,v7
AW 208,v4
AW 209,v4
AW 210,v4
AW 211,v4
AW 212,v5
AW 213,v5
AW 214,v5
AW 215,v5
AW 216,v6
AW 217,v6
AW 218,v6
AW 219,v6
AW 220,v7
AW 221,v7
AW 222,v7
AW 223,v7
AR 144,0
AR 145,1
AR 146,2
AR 147,3
AR 148,4
AR 149,5
AR 150,6
AR 151,7
PM 134,144,144
PM 136,146,146
PM 138,148,148
PM 140,150,150
v_pk_fma_f32 v[134:135], v[134:135], s[60:61], s[60:61] op_sel:[0,0,1] op_sel_hi:[1,0,1]
v_pk_fma_f32 v[136:137], v[136:137], s[60:61], s[60:61] op_sel:[0,0,1] op_sel_hi:[1,0,1]
v_pk_fma_f32 v[138:139], v[138:139], s[60:61], s[60:61] op_sel:[0,0,1] op_sel_hi:[1,0,1]
v_pk_fma_f32 v[140:141], v[140:141], s[60:61], s[60:61] op_sel:[0,0,1] op_sel_hi:[1,0,1]
PM 134,134,144
PM 136,136,146
PM 138,138,148
PM 140,140,150
v_exp_f32 v134, v134
v_exp_f32 v135, v135
v_exp_f32 v136, v136
v_exp_f32 v137, v137
v_exp_f32 v138, v138
v_exp_f32 v139, v139
v_exp_f32 v140, v140
v_exp_f32 v141, v141
v_pk_add_f32 v[134:135], v[134:135], 1.0 op_sel_hi:[1,0]
v_pk_add_f32 v[136:137], v[136:137], 1.0 op_sel_hi:[1,0]
v_pk_add_f32 v[138:139], v[138:139], 1.0 op_sel_hi:[1,0]
v_pk_add_f32 v[140:141], v[140:141], 1.0 op_sel_hi:[1,0]
v_rcp_f32 v134, v134
v_rcp_f32 v135, v135
v_rcp_f32 v136, v136
v_rcp_f32 v137, v137
v_rcp_f32 v138, v138
v_rcp_f32 v139, v139
v_rcp_f32 v140, v140
v_rcp_f32 v141, v141
PM 144,144,134
PM 146,146,136
PM 148,148,138
PM 150,150,140
AR 152,8
AR 153,9
AR 154,10
AR 155,11
AR 156,12
AR 157,13
AR 158,14
AR 159,15
PM 134,152,152
PM 136,154,154
PM 138,156,156
PM 140,158,158
v_pk_fma_f32 v[134:135], v[134:135], s[60:61], s[60:61] op_sel:[0,0,1] op_sel_hi:[1,0,1]
v_pk_fma_f32 v[136:137], v[136:137], s[60:61], s[60:61] op_sel:[0,0,1] op_sel_hi:[1,0,1]
v_pk_fma_f32 v[138:139], v[138:139], s[60:61], s[60:61] op_sel:[0,0,1] op_sel_hi:[1,0,1]
v_pk_fma_f32 v[140:141], v[140:141], s[60:61], s[60:61] op_sel:[0,0,1] op_sel_hi:[1,0,1]
PM 134,134,152
PM 136,136,154
PM 138,138,156
PM 140,140,158
v_exp_f32 v134, v134
v_exp_f32 v135, v135
v_exp_f32 v136, v136
v_exp_f32 v137, v137
v_exp_f32 v138, v138
v_exp_f32 v139, v139
v_exp_f32 v140, v140
v_exp_f32 v141, v141
v_pk_add_f32 v[134:135], v[134:135], 1.0 op_sel_hi:[1,0]
v_pk_add_f32 v[136:137], v[136:137], 1.0 op_sel_hi:[1,0]
v_pk_add_f32 v[138:139], v[138:139], 1.0 op_sel_hi:[1,0]
v_pk_add_f32 v[140:141], v[140:141], 1.0 op_sel_hi:[1,0]
v_rcp_f32 v134, v134
v_rcp_f32 v135, v135
v_rcp_f32 v136, v136
v_rcp_f32 v137, v137
v_rcp_f32 v138, v138
v_rcp_f32 v139, v139
v_rcp_f32 v140, v140
v_rcp_f32 v141, v141
PM 152,152,134
PM 154,154,136
PM 156,156,138
PM 158,158,140
AR 160,16
AR 161,17
AR 162,18
AR 163,19
AR 164,20
AR 165,21
AR 166,22
AR 167,23
PM 134,160,160
PM 136,162,162
PM 138,164,164
PM 140,166,166
v_pk_fma_f32 v[134:135], v[134:135], s[60:61], s[60:61] op_sel:[0,0,1] op_sel_hi:[1,0,1]
v_pk_fma_f32 v[136:137], v[136:137], s[60:61], s[60:61] op_sel:[0,0,1] op_sel_hi:[1,0,1]
v_pk_fma_f32 v[138:139], v[138:139], s[60:61], s[60:61] op_sel:[0,0,1] op_sel_hi:[1,0,1]
v_pk_fma_f32 v[140:141], v[140:141], s[60:61], s[60:61] op_sel:[0,0,1] op_sel_hi:[1,0,1]
PM 134,134,160
PM 136,136,162
PM 138,138,164
PM 140,140,166
v_exp_f32 v134, v134
v_exp_f32 v135, v135
v_exp_f32 v136, v136
v_exp_f32 v137, v137
v_exp_f32 v138, v138
v_exp_f32 v139, v139
v_exp_f32 v140, v140
v_exp_f32 v141, v141
v_pk_add_f32 v[134:135], v[134:135], 1.0 op_sel_hi:[1,0]
v_pk_add_f32 v[136:137], v[136:137], 1.0 op_sel_hi:[1,0]
v_pk_add_f32 v[138:139], v[138:139], 1.0 op_sel_hi:[1,0]
v_pk_add_f32 v[140:141], v[140:141], 1.0 op_sel_hi:[1,0]
v_rcp_f32 v134, v134
v_rcp_f32 v135, v135
v_rcp_f32 v136, v136
v_rcp_f32 v137, v137
v_rcp_f32 v138, v138
v_rcp_f32 v139, v139
v_rcp_f32 v140, v140
v_rcp_f32 v141, v141
PM 160,160,134
PM 162,162,136
PM 164,164,138
PM 166,166,140
AR 168,24
AR 169,25
AR 170,26
AR 171,27
AR 172,28
AR 173,29
AR 174,30
AR 175,31
PM 134,168,168
PM 136,170,170
PM 138,172,172
PM 140,174,174
v_pk_fma_f32 v[134:135], v[134:135], s[60:61], s[60:61] op_sel:[0,0,1] op_sel_hi:[1,0,1]
v_pk_fma_f32 v[136:137], v[136:137], s[60:61], s[60:61] op_sel:[0,0,1] op_sel_hi:[1,0,1]
v_pk_fma_f32 v[138:139], v[138:139], s[60:61], s[60:61] op_sel:[0,0,1] op_sel_hi:[1,0,1]
v_pk_fma_f32 v[140:141], v[140:141], s[60:61], s[60:61] op_sel:[0,0,1] op_sel_hi:[1,0,1]
PM 134,134,168
PM 136,136,170
PM 138,138,172
PM 140,140,174
v_exp_f32 v134, v134
v_exp_f32 v135, v135
v_exp_f32 v136, v136
v_exp_f32 v137, v137
v_exp_f32 v138, v138
v_exp_f32 v139, v139
v_exp_f32 v140, v140
v_exp_f32 v141, v141
v_pk_add_f32 v[134:135], v[134:135], 1.0 op_sel_hi:[1,0]
v_pk_add_f32 v[136:137], v[136:137], 1.0 op_sel_hi:[1,0]
v_pk_add_f32 v[138:139], v[138:139], 1.0 op_sel_hi:[1,0]
v_pk_add_f32 v[140:141], v[140:141], 1.0 op_sel_hi:[1,0]
v_rcp_f32 v134, v134
v_rcp_f32 v135, v135
v_rcp_f32 v136, v136
v_rcp_f32 v137, v137
v_rcp_f32 v138, v138
v_rcp_f32 v139, v139
v_rcp_f32 v140, v140
v_rcp_f32 v141, v141
PM 168,168,134
PM 170,170,136
PM 172,172,138
PM 174,174,140
AR 176,32
AR 177,33
AR 178,34
AR 179,35
AR 180,36
AR 181,37
AR 182,38
AR 183,39
PM 134,176,176
PM 136,178,178
PM 138,180,180
PM 140,182,182
v_pk_fma_f32 v[134:135], v[134:135], s[60:61], s[60:61] op_sel:[0,0,1] op_sel_hi:[1,0,1]
v_pk_fma_f32 v[136:137], v[136:137], s[60:61], s[60:61] op_sel:[0,0,1] op_sel_hi:[1,0,1]
v_pk_fma_f32 v[138:139], v[138:139], s[60:61], s[60:61] op_sel:[0,0,1] op_sel_hi:[1,0,1]
v_pk_fma_f32 v[140:141], v[140:141], s[60:61], s[60:61] op_sel:[0,0,1] op_sel_hi:[1,0,1]
PM 134,134,176
PM 136,136,178
PM 138,138,180
PM 140,140,182
v_exp_f32 v134, v134
v_exp_f32 v135, v135
v_exp_f32 v136, v136
v_exp_f32 v137, v137
v_exp_f32 v138, v138
v_exp_f32 v139, v139
v_exp_f32 v140, v140
v_exp_f32 v141, v141
v_pk_add_f32 v[134:135], v[134:135], 1.0 op_sel_hi:[1,0]
v_pk_add_f32 v[136:137], v[136:137], 1.0 op_sel_hi:[1,0]
v_pk_add_f32 v[138:139], v[138:139], 1.0 op_sel_hi:[1,0]
v_pk_add_f32 v[140:141], v[140:141], 1.0 op_sel_hi:[1,0]
v_rcp_f32 v134, v134
v_rcp_f32 v135, v135
v_rcp_f32 v136, v136
v_rcp_f32 v137, v137
v_rcp_f32 v138, v138
v_rcp_f32 v139, v139
v_rcp_f32 v140, v140
v_rcp_f32 v141, v141
PM 176,176,134
PM 178,178,136
PM 180,180,138
PM 182,182,140
AR 184,40
AR 185,41
AR 186,42
AR 187,43
AR 188,44
AR 189,45
AR 190,46
AR 191,47
PM 134,184,184
PM 136,186,186
PM 138,188,188
PM 140,190,190
v_pk_fma_f32 v[134:135], v[134:135], s[60:61], s[60:61] op_sel:[0,0,1] op_sel_hi:[1,0,1]
v_pk_fma_f32 v[136:137], v[136:137], s[60:61], s[60:61] op_sel:[0,0,1] op_sel_hi:[1,0,1]
v_pk_fma_f32 v[138:139], v[138:139], s[60:61], s[60:61] op_sel:[0,0,1] op_sel_hi:[1,0,1]
v_pk_fma_f32 v[140:141], v[140:141], s[60:61], s[60:61] op_sel:[0,0,1] op_sel_hi:[1,0,1]
PM 134,134,184
PM 136,136,186
PM 138,138,188
PM 140,140,190
v_exp_f32 v134, v134
v_exp_f32 v135, v135
v_exp_f32 v136, v136
v_exp_f32 v137, v137
v_exp_f32 v138, v138
v_exp_f32 v139, v139
v_exp_f32 v140, v140
v_exp_f32 v141, v141
v_pk_add_f32 v[134:135], v[134:135], 1.0 op_sel_hi:[1,0]
v_pk_add_f32 v[136:137], v[136:137], 1.0 op_sel_hi:[1,0]
v_pk_add_f32 v[138:139], v[138:139], 1.0 op_sel_hi:[1,0]
v_pk_add_f32 v[140:141], v[140:141], 1.0 op_sel_hi:[1,0]
v_rcp_f32 v134, v134
v_rcp_f32 v135, v135
v_rcp_f32 v136, v136
v_rcp_f32 v137, v137
v_rcp_f32 v138, v138
v_rcp_f32 v139, v139
v_rcp_f32 v140, v140
v_rcp_f32 v141, v141
PM 184,184,134
PM 186,186,136
PM 188,188,138
PM 190,190,140
AR 192,48
AR 193,49
AR 194,50
AR 195,51
AR 196,52
AR 197,53
AR 198,54
AR 199,55
PM 134,192,192
PM 136,194,194
PM 138,196,196
PM 140,198,198
v_pk_fma_f32 v[134:135], v[134:135], s[60:61], s[60:61] op_sel:[0,0,1] op_sel_hi:[1,0,1]
v_pk_fma_f32 v[136:137], v[136:137], s[60:61], s[60:61] op_sel:[0,0,1] op_sel_hi:[1,0,1]
v_pk_fma_f32 v[138:139], v[138:139], s[60:61], s[60:61] op_sel:[0,0,1] op_sel_hi:[1,0,1]
v_pk_fma_f32 v[140:141], v[140:141], s[60:61], s[60:61] op_sel:[0,0,1] op_sel_hi:[1,0,1]
PM 134,134,192
PM 136,136,194
PM 138,138,196
PM 140,140,198
v_exp_f32 v134, v134
v_exp_f32 v135, v135
v_exp_f32 v136, v136
v_exp_f32 v137, v137
v_exp_f32 v138, v138
v_exp_f32 v139, v139
v_exp_f32 v140, v140
v_exp_f32 v141, v141
v_pk_add_f32 v[134:135], v[134:135], 1.0 op_sel_hi:[1,0]
v_pk_add_f32 v[136:137], v[136:137], 1.0 op_sel_hi:[1,0]
v_pk_add_f32 v[138:139], v[138:139], 1.0 op_sel_hi:[1,0]
v_pk_add_f32 v[140:141], v[140:141], 1.0 op_sel_hi:[1,0]
v_rcp_f32 v134, v134
v_rcp_f32 v135, v135
v_rcp_f32 v136, v136
v_rcp_f32 v137, v137
v_rcp_f32 v138, v138
v_rcp_f32 v139, v139
v_rcp_f32 v140, v140
v_rcp_f32 v141, v141
PM 192,192,134
PM 194,194,136
PM 196,196,138
PM 198,198,140
AR 200,56
AR 201,57
AR 202,58
AR 203,59
AR 204,60
AR 205,61
AR 206,62
AR 207,63
PM 134,200,200
PM 136,202,202
PM 138,204,204
PM 140,206,206
v_pk_fma_f32 v[134:135], v[134:135], s[60:61], s[60:61] op_sel:[0,0,1] op_sel_hi:[1,0,1]
v_pk_fma_f32 v[136:137], v[136:137], s[60:61], s[60:61] op_sel:[0,0,1] op_sel_hi:[1,0,1]
v_pk_fma_f32 v[138:139], v[138:139], s[60:61], s[60:61] op_sel:[0,0,1] op_sel_hi:[1,0,1]
v_pk_fma_f32 v[140:141], v[140:141], s[60:61], s[60:61] op_sel:[0,0,1] op_sel_hi:[1,0,1]
PM 134,134,200
PM 136,136,202
PM 138,138,204
PM 140,140,206
v_exp_f32 v134, v134
v_exp_f32 v135, v135
v_exp_f32 v136, v136
v_exp_f32 v137, v137
v_exp_f32 v138, v138
v_exp_f32 v139, v139
v_exp_f32 v140, v140
v_exp_f32 v141, v141
v_pk_add_f32 v[134:135], v[134:135], 1.0 op_sel_hi:[1,0]
v_pk_add_f32 v[136:137], v[136:137], 1.0 op_sel_hi:[1,0]
v_pk_add_f32 v[138:139], v[138:139], 1.0 op_sel_hi:[1,0]
v_pk_add_f32 v[140:141], v[140:141], 1.0 op_sel_hi:[1,0]
v_rcp_f32 v134, v134
v_rcp_f32 v135, v135
v_rcp_f32 v136, v136
v_rcp_f32 v137, v137
v_rcp_f32 v138, v138
v_rcp_f32 v139, v139
v_rcp_f32 v140, v140
v_rcp_f32 v141, v141
PM 200,200,134
PM 202,202,136
PM 204,204,138
PM 206,206,140
AR 208,64
AR 209,65
AR 210,66
AR 211,67
AR 212,68
AR 213,69
AR 214,70
AR 215,71
PM 134,208,208
PM 136,210,210
PM 138,212,212
PM 140,214,214
v_pk_fma_f32 v[134:135], v[134:135], s[60:61], s[60:61] op_sel:[0,0,1] op_sel_hi:[1,0,1]
v_pk_fma_f32 v[136:137], v[136:137], s[60:61], s[60:61] op_sel:[0,0,1] op_sel_hi:[1,0,1]
v_pk_fma_f32 v[138:139], v[138:139], s[60:61], s[60:61] op_sel:[0,0,1] op_sel_hi:[1,0,1]
v_pk_fma_f32 v[140:141], v[140:141], s[60:61], s[60:61] op_sel:[0,0,1] op_sel_hi:[1,0,1]
PM 134,134,208
PM 136,136,210
PM 138,138,212
PM 140,140,214
v_exp_f32 v134, v134
v_exp_f32 v135, v135
v_exp_f32 v136, v136
v_exp_f32 v137, v137
v_exp_f32 v138, v138
v_exp_f32 v139, v139
v_exp_f32 v140, v140
v_exp_f32 v141, v141
v_pk_add_f32 v[134:135], v[134:135], 1.0 op_sel_hi:[1,0]
v_pk_add_f32 v[136:137], v[136:137], 1.0 op_sel_hi:[1,0]
v_pk_add_f32 v[138:139], v[138:139], 1.0 op_sel_hi:[1,0]
v_pk_add_f32 v[140:141], v[140:141], 1.0 op_sel_hi:[1,0]
v_rcp_f32 v134, v134
v_rcp_f32 v135, v135
v_rcp_f32 v136, v136
v_rcp_f32 v137, v137
v_rcp_f32 v138, v138
v_rcp_f32 v139, v139
v_rcp_f32 v140, v140
v_rcp_f32 v141, v141
PM 208,208,134
PM 210,210,136
PM 212,212,138
PM 214,214,140
AR 216,72
AR 217,73
AR 218,74
AR 219,75
AR 220,76
AR 221,77
AR 222,78
AR 223,79
PM 134,216,216
PM 136,218,218
PM 138,220,220
PM 140,222,222
v_pk_fma_f32 v[134:135], v[134:135], s[60:61], s[60:61] op_sel:[0,0,1] op_sel_hi:[1,0,1]
v_pk_fma_f32 v[136:137], v[136:137], s[60:61], s[60:61] op_sel:[0,0,1] op_sel_hi:[1,0,1]
v_pk_fma_f32 v[138:139], v[138:139], s[60:61], s[60:61] op_sel:[0,0,1] op_sel_hi:[1,0,1]
v_pk_fma_f32 v[140:141], v[140:141], s[60:61], s[60:61] op_sel:[0,0,1] op_sel_hi:[1,0,1]
PM 134,134,216
PM 136,136,218
PM 138,138,220
PM 140,140,222
v_exp_f32 v134, v134
v_exp_f32 v135, v135
v_exp_f32 v136, v136
v_exp_f32 v137, v137
v_exp_f32 v138, v138
v_exp_f32 v139, v139
v_exp_f32 v140, v140
v_exp_f32 v141, v141
v_pk_add_f32 v[134:135], v[134:135], 1.0 op_sel_hi:[1,0]
v_pk_add_f32 v[136:137], v[136:137], 1.0 op_sel_hi:[1,0]
v_pk_add_f32 v[138:139], v[138:139], 1.0 op_sel_hi:[1,0]
v_pk_add_f32 v[140:141], v[140:141], 1.0 op_sel_hi:[1,0]
v_rcp_f32 v134, v134
v_rcp_f32 v135, v135
v_rcp_f32 v136, v136
v_rcp_f32 v137, v137
v_rcp_f32 v138, v138
v_rcp_f32 v139, v139
v_rcp_f32 v140, v140
v_rcp_f32 v141, v141
PM 216,216,134
PM 218,218,136
PM 220,220,138
PM 222,222,140
s_mov_b32 s15, s34
buffer_load_dwordx2 a[224:225], v10, s[48:51], s15 offen sc1
buffer_load_dwordx2 a[226:227], v10, s[48:51], s15 offen offset:2048 sc1
s_add_u32 s15, s15, 4096
buffer_load_dwordx2 a[228:229], v10, s[48:51], s15 offen sc1
buffer_load_dwordx2 a[230:231], v10, s[48:51], s15 offen offset:2048 sc1
s_add_u32 s15, s15, 4096
buffer_load_dwordx2 a[232:233], v10, s[48:51], s15 offen sc1
buffer_load_dwordx2 a[234:235], v10, s[48:51], s15 offen offset:2048 sc1
s_add_u32 s15, s15, 4096
buffer_load_dwordx2 a[236:237], v10, s[48:51], s15 offen sc1
buffer_load_dwordx2 a[238:239], v10, s[48:51], s15 offen offset:2048 sc1
s_add_u32 s15, s15, 4096
buffer_load_dwordx2 a[240:241], v10, s[48:51], s15 offen sc1
buffer_load_dwordx2 a[242:243], v10, s[48:51], s15 offen offset:2048 sc1
s_add_u32 s15, s15, 4096
buffer_load_dwordx2 a[244:245], v10, s[48:51], s15 offen sc1
buffer_load_dwordx2 a[246:247], v10, s[48:51], s15 offen offset:2048 sc1
s_add_u32 s15, s15, 4096
buffer_load_dwordx2 a[248:249], v10, s[48:51], s15 offen sc1
buffer_load_dwordx2 a[250:251], v10, s[48:51], s15 offen offset:2048 sc1
s_add_u32 s15, s15, 4096
buffer_load_dwordx2 a[252:253], v10, s[48:51], s15 offen sc1
buffer_load_dwordx2 a[254:255], v10, s[48:51], s15 offen offset:2048 sc1
s_add_u32 s15, s15, 4096
AR 224,80
AR 225,81
AR 226,82
AR 227,83
AR 228,84
AR 229,85
AR 230,86
AR 231,87
PM 134,224,224
PM 136,226,226
PM 138,228,228
PM 140,230,230
v_pk_fma_f32 v[134:135], v[134:135], s[60:61], s[60:61] op_sel:[0,0,1] op_sel_hi:[1,0,1]
v_pk_fma_f32 v[136:137], v[136:137], s[60:61], s[60:61] op_sel:[0,0,1] op_sel_hi:[1,0,1]
v_pk_fma_f32 v[138:139], v[138:139], s[60:61], s[60:61] op_sel:[0,0,1] op_sel_hi:[1,0,1]
v_pk_fma_f32 v[140:141], v[140:141], s[60:61], s[60:61] op_sel:[0,0,1] op_sel_hi:[1,0,1]
PM 134,134,224
PM 136,136,226
PM 138,138,228
PM 140,140,230
v_exp_f32 v134, v134
v_exp_f32 v135, v135
v_exp_f32 v136, v136
v_exp_f32 v137, v137
v_exp_f32 v138, v138
v_exp_f32 v139, v139
v_exp_f32 v140, v140
v_exp_f32 v141, v141
v_pk_add_f32 v[134:135], v[134:135], 1.0 op_sel_hi:[1,0]
v_pk_add_f32 v[136:137], v[136:137], 1.0 op_sel_hi:[1,0]
v_pk_add_f32 v[138:139], v[138:139], 1.0 op_sel_hi:[1,0]
v_pk_add_f32 v[140:141], v[140:141], 1.0 op_sel_hi:[1,0]
v_rcp_f32 v134, v134
v_rcp_f32 v135, v135
v_rcp_f32 v136, v136
v_rcp_f32 v137, v137
v_rcp_f32 v138, v138
v_rcp_f32 v139, v139
v_rcp_f32 v140, v140
v_rcp_f32 v141, v141
PM 224,224,134
PM 226,226,136
PM 228,228,138
PM 230,230,140
AR 232,88
AR 233,89
AR 234,90
AR 235,91
AR 236,92
AR 237,93
AR 238,94
AR 239,95
PM 134,232,232
PM 136,234,234
PM 138,236,236
PM 140,238,238
v_pk_fma_f32 v[134:135], v[134:135], s[60:61], s[60:61] op_sel:[0,0,1] op_sel_hi:[1,0,1]
v_pk_fma_f32 v[136:137], v[136:137], s[60:61], s[60:61] op_sel:[0,0,1] op_sel_hi:[1,0,1]
v_pk_fma_f32 v[138:139], v[138:139], s[60:61], s[60:61] op_sel:[0,0,1] op_sel_hi:[1,0,1]
v_pk_fma_f32 v[140:141], v[140:141], s[60:61], s[60:61] op_sel:[0,0,1] op_sel_hi:[1,0,1]
PM 134,134,232
PM 136,136,234
PM 138,138,236
PM 140,140,238
v_exp_f32 v134, v134
v_exp_f32 v135, v135
v_exp_f32 v136, v136
v_exp_f32 v137, v137
v_exp_f32 v138, v138
v_exp_f32 v139, v139
v_exp_f32 v140, v140
v_exp_f32 v141, v141
v_pk_add_f32 v[134:135], v[134:135], 1.0 op_sel_hi:[1,0]
v_pk_add_f32 v[136:137], v[136:137], 1.0 op_sel_hi:[1,0]
v_pk_add_f32 v[138:139], v[138:139], 1.0 op_sel_hi:[1,0]
v_pk_add_f32 v[140:141], v[140:141], 1.0 op_sel_hi:[1,0]
v_rcp_f32 v134, v134
v_rcp_f32 v135, v135
v_rcp_f32 v136, v136
v_rcp_f32 v137, v137
v_rcp_f32 v138, v138
v_rcp_f32 v139, v139
v_rcp_f32 v140, v140
v_rcp_f32 v141, v141
PM 232,232,134
PM 234,234,136
PM 236,236,138
PM 238,238,140
AR 240,96
AR 241,97
AR 242,98
AR 243,99
AR 244,100
AR 245,101
AR 246,102
AR 247,103
PM 134,240,240
PM 136,242,242
PM 138,244,244
PM 140,246,246
v_pk_fma_f32 v[134:135], v[134:135], s[60:61], s[60:61] op_sel:[0,0,1] op_sel_hi:[1,0,1]
v_pk_fma_f32 v[136:137], v[136:137], s[60:61], s[60:61] op_sel:[0,0,1] op_sel_hi:[1,0,1]
v_pk_fma_f32 v[138:139], v[138:139], s[60:61], s[60:61] op_sel:[0,0,1] op_sel_hi:[1,0,1]
v_pk_fma_f32 v[140:141], v[140:141], s[60:61], s[60:61] op_sel:[0,0,1] op_sel_hi:[1,0,1]
PM 134,134,240
PM 136,136,242
PM 138,138,244
PM 140,140,246
v_exp_f32 v134, v134
v_exp_f32 v135, v135
v_exp_f32 v136, v136
v_exp_f32 v137, v137
v_exp_f32 v138, v138
v_exp_f32 v139, v139
v_exp_f32 v140, v140
v_exp_f32 v141, v141
v_pk_add_f32 v[134:135], v[134:135], 1.0 op_sel_hi:[1,0]
v_pk_add_f32 v[136:137], v[136:137], 1.0 op_sel_hi:[1,0]
v_pk_add_f32 v[138:139], v[138:139], 1.0 op_sel_hi:[1,0]
v_pk_add_f32 v[140:141], v[140:141], 1.0 op_sel_hi:[1,0]
v_rcp_f32 v134, v134
v_rcp_f32 v135, v135
v_rcp_f32 v136, v136
v_rcp_f32 v137, v137
v_rcp_f32 v138, v138
v_rcp_f32 v139, v139
v_rcp_f32 v140, v140
v_rcp_f32 v141, v141
PM 240,240,134
PM 242,242,136
PM 244,244,138
PM 246,246,140
AR 248,104
AR 249,105
AR 250,106
AR 251,107
AR 252,108
AR 253,109
AR 254,110
AR 255,111
PM 134,248,248
PM 136,250,250
PM 138,252,252
PM 140,254,254
v_pk_fma_f32 v[134:135], v[134:135], s[60:61], s[60:61] op_sel:[0,0,1] op_sel_hi:[1,0,1]
v_pk_fma_f32 v[136:137], v[136:137], s[60:61], s[60:61] op_sel:[0,0,1] op_sel_hi:[1,0,1]
v_pk_fma_f32 v[138:139], v[138:139], s[60:61], s[60:61] op_sel:[0,0,1] op_sel_hi:[1,0,1]
v_pk_fma_f32 v[140:141], v[140:141], s[60:61], s[60:61] op_sel:[0,0,1] op_sel_hi:[1,0,1]
PM 134,134,248
PM 136,136,250
PM 138,138,252
PM 140,140,254
v_exp_f32 v134, v134
v_exp_f32 v135, v135
v_exp_f32 v136, v136
v_exp_f32 v137, v137
v_exp_f32 v138, v138
v_exp_f32 v139, v139
v_exp_f32 v140, v140
v_exp_f32 v141, v141
v_pk_add_f32 v[134:135], v[134:135], 1.0 op_sel_hi:[1,0]
v_pk_add_f32 v[136:137], v[136:137], 1.0 op_sel_hi:[1,0]
v_pk_add_f32 v[138:139], v[138:139], 1.0 op_sel_hi:[1,0]
v_pk_add_f32 v[140:141], v[140:141], 1.0 op_sel_hi:[1,0]
v_rcp_f32 v134, v134
v_rcp_f32 v135, v135
v_rcp_f32 v136, v136
v_rcp_f32 v137, v137
v_rcp_f32 v138, v138
v_rcp_f32 v139, v139
v_rcp_f32 v140, v140
v_rcp_f32 v141, v141
PM 248,248,134
PM 250,250,136
PM 252,252,138
PM 254,254,140
v_bfe_u32 v11, v1, 2, 2
v_lshlrev_b32 v11, 8, v11
v_lshrrev_b32 v3, 4, v1
v_lshl_add_u32 v11, v3, 6, v11
v_and_b32 v3, 3, v1
v_lshl_add_u32 v11, v3, 4, v11
s_mul_i32 s33, s14, 458752
s_lshl_b32 s3, s13, 2
s_add_u32 s3, s3, s10
s_mul_i32 s3, s3, 14336
s_add_u32 s3, s3, s33
v_lshrrev_b32 v140, 5, v1
v_lshlrev_b32 v140, 9, v140
v_and_b32 v3, 3, v1
v_lshl_add_u32 v140, v3, 6, v140
v_bfe_u32 v3, v1, 2, 2
v_lshl_add_u32 v140, v3, 4, v140
v_bfe_u32 v3, v1, 4, 1
v_lshl_add_u32 v140, v3, 3, v140
s_lshl_b32 s35, s10, 12
s_cmp_eq_u32 s10, 3
s_cselect_b32 s15, 1024, 0
s_sub_u32 s15, s35, s15
v_lshlrev_b32 v8, 4, v1
v_add_u32 v8, s15, v8
s_cmp_ge_u32 s10, 2
s_cselect_b32 s15, 0x40000000, 0
v_add_u32 v5, s15, v8
v_bfe_u32 v3, v1, 4, 1
v_lshlrev_b32 v141, 1, v3
v_lshrrev_b32 v3, 5, v1
v_or_b32 v141, v141, v3
v_bfe_u32 v3, v1, 1, 1
v_xor_b32 v141, v141, v3
v_bfe_u32 v3, v1, 3, 1
v_mul_u32_u24 v3, 6, v3
v_xor_b32 v141, v141, v3
v_lshlrev_b32 v141, 4, v141
v_and_b32 v3, 15, v1
v_lshl_add_u32 v141, v3, 7, v141
v_lshl_add_u32 v141, v2, 13, v141
v_add_u32 v141, 65536, v141
v_xor_b32 v143, 64, v141
s_lshl_b32 s15, s14, 11
s_add_u32 s36, s15, 335872
s_lshl_b32 s15, s13, 8
s_lshl_b32 s38, s10, 6
s_add_u32 s15, s15, s38
s_add_u32 s101, s15, s36
s_lshl_b32 s15, s10, 14
v_add_u32 v142, s15, v11
s_mov_b32 s58, s33
s_add_u32 s59, s33, 458752
s_add_u32 s15, s13, 1
s_and_b32 s15, s15, 7
s_mul_i32 s15, s15, 57344
s_add_u32 s33, s33, s15
s_mov_b32 s37, 0
s_branch L_b_poll1_chk
L_b_poll1:
s_mov_b32 s15, s34
buffer_load_dwordx2 a[224:225], v10, s[48:51], s15 offen sc1
buffer_load_dwordx2 a[226:227], v10, s[48:51], s15 offen offset:2048 sc1
s_add_u32 s15, s15, 4096
buffer_load_dwordx2 a[228:229], v10, s[48:51], s15 offen sc1
buffer_load_dwordx2 a[230:231], v10, s[48:51], s15 offen offset:2048 sc1
s_add_u32 s15, s15, 4096
buffer_load_dwordx2 a[232:233], v10, s[48:51], s15 offen sc1
buffer_load_dwordx2 a[234:235], v10, s[48:51], s15 offen offset:2048 sc1
s_add_u32 s15, s15, 4096
buffer_load_dwordx2 a[236:237], v10, s[48:51], s15 offen sc1
buffer_load_dwordx2 a[238:239], v10, s[48:51], s15 offen offset:2048 sc1
s_add_u32 s15, s15, 4096
buffer_load_dwordx2 a[240:241], v10, s[48:51], s15 offen sc1
buffer_load_dwordx2 a[242:243], v10, s[48:51], s15 offen offset:2048 sc1
s_add_u32 s15, s15, 4096
buffer_load_dwordx2 a[244:245], v10, s[48:51], s15 offen sc1
buffer_load_dwordx2 a[246:247], v10, s[48:51], s15 offen offset:2048 sc1
s_add_u32 s15, s15, 4096
buffer_load_dwordx2 a[248:249], v10, s[48:51], s15 offen sc1
buffer_load_dwordx2 a[250:251], v10, s[48:51], s15 offen offset:2048 sc1
s_add_u32 s15, s15, 4096
buffer_load_dwordx2 a[252:253], v10, s[48:51], s15 offen sc1
buffer_load_dwordx2 a[254:255], v10, s[48:51], s15 offen offset:2048 sc1
s_add_u32 s15, s15, 4096
L_b_poll1_chk:
s_waitcnt vmcnt(0)
AR 128,224
AR 129,225
v_mov_b32 v130, v129
AR 134,226
AR 135,227
PD 128,128,134
v_max_u32 v130, v130, v135
AR 132,228
AR 133,229
PD 128,128,132
v_max_u32 v130, v130, v133
AR 134,230
AR 135,231
PD 128,128,134
v_max_u32 v130, v130, v135
AR 132,232
AR 133,233
PD 128,128,132
v_max_u32 v130, v130, v133
AR 134,234
AR 135,235
PD 128,128,134
v_max_u32 v130, v130, v135
AR 132,236
AR 133,237
PD 128,128,132
v_max_u32 v130, v130, v133
AR 134,238
AR 135,239
PD 128,128,134
v_max_u32 v130, v130, v135
AR 132,240
AR 133,241
PD 128,128,132
v_max_u32 v130, v130, v133
AR 134,242
AR 135,243
PD 128,128,134
v_max_u32 v130, v130, v135
AR 132,244
AR 133,245
PD 128,128,132
v_max_u32 v130, v130, v133
AR 134,246
AR 135,247
PD 128,128,134
v_max_u32 v130, v130, v135
AR 132,248
AR 133,249
PD 128,128,132
v_max_u32 v130, v130, v133
AR 134,250
AR 135,251
PD 128,128,134
v_max_u32 v130, v130, v135
AR 132,252
AR 133,253
PD 128,128,132
v_max_u32 v130, v130, v133
AR 134,254
AR 135,255
PD 128,128,134
v_max_u32 v130, v130, v135
v_cmp_eq_u32 vcc, -1, v130
s_add_u32 s37, s37, 1
s_cmp_ge_u32 s37, 65536
s_cbranch_scc1 L_b_poll1_done
s_cbranch_vccnz L_b_poll1
L_b_poll1_done:
v_mul_f32 v128, 0x3a124925, v128
v_mul_f32 v129, 0x3a124925, v129
v_fma_f32 v129, -v128, v128, v129
v_max_f32 v129, 0, v129
CV 128,128,128
v_and_b32 v128, 0xffff0000, v128
CV 129,129,129
v_and_b32 v129, 0xffff0000, v129
v_add_f32 v129, 0x3727c5ac, v129
CV 129,129,129
v_and_b32 v129, 0xffff0000, v129
v_sqrt_f32 v129, v129
s_nop 0
CV 129,129,129
v_and_b32 v129, 0xffff0000, v129
v_rcp_f32 v129, v129
v_and_b32 v3, 15, v1
v_mul_f32 v128, v128, v129
v_sub_f32 v128, 0, v128
v_lshlrev_b32 v3, 2, v3
ds_bpermute_b32 v132, v3, v129 offset:0
ds_bpermute_b32 v133, v3, v128 offset:0
ds_bpermute_b32 v134, v3, v129 offset:64
ds_bpermute_b32 v135, v3, v128 offset:64
ds_bpermute_b32 v136, v3, v129 offset:128
ds_bpermute_b32 v137, v3, v128 offset:128
ds_bpermute_b32 v138, v3, v129 offset:192
ds_bpermute_b32 v139, v3, v128 offset:192
s_waitcnt lgkmcnt(0)
v_pk_fma_f32 v[16:17], v[16:17], v[132:133], v[132:133] op_sel:[0,0,1] op_sel_hi:[1,0,1]
v_pk_fma_f32 v[18:19], v[18:19], v[132:133], v[132:133] op_sel:[0,0,1] op_sel_hi:[1,0,1]
CV 16,16,17
CV 17,18,19
v_pk_fma_f32 v[20:21], v[20:21], v[134:135], v[134:135] op_sel:[0,0,1] op_sel_hi:[1,0,1]
v_pk_fma_f32 v[22:23], v[22:23], v[134:135], v[134:135] op_sel:[0,0,1] op_sel_hi:[1,0,1]
CV 18,20,21
CV 19,22,23
ds_write_b128 v142, v[16:19] offset:0
buffer_store_dwordx4 v[16:19], v11, s[24:27], s3 offen sc1
v_pk_fma_f32 v[32:33], v[32:33], v[132:133], v[132:133] op_sel:[0,0,1] op_sel_hi:[1,0,1]
v_pk_fma_f32 v[34:35], v[34:35], v[132:133], v[132:133] op_sel:[0,0,1] op_sel_hi:[1,0,1]
CV 32,32,33
CV 33,34,35
v_pk_fma_f32 v[36:37], v[36:37], v[134:135], v[134:135] op_sel:[0,0,1] op_sel_hi:[1,0,1]
v_pk_fma_f32 v[38:39], v[38:39], v[134:135], v[134:135] op_sel:[0,0,1] op_sel_hi:[1,0,1]
CV 34,36,37
CV 35,38,39
ds_write_b128 v142, v[32:35] offset:1024
buffer_store_dwordx4 v[32:35], v11, s[24:27], s3 offen offset:1024 sc1
v_pk_fma_f32 v[48:49], v[48:49], v[132:133], v[132:133] op_sel:[0,0,1] op_sel_hi:[1,0,1]
v_pk_fma_f32 v[50:51], v[50:51], v[132:133], v[132:133] op_sel:[0,0,1] op_sel_hi:[1,0,1]
CV 48,48,49
CV 49,50,51
v_pk_fma_f32 v[52:53], v[52:53], v[134:135], v[134:135] op_sel:[0,0,1] op_sel_hi:[1,0,1]
v_pk_fma_f32 v[54:55], v[54:55], v[134:135], v[134:135] op_sel:[0,0,1] op_sel_hi:[1,0,1]
CV 50,52,53
CV 51,54,55
ds_write_b128 v142, v[48:51] offset:2048
buffer_store_dwordx4 v[48:51], v11, s[24:27], s3 offen offset:2048 sc1
v_pk_fma_f32 v[64:65], v[64:65], v[132:133], v[132:133] op_sel:[0,0,1] op_sel_hi:[1,0,1]
v_pk_fma_f32 v[66:67], v[66:67], v[132:133], v[132:133] op_sel:[0,0,1] op_sel_hi:[1,0,1]
CV 64,64,65
CV 65,66,67
v_pk_fma_f32 v[68:69], v[68:69], v[134:135], v[134:135] op_sel:[0,0,1] op_sel_hi:[1,0,1]
v_pk_fma_f32 v[70:71], v[70:71], v[134:135], v[134:135] op_sel:[0,0,1] op_sel_hi:[1,0,1]
CV 66,68,69
CV 67,70,71
ds_write_b128 v142, v[64:67] offset:3072
buffer_store_dwordx4 v[64:67], v11, s[24:27], s3 offen offset:3072 sc1
s_add_u32 s3, s3, 4096
v_pk_fma_f32 v[80:81], v[80:81], v[132:133], v[132:133] op_sel:[0,0,1] op_sel_hi:[1,0,1]
v_pk_fma_f32 v[82:83], v[82:83], v[132:133], v[132:133] op_sel:[0,0,1] op_sel_hi:[1,0,1]
CV 80,80,81
CV 81,82,83
v_pk_fma_f32 v[84:85], v[84:85], v[134:135], v[134:135] op_sel:[0,0,1] op_sel_hi:[1,0,1]
v_pk_fma_f32 v[86:87], v[86:87], v[134:135], v[134:135] op_sel:[0,0,1] op_sel_hi:[1,0,1]
CV 82,84,85
CV 83,86,87
ds_write_b128 v142, v[80:83] offset:4096
buffer_store_dwordx4 v[80:83], v11, s[24:27], s3 offen sc1
v_pk_fma_f32 v[96:97], v[96:97], v[132:133], v[132:133] op_sel:[0,0,1] op_sel_hi:[1,0,1]
v_pk_fma_f32 v[98:99], v[98:99], v[132:133], v[132:133] op_sel:[0,0,1] op_sel_hi:[1,0,1]
CV 96,96,97
CV 97,98,99
v_pk_fma_f32 v[100:101], v[100:101], v[134:135], v[134:135] op_sel:[0,0,1] op_sel_hi:[1,0,1]
v_pk_fma_f32 v[102:103], v[102:103], v[134:135], v[134:135] op_sel:[0,0,1] op_sel_hi:[1,0,1]
CV 98,100,101
CV 99,102,103
ds_write_b128 v142, v[96:99] offset:5120
buffer_store_dwordx4 v[96:99], v11, s[24:27], s3 offen offset:1024 sc1
v_pk_fma_f32 v[112:113], v[112:113], v[132:133], v[132:133] op_sel:[0,0,1] op_sel_hi:[1,0,1]
v_pk_fma_f32 v[114:115], v[114:115], v[132:133], v[132:133] op_sel:[0,0,1] op_sel_hi:[1,0,1]
CV 112,112,113
CV 113,114,115
v_pk_fma_f32 v[116:117], v[116:117], v[134:135], v[134:135] op_sel:[0,0,1] op_sel_hi:[1,0,1]
v_pk_fma_f32 v[118:119], v[118:119], v[134:135], v[134:135] op_sel:[0,0,1] op_sel_hi:[1,0,1]
CV 114,116,117
CV 115,118,119
ds_write_b128 v142, v[112:115] offset:6144
buffer_store_dwordx4 v[112:115], v11, s[24:27], s3 offen offset:2048 sc1
v_pk_fma_f32 v[24:25], v[24:25], v[136:137], v[136:137] op_sel:[0,0,1] op_sel_hi:[1,0,1]
v_pk_fma_f32 v[26:27], v[26:27], v[136:137], v[136:137] op_sel:[0,0,1] op_sel_hi:[1,0,1]
CV 24,24,25
CV 25,26,27
v_pk_fma_f32 v[28:29], v[28:29], v[138:139], v[138:139] op_sel:[0,0,1] op_sel_hi:[1,0,1]
v_pk_fma_f32 v[30:31], v[30:31], v[138:139], v[138:139] op_sel:[0,0,1] op_sel_hi:[1,0,1]
CV 26,28,29
CV 27,30,31
ds_write_b128 v142, v[24:27] offset:7168
buffer_store_dwordx4 v[24:27], v11, s[24:27], s3 offen offset:3072 sc1
s_add_u32 s3, s3, 4096
v_pk_fma_f32 v[40:41], v[40:41], v[136:137], v[136:137] op_sel:[0,0,1] op_sel_hi:[1,0,1]
v_pk_fma_f32 v[42:43], v[42:43], v[136:137], v[136:137] op_sel:[0,0,1] op_sel_hi:[1,0,1]
CV 40,40,41
CV 41,42,43
v_pk_fma_f32 v[44:45], v[44:45], v[138:139], v[138:139] op_sel:[0,0,1] op_sel_hi:[1,0,1]
v_pk_fma_f32 v[46:47], v[46:47], v[138:139], v[138:139] op_sel:[0,0,1] op_sel_hi:[1,0,1]
CV 42,44,45
CV 43,46,47
ds_write_b128 v142, v[40:43] offset:8192
buffer_store_dwordx4 v[40:43], v11, s[24:27], s3 offen sc1
v_pk_fma_f32 v[56:57], v[56:57], v[136:137], v[136:137] op_sel:[0,0,1] op_sel_hi:[1,0,1]
v_pk_fma_f32 v[58:59], v[58:59], v[136:137], v[136:137] op_sel:[0,0,1] op_sel_hi:[1,0,1]
CV 56,56,57
CV 57,58,59
v_pk_fma_f32 v[60:61], v[60:61], v[138:139], v[138:139] op_sel:[0,0,1] op_sel_hi:[1,0,1]
v_pk_fma_f32 v[62:63], v[62:63], v[138:139], v[138:139] op_sel:[0,0,1] op_sel_hi:[1,0,1]
CV 58,60,61
CV 59,62,63
ds_write_b128 v142, v[56:59] offset:9216
buffer_store_dwordx4 v[56:59], v11, s[24:27], s3 offen offset:1024 sc1
v_pk_fma_f32 v[72:73], v[72:73], v[136:137], v[136:137] op_sel:[0,0,1] op_sel_hi:[1,0,1]
v_pk_fma_f32 v[74:75], v[74:75], v[136:137], v[136:137] op_sel:[0,0,1] op_sel_hi:[1,0,1]
CV 72,72,73
CV 73,74,75
v_pk_fma_f32 v[76:77], v[76:77], v[138:139], v[138:139] op_sel:[0,0,1] op_sel_hi:[1,0,1]
v_pk_fma_f32 v[78:79], v[78:79], v[138:139], v[138:139] op_sel:[0,0,1] op_sel_hi:[1,0,1]
CV 74,76,77
CV 75,78,79
ds_write_b128 v142, v[72:75] offset:10240
buffer_store_dwordx4 v[72:75], v11, s[24:27], s3 offen offset:2048 sc1
v_pk_fma_f32 v[88:89], v[88:89], v[136:137], v[136:137] op_sel:[0,0,1] op_sel_hi:[1,0,1]
v_pk_fma_f32 v[90:91], v[90:91], v[136:137], v[136:137] op_sel:[0,0,1] op_sel_hi:[1,0,1]
CV 88,88,89
CV 89,90,91
v_pk_fma_f32 v[92:93], v[92:93], v[138:139], v[138:139] op_sel:[0,0,1] op_sel_hi:[1,0,1]
v_pk_fma_f32 v[94:95], v[94:95], v[138:139], v[138:139] op_sel:[0,0,1] op_sel_hi:[1,0,1]
CV 90,92,93
CV 91,94,95
ds_write_b128 v142, v[88:91] offset:12288
buffer_store_dwordx4 v[88:91], v11, s[24:27], s3 offen offset:3072 sc1
s_add_u32 s3, s3, 4096
v_pk_fma_f32 v[104:105], v[104:105], v[136:137], v[136:137] op_sel:[0,0,1] op_sel_hi:[1,0,1]
v_pk_fma_f32 v[106:107], v[106:107], v[136:137], v[136:137] op_sel:[0,0,1] op_sel_hi:[1,0,1]
CV 104,104,105
CV 105,106,107
v_pk_fma_f32 v[108:109], v[108:109], v[138:139], v[138:139] op_sel:[0,0,1] op_sel_hi:[1,0,1]
v_pk_fma_f32 v[110:111], v[110:111], v[138:139], v[138:139] op_sel:[0,0,1] op_sel_hi:[1,0,1]
CV 106,108,109
CV 107,110,111
ds_write_b128 v142, v[104:107] offset:13312
buffer_store_dwordx4 v[104:107], v11, s[24:27], s3 offen sc1
v_pk_fma_f32 v[120:121], v[120:121], v[136:137], v[136:137] op_sel:[0,0,1] op_sel_hi:[1,0,1]
v_pk_fma_f32 v[122:123], v[122:123], v[136:137], v[136:137] op_sel:[0,0,1] op_sel_hi:[1,0,1]
CV 120,120,121
CV 121,122,123
v_pk_fma_f32 v[124:125], v[124:125], v[138:139], v[138:139] op_sel:[0,0,1] op_sel_hi:[1,0,1]
v_pk_fma_f32 v[126:127], v[126:127], v[138:139], v[138:139] op_sel:[0,0,1] op_sel_hi:[1,0,1]
CV 122,124,125
CV 123,126,127
ds_write_b128 v142, v[120:123] offset:14336
buffer_store_dwordx4 v[120:123], v11, s[24:27], s3 offen offset:1024 sc1
v_and_b32 v10, 31, v1
v_lshlrev_b32 v10, 6, v10
s_mov_b32 s3, 32768
s_sub_u32 s38, s39, s3
v_add_u32 v136, s3, v141
v_add_u32 v137, s3, v143
s_add_u32 s39, s3, s38
s_add_u32 s3, s3, 32768
s_cmp_eq_u32 s3, 98304
s_cselect_b32 s3, 0, s3
s_waitcnt lgkmcnt(0)
s_barrier
RD 72,136,0
RD 76,136,2048
RD 80,136,4096
RD 84,136,6144
RD 88,137,0
RD 92,137,2048
RD 96,137,4096
RD 100,137,6144
TR 16,140,0
TR 18,140,256
TR 20,140,1024
TR 22,140,1280
TR 24,140,2048
TR 26,140,2304
TR 28,140,3072
TR 30,140,3328
TR 32,140,4096
TR 34,140,4352
TR 36,140,5120
TR 38,140,5376
TR 40,140,6144
TR 42,140,6400
s_waitcnt lgkmcnt(0)
MA 112,16,72
TR 44,140,7168
s_add_u32 m0, s39, 0
MA 128,20,72
TR 46,140,7424
buffer_load_dwordx4 v12, s[44:47], s62 offen lds
MA 132,20,76
TR 48,140,8192
MA 116,16,76
MA 120,16,80
TR 50,140,8448
MA 136,20,80
buffer_load_dwordx4 v13, s[44:47], s62 offen offset:1024 lds
MA 140,20,84
TR 52,140,9216
MA 124,16,84
MA 156,24,84
TR 54,140,9472
MA 172,28,84
buffer_load_dwordx4 v14, s[44:47], s62 offen offset:2048 lds
MA 168,28,80
TR 56,140,10240
MA 152,24,80
MA 148,24,76
TR 58,140,10496
MA 164,28,76
buffer_load_dwordx4 v15, s[44:47], s62 offen offset:3072 lds
MA 160,28,72
TR 60,140,12288
s_add_u32 s4, s62, 128
s_and_b32 s4, s4, 0xfff
s_or_b32 s62, s4, s5
MA 144,24,72
MA 176,32,72
TR 62,140,12544
s_add_u32 m0, s39, 4096
MA 192,36,72
buffer_load_dwordx4 v12, s[44:47], s63 offen lds
MA 196,36,76
TR 64,140,13312
MA 180,32,76
MA 184,32,80
TR 66,140,13568
MA 200,36,80
TR 68,140,14336
buffer_load_dwordx4 v13, s[44:47], s63 offen offset:1024 lds
MA 204,36,84
TR 70,140,14592
MA 188,32,84
MA 220,40,84
MA 216,40,80
MA 212,40,76
MA 208,40,72
s_waitcnt vmcnt(6)
v_mov_b32 v4, s100
s_mov_b64 exec, 1
buffer_store_dword v4, off, s[48:51], s101 sc1
s_mov_b64 exec, -1
s_waitcnt vmcnt(63) lgkmcnt(0)
s_barrier
v_add_u32 v136, s3, v141
v_add_u32 v137, s3, v143
MA 112,44,88
TR 16,140,16384
s_add_u32 m0, s39, 4096
MA 128,48,88
TR 18,140,16640
buffer_load_dwordx4 v14, s[44:47], s63 offen offset:2048 lds
MA 132,48,92
TR 20,140,17408
MA 116,44,92
TR 22,140,17664
MA 120,44,96
RD 104,136,0
MA 136,48,96
RD 108,136,2048
MA 140,48,100
RD 112,136,4096
MA 124,44,100
RD 116,136,6144
MA 156,52,100
TR 24,140,18432
MA 172,56,100
TR 26,140,18688
MA 168,56,96
TR 28,140,19456
MA 152,52,96
TR 30,140,19712
MA 148,52,92
TR 32,140,20480
MA 164,56,92
TR 34,140,20736
buffer_load_dwordx4 v15, s[44:47], s63 offen offset:3072 lds
MA 160,56,88
TR 36,140,21504
s_add_u32 s63, s62, 131072
MA 144,52,88
TR 38,140,21760
MA 176,60,88
TR 40,140,22528
MA 192,64,88
TR 42,140,22784
MA 196,64,92
RD 120,137,0
MA 180,60,92
RD 124,137,2048
MA 184,60,96
RD 128,137,4096
MA 200,64,96
RD 132,137,6144
MA 204,64,100
MA 188,60,100
MA 220,68,100
s_add_u32 s39, s3, s38
s_add_u32 s3, s3, 32768
MA 216,68,96
MA 212,68,92
s_cmp_eq_u32 s3, 98304
s_cselect_b32 s3, 0, s3
MA 208,68,88
s_waitcnt lgkmcnt(0)
MA 112,16,104
TR 44,140,23552
s_add_u32 m0, s39, 0
MA 128,20,104
TR 46,140,23808
buffer_load_dwordx4 v12, s[44:47], s62 offen lds
MA 132,20,108
TR 48,140,24576
MA 116,16,108
MA 120,16,112
TR 50,140,24832
MA 136,20,112
buffer_load_dwordx4 v13, s[44:47], s62 offen offset:1024 lds
MA 140,20,116
TR 52,140,25600
MA 124,16,116
MA 156,24,116
TR 54,140,25856
MA 172,28,116
buffer_load_dwordx4 v14, s[44:47], s62 offen offset:2048 lds
MA 168,28,112
TR 56,140,26624
MA 152,24,112
MA 148,24,108
TR 58,140,26880
MA 164,28,108
buffer_load_dwordx4 v15, s[44:47], s62 offen offset:3072 lds
MA 160,28,104
TR 60,140,28672
s_add_u32 s62, s62, 128
MA 144,24,104
MA 176,32,104
TR 62,140,28928
s_add_u32 m0, s39, 4096
MA 192,36,104
buffer_load_dwordx4 v12, s[44:47], s63 offen lds
MA 196,36,108
TR 64,140,29696
MA 180,32,108
MA 184,32,112
TR 66,140,29952
MA 200,36,112
TR 68,140,30720
buffer_load_dwordx4 v13, s[44:47], s63 offen offset:1024 lds
MA 204,36,116
TR 70,140,30976
MA 188,32,116
MA 220,40,116
MA 216,40,112
MA 212,40,108
MA 208,40,104
s_waitcnt vmcnt(63) lgkmcnt(0)
s_barrier
v_add_u32 v136, s3, v141
v_add_u32 v137, s3, v143
MA 112,44,120
TR 16,140,32768
s_add_u32 m0, s39, 4096
MA 128,48,120
TR 18,140,33024
buffer_load_dwordx4 v14, s[44:47], s63 offen offset:2048 lds
MA 132,48,124
TR 20,140,33792
MA 116,44,124
TR 22,140,34048
MA 120,44,128
RD 72,136,0
MA 136,48,128
RD 76,136,2048
MA 140,48,132
RD 80,136,4096
MA 124,44,132
RD 84,136,6144
MA 156,52,132
TR 24,140,34816
MA 172,56,132
TR 26,140,35072
MA 168,56,128
TR 28,140,35840
MA 152,52,128
TR 30,140,36096
MA 148,52,124
TR 32,140,36864
MA 164,56,124
TR 34,140,37120
buffer_load_dwordx4 v15, s[44:47], s63 offen offset:3072 lds
MA 160,56,120
TR 36,140,37888
s_add_u32 s63, s62, 131072
MA 144,52,120
TR 38,140,38144
MA 176,60,120
TR 40,140,38912
MA 192,64,120
TR 42,140,39168
MA 196,64,124
RD 88,137,0
MA 180,60,124
RD 92,137,2048
MA 184,60,128
RD 96,137,4096
MA 200,64,128
RD 100,137,6144
MA 204,64,132
MA 188,60,132
MA 220,68,132
s_add_u32 s39, s3, s38
s_add_u32 s3, s3, 32768
MA 216,68,128
MA 212,68,124
s_cmp_eq_u32 s3, 98304
s_cselect_b32 s3, 0, s3
MA 208,68,120
s_waitcnt lgkmcnt(0)
MA 112,16,72
TR 44,140,39936
MA 128,20,72
TR 46,140,40192
buffer_load_dword v138, v10, s[48:51], s36 offen sc1
MA 132,20,76
TR 48,140,40960
MA 116,16,76
s_add_u32 m0, s39, 0
MA 120,16,80
TR 50,140,41216
buffer_load_dwordx4 v12, s[44:47], s62 offen lds
MA 136,20,80
MA 140,20,84
TR 52,140,41984
MA 124,16,84
buffer_load_dwordx4 v13, s[44:47], s62 offen offset:1024 lds
MA 156,24,84
TR 54,140,42240
MA 172,28,84
MA 168,28,80
TR 56,140,43008
MA 152,24,80
buffer_load_dwordx4 v14, s[44:47], s62 offen offset:2048 lds
MA 148,24,76
TR 58,140,43264
MA 164,28,76
MA 160,28,72
TR 60,140,45056
buffer_load_dwordx4 v15, s[44:47], s62 offen offset:3072 lds
MA 144,24,72
s_add_u32 s62, s62, 128
MA 176,32,72
TR 62,140,45312
MA 192,36,72
s_add_u32 m0, s39, 4096
MA 196,36,76
TR 64,140,46080
buffer_load_dwordx4 v12, s[44:47], s63 offen lds
MA 180,32,76
MA 184,32,80
TR 66,140,46336
MA 200,36,80
TR 68,140,47104
buffer_load_dwordx4 v13, s[44:47], s63 offen offset:1024 lds
MA 204,36,84
TR 70,140,47360
MA 188,32,84
MA 220,40,84
MA 216,40,80
MA 212,40,76
MA 208,40,72
s_waitcnt vmcnt(6)
v_cmp_ne_u32 vcc, s100, v138
s_cbranch_vccnz L_b_zslow
L_b_zok:
s_waitcnt vmcnt(15) lgkmcnt(0)
s_barrier
v_add_u32 v136, s3, v141
v_add_u32 v137, s3, v143
MA 112,44,88
TR 16,140,49152
s_add_u32 m0, s39, 4096
MA 128,48,88
TR 18,140,49408
buffer_load_dwordx4 v14, s[44:47], s63 offen offset:2048 lds
MA 132,48,92
TR 20,140,50176
MA 116,44,92
TR 22,140,50432
buffer_load_dwordx4 v15, s[44:47], s63 offen offset:3072 lds
MA 120,44,96
RD 104,136,0
s_add_u32 s63, s62, 131072
s_add_u32 m0, s35, 0
MA 136,48,96
RD 108,136,2048
buffer_load_dwordx4 v8, s[24:27], s33 offen sc1 lds
MA 140,48,100
RD 112,136,4096
MA 124,44,100
RD 116,136,6144
MA 156,52,100
TR 24,140,51200
buffer_load_dwordx4 v8, s[24:27], s33 offen offset:1024 sc1 lds
MA 172,56,100
TR 26,140,51456
MA 168,56,96
TR 28,140,52224
buffer_load_dwordx4 v8, s[24:27], s33 offen offset:2048 sc1 lds
MA 152,52,96
TR 30,140,52480
MA 148,52,92
TR 32,140,53248
MA 164,56,92
TR 34,140,53504
buffer_load_dwordx4 v5, s[24:27], s33 offen offset:3072 sc1 lds
MA 160,56,88
TR 36,140,54272
s_add_u32 s33, s33, 14336
s_add_u32 m0, s35, 16384
MA 144,52,88
TR 38,140,54528
buffer_load_dwordx4 v8, s[24:27], s33 offen sc1 lds
MA 176,60,88
TR 40,140,55296
MA 192,64,88
TR 42,140,55552
buffer_load_dwordx4 v8, s[24:27], s33 offen offset:1024 sc1 lds
MA 196,64,92
RD 120,137,0
MA 180,60,92
RD 124,137,2048
MA 184,60,96
RD 128,137,4096
buffer_load_dwordx4 v8, s[24:27], s33 offen offset:2048 sc1 lds
MA 200,64,96
RD 132,137,6144
MA 204,64,100
buffer_load_dwordx4 v5, s[24:27], s33 offen offset:3072 sc1 lds
MA 188,60,100
s_add_u32 s33, s33, 14336
MA 220,68,100
s_add_u32 s39, s3, s38
s_add_u32 s3, s3, 32768
MA 216,68,96
MA 212,68,92
s_cmp_eq_u32 s3, 98304
s_cselect_b32 s3, 0, s3
MA 208,68,88
s_waitcnt lgkmcnt(0)
MA 112,16,104
TR 44,140,56320
s_add_u32 m0, s35, 32768
MA 128,20,104
TR 46,140,56576
buffer_load_dwordx4 v8, s[24:27], s33 offen sc1 lds
MA 132,20,108
TR 48,140,57344
MA 116,16,108
buffer_load_dwordx4 v8, s[24:27], s33 offen offset:1024 sc1 lds
MA 120,16,112
TR 50,140,57600
MA 136,20,112
buffer_load_dwordx4 v8, s[24:27], s33 offen offset:2048 sc1 lds
MA 140,20,116
TR 52,140,58368
MA 124,16,116
MA 156,24,116
TR 54,140,58624
buffer_load_dwordx4 v5, s[24:27], s33 offen offset:3072 sc1 lds
MA 172,28,116
s_add_u32 s33, s33, 14336
s_add_u32 m0, s39, 0
MA 168,28,112
TR 56,140,59392
buffer_load_dwordx4 v12, s[44:47], s62 offen lds
MA 152,24,112
MA 148,24,108
TR 58,140,59648
MA 164,28,108
buffer_load_dwordx4 v13, s[44:47], s62 offen offset:1024 lds
MA 160,28,104
TR 60,140,61440
MA 144,24,104
buffer_load_dwordx4 v14, s[44:47], s62 offen offset:2048 lds
MA 176,32,104
TR 62,140,61696
MA 192,36,104
buffer_load_dwordx4 v15, s[44:47], s62 offen offset:3072 lds
MA 196,36,108
TR 64,140,62464
s_add_u32 s62, s62, 128
MA 180,32,108
s_add_u32 m0, s39, 4096
MA 184,32,112
TR 66,140,62720
buffer_load_dwordx4 v12, s[44:47], s63 offen lds
MA 200,36,112
TR 68,140,63488
MA 204,36,116
TR 70,140,63744
buffer_load_dwordx4 v13, s[44:47], s63 offen offset:1024 lds
MA 188,32,116
MA 220,40,116
MA 216,40,112
MA 212,40,108
MA 208,40,104
s_waitcnt vmcnt(14) lgkmcnt(0)
s_barrier
v_add_u32 v136, s3, v141
v_add_u32 v137, s3, v143
MA 112,44,120
TR 16,140,0
s_add_u32 m0, s39, 4096
MA 128,48,120
TR 18,140,256
buffer_load_dwordx4 v14, s[44:47], s63 offen offset:2048 lds
MA 132,48,124
TR 20,140,1024
MA 116,44,124
TR 22,140,1280
MA 120,44,128
RD 72,136,0
MA 136,48,128
RD 76,136,2048
buffer_load_dwordx4 v15, s[44:47], s63 offen offset:3072 lds
MA 140,48,132
RD 80,136,4096
s_add_u32 s63, s62, 131072
MA 124,44,132
RD 84,136,6144
MA 156,52,132
TR 24,140,2048
s_add_u32 m0, s35, 49152
MA 172,56,132
TR 26,140,2304
buffer_load_dwordx4 v8, s[24:27], s33 offen sc1 lds
MA 168,56,128
TR 28,140,3072
MA 152,52,128
TR 30,140,3328
MA 148,52,124
TR 32,140,4096
MA 164,56,124
TR 34,140,4352
buffer_load_dwordx4 v8, s[24:27], s33 offen offset:1024 sc1 lds
MA 160,56,120
TR 36,140,5120
MA 144,52,120
TR 38,140,5376
MA 176,60,120
TR 40,140,6144
MA 192,64,120
TR 42,140,6400
buffer_load_dwordx4 v8, s[24:27], s33 offen offset:2048 sc1 lds
MA 196,64,124
RD 88,137,0
MA 180,60,124
RD 92,137,2048
MA 184,60,128
RD 96,137,4096
MA 200,64,128
RD 100,137,6144
buffer_load_dwordx4 v5, s[24:27], s33 offen offset:3072 sc1 lds
MA 204,64,132
s_add_u32 s33, s33, 14336
s_cmp_eq_u32 s33, s59
s_cselect_b32 s33, s58, s33
MA 188,60,132
MA 220,68,132
s_add_u32 s39, s3, s38
s_add_u32 s3, s3, 32768
MA 216,68,128
MA 212,68,124
s_cmp_eq_u32 s3, 98304
s_cselect_b32 s3, 0, s3
MA 208,68,120
s_mov_b32 s37, 6
.p2align 6
L_b_g_0:
s_waitcnt lgkmcnt(0)
MA 112,16,72
TR 44,140,7168
s_add_u32 m0, s39, 0
MA 128,20,72
TR 46,140,7424
buffer_load_dwordx4 v12, s[44:47], s62 offen lds
MA 132,20,76
TR 48,140,8192
MA 116,16,76
MA 120,16,80
TR 50,140,8448
MA 136,20,80
buffer_load_dwordx4 v13, s[44:47], s62 offen offset:1024 lds
MA 140,20,84
TR 52,140,9216
MA 124,16,84
MA 156,24,84
TR 54,140,9472
MA 172,28,84
buffer_load_dwordx4 v14, s[44:47], s62 offen offset:2048 lds
MA 168,28,80
TR 56,140,10240
MA 152,24,80
MA 148,24,76
TR 58,140,10496
MA 164,28,76
buffer_load_dwordx4 v15, s[44:47], s62 offen offset:3072 lds
MA 160,28,72
TR 60,140,12288
s_add_u32 s4, s62, 128
s_and_b32 s4, s4, 0xfff
s_or_b32 s62, s4, s5
MA 144,24,72
MA 176,32,72
TR 62,140,12544
s_add_u32 m0, s39, 4096
MA 192,36,72
buffer_load_dwordx4 v12, s[44:47], s63 offen lds
MA 196,36,76
TR 64,140,13312
MA 180,32,76
MA 184,32,80
TR 66,140,13568
MA 200,36,80
TR 68,140,14336
buffer_load_dwordx4 v13, s[44:47], s63 offen offset:1024 lds
MA 204,36,84
TR 70,140,14592
MA 188,32,84
MA 220,40,84
MA 216,40,80
MA 212,40,76
MA 208,40,72
s_waitcnt vmcnt(22) lgkmcnt(0)
s_barrier
v_add_u32 v136, s3, v141
v_add_u32 v137, s3, v143
MA 112,44,88
TR 16,140,16384
s_add_u32 m0, s39, 4096
MA 128,48,88
TR 18,140,16640
buffer_load_dwordx4 v14, s[44:47], s63 offen offset:2048 lds
MA 132,48,92
TR 20,140,17408
MA 116,44,92
TR 22,140,17664
MA 120,44,96
RD 104,136,0
MA 136,48,96
RD 108,136,2048
buffer_load_dwordx4 v15, s[44:47], s63 offen offset:3072 lds
MA 140,48,100
RD 112,136,4096
s_add_u32 s63, s62, 131072
MA 124,44,100
RD 116,136,6144
MA 156,52,100
TR 24,140,18432
s_add_u32 m0, s35, 0
MA 172,56,100
TR 26,140,18688
buffer_load_dwordx4 v8, s[24:27], s33 offen sc1 lds
MA 168,56,96
TR 28,140,19456
MA 152,52,96
TR 30,140,19712
MA 148,52,92
TR 32,140,20480
MA 164,56,92
TR 34,140,20736
buffer_load_dwordx4 v8, s[24:27], s33 offen offset:1024 sc1 lds
MA 160,56,88
TR 36,140,21504
MA 144,52,88
TR 38,140,21760
MA 176,60,88
TR 40,140,22528
MA 192,64,88
TR 42,140,22784
buffer_load_dwordx4 v8, s[24:27], s33 offen offset:2048 sc1 lds
MA 196,64,92
RD 120,137,0
MA 180,60,92
RD 124,137,2048
MA 184,60,96
RD 128,137,4096
MA 200,64,96
RD 132,137,6144
buffer_load_dwordx4 v5, s[24:27], s33 offen offset:3072 sc1 lds
MA 204,64,100
s_add_u32 s33, s33, 14336
MA 188,60,100
MA 220,68,100
s_add_u32 s39, s3, s38
s_add_u32 s3, s3, 32768
MA 216,68,96
MA 212,68,92
s_cmp_eq_u32 s3, 98304
s_cselect_b32 s3, 0, s3
MA 208,68,88
s_waitcnt lgkmcnt(0)
MA 112,16,104
TR 44,140,23552
s_add_u32 m0, s39, 0
MA 128,20,104
TR 46,140,23808
buffer_load_dwordx4 v12, s[44:47], s62 offen lds
MA 132,20,108
TR 48,140,24576
MA 116,16,108
MA 120,16,112
TR 50,140,24832
MA 136,20,112
buffer_load_dwordx4 v13, s[44:47], s62 offen offset:1024 lds
MA 140,20,116
TR 52,140,25600
MA 124,16,116
MA 156,24,116
TR 54,140,25856
MA 172,28,116
buffer_load_dwordx4 v14, s[44:47], s62 offen offset:2048 lds
MA 168,28,112
TR 56,140,26624
MA 152,24,112
MA 148,24,108
TR 58,140,26880
MA 164,28,108
buffer_load_dwordx4 v15, s[44:47], s62 offen offset:3072 lds
MA 160,28,104
TR 60,140,28672
s_add_u32 s62, s62, 128
MA 144,24,104
MA 176,32,104
TR 62,140,28928
s_add_u32 m0, s39, 4096
MA 192,36,104
buffer_load_dwordx4 v12, s[44:47], s63 offen lds
MA 196,36,108
TR 64,140,29696
MA 180,32,108
MA 184,32,112
TR 66,140,29952
MA 200,36,112
TR 68,140,30720
buffer_load_dwordx4 v13, s[44:47], s63 offen offset:1024 lds
MA 204,36,116
TR 70,140,30976
MA 188,32,116
MA 220,40,116
MA 216,40,112
MA 212,40,108
MA 208,40,104
s_waitcnt vmcnt(22) lgkmcnt(0)
s_barrier
v_add_u32 v136, s3, v141
v_add_u32 v137, s3, v143
MA 112,44,120
TR 16,140,32768
s_add_u32 m0, s39, 4096
MA 128,48,120
TR 18,140,33024
buffer_load_dwordx4 v14, s[44:47], s63 offen offset:2048 lds
MA 132,48,124
TR 20,140,33792
MA 116,44,124
TR 22,140,34048
MA 120,44,128
RD 72,136,0
MA 136,48,128
RD 76,136,2048
buffer_load_dwordx4 v15, s[44:47], s63 offen offset:3072 lds
MA 140,48,132
RD 80,136,4096
s_add_u32 s63, s62, 131072
MA 124,44,132
RD 84,136,6144
MA 156,52,132
TR 24,140,34816
s_add_u32 m0, s35, 16384
MA 172,56,132
TR 26,140,35072
buffer_load_dwordx4 v8, s[24:27], s33 offen sc1 lds
MA 168,56,128
TR 28,140,35840
MA 152,52,128
TR 30,140,36096
MA 148,52,124
TR 32,140,36864
MA 164,56,124
TR 34,140,37120
buffer_load_dwordx4 v8, s[24:27], s33 offen offset:1024 sc1 lds
MA 160,56,120
TR 36,140,37888
MA 144,52,120
TR 38,140,38144
MA 176,60,120
TR 40,140,38912
MA 192,64,120
TR 42,140,39168
buffer_load_dwordx4 v8, s[24:27], s33 offen offset:2048 sc1 lds
MA 196,64,124
RD 88,137,0
MA 180,60,124
RD 92,137,2048
MA 184,60,128
RD 96,137,4096
MA 200,64,128
RD 100,137,6144
buffer_load_dwordx4 v5, s[24:27], s33 offen offset:3072 sc1 lds
MA 204,64,132
s_add_u32 s33, s33, 14336
MA 188,60,132
MA 220,68,132
s_add_u32 s39, s3, s38
s_add_u32 s3, s3, 32768
MA 216,68,128
MA 212,68,124
s_cmp_eq_u32 s3, 98304
s_cselect_b32 s3, 0, s3
MA 208,68,120
s_waitcnt lgkmcnt(0)
MA 112,16,72
TR 44,140,39936
s_add_u32 m0, s39, 0
MA 128,20,72
TR 46,140,40192
buffer_load_dwordx4 v12, s[44:47], s62 offen lds
MA 132,20,76
TR 48,140,40960
MA 116,16,76
MA 120,16,80
TR 50,140,41216
MA 136,20,80
buffer_load_dwordx4 v13, s[44:47], s62 offen offset:1024 lds
MA 140,20,84
TR 52,140,41984
MA 124,16,84
MA 156,24,84
TR 54,140,42240
MA 172,28,84
buffer_load_dwordx4 v14, s[44:47], s62 offen offset:2048 lds
MA 168,28,80
TR 56,140,43008
MA 152,24,80
MA 148,24,76
TR 58,140,43264
MA 164,28,76
buffer_load_dwordx4 v15, s[44:47], s62 offen offset:3072 lds
MA 160,28,72
TR 60,140,45056
s_add_u32 s62, s62, 128
MA 144,24,72
MA 176,32,72
TR 62,140,45312
s_add_u32 m0, s39, 4096
MA 192,36,72
buffer_load_dwordx4 v12, s[44:47], s63 offen lds
MA 196,36,76
TR 64,140,46080
MA 180,32,76
MA 184,32,80
TR 66,140,46336
MA 200,36,80
TR 68,140,47104
buffer_load_dwordx4 v13, s[44:47], s63 offen offset:1024 lds
MA 204,36,84
TR 70,140,47360
MA 188,32,84
MA 220,40,84
MA 216,40,80
MA 212,40,76
MA 208,40,72
s_waitcnt vmcnt(22) lgkmcnt(0)
s_barrier
v_add_u32 v136, s3, v141
v_add_u32 v137, s3, v143
MA 112,44,88
TR 16,140,49152
s_add_u32 m0, s39, 4096
MA 128,48,88
TR 18,140,49408
buffer_load_dwordx4 v14, s[44:47], s63 offen offset:2048 lds
MA 132,48,92
TR 20,140,50176
MA 116,44,92
TR 22,140,50432
MA 120,44,96
RD 104,136,0
MA 136,48,96
RD 108,136,2048
buffer_load_dwordx4 v15, s[44:47], s63 offen offset:3072 lds
MA 140,48,100
RD 112,136,4096
s_add_u32 s63, s62, 131072
MA 124,44,100
RD 116,136,6144
MA 156,52,100
TR 24,140,51200
s_add_u32 m0, s35, 32768
MA 172,56,100
TR 26,140,51456
buffer_load_dwordx4 v8, s[24:27], s33 offen sc1 lds
MA 168,56,96
TR 28,140,52224
MA 152,52,96
TR 30,140,52480
MA 148,52,92
TR 32,140,53248
MA 164,56,92
TR 34,140,53504
buffer_load_dwordx4 v8, s[24:27], s33 offen offset:1024 sc1 lds
MA 160,56,88
TR 36,140,54272
MA 144,52,88
TR 38,140,54528
MA 176,60,88
TR 40,140,55296
MA 192,64,88
TR 42,140,55552
buffer_load_dwordx4 v8, s[24:27], s33 offen offset:2048 sc1 lds
MA 196,64,92
RD 120,137,0
MA 180,60,92
RD 124,137,2048
MA 184,60,96
RD 128,137,4096
MA 200,64,96
RD 132,137,6144
buffer_load_dwordx4 v5, s[24:27], s33 offen offset:3072 sc1 lds
MA 204,64,100
s_add_u32 s33, s33, 14336
MA 188,60,100
MA 220,68,100
s_add_u32 s39, s3, s38
s_add_u32 s3, s3, 32768
MA 216,68,96
MA 212,68,92
s_cmp_eq_u32 s3, 98304
s_cselect_b32 s3, 0, s3
MA 208,68,88
s_waitcnt lgkmcnt(0)
MA 112,16,104
TR 44,140,56320
s_add_u32 m0, s39, 0
MA 128,20,104
TR 46,140,56576
buffer_load_dwordx4 v12, s[44:47], s62 offen lds
MA 132,20,108
TR 48,140,57344
MA 116,16,108
MA 120,16,112
TR 50,140,57600
MA 136,20,112
buffer_load_dwordx4 v13, s[44:47], s62 offen offset:1024 lds
MA 140,20,116
TR 52,140,58368
MA 124,16,116
MA 156,24,116
TR 54,140,58624
MA 172,28,116
buffer_load_dwordx4 v14, s[44:47], s62 offen offset:2048 lds
MA 168,28,112
TR 56,140,59392
MA 152,24,112
MA 148,24,108
TR 58,140,59648
MA 164,28,108
buffer_load_dwordx4 v15, s[44:47], s62 offen offset:3072 lds
MA 160,28,104
TR 60,140,61440
s_add_u32 s62, s62, 128
MA 144,24,104
MA 176,32,104
TR 62,140,61696
s_add_u32 m0, s39, 4096
MA 192,36,104
buffer_load_dwordx4 v12, s[44:47], s63 offen lds
MA 196,36,108
TR 64,140,62464
MA 180,32,108
MA 184,32,112
TR 66,140,62720
MA 200,36,112
TR 68,140,63488
buffer_load_dwordx4 v13, s[44:47], s63 offen offset:1024 lds
MA 204,36,116
TR 70,140,63744
MA 188,32,116
MA 220,40,116
MA 216,40,112
MA 212,40,108
MA 208,40,104
s_waitcnt vmcnt(22) lgkmcnt(0)
s_barrier
v_add_u32 v136, s3, v141
v_add_u32 v137, s3, v143
MA 112,44,120
TR 16,140,0
s_add_u32 m0, s39, 4096
MA 128,48,120
TR 18,140,256
buffer_load_dwordx4 v14, s[44:47], s63 offen offset:2048 lds
MA 132,48,124
TR 20,140,1024
MA 116,44,124
TR 22,140,1280
MA 120,44,128
RD 72,136,0
MA 136,48,128
RD 76,136,2048
buffer_load_dwordx4 v15, s[44:47], s63 offen offset:3072 lds
MA 140,48,132
RD 80,136,4096
s_add_u32 s63, s62, 131072
MA 124,44,132
RD 84,136,6144
MA 156,52,132
TR 24,140,2048
s_add_u32 m0, s35, 49152
MA 172,56,132
TR 26,140,2304
buffer_load_dwordx4 v8, s[24:27], s33 offen sc1 lds
MA 168,56,128
TR 28,140,3072
MA 152,52,128
TR 30,140,3328
MA 148,52,124
TR 32,140,4096
MA 164,56,124
TR 34,140,4352
buffer_load_dwordx4 v8, s[24:27], s33 offen offset:1024 sc1 lds
MA 160,56,120
TR 36,140,5120
MA 144,52,120
TR 38,140,5376
MA 176,60,120
TR 40,140,6144
MA 192,64,120
TR 42,140,6400
buffer_load_dwordx4 v8, s[24:27], s33 offen offset:2048 sc1 lds
MA 196,64,124
RD 88,137,0
MA 180,60,124
RD 92,137,2048
MA 184,60,128
RD 96,137,4096
MA 200,64,128
RD 100,137,6144
buffer_load_dwordx4 v5, s[24:27], s33 offen offset:3072 sc1 lds
MA 204,64,132
s_add_u32 s33, s33, 14336
s_cmp_eq_u32 s33, s59
s_cselect_b32 s33, s58, s33
MA 188,60,132
MA 220,68,132
s_add_u32 s39, s3, s38
s_add_u32 s3, s3, 32768
MA 216,68,128
MA 212,68,124
s_cmp_eq_u32 s3, 98304
s_cselect_b32 s3, 0, s3
MA 208,68,120
s_sub_u32 s37, s37, 1
s_cmp_lg_u32 s37, 0
s_cbranch_scc1 L_b_g_0
s_waitcnt lgkmcnt(0)
MA 112,16,72
TR 44,140,7168
s_add_u32 m0, s39, 0
MA 128,20,72
TR 46,140,7424
buffer_load_dwordx4 v12, s[44:47], s62 offen lds
MA 132,20,76
TR 48,140,8192
MA 116,16,76
MA 120,16,80
TR 50,140,8448
MA 136,20,80
buffer_load_dwordx4 v13, s[44:47], s62 offen offset:1024 lds
MA 140,20,84
TR 52,140,9216
MA 124,16,84
MA 156,24,84
TR 54,140,9472
MA 172,28,84
buffer_load_dwordx4 v14, s[44:47], s62 offen offset:2048 lds
MA 168,28,80
TR 56,140,10240
MA 152,24,80
MA 148,24,76
TR 58,140,10496
MA 164,28,76
buffer_load_dwordx4 v15, s[44:47], s62 offen offset:3072 lds
MA 160,28,72
TR 60,140,12288
s_add_u32 s4, s62, 128
s_and_b32 s4, s4, 0xfff
s_or_b32 s62, s4, s5
MA 144,24,72
MA 176,32,72
TR 62,140,12544
s_add_u32 m0, s39, 4096
MA 192,36,72
buffer_load_dwordx4 v12, s[44:47], s63 offen lds
MA 196,36,76
TR 64,140,13312
MA 180,32,76
MA 184,32,80
TR 66,140,13568
MA 200,36,80
TR 68,140,14336
buffer_load_dwordx4 v13, s[44:47], s63 offen offset:1024 lds
MA 204,36,84
TR 70,140,14592
MA 188,32,84
MA 220,40,84
MA 216,40,80
MA 212,40,76
MA 208,40,72
s_waitcnt vmcnt(22) lgkmcnt(0)
s_barrier
v_add_u32 v136, s3, v141
v_add_u32 v137, s3, v143
MA 112,44,88
TR 16,140,16384
s_add_u32 m0, s39, 4096
MA 128,48,88
TR 18,140,16640
buffer_load_dwordx4 v14, s[44:47], s63 offen offset:2048 lds
MA 132,48,92
TR 20,140,17408
MA 116,44,92
TR 22,140,17664
MA 120,44,96
RD 104,136,0
MA 136,48,96
RD 108,136,2048
MA 140,48,100
RD 112,136,4096
MA 124,44,100
RD 116,136,6144
buffer_load_dwordx4 v15, s[44:47], s63 offen offset:3072 lds
MA 156,52,100
TR 24,140,18432
s_add_u32 s63, s62, 131072
MA 172,56,100
TR 26,140,18688
MA 168,56,96
TR 28,140,19456
MA 152,52,96
TR 30,140,19712
MA 148,52,92
TR 32,140,20480
s_getpc_b64 s[60:61]
L_ct8:
s_add_u32 s60, s60, L_b_hepi-L_ct8
s_addc_u32 s61, s61, 0
v_lshlrev_b32 v139, 7, v0
v_min_u32 v139, L_b_oslow-L_b_hepi-4, v139
MA 164,56,92
TR 34,140,20736
global_load_dword v138, v139, s[60:61]
MA 160,56,88
TR 36,140,21504
MA 144,52,88
TR 38,140,21760
MA 176,60,88
TR 40,140,22528
MA 192,64,88
TR 42,140,22784
MA 196,64,92
RD 120,137,0
v_add_u32 v139, 0x8000, v139
v_min_u32 v139, L_b_oslow-L_b_hepi-4, v139
MA 180,60,92
RD 124,137,2048
global_load_dword v138, v139, s[60:61]
MA 184,60,96
RD 128,137,4096
MA 200,64,96
RD 132,137,6144
MA 204,64,100
MA 188,60,100
MA 220,68,100
s_add_u32 s39, s3, s38
s_add_u32 s3, s3, 32768
MA 216,68,96
MA 212,68,92
s_cmp_eq_u32 s3, 98304
s_cselect_b32 s3, 0, s3
MA 208,68,88
s_waitcnt lgkmcnt(0)
MA 112,16,104
TR 44,140,23552
MA 128,20,104
TR 46,140,23808
MA 132,20,108
TR 48,140,24576
MA 116,16,108
MA 120,16,112
TR 50,140,24832
MA 136,20,112
MA 140,20,116
TR 52,140,25600
MA 124,16,116
MA 156,24,116
TR 54,140,25856
MA 172,28,116
MA 168,28,112
TR 56,140,26624
MA 152,24,112
MA 148,24,108
TR 58,140,26880
MA 164,28,108
MA 160,28,104
TR 60,140,28672
MA 144,24,104
MA 176,32,104
TR 62,140,28928
MA 192,36,104
MA 196,36,108
TR 64,140,29696
MA 180,32,108
MA 184,32,112
TR 66,140,29952
MA 200,36,112
TR 68,140,30720
MA 204,36,116
TR 70,140,30976
MA 188,32,116
MA 220,40,116
MA 216,40,112
MA 212,40,108
MA 208,40,104
s_waitcnt vmcnt(14) lgkmcnt(0)
s_barrier
v_add_u32 v136, s3, v141
v_add_u32 v137, s3, v143
MA 112,44,120
TR 16,140,32768
MA 128,48,120
TR 18,140,33024
MA 132,48,124
TR 20,140,33792
s_lshr_b32 s52, s11, 1
MA 116,44,124
TR 22,140,34048
s_lshl_b32 s52, s52, 2
MA 120,44,128
RD 72,136,0
s_and_b32 s15, s12, 3
MA 136,48,128
RD 76,136,2048
s_add_u32 s52, s52, s15
MA 140,48,132
RD 80,136,4096
s_and_b32 s53, s11, 1
MA 124,44,132
RD 84,136,6144
s_lshl_b32 s53, s53, 2
MA 156,52,132
TR 24,140,34816
s_bfe_u32 s15, s12, 0x20002
MA 172,56,132
TR 26,140,35072
s_add_u32 s53, s53, s15
MA 168,56,128
TR 28,140,35840
s_lshl_b32 s15, s53, 8
MA 152,52,128
TR 30,140,36096
s_and_b32 s38, s10, 1
MA 148,52,124
TR 32,140,36864
s_lshl_b32 s38, s38, 12
MA 164,56,124
TR 34,140,37120
s_add_u32 s15, s15, s38
MA 160,56,120
TR 36,140,37888
v_and_b32 v12, 15, v1
MA 144,52,120
TR 38,140,38144
v_lshlrev_b32 v12, 4, v12
MA 176,60,120
TR 40,140,38912
v_add_u32 v12, s15, v12
MA 192,64,120
TR 42,140,39168
v_lshrrev_b32 v13, 5, v1
MA 196,64,124
RD 88,137,0
v_bfe_u32 v14, v1, 4, 1
MA 180,60,124
RD 92,137,2048
s_lshr_b32 s38, s10, 1
MA 184,60,128
RD 96,137,4096
s_lshl_b32 s15, s38, 13
MA 200,64,128
RD 100,137,6144
v_lshl_add_u32 v4, v13, 14, v12
MA 204,64,132
v_lshl_add_u32 v4, v14, 15, v4
MA 188,60,132
v_add_u32 v4, s15, v4
MA 220,68,132
s_add_u32 s3, s3, 32768
MA 216,68,128
MA 212,68,124
s_cmp_eq_u32 s3, 98304
s_cselect_b32 s3, 0, s3
MA 208,68,120
s_waitcnt lgkmcnt(0)
MA 112,16,72
TR 44,140,39936
MA 128,20,72
TR 46,140,40192
MA 132,20,76
TR 48,140,40960
v_add_u32 v5, 992, v4
MA 116,16,76
s_lshl_b32 s15, s38, 13
MA 120,16,80
TR 50,140,41216
v_lshl_add_u32 v8, v13, 14, v12
MA 136,20,80
v_add_u32 v8, s15, v8
MA 140,20,84
TR 52,140,41984
v_lshl_add_u32 v6, v14, 15, v8
MA 124,16,84
v_add_u32 v7, 992, v6
MA 156,24,84
TR 54,140,42240
v_mul_u32_u24 v15, 229376, v14
MA 172,28,84
v_add_u32 v8, v8, v15
MA 168,28,80
TR 56,140,43008
v_add_u32 v9, 992, v8
MA 152,24,80
s_mov_b32 s24, s40
MA 148,24,76
TR 58,140,43264
s_mov_b32 s25, s41
MA 164,28,76
s_mov_b32 s26, 0x380000
MA 160,28,72
TR 60,140,45056
s_mov_b32 s27, 0x00020000
MA 144,24,72
s_mov_b32 s34, 0
MA 176,32,72
TR 62,140,45312
s_mov_b32 s16, s6
MA 192,36,72
s_mov_b32 s17, s7
MA 196,36,76
TR 64,140,46080
s_mov_b32 s18, 0x800000
MA 180,32,76
s_mov_b32 s19, 0x00020000
MA 184,32,80
TR 66,140,46336
s_mov_b32 s32, 6291456
MA 200,36,80
TR 68,140,47104
s_mul_i32 s38, s10, 2112
MA 204,36,84
TR 70,140,47360
v_and_b32 v10, 15, v1
MA 188,32,84
v_lshlrev_b32 v15, 6, v10
MA 220,40,84
MA 216,40,80
MA 212,40,76
MA 208,40,72
s_waitcnt vmcnt(2) lgkmcnt(0)
s_barrier
v_add_u32 v136, s3, v141
v_add_u32 v137, s3, v143
MA 112,44,88
TR 16,140,49152
MA 128,48,88
TR 18,140,49408
MA 132,48,92
TR 20,140,50176
v_lshlrev_b32 v10, 4, v10
MA 116,44,92
TR 22,140,50432
v_lshrrev_b32 v14, 4, v1
MA 120,44,96
RD 104,136,0
v_lshl_add_u32 v10, v14, 9, v10
MA 136,48,96
RD 108,136,2048
v_lshlrev_b32 v11, 4, v1
MA 140,48,100
RD 112,136,4096
v_lshlrev_b32 v12, 3, v1
MA 124,44,100
RD 116,136,6144
v_bfe_u32 v14, v1, 2, 3
MA 156,52,100
TR 24,140,51200
v_mul_u32_u24 v13, 1056, v14
MA 172,56,100
TR 26,140,51456
v_lshrrev_b32 v14, 5, v1
MA 168,56,96
TR 28,140,52224
v_lshl_add_u32 v13, v14, 9, v13
MA 152,52,96
TR 30,140,52480
v_and_b32 v14, 3, v1
MA 148,52,92
TR 32,140,53248
v_lshl_add_u32 v13, v14, 3, v13
MA 164,56,92
TR 34,140,53504
v_add_u32 v14, 59136, v13
MA 160,56,88
TR 36,140,54272
s_add_u32 s20, s8, 0x800000
s_addc_u32 s21, s9, 0
MA 144,52,88
TR 38,140,54528
s_mov_b32 s22, 0x1044000
MA 176,60,88
TR 40,140,55296
s_mov_b32 s23, 0x00020000
MA 192,64,88
TR 42,140,55552
v_add_u32 v10, 133248, v11
MA 196,64,92
RD 120,137,0
s_add_u32 s44, s8, 0x8800000
s_addc_u32 s45, s9, 0
MA 180,60,92
RD 124,137,2048
s_mov_b32 s46, 0x800000
MA 184,60,96
RD 128,137,4096
s_mov_b32 s47, 0x00020000
MA 200,64,96
RD 132,137,6144
s_lshl_b32 s15, s52, 2
MA 204,64,100
s_add_u32 s15, s15, s10
MA 188,60,100
s_mul_i32 s33, s15, 266496
MA 220,68,100
s_add_u32 s3, s3, 32768
MA 216,68,96
MA 212,68,92
s_cmp_eq_u32 s3, 98304
s_cselect_b32 s3, 0, s3
MA 208,68,88
s_waitcnt lgkmcnt(0)
MA 112,16,104
TR 44,140,56320
MA 128,20,104
TR 46,140,56576
MA 132,20,108
TR 48,140,57344
s_add_u32 s33, s33, 98304
MA 116,16,108
s_mul_i32 s35, s15, 117248
MA 120,16,112
TR 50,140,57600
s_add_u32 s36, s35, 58624
MA 136,20,112
s_lshr_b32 s15, s15, 1
MA 140,20,116
TR 52,140,58368
s_lshl_b32 s15, s15, 10
MA 124,16,116
s_add_u32 s54, s15, 368640
MA 156,24,116
TR 54,140,58624
s_add_u32 s55, s15, 401408
MA 172,28,116
s_add_u32 s59, s15, 466944
MA 168,28,112
TR 56,140,59392
s_lshl_b32 s39, s52, 3
MA 152,24,112
s_add_u32 s39, s39, s53
MA 148,24,108
TR 58,140,59648
s_lshl_b32 s62, s39, 3
MA 164,28,108
MA 160,28,104
TR 60,140,61440
s_add_u32 s62, s62, s10
MA 144,24,104
s_lshl_b32 s62, s62, 13
MA 176,32,104
TR 62,140,61696
s_lshl_b32 s63, s39, 2
MA 192,36,104
s_lshr_b32 s15, s10, 1
MA 196,36,108
TR 64,140,62464
s_add_u32 s63, s63, s15
MA 180,32,108
s_lshl_b32 s39, s39, 2
MA 184,32,112
TR 66,140,62720
s_add_u32 s39, s39, s10
MA 200,36,112
TR 68,140,63488
s_lshl_b32 s63, s63, 6
MA 204,36,116
TR 70,140,63744
s_add_u32 s63, s63, 434176
MA 188,32,116
buffer_load_dword v138, v15, s[48:51], s59 offen sc1
MA 220,40,116
MA 216,40,112
MA 212,40,108
MA 208,40,104
s_waitcnt lgkmcnt(0)
s_barrier
MA 112,44,120
s_add_u32 m0, s38, 0
MA 128,48,120
MA 132,48,124
buffer_load_dwordx4 v4, s[16:19], s32 offen lds
MA 116,44,124
MA 120,44,128
buffer_load_dwordx4 v5, s[16:19], s32 offen offset:1056 lds
s_add_u32 s32, s32, 65536
MA 136,48,128
MA 140,48,132
s_add_u32 m0, s38, 8448
MA 124,44,132
MA 156,52,132
buffer_load_dwordx4 v4, s[16:19], s32 offen lds
MA 172,56,132
MA 168,56,128
buffer_load_dwordx4 v5, s[16:19], s32 offen offset:1056 lds
s_add_u32 s32, s32, 65536
MA 152,52,128
MA 148,52,124
MA 164,56,124
s_add_u32 m0, s38, 16896
MA 160,56,120
MA 144,52,120
buffer_load_dwordx4 v4, s[16:19], s32 offen lds
MA 176,60,120
MA 192,64,120
buffer_load_dwordx4 v5, s[16:19], s32 offen offset:1056 lds
s_add_u32 s32, s32, 65536
MA 196,64,124
MA 180,60,124
s_add_u32 m0, s38, 25344
MA 184,60,128
MA 200,64,128
buffer_load_dwordx4 v4, s[16:19], s32 offen lds
MA 204,64,132
MA 188,60,132
buffer_load_dwordx4 v5, s[16:19], s32 offen offset:1056 lds
s_add_u32 s32, s32, 327680
MA 220,68,132
MA 216,68,128
MA 212,68,124
MA 208,68,120
L_b_hepi:
s_waitcnt vmcnt(8)
v_cmp_ne_u32 vcc, s100, v138
s_cbranch_vccnz L_b_oslow
L_b_ook:
buffer_load_dwordx4 v[80:83], v11, s[20:23], s33 offen sc1
buffer_load_dwordx4 v[84:87], v10, s[20:23], s33 offen sc1
s_add_u32 s33, s33, 1024
buffer_load_dwordx4 v[88:91], v11, s[20:23], s33 offen sc1
buffer_load_dwordx4 v[92:95], v10, s[20:23], s33 offen sc1
s_add_u32 s33, s33, 1024
buffer_load_dwordx4 v[96:99], v11, s[20:23], s33 offen sc1
buffer_load_dwordx4 v[100:103], v10, s[20:23], s33 offen sc1
s_add_u32 s33, s33, 1024
buffer_load_dwordx4 v[104:107], v11, s[20:23], s33 offen sc1
buffer_load_dwordx4 v[108:111], v10, s[20:23], s33 offen sc1
s_add_u32 s33, s33, 5120
s_lshl_b32 s15, s13, 2
s_add_u32 s15, s15, s10
s_mul_i32 s15, s15, 234496
s_lshr_b32 s60, s14, 1
s_mul_i32 s60, s60, 7168
s_add_u32 s15, s15, s60
s_and_b32 s60, s14, 1
s_mul_i32 s61, s60, 3072
s_lshl_b32 s60, s60, 9
s_add_u32 s60, s60, s15
s_add_u32 s60, s60, 6144
s_add_u32 s15, s15, s61
s_nop 4
AR 16,112
AR 17,113
AR 18,114
AR 19,115
AR 20,128
AR 21,129
AR 22,130
AR 23,131
PM 16,16,144
PM 18,18,146
PM 20,20,160
PM 22,22,162
CV 24,16,17
CV 25,18,19
CV 26,20,21
CV 27,22,23
buffer_store_dwordx4 v[24:27], v11, s[28:31], s15 offen sc1
AR 32,144
AR 33,145
AR 34,146
AR 35,147
AR 36,160
AR 37,161
AR 38,162
AR 39,163
PM 32,32,176
PM 34,34,178
PM 36,36,192
PM 38,38,194
CV 40,32,33
CV 41,34,35
CV 42,36,37
CV 43,38,39
buffer_store_dwordx4 v[40:43], v11, s[28:31], s15 offen offset:1024 sc1
AR 48,176
AR 49,177
AR 50,178
AR 51,179
AR 52,192
AR 53,193
AR 54,194
AR 55,195
PM 48,48,208
PM 50,50,210
PM 52,52,224
PM 54,54,226
CV 56,48,49
CV 57,50,51
CV 58,52,53
CV 59,54,55
buffer_store_dwordx4 v[56:59], v11, s[28:31], s15 offen offset:2048 sc1
AR 16,208
AR 17,209
AR 18,210
AR 19,211
PM 16,16,240
PM 18,18,242
CV 24,16,17
CV 25,18,19
buffer_store_dwordx2 v[24:25], v12, s[28:31], s60 offen sc1
s_add_u32 s15, s15, 58624
s_add_u32 s60, s60, 58624
AR 32,116
AR 33,117
AR 34,118
AR 35,119
AR 36,132
AR 37,133
AR 38,134
AR 39,135
PM 32,32,148
PM 34,34,150
PM 36,36,164
PM 38,38,166
CV 40,32,33
CV 41,34,35
CV 42,36,37
CV 43,38,39
buffer_store_dwordx4 v[40:43], v11, s[28:31], s15 offen sc1
AR 48,148
AR 49,149
AR 50,150
AR 51,151
AR 52,164
AR 53,165
AR 54,166
AR 55,167
PM 48,48,180
PM 50,50,182
PM 52,52,196
PM 54,54,198
CV 56,48,49
CV 57,50,51
CV 58,52,53
CV 59,54,55
buffer_store_dwordx4 v[56:59], v11, s[28:31], s15 offen offset:1024 sc1
AR 16,180
AR 17,181
AR 18,182
AR 19,183
AR 20,196
AR 21,197
AR 22,198
AR 23,199
PM 16,16,212
PM 18,18,214
PM 20,20,228
PM 22,22,230
CV 24,16,17
CV 25,18,19
CV 26,20,21
CV 27,22,23
buffer_store_dwordx4 v[24:27], v11, s[28:31], s15 offen offset:2048 sc1
AR 32,212
AR 33,213
AR 34,214
AR 35,215
PM 32,32,244
PM 34,34,246
CV 40,32,33
CV 41,34,35
buffer_store_dwordx2 v[40:41], v12, s[28:31], s60 offen sc1
s_add_u32 s15, s15, 58624
s_add_u32 s60, s60, 58624
AR 48,120
AR 49,121
AR 50,122
AR 51,123
AR 52,136
AR 53,137
AR 54,138
AR 55,139
PM 48,48,152
PM 50,50,154
PM 52,52,168
PM 54,54,170
CV 56,48,49
CV 57,50,51
CV 58,52,53
CV 59,54,55
buffer_store_dwordx4 v[56:59], v11, s[28:31], s15 offen sc1
AR 16,152
AR 17,153
AR 18,154
AR 19,155
AR 20,168
AR 21,169
AR 22,170
AR 23,171
PM 16,16,184
PM 18,18,186
PM 20,20,200
PM 22,22,202
CV 24,16,17
CV 25,18,19
CV 26,20,21
CV 27,22,23
buffer_store_dwordx4 v[24:27], v11, s[28:31], s15 offen offset:1024 sc1
AR 32,184
AR 33,185
AR 34,186
AR 35,187
AR 36,200
AR 37,201
AR 38,202
AR 39,203
PM 32,32,216
PM 34,34,218
PM 36,36,232
PM 38,38,234
CV 40,32,33
CV 41,34,35
CV 42,36,37
CV 43,38,39
buffer_store_dwordx4 v[40:43], v11, s[28:31], s15 offen offset:2048 sc1
AR 48,216
AR 49,217
AR 50,218
AR 51,219
PM 48,48,248
PM 50,50,250
CV 56,48,49
CV 57,50,51
buffer_store_dwordx2 v[56:57], v12, s[28:31], s60 offen sc1
s_add_u32 s15, s15, 58624
s_add_u32 s60, s60, 58624
AR 16,124
AR 17,125
AR 18,126
AR 19,127
AR 20,140
AR 21,141
AR 22,142
AR 23,143
PM 16,16,156
PM 18,18,158
PM 20,20,172
PM 22,22,174
CV 24,16,17
CV 25,18,19
CV 26,20,21
CV 27,22,23
buffer_store_dwordx4 v[24:27], v11, s[28:31], s15 offen sc1
AR 32,156
AR 33,157
AR 34,158
AR 35,159
AR 36,172
AR 37,173
AR 38,174
AR 39,175
PM 32,32,188
PM 34,34,190
PM 36,36,204
PM 38,38,206
CV 40,32,33
CV 41,34,35
CV 42,36,37
CV 43,38,39
buffer_store_dwordx4 v[40:43], v11, s[28:31], s15 offen offset:1024 sc1
AR 48,188
AR 49,189
AR 50,190
AR 51,191
AR 52,204
AR 53,205
AR 54,206
AR 55,207
PM 48,48,220
PM 50,50,222
PM 52,52,236
PM 54,54,238
CV 56,48,49
CV 57,50,51
CV 58,52,53
CV 59,54,55
buffer_store_dwordx4 v[56:59], v11, s[28:31], s15 offen offset:2048 sc1
AR 16,220
AR 17,221
AR 18,222
AR 19,223
PM 16,16,252
PM 18,18,254
CV 24,16,17
CV 25,18,19
buffer_store_dwordx2 v[24:25], v12, s[28:31], s60 offen sc1
s_lshl_b32 s101, s13, 2
s_add_u32 s101, s101, s10
s_lshl_b32 s101, s101, 4
s_add_u32 s101, s101, s14
s_lshl_b32 s101, s101, 6
s_add_u32 s101, s101, 401408
s_mov_b32 s60, 0xbfb8aa3b
s_waitcnt vmcnt(22)
s_barrier
TR 16,13,0
TR 18,13,256
TR 20,13,32
TR 22,13,288
TR 24,13,64
TR 26,13,320
TR 28,13,96
TR 30,13,352
TR 32,13,128
TR 34,13,384
TR 36,13,160
TR 38,13,416
TR 40,13,192
TR 42,13,448
TR 44,13,224
TR 46,13,480
s_waitcnt vmcnt(20) lgkmcnt(0)
s_barrier
MZ 0,16,80
TR 48,13,8448
s_add_u32 m0, s38, 33792
MZ 8,20,80
buffer_load_dwordx4 v4, s[16:19], s32 offen lds
MZ 12,20,84
TR 50,13,8704
TR 52,13,8480
MZ 4,16,84
TR 54,13,8736
TR 56,13,8512
buffer_load_dwordx4 v5, s[16:19], s32 offen offset:1056 lds
s_add_u32 s32, s32, 65536
MZ 20,24,84
TR 58,13,8768
TR 60,13,8544
MZ 28,28,84
buffer_load_dwordx4 v[112:115], v11, s[20:23], s33 offen sc1
MZ 24,28,80
TR 62,13,8800
TR 64,13,8576
MZ 16,24,80
TR 66,13,8832
TR 68,13,8608
buffer_load_dwordx4 v[116:119], v10, s[20:23], s33 offen sc1
s_add_u32 s33, s33, 1024
MZ 32,32,80
TR 70,13,8864
s_add_u32 m0, s38, 42240
MZ 40,36,80
buffer_load_dwordx4 v4, s[16:19], s32 offen lds
MZ 44,36,84
TR 72,13,8640
TR 74,13,8896
MZ 36,32,84
TR 76,13,8672
buffer_load_dwordx4 v5, s[16:19], s32 offen offset:1056 lds
s_add_u32 s32, s32, 65536
MZ 52,40,84
TR 78,13,8928
MZ 60,44,84
buffer_load_dwordx4 v[120:123], v11, s[20:23], s33 offen sc1
MZ 56,44,80
buffer_load_dwordx4 v[124:127], v10, s[20:23], s33 offen sc1
s_add_u32 s33, s33, 1024
MZ 48,40,80
s_waitcnt lgkmcnt(0)
MA 0,48,88
TR 16,13,16896
s_add_u32 m0, s38, 50688
MA 8,52,88
buffer_load_dwordx4 v4, s[16:19], s32 offen lds
MA 12,52,92
TR 18,13,17152
TR 20,13,16928
MA 4,48,92
TR 22,13,17184
TR 24,13,16960
buffer_load_dwordx4 v5, s[16:19], s32 offen offset:1056 lds
s_add_u32 s32, s32, 65536
MA 20,56,92
TR 26,13,17216
TR 28,13,16992
MA 28,60,92
buffer_load_dwordx4 v[128:131], v11, s[20:23], s33 offen sc1
MA 24,60,88
TR 30,13,17248
TR 32,13,17024
MA 16,56,88
TR 34,13,17280
TR 36,13,17056
buffer_load_dwordx4 v[132:135], v10, s[20:23], s33 offen sc1
s_add_u32 s33, s33, 1024
MA 32,64,88
TR 38,13,17312
s_add_u32 m0, s38, 0
MA 40,68,88
buffer_load_dwordx4 v4, s[16:19], s32 offen lds
MA 44,68,92
TR 40,13,17088
TR 42,13,17344
MA 36,64,92
TR 44,13,17120
buffer_load_dwordx4 v5, s[16:19], s32 offen offset:1056 lds
s_add_u32 s32, s32, 327680
MA 52,72,92
TR 46,13,17376
MA 60,76,92
buffer_load_dwordx4 v[80:83], v11, s[20:23], s33 offen sc1
MA 56,76,88
buffer_load_dwordx4 v[84:87], v10, s[20:23], s33 offen sc1
s_add_u32 s33, s33, 5120
MA 48,72,88
s_waitcnt vmcnt(12) lgkmcnt(0)
s_barrier
MA 0,16,96
TR 48,13,25344
s_add_u32 m0, s38, 8448
MA 8,20,96
buffer_load_dwordx4 v4, s[16:19], s32 offen lds
MA 12,20,100
TR 50,13,25600
TR 52,13,25376
MA 4,16,100
TR 54,13,25632
TR 56,13,25408
MA 20,24,100
TR 58,13,25664
TR 60,13,25440
MA 28,28,100
buffer_load_dwordx4 v5, s[16:19], s32 offen offset:1056 lds
s_add_u32 s32, s32, 65536
MA 24,28,96
TR 62,13,25696
TR 64,13,25472
MA 16,24,96
TR 66,13,25728
TR 68,13,25504
MA 32,32,96
TR 70,13,25760
MA 40,36,96
buffer_load_dwordx4 v[88:91], v11, s[20:23], s33 offen sc1
MA 44,36,100
TR 72,13,25536
TR 74,13,25792
MA 36,32,100
TR 76,13,25568
MA 52,40,100
TR 78,13,25824
MA 60,44,100
buffer_load_dwordx4 v[92:95], v10, s[20:23], s33 offen sc1
s_add_u32 s33, s33, 1024
MA 56,44,96
MA 48,40,96
s_waitcnt vmcnt(20)
v_mov_b32 v162, s100
s_mov_b64 exec, 1
buffer_store_dword v162, off, s[48:51], s101 sc1
s_mov_b64 exec, -1
s_waitcnt lgkmcnt(0)
MA 0,48,104
TR 16,13,33792
s_add_u32 m0, s38, 16896
MA 8,52,104
buffer_load_dwordx4 v4, s[16:19], s32 offen lds
MA 12,52,108
TR 18,13,34048
TR 20,13,33824
MA 4,48,108
TR 22,13,34080
TR 24,13,33856
MA 20,56,108
TR 26,13,34112
TR 28,13,33888
MA 28,60,108
buffer_load_dwordx4 v5, s[16:19], s32 offen offset:1056 lds
s_add_u32 s32, s32, 65536
MA 24,60,104
TR 30,13,34144
TR 32,13,33920
MA 16,56,104
TR 34,13,34176
TR 36,13,33952
MA 32,64,104
TR 38,13,34208
MA 40,68,104
buffer_load_dwordx4 v[96:99], v11, s[20:23], s33 offen sc1
MA 44,68,108
TR 40,13,33984
TR 42,13,34240
MA 36,64,108
TR 44,13,34016
MA 52,72,108
TR 46,13,34272
MA 60,76,108
buffer_load_dwordx4 v[100:103], v10, s[20:23], s33 offen sc1
s_add_u32 s33, s33, 1024
MA 56,76,104
MA 48,72,104
s_waitcnt vmcnt(13) lgkmcnt(0)
s_barrier
MA 0,16,112
TR 48,13,42240
s_add_u32 m0, s38, 25344
MA 8,20,112
buffer_load_dwordx4 v4, s[16:19], s32 offen lds
MA 12,20,116
TR 50,13,42496
TR 52,13,42272
MA 4,16,116
TR 54,13,42528
TR 56,13,42304
MA 20,24,116
TR 58,13,42560
TR 60,13,42336
MA 28,28,116
buffer_load_dwordx4 v5, s[16:19], s32 offen offset:1056 lds
s_add_u32 s32, s32, 65536
MA 24,28,112
TR 62,13,42592
TR 64,13,42368
MA 16,24,112
TR 66,13,42624
TR 68,13,42400
MA 32,32,112
TR 70,13,42656
MA 40,36,112
buffer_load_dwordx4 v[104:107], v11, s[20:23], s33 offen sc1
MA 44,36,116
TR 72,13,42432
TR 74,13,42688
MA 36,32,116
TR 76,13,42464
MA 52,40,116
TR 78,13,42720
MA 60,44,116
buffer_load_dwordx4 v[108:111], v10, s[20:23], s33 offen sc1
s_add_u32 s33, s33, 1024
MA 56,44,112
MA 48,40,112
s_waitcnt lgkmcnt(0)
MA 0,48,120
TR 16,13,50688
s_add_u32 m0, s38, 33792
MA 8,52,120
buffer_load_dwordx4 v4, s[16:19], s32 offen lds
MA 12,52,124
TR 18,13,50944
TR 20,13,50720
MA 4,48,124
TR 22,13,50976
TR 24,13,50752
MA 20,56,124
TR 26,13,51008
TR 28,13,50784
MA 28,60,124
buffer_load_dwordx4 v5, s[16:19], s32 offen offset:1056 lds
s_add_u32 s32, s32, 327680
MA 24,60,120
TR 30,13,51040
TR 32,13,50816
MA 16,56,120
TR 34,13,51072
TR 36,13,50848
MA 32,64,120
TR 38,13,51104
MA 40,68,120
buffer_load_dwordx4 v[112:115], v11, s[20:23], s33 offen sc1
MA 44,68,124
TR 40,13,50880
TR 42,13,51136
MA 36,64,124
TR 44,13,50912
MA 52,72,124
TR 46,13,51168
MA 60,76,124
buffer_load_dwordx4 v[116:119], v10, s[20:23], s33 offen sc1
s_add_u32 s33, s33, 5120
MA 56,76,120
MA 48,72,120
s_waitcnt vmcnt(13) lgkmcnt(0)
s_barrier
MA 0,16,128
TR 48,13,0
s_add_u32 m0, s38, 42240
MA 8,20,128
buffer_load_dwordx4 v4, s[16:19], s32 offen lds
MA 12,20,132
TR 50,13,256
TR 52,13,32
MA 4,16,132
TR 54,13,288
TR 56,13,64
MA 20,24,132
TR 58,13,320
TR 60,13,96
MA 28,28,132
buffer_load_dwordx4 v5, s[16:19], s32 offen offset:1056 lds
s_add_u32 s32, s32, 65536
MA 24,28,128
TR 62,13,352
TR 64,13,128
MA 16,24,128
TR 66,13,384
TR 68,13,160
MA 32,32,128
TR 70,13,416
MA 40,36,128
buffer_load_dwordx4 v[120:123], v11, s[20:23], s33 offen sc1
MA 44,36,132
TR 72,13,192
TR 74,13,448
MA 36,32,132
TR 76,13,224
MA 52,40,132
TR 78,13,480
MA 60,44,132
buffer_load_dwordx4 v[124:127], v10, s[20:23], s33 offen sc1
s_add_u32 s33, s33, 1024
MA 56,44,128
MA 48,40,128
s_waitcnt lgkmcnt(0)
MA 0,48,80
TR 16,13,8448
s_add_u32 m0, s38, 50688
MA 8,52,80
buffer_load_dwordx4 v4, s[16:19], s32 offen lds
MA 12,52,84
TR 18,13,8704
TR 20,13,8480
MA 4,48,84
TR 22,13,8736
TR 24,13,8512
MA 20,56,84
TR 26,13,8768
TR 28,13,8544
MA 28,60,84
buffer_load_dwordx4 v5, s[16:19], s32 offen offset:1056 lds
s_add_u32 s32, s32, 65536
MA 24,60,80
TR 30,13,8800
TR 32,13,8576
MA 16,56,80
TR 34,13,8832
TR 36,13,8608
MA 32,64,80
TR 38,13,8864
MA 40,68,80
buffer_load_dwordx4 v[128:131], v11, s[20:23], s33 offen sc1
MA 44,68,84
TR 40,13,8640
TR 42,13,8896
MA 36,64,84
TR 44,13,8672
MA 52,72,84
TR 46,13,8928
MA 60,76,84
buffer_load_dwordx4 v[132:135], v10, s[20:23], s33 offen sc1
s_add_u32 s33, s33, 1024
MA 56,76,80
MA 48,72,80
v_min_u32 v161, 64, v15
buffer_load_dword v160, v161, s[48:51], s55 offen sc1
s_waitcnt vmcnt(13) lgkmcnt(0)
s_barrier
MA 0,16,88
TR 48,13,16896
s_add_u32 m0, s38, 0
MA 8,20,88
buffer_load_dwordx4 v4, s[16:19], s32 offen lds
MA 12,20,92
TR 50,13,17152
TR 52,13,16928
MA 4,16,92
TR 54,13,17184
TR 56,13,16960
MA 20,24,92
TR 58,13,17216
TR 60,13,16992
MA 28,28,92
buffer_load_dwordx4 v5, s[16:19], s32 offen offset:1056 lds
s_add_u32 s32, s32, 65536
MA 24,28,88
TR 62,13,17248
TR 64,13,17024
MA 16,24,88
TR 66,13,17280
TR 68,13,17056
MA 32,32,88
TR 70,13,17312
MA 40,36,88
buffer_load_dwordx4 v[80:83], v11, s[20:23], s33 offen sc1
MA 44,36,92
TR 72,13,17088
TR 74,13,17344
MA 36,32,92
TR 76,13,17120
MA 52,40,92
TR 78,13,17376
MA 60,44,92
buffer_load_dwordx4 v[84:87], v10, s[20:23], s33 offen sc1
s_add_u32 s33, s33, 1024
MA 56,44,88
MA 48,40,88
s_waitcnt lgkmcnt(0)
MA 0,48,96
TR 16,13,25344
s_add_u32 m0, s38, 8448
MA 8,52,96
buffer_load_dwordx4 v4, s[16:19], s32 offen lds
MA 12,52,100
TR 18,13,25600
TR 20,13,25376
MA 4,48,100
TR 22,13,25632
TR 24,13,25408
MA 20,56,100
TR 26,13,25664
TR 28,13,25440
MA 28,60,100
buffer_load_dwordx4 v5, s[16:19], s32 offen offset:1056 lds
s_sub_u32 s32, s32, 1507328
MA 24,60,96
TR 30,13,25696
TR 32,13,25472
MA 16,56,96
TR 34,13,25728
TR 36,13,25504
MA 32,64,96
TR 38,13,25760
MA 40,68,96
buffer_load_dwordx4 v[88:91], v11, s[20:23], s33 offen sc1
MA 44,68,100
TR 40,13,25536
TR 42,13,25792
MA 36,64,100
TR 44,13,25568
MA 52,72,100
TR 46,13,25824
MA 60,76,100
buffer_load_dwordx4 v[92:95], v10, s[20:23], s33 offen sc1
s_sub_u32 s33, s33, 23552
MA 56,76,96
MA 48,72,96
s_waitcnt vmcnt(8)
v_cmp_ne_u32 vcc, s100, v160
s_cbranch_vccnz L_p2g_slow
L_p2g_ok:
s_waitcnt vmcnt(13) lgkmcnt(0)
s_barrier
MA 0,16,104
TR 48,13,33792
s_add_u32 m0, s38, 16896
MA 8,20,104
buffer_load_dwordx4 v6, s[24:27], s34 offen lds
MA 12,20,108
TR 50,13,34048
TR 52,13,33824
MA 4,16,108
TR 54,13,34080
TR 56,13,33856
MA 20,24,108
TR 58,13,34112
TR 60,13,33888
MA 28,28,108
buffer_load_dwordx4 v7, s[24:27], s34 offen offset:1056 lds
s_add_u32 s34, s34, 65536
MA 24,28,104
TR 62,13,34144
TR 64,13,33920
MA 16,24,104
TR 66,13,34176
TR 68,13,33952
MA 32,32,104
TR 70,13,34208
MA 40,36,104
buffer_load_dwordx4 v[96:99], v11, s[28:31], s35 offen sc1
s_add_u32 s35, s35, 1024
MA 44,36,108
TR 72,13,33984
TR 74,13,34240
MA 36,32,108
TR 76,13,34016
MA 52,40,108
TR 78,13,34272
MA 60,44,108
buffer_load_dwordx4 v[100:103], v11, s[28:31], s36 offen sc1
s_add_u32 s36, s36, 1024
MA 56,44,104
MA 48,40,104
s_waitcnt lgkmcnt(0)
MA 0,48,112
TR 16,13,42240
s_add_u32 m0, s38, 25344
MA 8,52,112
buffer_load_dwordx4 v6, s[24:27], s34 offen lds
MA 12,52,116
TR 18,13,42496
TR 20,13,42272
MA 4,48,116
TR 22,13,42528
TR 24,13,42304
MA 20,56,116
TR 26,13,42560
TR 28,13,42336
MA 28,60,116
buffer_load_dwordx4 v7, s[24:27], s34 offen offset:1056 lds
s_add_u32 s34, s34, 65536
MA 24,60,112
TR 30,13,42592
TR 32,13,42368
MA 16,56,112
TR 34,13,42624
TR 36,13,42400
MA 32,64,112
TR 38,13,42656
MA 40,68,112
buffer_load_dwordx4 v[104:107], v11, s[28:31], s35 offen sc1
s_add_u32 s35, s35, 1024
MA 44,68,116
TR 40,13,42432
TR 42,13,42688
MA 36,64,116
TR 44,13,42464
MA 52,72,116
TR 46,13,42720
MA 60,76,116
buffer_load_dwordx4 v[108:111], v11, s[28:31], s36 offen sc1
s_add_u32 s36, s36, 1024
MA 56,76,112
MA 48,72,112
s_waitcnt vmcnt(12) lgkmcnt(0)
s_barrier
MA 0,16,120
TR 48,13,50688
s_add_u32 m0, s38, 33792
MA 8,20,120
buffer_load_dwordx4 v6, s[24:27], s34 offen lds
MA 12,20,124
TR 50,13,50944
TR 52,13,50720
MA 4,16,124
TR 54,13,50976
TR 56,13,50752
MA 20,24,124
TR 58,13,51008
TR 60,13,50784
MA 28,28,124
buffer_load_dwordx4 v7, s[24:27], s34 offen offset:1056 lds
s_add_u32 s34, s34, 98304
MA 24,28,120
TR 62,13,51040
TR 64,13,50816
MA 16,24,120
TR 66,13,51072
TR 68,13,50848
MA 32,32,120
TR 70,13,51104
MA 40,36,120
buffer_load_dwordx4 v[112:115], v11, s[28:31], s35 offen sc1
s_add_u32 s35, s35, 1024
MA 44,36,124
TR 72,13,50880
TR 74,13,51136
MA 36,32,124
TR 76,13,50912
MA 52,40,124
TR 78,13,51168
MA 60,44,124
buffer_load_dwordx4 v[116:119], v11, s[28:31], s36 offen sc1
s_add_u32 s36, s36, 1024
MA 56,44,120
MA 48,40,120
s_waitcnt lgkmcnt(0)
MA 0,48,128
TR 16,13,0
s_add_u32 m0, s38, 42240
MA 8,52,128
buffer_load_dwordx4 v6, s[24:27], s34 offen lds
MA 12,52,132
TR 18,13,256
TR 20,13,32
MA 4,48,132
TR 22,13,288
TR 24,13,64
MA 20,56,132
TR 26,13,320
TR 28,13,96
MA 28,60,132
buffer_load_dwordx4 v7, s[24:27], s34 offen offset:1056 lds
s_add_u32 s34, s34, 65536
MA 24,60,128
TR 30,13,352
TR 32,13,128
MA 16,56,128
TR 34,13,384
TR 36,13,160
MA 32,64,128
TR 38,13,416
MA 40,68,128
buffer_load_dwordx4 v[120:123], v11, s[28:31], s35 offen sc1
s_add_u32 s35, s35, 1024
MA 44,68,132
TR 40,13,192
TR 42,13,448
MA 36,64,132
TR 44,13,224
MA 52,72,132
TR 46,13,480
MA 60,76,132
buffer_load_dwordx4 v[124:127], v11, s[28:31], s36 offen sc1
s_add_u32 s36, s36, 1024
MA 56,76,128
MA 48,72,128
s_waitcnt vmcnt(12) lgkmcnt(0)
s_barrier
MA 0,16,80
TR 48,13,8448
s_add_u32 m0, s38, 50688
MA 8,20,80
buffer_load_dwordx4 v6, s[24:27], s34 offen lds
MA 12,20,84
TR 50,13,8704
TR 52,13,8480
MA 4,16,84
TR 54,13,8736
TR 56,13,8512
MA 20,24,84
TR 58,13,8768
TR 60,13,8544
MA 28,28,84
buffer_load_dwordx4 v7, s[24:27], s34 offen offset:1056 lds
s_add_u32 s34, s34, 65536
MA 24,28,80
TR 62,13,8800
TR 64,13,8576
MA 16,24,80
TR 66,13,8832
TR 68,13,8608
MA 32,32,80
TR 70,13,8864
MA 40,36,80
buffer_load_dwordx4 v[128:131], v11, s[28:31], s35 offen sc1
s_add_u32 s35, s35, 1024
MA 44,36,84
TR 72,13,8640
TR 74,13,8896
MA 36,32,84
TR 76,13,8672
MA 52,40,84
TR 78,13,8928
MA 60,44,84
buffer_load_dwordx4 v[132:135], v11, s[28:31], s36 offen sc1
s_add_u32 s36, s36, 1024
MA 56,44,80
MA 48,40,80
buffer_load_dword v160, v15, s[48:51], s55 offen sc1
s_waitcnt lgkmcnt(0)
MA 0,48,88
TR 16,13,16896
s_add_u32 m0, s38, 0
MA 8,52,88
buffer_load_dwordx4 v6, s[24:27], s34 offen lds
MA 12,52,92
TR 18,13,17152
TR 20,13,16928
MA 4,48,92
TR 22,13,17184
TR 24,13,16960
MA 20,56,92
TR 26,13,17216
TR 28,13,16992
MA 28,60,92
buffer_load_dwordx4 v7, s[24:27], s34 offen offset:1056 lds
s_sub_u32 s34, s34, 163840
MA 24,60,88
TR 30,13,17248
TR 32,13,17024
MA 16,56,88
TR 34,13,17280
TR 36,13,17056
MA 32,64,88
TR 38,13,17312
MA 40,68,88
buffer_load_dwordx4 v[80:83], v11, s[28:31], s35 offen sc1
s_add_u32 s35, s35, 1024
MA 44,68,92
TR 40,13,17088
TR 42,13,17344
MA 36,64,92
TR 44,13,17120
MA 52,72,92
TR 46,13,17376
MA 60,76,92
buffer_load_dwordx4 v[84:87], v11, s[28:31], s36 offen sc1
s_add_u32 s36, s36, 1024
MA 56,76,88
MA 48,72,88
s_waitcnt vmcnt(13) lgkmcnt(0)
s_barrier
MZ 64,16,96
TR 48,13,25344
s_add_u32 m0, s38, 8448
MZ 72,20,96
buffer_load_dwordx4 v8, s[24:27], s34 offen lds
MZ 76,20,100
TR 50,13,25600
TR 52,13,25376
MZ 68,16,100
TR 54,13,25632
TR 56,13,25408
MZ 84,24,100
TR 58,13,25664
TR 60,13,25440
MZ 92,28,100
buffer_load_dwordx4 v9, s[24:27], s34 offen offset:1056 lds
s_add_u32 s34, s34, 262144
MZ 88,28,96
TR 62,13,25696
TR 64,13,25472
MZ 80,24,96
TR 66,13,25728
TR 68,13,25504
MZ 96,32,96
TR 70,13,25760
MZ 104,36,96
buffer_load_dwordx2 v[88:89], v12, s[28:31], s35 offen sc1
buffer_load_dwordx2 v[90:91], v12, s[28:31], s35 offen offset:512 sc1
s_add_u32 s35, s35, 1024
MZ 108,36,100
TR 72,13,25536
TR 74,13,25792
MZ 100,32,100
TR 76,13,25568
MZ 116,40,100
TR 78,13,25824
MZ 124,44,100
buffer_load_dwordx2 v[92:93], v12, s[28:31], s36 offen sc1
buffer_load_dwordx2 v[94:95], v12, s[28:31], s36 offen offset:512 sc1
s_add_u32 s36, s36, 1024
MZ 120,44,96
MZ 112,40,96
s_waitcnt vmcnt(10)
v_cmp_ne_u32 vcc, s100, v160
s_cbranch_vccnz L_p2h_slow
L_p2h_ok:
s_waitcnt lgkmcnt(0)
MA 64,48,104
TR 16,13,33792
s_add_u32 m0, s38, 16896
MA 72,52,104
buffer_load_dwordx4 v6, s[24:27], s34 offen lds
MA 76,52,108
TR 18,13,34048
TR 20,13,33824
MA 68,48,108
TR 22,13,34080
TR 24,13,33856
MA 84,56,108
TR 26,13,34112
TR 28,13,33888
MA 92,60,108
buffer_load_dwordx4 v7, s[24:27], s34 offen offset:1056 lds
s_add_u32 s34, s34, 65536
MA 88,60,104
TR 30,13,34144
TR 32,13,33920
MA 80,56,104
TR 34,13,34176
TR 36,13,33952
MA 96,64,104
TR 38,13,34208
MA 104,68,104
buffer_load_dwordx4 v[96:99], v11, s[28:31], s35 offen sc1
s_add_u32 s35, s35, 1024
MA 108,68,108
TR 40,13,33984
TR 42,13,34240
MA 100,64,108
TR 44,13,34016
MA 116,72,108
TR 46,13,34272
MA 124,76,108
buffer_load_dwordx4 v[100:103], v11, s[28:31], s36 offen sc1
s_add_u32 s36, s36, 1024
MA 120,76,104
MA 112,72,104
s_mov_b32 s37, 3
.p2align 6
L_p2_0:
s_waitcnt vmcnt(14) lgkmcnt(0)
s_barrier
MA 64,16,112
TR 48,13,42240
s_add_u32 m0, s38, 25344
MA 72,20,112
buffer_load_dwordx4 v6, s[24:27], s34 offen lds
MA 76,20,116
TR 50,13,42496
TR 52,13,42272
MA 68,16,116
TR 54,13,42528
TR 56,13,42304
MA 84,24,116
TR 58,13,42560
TR 60,13,42336
MA 92,28,116
buffer_load_dwordx4 v7, s[24:27], s34 offen offset:1056 lds
s_add_u32 s34, s34, 65536
MA 88,28,112
TR 62,13,42592
TR 64,13,42368
MA 80,24,112
TR 66,13,42624
TR 68,13,42400
MA 96,32,112
TR 70,13,42656
MA 104,36,112
buffer_load_dwordx4 v[104:107], v11, s[28:31], s35 offen sc1
s_add_u32 s35, s35, 1024
MA 108,36,116
TR 72,13,42432
TR 74,13,42688
MA 100,32,116
TR 76,13,42464
MA 116,40,116
TR 78,13,42720
MA 124,44,116
buffer_load_dwordx4 v[108:111], v11, s[28:31], s36 offen sc1
s_add_u32 s36, s36, 1024
MA 120,44,112
MA 112,40,112
s_waitcnt lgkmcnt(0)
MA 64,48,120
TR 16,13,50688
s_add_u32 m0, s38, 33792
MA 72,52,120
buffer_load_dwordx4 v6, s[24:27], s34 offen lds
MA 76,52,124
TR 18,13,50944
TR 20,13,50720
MA 68,48,124
TR 22,13,50976
TR 24,13,50752
MA 84,56,124
TR 26,13,51008
TR 28,13,50784
MA 92,60,124
buffer_load_dwordx4 v7, s[24:27], s34 offen offset:1056 lds
s_add_u32 s34, s34, 98304
MA 88,60,120
TR 30,13,51040
TR 32,13,50816
MA 80,56,120
TR 34,13,51072
TR 36,13,50848
MA 96,64,120
TR 38,13,51104
MA 104,68,120
buffer_load_dwordx4 v[112:115], v11, s[28:31], s35 offen sc1
s_add_u32 s35, s35, 1024
MA 108,68,124
TR 40,13,50880
TR 42,13,51136
MA 100,64,124
TR 44,13,50912
MA 116,72,124
TR 46,13,51168
MA 124,76,124
buffer_load_dwordx4 v[116:119], v11, s[28:31], s36 offen sc1
s_add_u32 s36, s36, 1024
MA 120,76,120
MA 112,72,120
s_waitcnt vmcnt(12) lgkmcnt(0)
s_barrier
MA 64,16,128
TR 48,13,0
s_add_u32 m0, s38, 42240
MA 72,20,128
buffer_load_dwordx4 v6, s[24:27], s34 offen lds
MA 76,20,132
TR 50,13,256
TR 52,13,32
MA 68,16,132
TR 54,13,288
TR 56,13,64
MA 84,24,132
TR 58,13,320
TR 60,13,96
MA 92,28,132
buffer_load_dwordx4 v7, s[24:27], s34 offen offset:1056 lds
s_add_u32 s34, s34, 65536
MA 88,28,128
TR 62,13,352
TR 64,13,128
MA 80,24,128
TR 66,13,384
TR 68,13,160
MA 96,32,128
TR 70,13,416
MA 104,36,128
buffer_load_dwordx4 v[120:123], v11, s[28:31], s35 offen sc1
s_add_u32 s35, s35, 1024
MA 108,36,132
TR 72,13,192
TR 74,13,448
MA 100,32,132
TR 76,13,224
MA 116,40,132
TR 78,13,480
MA 124,44,132
buffer_load_dwordx4 v[124:127], v11, s[28:31], s36 offen sc1
s_add_u32 s36, s36, 1024
MA 120,44,128
MA 112,40,128
s_waitcnt lgkmcnt(0)
MA 64,48,80
TR 16,13,8448
s_add_u32 m0, s38, 50688
MA 72,52,80
buffer_load_dwordx4 v6, s[24:27], s34 offen lds
MA 76,52,84
TR 18,13,8704
TR 20,13,8480
MA 68,48,84
TR 22,13,8736
TR 24,13,8512
MA 84,56,84
TR 26,13,8768
TR 28,13,8544
MA 92,60,84
buffer_load_dwordx4 v7, s[24:27], s34 offen offset:1056 lds
s_add_u32 s34, s34, 65536
MA 88,60,80
TR 30,13,8800
TR 32,13,8576
MA 80,56,80
TR 34,13,8832
TR 36,13,8608
MA 96,64,80
TR 38,13,8864
MA 104,68,80
buffer_load_dwordx4 v[128:131], v11, s[28:31], s35 offen sc1
s_add_u32 s35, s35, 1024
MA 108,68,84
TR 40,13,8640
TR 42,13,8896
MA 100,64,84
TR 44,13,8672
MA 116,72,84
TR 46,13,8928
MA 124,76,84
buffer_load_dwordx4 v[132:135], v11, s[28:31], s36 offen sc1
s_add_u32 s36, s36, 1024
MA 120,76,80
MA 112,72,80
s_waitcnt vmcnt(12) lgkmcnt(0)
s_barrier
MA 64,16,88
TR 48,13,16896
s_add_u32 m0, s38, 0
MA 72,20,88
buffer_load_dwordx4 v6, s[24:27], s34 offen lds
MA 76,20,92
TR 50,13,17152
TR 52,13,16928
MA 68,16,92
TR 54,13,17184
TR 56,13,16960
MA 84,24,92
TR 58,13,17216
TR 60,13,16992
MA 92,28,92
buffer_load_dwordx4 v7, s[24:27], s34 offen offset:1056 lds
s_sub_u32 s34, s34, 163840
MA 88,28,88
TR 62,13,17248
TR 64,13,17024
MA 80,24,88
TR 66,13,17280
TR 68,13,17056
MA 96,32,88
TR 70,13,17312
MA 104,36,88
buffer_load_dwordx4 v[80:83], v11, s[28:31], s35 offen sc1
s_add_u32 s35, s35, 1024
MA 108,36,92
TR 72,13,17088
TR 74,13,17344
MA 100,32,92
TR 76,13,17120
MA 116,40,92
TR 78,13,17376
MA 124,44,92
buffer_load_dwordx4 v[84:87], v11, s[28:31], s36 offen sc1
s_add_u32 s36, s36, 1024
MA 120,44,88
MA 112,40,88
s_waitcnt lgkmcnt(0)
MA 64,48,96
TR 16,13,25344
s_add_u32 m0, s38, 8448
MA 72,52,96
buffer_load_dwordx4 v8, s[24:27], s34 offen lds
MA 76,52,100
TR 18,13,25600
TR 20,13,25376
MA 68,48,100
TR 22,13,25632
TR 24,13,25408
MA 84,56,100
TR 26,13,25664
TR 28,13,25440
MA 92,60,100
buffer_load_dwordx4 v9, s[24:27], s34 offen offset:1056 lds
s_add_u32 s34, s34, 262144
MA 88,60,96
TR 30,13,25696
TR 32,13,25472
MA 80,56,96
TR 34,13,25728
TR 36,13,25504
MA 96,64,96
TR 38,13,25760
MA 104,68,96
buffer_load_dwordx2 v[88:89], v12, s[28:31], s35 offen sc1
buffer_load_dwordx2 v[90:91], v12, s[28:31], s35 offen offset:512 sc1
s_add_u32 s35, s35, 1024
MA 108,68,100
TR 40,13,25536
TR 42,13,25792
MA 100,64,100
TR 44,13,25568
MA 116,72,100
TR 46,13,25824
MA 124,76,100
buffer_load_dwordx2 v[92:93], v12, s[28:31], s36 offen sc1
buffer_load_dwordx2 v[94:95], v12, s[28:31], s36 offen offset:512 sc1
s_add_u32 s36, s36, 1024
MA 120,76,96
MA 112,72,96
s_waitcnt vmcnt(14) lgkmcnt(0)
s_barrier
MA 64,16,104
TR 48,13,33792
s_add_u32 m0, s38, 16896
MA 72,20,104
buffer_load_dwordx4 v6, s[24:27], s34 offen lds
MA 76,20,108
TR 50,13,34048
TR 52,13,33824
MA 68,16,108
TR 54,13,34080
TR 56,13,33856
MA 84,24,108
TR 58,13,34112
TR 60,13,33888
MA 92,28,108
buffer_load_dwordx4 v7, s[24:27], s34 offen offset:1056 lds
s_add_u32 s34, s34, 65536
MA 88,28,104
TR 62,13,34144
TR 64,13,33920
MA 80,24,104
TR 66,13,34176
TR 68,13,33952
MA 96,32,104
TR 70,13,34208
MA 104,36,104
buffer_load_dwordx4 v[96:99], v11, s[28:31], s35 offen sc1
s_add_u32 s35, s35, 1024
MA 108,36,108
TR 72,13,33984
TR 74,13,34240
MA 100,32,108
TR 76,13,34016
MA 116,40,108
TR 78,13,34272
MA 124,44,108
buffer_load_dwordx4 v[100:103], v11, s[28:31], s36 offen sc1
s_add_u32 s36, s36, 1024
MA 120,44,104
MA 112,40,104
s_waitcnt lgkmcnt(0)
MA 64,48,112
TR 16,13,42240
s_add_u32 m0, s38, 25344
MA 72,52,112
buffer_load_dwordx4 v6, s[24:27], s34 offen lds
MA 76,52,116
TR 18,13,42496
TR 20,13,42272
MA 68,48,116
TR 22,13,42528
TR 24,13,42304
MA 84,56,116
TR 26,13,42560
TR 28,13,42336
MA 92,60,116
buffer_load_dwordx4 v7, s[24:27], s34 offen offset:1056 lds
s_add_u32 s34, s34, 65536
MA 88,60,112
TR 30,13,42592
TR 32,13,42368
MA 80,56,112
TR 34,13,42624
TR 36,13,42400
MA 96,64,112
TR 38,13,42656
MA 104,68,112
buffer_load_dwordx4 v[104:107], v11, s[28:31], s35 offen sc1
s_add_u32 s35, s35, 1024
MA 108,68,116
TR 40,13,42432
TR 42,13,42688
MA 100,64,116
TR 44,13,42464
MA 116,72,116
TR 46,13,42720
MA 124,76,116
buffer_load_dwordx4 v[108:111], v11, s[28:31], s36 offen sc1
s_add_u32 s36, s36, 1024
MA 120,76,112
MA 112,72,112
s_waitcnt vmcnt(14) lgkmcnt(0)
s_barrier
MA 64,16,120
TR 48,13,50688
s_add_u32 m0, s38, 33792
MA 72,20,120
buffer_load_dwordx4 v6, s[24:27], s34 offen lds
MA 76,20,124
TR 50,13,50944
TR 52,13,50720
MA 68,16,124
TR 54,13,50976
TR 56,13,50752
MA 84,24,124
TR 58,13,51008
TR 60,13,50784
MA 92,28,124
buffer_load_dwordx4 v7, s[24:27], s34 offen offset:1056 lds
s_add_u32 s34, s34, 98304
MA 88,28,120
TR 62,13,51040
TR 64,13,50816
MA 80,24,120
TR 66,13,51072
TR 68,13,50848
MA 96,32,120
TR 70,13,51104
MA 104,36,120
buffer_load_dwordx4 v[112:115], v11, s[28:31], s35 offen sc1
s_add_u32 s35, s35, 1024
MA 108,36,124
TR 72,13,50880
TR 74,13,51136
MA 100,32,124
TR 76,13,50912
MA 116,40,124
TR 78,13,51168
MA 124,44,124
buffer_load_dwordx4 v[116:119], v11, s[28:31], s36 offen sc1
s_add_u32 s36, s36, 1024
MA 120,44,120
MA 112,40,120
s_waitcnt lgkmcnt(0)
MA 64,48,128
TR 16,13,0
s_add_u32 m0, s38, 42240
MA 72,52,128
buffer_load_dwordx4 v6, s[24:27], s34 offen lds
MA 76,52,132
TR 18,13,256
TR 20,13,32
MA 68,48,132
TR 22,13,288
TR 24,13,64
MA 84,56,132
TR 26,13,320
TR 28,13,96
MA 92,60,132
buffer_load_dwordx4 v7, s[24:27], s34 offen offset:1056 lds
s_add_u32 s34, s34, 65536
MA 88,60,128
TR 30,13,352
TR 32,13,128
MA 80,56,128
TR 34,13,384
TR 36,13,160
MA 96,64,128
TR 38,13,416
MA 104,68,128
buffer_load_dwordx4 v[120:123], v11, s[28:31], s35 offen sc1
s_add_u32 s35, s35, 1024
MA 108,68,132
TR 40,13,192
TR 42,13,448
MA 100,64,132
TR 44,13,224
MA 116,72,132
TR 46,13,480
MA 124,76,132
buffer_load_dwordx4 v[124:127], v11, s[28:31], s36 offen sc1
s_add_u32 s36, s36, 1024
MA 120,76,128
MA 112,72,128
s_waitcnt vmcnt(12) lgkmcnt(0)
s_barrier
MA 64,16,80
TR 48,13,8448
s_add_u32 m0, s38, 50688
MA 72,20,80
buffer_load_dwordx4 v6, s[24:27], s34 offen lds
MA 76,20,84
TR 50,13,8704
TR 52,13,8480
MA 68,16,84
TR 54,13,8736
TR 56,13,8512
MA 84,24,84
TR 58,13,8768
TR 60,13,8544
MA 92,28,84
buffer_load_dwordx4 v7, s[24:27], s34 offen offset:1056 lds
s_add_u32 s34, s34, 65536
MA 88,28,80
TR 62,13,8800
TR 64,13,8576
MA 80,24,80
TR 66,13,8832
TR 68,13,8608
MA 96,32,80
TR 70,13,8864
MA 104,36,80
buffer_load_dwordx4 v[128:131], v11, s[28:31], s35 offen sc1
s_add_u32 s35, s35, 1024
MA 108,36,84
TR 72,13,8640
TR 74,13,8896
MA 100,32,84
TR 76,13,8672
MA 116,40,84
TR 78,13,8928
MA 124,44,84
buffer_load_dwordx4 v[132:135], v11, s[28:31], s36 offen sc1
s_add_u32 s36, s36, 1024
MA 120,44,80
MA 112,40,80
s_waitcnt lgkmcnt(0)
MA 64,48,88
TR 16,13,16896
s_add_u32 m0, s38, 0
MA 72,52,88
buffer_load_dwordx4 v6, s[24:27], s34 offen lds
MA 76,52,92
TR 18,13,17152
TR 20,13,16928
MA 68,48,92
TR 22,13,17184
TR 24,13,16960
MA 84,56,92
TR 26,13,17216
TR 28,13,16992
MA 92,60,92
buffer_load_dwordx4 v7, s[24:27], s34 offen offset:1056 lds
s_sub_u32 s34, s34, 163840
MA 88,60,88
TR 30,13,17248
TR 32,13,17024
MA 80,56,88
TR 34,13,17280
TR 36,13,17056
MA 96,64,88
TR 38,13,17312
MA 104,68,88
buffer_load_dwordx4 v[80:83], v11, s[28:31], s35 offen sc1
s_add_u32 s35, s35, 1024
MA 108,68,92
TR 40,13,17088
TR 42,13,17344
MA 100,64,92
TR 44,13,17120
MA 116,72,92
TR 46,13,17376
MA 124,76,92
buffer_load_dwordx4 v[84:87], v11, s[28:31], s36 offen sc1
s_add_u32 s36, s36, 1024
MA 120,76,88
MA 112,72,88
s_waitcnt vmcnt(12) lgkmcnt(0)
s_barrier
MA 64,16,96
TR 48,13,25344
s_add_u32 m0, s38, 8448
MA 72,20,96
buffer_load_dwordx4 v8, s[24:27], s34 offen lds
MA 76,20,100
TR 50,13,25600
TR 52,13,25376
MA 68,16,100
TR 54,13,25632
TR 56,13,25408
MA 84,24,100
TR 58,13,25664
TR 60,13,25440
MA 92,28,100
buffer_load_dwordx4 v9, s[24:27], s34 offen offset:1056 lds
s_add_u32 s34, s34, 262144
MA 88,28,96
TR 62,13,25696
TR 64,13,25472
MA 80,24,96
TR 66,13,25728
TR 68,13,25504
MA 96,32,96
TR 70,13,25760
MA 104,36,96
buffer_load_dwordx2 v[88:89], v12, s[28:31], s35 offen sc1
buffer_load_dwordx2 v[90:91], v12, s[28:31], s35 offen offset:512 sc1
s_add_u32 s35, s35, 1024
MA 108,36,100
TR 72,13,25536
TR 74,13,25792
MA 100,32,100
TR 76,13,25568
MA 116,40,100
TR 78,13,25824
MA 124,44,100
buffer_load_dwordx2 v[92:93], v12, s[28:31], s36 offen sc1
buffer_load_dwordx2 v[94:95], v12, s[28:31], s36 offen offset:512 sc1
s_add_u32 s36, s36, 1024
MA 120,44,96
MA 112,40,96
s_waitcnt lgkmcnt(0)
MA 64,48,104
TR 16,13,33792
s_add_u32 m0, s38, 16896
MA 72,52,104
buffer_load_dwordx4 v6, s[24:27], s34 offen lds
MA 76,52,108
TR 18,13,34048
TR 20,13,33824
MA 68,48,108
TR 22,13,34080
TR 24,13,33856
MA 84,56,108
TR 26,13,34112
TR 28,13,33888
MA 92,60,108
buffer_load_dwordx4 v7, s[24:27], s34 offen offset:1056 lds
s_add_u32 s34, s34, 65536
MA 88,60,104
TR 30,13,34144
TR 32,13,33920
MA 80,56,104
TR 34,13,34176
TR 36,13,33952
MA 96,64,104
TR 38,13,34208
MA 104,68,104
buffer_load_dwordx4 v[96:99], v11, s[28:31], s35 offen sc1
s_add_u32 s35, s35, 1024
MA 108,68,108
TR 40,13,33984
TR 42,13,34240
MA 100,64,108
TR 44,13,34016
MA 116,72,108
TR 46,13,34272
MA 124,76,108
buffer_load_dwordx4 v[100:103], v11, s[28:31], s36 offen sc1
s_add_u32 s36, s36, 1024
MA 120,76,104
MA 112,72,104
s_sub_u32 s37, s37, 1
s_cmp_lg_u32 s37, 0
s_cbranch_scc1 L_p2_0
s_waitcnt vmcnt(14) lgkmcnt(0)
s_barrier
MA 64,16,112
TR 48,13,42240
s_add_u32 m0, s38, 25344
MA 72,20,112
buffer_load_dwordx4 v6, s[24:27], s34 offen lds
MA 76,20,116
TR 50,13,42496
TR 52,13,42272
MA 68,16,116
TR 54,13,42528
TR 56,13,42304
MA 84,24,116
TR 58,13,42560
TR 60,13,42336
MA 92,28,116
buffer_load_dwordx4 v7, s[24:27], s34 offen offset:1056 lds
s_add_u32 s34, s34, 65536
MA 88,28,112
TR 62,13,42592
TR 64,13,42368
MA 80,24,112
TR 66,13,42624
TR 68,13,42400
MA 96,32,112
TR 70,13,42656
MA 104,36,112
buffer_load_dwordx4 v[104:107], v11, s[28:31], s35 offen sc1
s_add_u32 s35, s35, 1024
MA 108,36,116
TR 72,13,42432
TR 74,13,42688
MA 100,32,116
TR 76,13,42464
MA 116,40,116
TR 78,13,42720
MA 124,44,116
buffer_load_dwordx4 v[108:111], v11, s[28:31], s36 offen sc1
s_add_u32 s36, s36, 1024
MA 120,44,112
MA 112,40,112
s_waitcnt lgkmcnt(0)
MA 64,48,120
TR 16,13,50688
s_add_u32 m0, s38, 33792
MA 72,52,120
buffer_load_dwordx4 v6, s[24:27], s34 offen lds
MA 76,52,124
TR 18,13,50944
TR 20,13,50720
MA 68,48,124
TR 22,13,50976
TR 24,13,50752
MA 84,56,124
TR 26,13,51008
TR 28,13,50784
MA 92,60,124
buffer_load_dwordx4 v7, s[24:27], s34 offen offset:1056 lds
s_add_u32 s34, s34, 98304
MA 88,60,120
TR 30,13,51040
TR 32,13,50816
MA 80,56,120
TR 34,13,51072
TR 36,13,50848
MA 96,64,120
TR 38,13,51104
MA 104,68,120
buffer_load_dwordx4 v[112:115], v11, s[28:31], s35 offen sc1
s_add_u32 s35, s35, 1024
MA 108,68,124
TR 40,13,50880
TR 42,13,51136
MA 100,64,124
TR 44,13,50912
MA 116,72,124
TR 46,13,51168
MA 124,76,124
buffer_load_dwordx4 v[116:119], v11, s[28:31], s36 offen sc1
s_add_u32 s36, s36, 1024
MA 120,76,120
MA 112,72,120
buffer_load_dword v3, v15, s[48:51], s54 offen sc1
s_waitcnt vmcnt(13) lgkmcnt(0)
s_barrier
MA 64,16,128
TR 48,13,0
s_add_u32 m0, s38, 42240
MA 72,20,128
buffer_load_dwordx4 v6, s[24:27], s34 offen lds
MA 76,20,132
TR 50,13,256
TR 52,13,32
MA 68,16,132
TR 54,13,288
TR 56,13,64
MA 84,24,132
TR 58,13,320
TR 60,13,96
MA 92,28,132
buffer_load_dwordx4 v7, s[24:27], s34 offen offset:1056 lds
s_add_u32 s34, s34, 65536
MA 88,28,128
TR 62,13,352
TR 64,13,128
MA 80,24,128
TR 66,13,384
TR 68,13,160
MA 96,32,128
TR 70,13,416
MA 104,36,128
buffer_load_dwordx4 v[120:123], v11, s[28:31], s35 offen sc1
s_add_u32 s35, s35, 1024
MA 108,36,132
TR 72,13,192
TR 74,13,448
MA 100,32,132
TR 76,13,224
MA 116,40,132
TR 78,13,480
MA 124,44,132
buffer_load_dwordx4 v[124:127], v11, s[28:31], s36 offen sc1
s_add_u32 s36, s36, 1024
MA 120,44,128
MA 112,40,128
s_waitcnt lgkmcnt(0)
MA 64,48,80
TR 16,13,8448
s_add_u32 m0, s38, 50688
MA 72,52,80
buffer_load_dwordx4 v6, s[24:27], s34 offen lds
MA 76,52,84
TR 18,13,8704
TR 20,13,8480
MA 68,48,84
TR 22,13,8736
TR 24,13,8512
MA 84,56,84
TR 26,13,8768
TR 28,13,8544
MA 92,60,84
buffer_load_dwordx4 v7, s[24:27], s34 offen offset:1056 lds
s_add_u32 s34, s34, 65536
MA 88,60,80
TR 30,13,8800
TR 32,13,8576
MA 80,56,80
TR 34,13,8832
TR 36,13,8608
MA 96,64,80
TR 38,13,8864
MA 104,68,80
buffer_load_dwordx4 v[128:131], v11, s[28:31], s35 offen sc1
s_add_u32 s35, s35, 1024
MA 108,68,84
TR 40,13,8640
TR 42,13,8896
MA 100,64,84
TR 44,13,8672
MA 116,72,84
TR 46,13,8928
MA 124,76,84
buffer_load_dwordx4 v[132:135], v11, s[28:31], s36 offen sc1
s_add_u32 s36, s36, 1024
MA 120,76,80
MA 112,72,80
s_waitcnt vmcnt(13) lgkmcnt(0)
s_barrier
MA 64,16,88
TR 48,13,16896
s_add_u32 m0, s38, 0
MA 72,20,88
buffer_load_dwordx4 v6, s[24:27], s34 offen lds
MA 76,20,92
TR 50,13,17152
TR 52,13,16928
MA 68,16,92
TR 54,13,17184
TR 56,13,16960
MA 84,24,92
TR 58,13,17216
TR 60,13,16992
MA 92,28,92
buffer_load_dwordx4 v7, s[24:27], s34 offen offset:1056 lds
s_sub_u32 s34, s34, 163840
MA 88,28,88
TR 62,13,17248
TR 64,13,17024
MA 80,24,88
TR 66,13,17280
TR 68,13,17056
MA 96,32,88
TR 70,13,17312
MA 104,36,88
buffer_load_dwordx4 v[80:83], v11, s[28:31], s35 offen sc1
s_add_u32 s35, s35, 1024
MA 108,36,92
TR 72,13,17088
TR 74,13,17344
MA 100,32,92
TR 76,13,17120
MA 116,40,92
TR 78,13,17376
MA 124,44,92
buffer_load_dwordx4 v[84:87], v11, s[28:31], s36 offen sc1
s_add_u32 s36, s36, 1024
MA 120,44,88
MA 112,40,88
s_waitcnt lgkmcnt(0)
MA 64,48,96
TR 16,13,25344
s_add_u32 m0, s38, 8448
MA 72,52,96
buffer_load_dwordx4 v8, s[24:27], s34 offen lds
MA 76,52,100
TR 18,13,25600
TR 20,13,25376
MA 68,48,100
TR 22,13,25632
TR 24,13,25408
MA 84,56,100
TR 26,13,25664
TR 28,13,25440
MA 92,60,100
buffer_load_dwordx4 v9, s[24:27], s34 offen offset:1056 lds
s_add_u32 s34, s34, 262144
MA 88,60,96
TR 30,13,25696
TR 32,13,25472
MA 80,56,96
TR 34,13,25728
TR 36,13,25504
MA 96,64,96
TR 38,13,25760
MA 104,68,96
buffer_load_dwordx2 v[88:89], v12, s[28:31], s35 offen sc1
buffer_load_dwordx2 v[90:91], v12, s[28:31], s35 offen offset:512 sc1
s_add_u32 s35, s35, 1024
MA 108,68,100
TR 40,13,25536
TR 42,13,25792
MA 100,64,100
TR 44,13,25568
MA 116,72,100
TR 46,13,25824
MA 124,76,100
buffer_load_dwordx2 v[92:93], v12, s[28:31], s36 offen sc1
buffer_load_dwordx2 v[94:95], v12, s[28:31], s36 offen offset:512 sc1
s_add_u32 s36, s36, 1024
MA 120,76,96
MA 112,72,96
s_waitcnt vmcnt(18)
v_cmp_ne_u32 vcc, s100, v3
s_cbranch_vccnz L_p2o_slow
L_p2o_ok:
s_waitcnt vmcnt(14) lgkmcnt(0)
s_barrier
MA 64,16,104
TR 48,13,33792
s_add_u32 m0, s38, 16896
MA 72,20,104
buffer_load_dwordx4 v4, s[16:19], s32 offen lds
MA 76,20,108
TR 50,13,34048
TR 52,13,33824
MA 68,16,108
TR 54,13,34080
TR 56,13,33856
MA 84,24,108
TR 58,13,34112
TR 60,13,33888
MA 92,28,108
buffer_load_dwordx4 v5, s[16:19], s32 offen offset:1056 lds
s_add_u32 s32, s32, 65536
MA 88,28,104
TR 62,13,34144
TR 64,13,33920
MA 80,24,104
TR 66,13,34176
TR 68,13,33952
MA 96,32,104
TR 70,13,34208
MA 104,36,104
buffer_load_dwordx4 v[96:99], v11, s[20:23], s33 offen sc1
MA 108,36,108
TR 72,13,33984
TR 74,13,34240
MA 100,32,108
TR 76,13,34016
MA 116,40,108
TR 78,13,34272
MA 124,44,108
buffer_load_dwordx4 v[100:103], v10, s[20:23], s33 offen sc1
s_add_u32 s33, s33, 1024
MA 120,44,104
MA 112,40,104
s_waitcnt lgkmcnt(0)
MA 64,48,112
TR 16,13,42240
s_add_u32 m0, s38, 25344
MA 72,52,112
buffer_load_dwordx4 v4, s[16:19], s32 offen lds
MA 76,52,116
TR 18,13,42496
TR 20,13,42272
MA 68,48,116
TR 22,13,42528
TR 24,13,42304
MA 84,56,116
TR 26,13,42560
TR 28,13,42336
MA 92,60,116
buffer_load_dwordx4 v5, s[16:19], s32 offen offset:1056 lds
s_add_u32 s32, s32, 65536
MA 88,60,112
TR 30,13,42592
TR 32,13,42368
MA 80,56,112
TR 34,13,42624
TR 36,13,42400
MA 96,64,112
TR 38,13,42656
MA 104,68,112
buffer_load_dwordx4 v[104:107], v11, s[20:23], s33 offen sc1
MA 108,68,116
TR 40,13,42432
TR 42,13,42688
MA 100,64,116
TR 44,13,42464
MA 116,72,116
TR 46,13,42720
MA 124,76,116
buffer_load_dwordx4 v[108:111], v10, s[20:23], s33 offen sc1
s_add_u32 s33, s33, 1024
MA 120,76,112
MA 112,72,112
s_waitcnt vmcnt(14) lgkmcnt(0)
s_barrier
MA 64,16,120
TR 48,13,50688
s_add_u32 m0, s38, 33792
MA 72,20,120
buffer_load_dwordx4 v4, s[16:19], s32 offen lds
MA 76,20,124
TR 50,13,50944
TR 52,13,50720
MA 68,16,124
TR 54,13,50976
TR 56,13,50752
MA 84,24,124
TR 58,13,51008
TR 60,13,50784
MA 92,28,124
buffer_load_dwordx4 v5, s[16:19], s32 offen offset:1056 lds
s_add_u32 s32, s32, 65536
MA 88,28,120
TR 62,13,51040
TR 64,13,50816
MA 80,24,120
TR 66,13,51072
TR 68,13,50848
MA 96,32,120
TR 70,13,51104
MA 104,36,120
buffer_load_dwordx4 v[112:115], v11, s[20:23], s33 offen sc1
MA 108,36,124
TR 72,13,50880
TR 74,13,51136
MA 100,32,124
TR 76,13,50912
MA 116,40,124
TR 78,13,51168
MA 124,44,124
buffer_load_dwordx4 v[116:119], v10, s[20:23], s33 offen sc1
s_add_u32 s33, s33, 1024
MA 120,44,120
MA 112,40,120
s_waitcnt lgkmcnt(0)
MA 64,48,128
TR 16,13,0
s_add_u32 m0, s38, 42240
MA 72,52,128
buffer_load_dwordx4 v4, s[16:19], s32 offen lds
MA 76,52,132
TR 18,13,256
TR 20,13,32
MA 68,48,132
TR 22,13,288
TR 24,13,64
MA 84,56,132
TR 26,13,320
TR 28,13,96
MA 92,60,132
buffer_load_dwordx4 v5, s[16:19], s32 offen offset:1056 lds
s_add_u32 s32, s32, 327680
MA 88,60,128
TR 30,13,352
TR 32,13,128
MA 80,56,128
TR 34,13,384
TR 36,13,160
MA 96,64,128
TR 38,13,416
MA 104,68,128
buffer_load_dwordx4 v[120:123], v11, s[20:23], s33 offen sc1
MA 108,68,132
TR 40,13,192
TR 42,13,448
MA 100,64,132
TR 44,13,224
MA 116,72,132
TR 46,13,480
MA 124,76,132
buffer_load_dwordx4 v[124:127], v10, s[20:23], s33 offen sc1
s_add_u32 s33, s33, 5120
MA 120,76,128
MA 112,72,128
s_waitcnt vmcnt(12) lgkmcnt(0)
s_barrier
MA 64,16,80
TR 48,13,8448
s_add_u32 m0, s38, 50688
MA 72,20,80
buffer_load_dwordx4 v4, s[16:19], s32 offen lds
MA 76,20,84
TR 50,13,8704
TR 52,13,8480
MA 68,16,84
TR 54,13,8736
TR 56,13,8512
MA 84,24,84
TR 58,13,8768
TR 60,13,8544
MA 92,28,84
buffer_load_dwordx4 v5, s[16:19], s32 offen offset:1056 lds
s_add_u32 s32, s32, 65536
MA 88,28,80
TR 62,13,8800
TR 64,13,8576
MA 80,24,80
TR 66,13,8832
TR 68,13,8608
MA 96,32,80
TR 70,13,8864
MA 104,36,80
buffer_load_dwordx4 v[128:131], v11, s[20:23], s33 offen sc1
MA 108,36,84
TR 72,13,8640
TR 74,13,8896
MA 100,32,84
TR 76,13,8672
MA 116,40,84
TR 78,13,8928
MA 124,44,84
buffer_load_dwordx4 v[132:135], v10, s[20:23], s33 offen sc1
s_add_u32 s33, s33, 1024
MA 120,44,80
MA 112,40,80
s_waitcnt lgkmcnt(0)
MA 64,48,88
TR 16,13,16896
s_add_u32 m0, s38, 0
MA 72,52,88
buffer_load_dwordx4 v4, s[16:19], s32 offen lds
MA 76,52,92
TR 18,13,17152
TR 20,13,16928
MA 68,48,92
TR 22,13,17184
TR 24,13,16960
MA 84,56,92
TR 26,13,17216
TR 28,13,16992
MA 92,60,92
buffer_load_dwordx4 v5, s[16:19], s32 offen offset:1056 lds
s_add_u32 s32, s32, 65536
MA 88,60,88
TR 30,13,17248
TR 32,13,17024
MA 80,56,88
TR 34,13,17280
TR 36,13,17056
MA 96,64,88
TR 38,13,17312
MA 104,68,88
buffer_load_dwordx4 v[80:83], v11, s[20:23], s33 offen sc1
MA 108,68,92
TR 40,13,17088
TR 42,13,17344
MA 100,64,92
TR 44,13,17120
MA 116,72,92
TR 46,13,17376
MA 124,76,92
buffer_load_dwordx4 v[84:87], v10, s[20:23], s33 offen sc1
s_add_u32 s33, s33, 1024
MA 120,76,88
MA 112,72,88
s_waitcnt vmcnt(12) lgkmcnt(0)
s_barrier
MA 0,16,96
TR 48,13,25344
s_add_u32 m0, s38, 8448
MA 8,20,96
buffer_load_dwordx4 v4, s[16:19], s32 offen lds
MA 12,20,100
TR 50,13,25600
TR 52,13,25376
MA 4,16,100
TR 54,13,25632
TR 56,13,25408
MA 20,24,100
TR 58,13,25664
TR 60,13,25440
MA 28,28,100
buffer_load_dwordx4 v5, s[16:19], s32 offen offset:1056 lds
s_add_u32 s32, s32, 65536
MA 24,28,96
TR 62,13,25696
TR 64,13,25472
MA 16,24,96
TR 66,13,25728
TR 68,13,25504
MA 32,32,96
TR 70,13,25760
MA 40,36,96
buffer_load_dwordx4 v[88:91], v11, s[20:23], s33 offen sc1
MA 44,36,100
TR 72,13,25536
TR 74,13,25792
MA 36,32,100
TR 76,13,25568
MA 52,40,100
TR 78,13,25824
MA 60,44,100
buffer_load_dwordx4 v[92:95], v10, s[20:23], s33 offen sc1
s_add_u32 s33, s33, 1024
MA 56,44,96
MA 48,40,96
s_waitcnt lgkmcnt(0)
MA 0,48,104
TR 16,13,33792
s_add_u32 m0, s38, 16896
MA 8,52,104
buffer_load_dwordx4 v4, s[16:19], s32 offen lds
MA 12,52,108
TR 18,13,34048
TR 20,13,33824
AR 192,64
AR 193,65
AR 194,66
MA 4,48,108
TR 22,13,34080
TR 24,13,33856
AR 195,67
AR 196,68
AR 197,69
MA 20,56,108
TR 26,13,34112
TR 28,13,33888
v_mul_f32 v176, s60, v192
v_mul_f32 v177, s60, v193
MA 28,60,108
buffer_load_dwordx4 v5, s[16:19], s32 offen offset:1056 lds
s_add_u32 s32, s32, 327680
v_mul_f32 v178, s60, v194
v_mul_f32 v179, s60, v195
v_mul_f32 v180, s60, v196
MA 24,60,104
TR 30,13,34144
TR 32,13,33920
v_mul_f32 v181, s60, v197
v_exp_f32 v176, v176
MA 16,56,104
TR 34,13,34176
TR 36,13,33952
v_exp_f32 v177, v177
v_exp_f32 v178, v178
v_exp_f32 v179, v179
MA 32,64,104
TR 38,13,34208
v_exp_f32 v180, v180
v_exp_f32 v181, v181
MA 40,68,104
buffer_load_dwordx4 v[96:99], v11, s[20:23], s33 offen sc1
v_add_f32 v176, 1.0, v176
v_add_f32 v177, 1.0, v177
v_add_f32 v178, 1.0, v178
MA 44,68,108
TR 40,13,33984
TR 42,13,34240
v_add_f32 v179, 1.0, v179
v_add_f32 v180, 1.0, v180
v_add_f32 v181, 1.0, v181
MA 36,64,108
TR 44,13,34016
v_rcp_f32 v176, v176
v_rcp_f32 v177, v177
MA 52,72,108
TR 46,13,34272
v_rcp_f32 v178, v178
v_rcp_f32 v179, v179
v_rcp_f32 v180, v180
MA 60,76,108
buffer_load_dwordx4 v[100:103], v10, s[20:23], s33 offen sc1
s_add_u32 s33, s33, 5120
v_rcp_f32 v181, v181
v_mul_f32 v192, v192, v176
MA 56,76,104
v_mul_f32 v193, v193, v177
v_mul_f32 v194, v194, v178
v_mul_f32 v195, v195, v179
MA 48,72,104
v_mul_f32 v196, v196, v180
v_mul_f32 v197, v197, v181
s_waitcnt vmcnt(12) lgkmcnt(0)
s_barrier
MA 0,16,112
TR 48,13,42240
s_add_u32 m0, s38, 25344
MA 8,20,112
buffer_load_dwordx4 v4, s[16:19], s32 offen lds
MA 12,20,116
TR 50,13,42496
TR 52,13,42272
AR 198,70
AR 199,71
AR 200,72
MA 4,16,116
TR 54,13,42528
TR 56,13,42304
AR 201,73
AR 202,74
AR 203,75
MA 20,24,116
TR 58,13,42560
TR 60,13,42336
v_mul_f32 v176, s60, v198
v_mul_f32 v177, s60, v199
MA 28,28,116
buffer_load_dwordx4 v5, s[16:19], s32 offen offset:1056 lds
s_add_u32 s32, s32, 65536
v_mul_f32 v178, s60, v200
v_mul_f32 v179, s60, v201
v_mul_f32 v180, s60, v202
MA 24,28,112
TR 62,13,42592
TR 64,13,42368
v_mul_f32 v181, s60, v203
v_exp_f32 v176, v176
MA 16,24,112
TR 66,13,42624
TR 68,13,42400
v_exp_f32 v177, v177
v_exp_f32 v178, v178
v_exp_f32 v179, v179
MA 32,32,112
TR 70,13,42656
v_exp_f32 v180, v180
v_exp_f32 v181, v181
MA 40,36,112
buffer_load_dwordx4 v[104:107], v11, s[20:23], s33 offen sc1
v_add_f32 v176, 1.0, v176
v_add_f32 v177, 1.0, v177
v_add_f32 v178, 1.0, v178
MA 44,36,116
TR 72,13,42432
TR 74,13,42688
v_add_f32 v179, 1.0, v179
v_add_f32 v180, 1.0, v180
v_add_f32 v181, 1.0, v181
MA 36,32,116
TR 76,13,42464
v_rcp_f32 v176, v176
v_rcp_f32 v177, v177
MA 52,40,116
TR 78,13,42720
v_rcp_f32 v178, v178
v_rcp_f32 v179, v179
v_rcp_f32 v180, v180
MA 60,44,116
buffer_load_dwordx4 v[108:111], v10, s[20:23], s33 offen sc1
s_add_u32 s33, s33, 1024
v_rcp_f32 v181, v181
v_mul_f32 v198, v198, v176
MA 56,44,112
v_mul_f32 v199, v199, v177
v_mul_f32 v200, v200, v178
v_mul_f32 v201, v201, v179
MA 48,40,112
v_mul_f32 v202, v202, v180
v_mul_f32 v203, v203, v181
s_waitcnt lgkmcnt(0)
MA 0,48,120
TR 16,13,50688
s_add_u32 m0, s38, 33792
MA 8,52,120
buffer_load_dwordx4 v4, s[16:19], s32 offen lds
MA 12,52,124
TR 18,13,50944
TR 20,13,50720
AR 204,76
AR 205,77
AR 206,78
MA 4,48,124
TR 22,13,50976
TR 24,13,50752
AR 207,79
AR 208,80
AR 209,81
MA 20,56,124
TR 26,13,51008
TR 28,13,50784
v_mul_f32 v176, s60, v204
v_mul_f32 v177, s60, v205
MA 28,60,124
buffer_load_dwordx4 v5, s[16:19], s32 offen offset:1056 lds
s_add_u32 s32, s32, 65536
v_mul_f32 v178, s60, v206
v_mul_f32 v179, s60, v207
v_mul_f32 v180, s60, v208
MA 24,60,120
TR 30,13,51040
TR 32,13,50816
v_mul_f32 v181, s60, v209
v_exp_f32 v176, v176
MA 16,56,120
TR 34,13,51072
TR 36,13,50848
v_exp_f32 v177, v177
v_exp_f32 v178, v178
v_exp_f32 v179, v179
MA 32,64,120
TR 38,13,51104
v_exp_f32 v180, v180
v_exp_f32 v181, v181
MA 40,68,120
buffer_load_dwordx4 v[112:115], v11, s[20:23], s33 offen sc1
v_add_f32 v176, 1.0, v176
v_add_f32 v177, 1.0, v177
v_add_f32 v178, 1.0, v178
MA 44,68,124
TR 40,13,50880
TR 42,13,51136
v_add_f32 v179, 1.0, v179
v_add_f32 v180, 1.0, v180
v_add_f32 v181, 1.0, v181
MA 36,64,124
TR 44,13,50912
v_rcp_f32 v176, v176
v_rcp_f32 v177, v177
MA 52,72,124
TR 46,13,51168
v_rcp_f32 v178, v178
v_rcp_f32 v179, v179
v_rcp_f32 v180, v180
MA 60,76,124
buffer_load_dwordx4 v[116:119], v10, s[20:23], s33 offen sc1
s_add_u32 s33, s33, 1024
v_rcp_f32 v181, v181
v_mul_f32 v204, v204, v176
MA 56,76,120
v_mul_f32 v205, v205, v177
v_mul_f32 v206, v206, v178
v_mul_f32 v207, v207, v179
MA 48,72,120
v_mul_f32 v208, v208, v180
v_mul_f32 v209, v209, v181
s_waitcnt vmcnt(12) lgkmcnt(0)
s_barrier
MA 0,16,128
TR 48,13,0
s_add_u32 m0, s38, 42240
MA 8,20,128
buffer_load_dwordx4 v4, s[16:19], s32 offen lds
MA 12,20,132
TR 50,13,256
TR 52,13,32
AR 210,82
AR 211,83
AR 212,84
MA 4,16,132
TR 54,13,288
TR 56,13,64
AR 213,85
AR 214,86
AR 215,87
MA 20,24,132
TR 58,13,320
TR 60,13,96
v_mul_f32 v176, s60, v210
v_mul_f32 v177, s60, v211
MA 28,28,132
buffer_load_dwordx4 v5, s[16:19], s32 offen offset:1056 lds
s_add_u32 s32, s32, 65536
v_mul_f32 v178, s60, v212
v_mul_f32 v179, s60, v213
v_mul_f32 v180, s60, v214
MA 24,28,128
TR 62,13,352
TR 64,13,128
v_mul_f32 v181, s60, v215
v_exp_f32 v176, v176
MA 16,24,128
TR 66,13,384
TR 68,13,160
v_exp_f32 v177, v177
v_exp_f32 v178, v178
v_exp_f32 v179, v179
MA 32,32,128
TR 70,13,416
v_exp_f32 v180, v180
v_exp_f32 v181, v181
MA 40,36,128
buffer_load_dwordx4 v[120:123], v11, s[20:23], s33 offen sc1
v_add_f32 v176, 1.0, v176
v_add_f32 v177, 1.0, v177
v_add_f32 v178, 1.0, v178
MA 44,36,132
TR 72,13,192
TR 74,13,448
v_add_f32 v179, 1.0, v179
v_add_f32 v180, 1.0, v180
v_add_f32 v181, 1.0, v181
MA 36,32,132
TR 76,13,224
v_rcp_f32 v176, v176
v_rcp_f32 v177, v177
MA 52,40,132
TR 78,13,480
v_rcp_f32 v178, v178
v_rcp_f32 v179, v179
v_rcp_f32 v180, v180
MA 60,44,132
buffer_load_dwordx4 v[124:127], v10, s[20:23], s33 offen sc1
s_add_u32 s33, s33, 1024
v_rcp_f32 v181, v181
v_mul_f32 v210, v210, v176
MA 56,44,128
v_mul_f32 v211, v211, v177
v_mul_f32 v212, v212, v178
v_mul_f32 v213, v213, v179
MA 48,40,128
v_mul_f32 v214, v214, v180
v_mul_f32 v215, v215, v181
s_waitcnt lgkmcnt(0)
MA 0,48,80
TR 16,13,8448
s_add_u32 m0, s38, 50688
MA 8,52,80
buffer_load_dwordx4 v4, s[16:19], s32 offen lds
MA 12,52,84
TR 18,13,8704
TR 20,13,8480
AR 216,88
AR 217,89
AR 218,90
MA 4,48,84
TR 22,13,8736
TR 24,13,8512
AR 219,91
AR 220,92
AR 221,93
MA 20,56,84
TR 26,13,8768
TR 28,13,8544
v_mul_f32 v176, s60, v216
v_mul_f32 v177, s60, v217
MA 28,60,84
buffer_load_dwordx4 v5, s[16:19], s32 offen offset:1056 lds
s_add_u32 s32, s32, 327680
v_mul_f32 v178, s60, v218
v_mul_f32 v179, s60, v219
v_mul_f32 v180, s60, v220
MA 24,60,80
TR 30,13,8800
TR 32,13,8576
v_mul_f32 v181, s60, v221
v_exp_f32 v176, v176
MA 16,56,80
TR 34,13,8832
TR 36,13,8608
v_exp_f32 v177, v177
v_exp_f32 v178, v178
v_exp_f32 v179, v179
MA 32,64,80
TR 38,13,8864
v_exp_f32 v180, v180
v_exp_f32 v181, v181
MA 40,68,80
buffer_load_dwordx4 v[128:131], v11, s[20:23], s33 offen sc1
v_add_f32 v176, 1.0, v176
v_add_f32 v177, 1.0, v177
v_add_f32 v178, 1.0, v178
MA 44,68,84
TR 40,13,8640
TR 42,13,8896
v_add_f32 v179, 1.0, v179
v_add_f32 v180, 1.0, v180
v_add_f32 v181, 1.0, v181
MA 36,64,84
TR 44,13,8672
v_rcp_f32 v176, v176
v_rcp_f32 v177, v177
MA 52,72,84
TR 46,13,8928
v_rcp_f32 v178, v178
v_rcp_f32 v179, v179
v_rcp_f32 v180, v180
MA 60,76,84
buffer_load_dwordx4 v[132:135], v10, s[20:23], s33 offen sc1
s_add_u32 s33, s33, 5120
v_rcp_f32 v181, v181
v_mul_f32 v216, v216, v176
MA 56,76,80
v_mul_f32 v217, v217, v177
v_mul_f32 v218, v218, v178
v_mul_f32 v219, v219, v179
MA 48,72,80
v_mul_f32 v220, v220, v180
v_mul_f32 v221, v221, v181
s_waitcnt vmcnt(12) lgkmcnt(0)
s_barrier
MA 0,16,88
TR 48,13,16896
s_add_u32 m0, s38, 0
MA 8,20,88
buffer_load_dwordx4 v4, s[16:19], s32 offen lds
MA 12,20,92
TR 50,13,17152
TR 52,13,16928
AR 222,94
AR 223,95
AR 224,96
MA 4,16,92
TR 54,13,17184
TR 56,13,16960
AR 225,97
AR 226,98
AR 227,99
MA 20,24,92
TR 58,13,17216
TR 60,13,16992
v_mul_f32 v176, s60, v222
v_mul_f32 v177, s60, v223
MA 28,28,92
buffer_load_dwordx4 v5, s[16:19], s32 offen offset:1056 lds
s_add_u32 s32, s32, 65536
v_mul_f32 v178, s60, v224
v_mul_f32 v179, s60, v225
v_mul_f32 v180, s60, v226
MA 24,28,88
TR 62,13,17248
TR 64,13,17024
v_mul_f32 v181, s60, v227
v_exp_f32 v176, v176
MA 16,24,88
TR 66,13,17280
TR 68,13,17056
v_exp_f32 v177, v177
v_exp_f32 v178, v178
v_exp_f32 v179, v179
MA 32,32,88
TR 70,13,17312
v_exp_f32 v180, v180
v_exp_f32 v181, v181
MA 40,36,88
buffer_load_dwordx4 v[80:83], v11, s[20:23], s33 offen sc1
v_add_f32 v176, 1.0, v176
v_add_f32 v177, 1.0, v177
v_add_f32 v178, 1.0, v178
MA 44,36,92
TR 72,13,17088
TR 74,13,17344
v_add_f32 v179, 1.0, v179
v_add_f32 v180, 1.0, v180
v_add_f32 v181, 1.0, v181
MA 36,32,92
TR 76,13,17120
v_rcp_f32 v176, v176
v_rcp_f32 v177, v177
MA 52,40,92
TR 78,13,17376
v_rcp_f32 v178, v178
v_rcp_f32 v179, v179
v_rcp_f32 v180, v180
MA 60,44,92
buffer_load_dwordx4 v[84:87], v10, s[20:23], s33 offen sc1
s_add_u32 s33, s33, 1024
v_rcp_f32 v181, v181
v_mul_f32 v222, v222, v176
MA 56,44,88
v_mul_f32 v223, v223, v177
v_mul_f32 v224, v224, v178
v_mul_f32 v225, v225, v179
MA 48,40,88
v_mul_f32 v226, v226, v180
v_mul_f32 v227, v227, v181
s_waitcnt lgkmcnt(0)
MA 0,48,96
TR 16,13,25344
s_add_u32 m0, s38, 8448
MA 8,52,96
buffer_load_dwordx4 v4, s[16:19], s32 offen lds
MA 12,52,100
TR 18,13,25600
TR 20,13,25376
AR 228,100
AR 229,101
AR 230,102
MA 4,48,100
TR 22,13,25632
TR 24,13,25408
AR 231,103
AR 232,104
AR 233,105
MA 20,56,100
TR 26,13,25664
TR 28,13,25440
v_mul_f32 v176, s60, v228
v_mul_f32 v177, s60, v229
MA 28,60,100
buffer_load_dwordx4 v5, s[16:19], s32 offen offset:1056 lds
s_add_u32 s32, s32, 65536
v_mul_f32 v178, s60, v230
v_mul_f32 v179, s60, v231
v_mul_f32 v180, s60, v232
MA 24,60,96
TR 30,13,25696
TR 32,13,25472
v_mul_f32 v181, s60, v233
v_exp_f32 v176, v176
MA 16,56,96
TR 34,13,25728
TR 36,13,25504
v_exp_f32 v177, v177
v_exp_f32 v178, v178
v_exp_f32 v179, v179
MA 32,64,96
TR 38,13,25760
v_exp_f32 v180, v180
v_exp_f32 v181, v181
MA 40,68,96
buffer_load_dwordx4 v[88:91], v11, s[20:23], s33 offen sc1
v_add_f32 v176, 1.0, v176
v_add_f32 v177, 1.0, v177
v_add_f32 v178, 1.0, v178
MA 44,68,100
TR 40,13,25536
TR 42,13,25792
v_add_f32 v179, 1.0, v179
v_add_f32 v180, 1.0, v180
v_add_f32 v181, 1.0, v181
MA 36,64,100
TR 44,13,25568
v_rcp_f32 v176, v176
v_rcp_f32 v177, v177
MA 52,72,100
TR 46,13,25824
v_rcp_f32 v178, v178
v_rcp_f32 v179, v179
v_rcp_f32 v180, v180
MA 60,76,100
buffer_load_dwordx4 v[92:95], v10, s[20:23], s33 offen sc1
s_add_u32 s33, s33, 1024
v_rcp_f32 v181, v181
v_mul_f32 v228, v228, v176
MA 56,76,96
v_mul_f32 v229, v229, v177
v_mul_f32 v230, v230, v178
v_mul_f32 v231, v231, v179
MA 48,72,96
v_mul_f32 v232, v232, v180
v_mul_f32 v233, v233, v181
s_waitcnt vmcnt(12) lgkmcnt(0)
s_barrier
MA 0,16,104
TR 48,13,33792
s_add_u32 m0, s38, 16896
MA 8,20,104
buffer_load_dwordx4 v4, s[16:19], s32 offen lds
MA 12,20,108
TR 50,13,34048
TR 52,13,33824
AR 234,106
AR 235,107
AR 236,108
MA 4,16,108
TR 54,13,34080
TR 56,13,33856
AR 237,109
AR 238,110
AR 239,111
MA 20,24,108
TR 58,13,34112
TR 60,13,33888
v_mul_f32 v176, s60, v234
v_mul_f32 v177, s60, v235
MA 28,28,108
buffer_load_dwordx4 v5, s[16:19], s32 offen offset:1056 lds
s_add_u32 s32, s32, 65536
v_mul_f32 v178, s60, v236
v_mul_f32 v179, s60, v237
v_mul_f32 v180, s60, v238
MA 24,28,104
TR 62,13,34144
TR 64,13,33920
v_mul_f32 v181, s60, v239
v_exp_f32 v176, v176
MA 16,24,104
TR 66,13,34176
TR 68,13,33952
v_exp_f32 v177, v177
v_exp_f32 v178, v178
v_exp_f32 v179, v179
MA 32,32,104
TR 70,13,34208
v_exp_f32 v180, v180
v_exp_f32 v181, v181
MA 40,36,104
buffer_load_dwordx4 v[96:99], v11, s[20:23], s33 offen sc1
v_add_f32 v176, 1.0, v176
v_add_f32 v177, 1.0, v177
v_add_f32 v178, 1.0, v178
MA 44,36,108
TR 72,13,33984
TR 74,13,34240
v_add_f32 v179, 1.0, v179
v_add_f32 v180, 1.0, v180
v_add_f32 v181, 1.0, v181
MA 36,32,108
TR 76,13,34016
v_rcp_f32 v176, v176
v_rcp_f32 v177, v177
MA 52,40,108
TR 78,13,34272
v_rcp_f32 v178, v178
v_rcp_f32 v179, v179
v_rcp_f32 v180, v180
MA 60,44,108
buffer_load_dwordx4 v[100:103], v10, s[20:23], s33 offen sc1
s_add_u32 s33, s33, 1024
v_rcp_f32 v181, v181
v_mul_f32 v234, v234, v176
MA 56,44,104
v_mul_f32 v235, v235, v177
v_mul_f32 v236, v236, v178
v_mul_f32 v237, v237, v179
MA 48,40,104
v_mul_f32 v238, v238, v180
v_mul_f32 v239, v239, v181
s_waitcnt lgkmcnt(0)
MA 0,48,112
TR 16,13,42240
s_add_u32 m0, s38, 25344
MA 8,52,112
buffer_load_dwordx4 v4, s[16:19], s32 offen lds
MA 12,52,116
TR 18,13,42496
TR 20,13,42272
AR 240,112
AR 241,113
AR 242,114
MA 4,48,116
TR 22,13,42528
TR 24,13,42304
AR 243,115
AR 244,116
AR 245,117
MA 20,56,116
TR 26,13,42560
TR 28,13,42336
v_mul_f32 v176, s60, v240
v_mul_f32 v177, s60, v241
MA 28,60,116
buffer_load_dwordx4 v5, s[16:19], s32 offen offset:1056 lds
s_add_u32 s32, s32, 65536
v_mul_f32 v178, s60, v242
v_mul_f32 v179, s60, v243
v_mul_f32 v180, s60, v244
MA 24,60,112
TR 30,13,42592
TR 32,13,42368
v_mul_f32 v181, s60, v245
v_exp_f32 v176, v176
MA 16,56,112
TR 34,13,42624
TR 36,13,42400
v_exp_f32 v177, v177
v_exp_f32 v178, v178
v_exp_f32 v179, v179
MA 32,64,112
TR 38,13,42656
v_exp_f32 v180, v180
v_exp_f32 v181, v181
MA 40,68,112
buffer_load_dwordx4 v[104:107], v11, s[20:23], s33 offen sc1
v_add_f32 v176, 1.0, v176
v_add_f32 v177, 1.0, v177
v_add_f32 v178, 1.0, v178
MA 44,68,116
TR 40,13,42432
TR 42,13,42688
v_add_f32 v179, 1.0, v179
v_add_f32 v180, 1.0, v180
v_add_f32 v181, 1.0, v181
MA 36,64,116
TR 44,13,42464
v_rcp_f32 v176, v176
v_rcp_f32 v177, v177
MA 52,72,116
TR 46,13,42720
v_rcp_f32 v178, v178
v_rcp_f32 v179, v179
v_rcp_f32 v180, v180
MA 60,76,116
buffer_load_dwordx4 v[108:111], v10, s[20:23], s33 offen sc1
s_add_u32 s33, s33, 1024
v_rcp_f32 v181, v181
v_mul_f32 v240, v240, v176
MA 56,76,112
v_mul_f32 v241, v241, v177
v_mul_f32 v242, v242, v178
v_mul_f32 v243, v243, v179
MA 48,72,112
v_mul_f32 v244, v244, v180
v_mul_f32 v245, v245, v181
s_mov_b32 s16, s56
s_mov_b32 s17, s57
s_mov_b32 s18, 0x400000
s_mov_b32 s19, 0x00020000
v_and_b32 v6, 15, v1
v_lshrrev_b32 v7, 4, v1
v_lshlrev_b32 v5, 11, v7
v_lshl_add_u32 v5, v6, 4, v5
s_lshl_b32 s15, s52, 2
s_add_u32 s15, s15, s10
s_lshl_b32 s15, s15, 16
s_lshl_b32 s34, s53, 8
s_add_u32 s34, s34, s15
s_mov_b32 s35, s34
s_mul_i32 s36, s10, 16896
s_add_u32 s36, s36, 59136
v_mul_u32_u24 v8, 528, v6
v_lshl_add_u32 v8, v7, 4, v8
v_add_u32 v8, s36, v8
v_mul_u32_u24 v9, 528, v7
v_lshl_add_u32 v9, v6, 5, v9
v_add_u32 v9, s36, v9
v_and_b32 v4, 1, v1
v_lshlrev_b32 v4, 7, v4
s_add_u32 s33, s62, 32768
s_mov_b32 s4, 0x3f80
s_mov_b32 s5, 0x3f800000
s_mov_b32 s20, s42
s_mov_b32 s21, s43
s_mov_b32 s22, 0x400000
s_mov_b32 s23, 0x00020000
s_waitcnt vmcnt(12) lgkmcnt(0)
s_barrier
MA 0,16,120
TR 48,13,50688
MA 8,20,120
MA 12,20,124
TR 50,13,50944
TR 52,13,50720
AR 246,118
AR 247,119
AR 248,120
MA 4,16,124
TR 54,13,50976
TR 56,13,50752
buffer_load_dwordx4 v[144:147], v5, s[16:19], s35 offen
AR 249,121
AR 250,122
AR 251,123
s_add_u32 s35, s35, 8192
MA 20,24,124
TR 58,13,51008
TR 60,13,50784
v_mul_f32 v176, s60, v246
v_mul_f32 v177, s60, v247
MA 28,28,124
buffer_load_dwordx4 v[148:151], v5, s[16:19], s35 offen
v_mul_f32 v178, s60, v248
v_mul_f32 v179, s60, v249
v_mul_f32 v180, s60, v250
s_add_u32 s35, s35, 8192
MA 24,28,120
TR 62,13,51040
TR 64,13,50816
buffer_load_dwordx4 v[152:155], v5, s[16:19], s35 offen
v_mul_f32 v181, s60, v251
v_exp_f32 v176, v176
s_add_u32 s35, s35, 8192
MA 16,24,120
TR 66,13,51072
TR 68,13,50848
v_exp_f32 v177, v177
v_exp_f32 v178, v178
v_exp_f32 v179, v179
MA 32,32,120
TR 70,13,51104
buffer_load_dwordx4 v[156:159], v5, s[16:19], s35 offen
v_exp_f32 v180, v180
v_exp_f32 v181, v181
s_add_u32 s35, s35, 8192
MA 40,36,120
buffer_load_dwordx4 v[160:163], v5, s[16:19], s35 offen
v_add_f32 v176, 1.0, v176
v_add_f32 v177, 1.0, v177
v_add_f32 v178, 1.0, v178
s_add_u32 s35, s35, 8192
MA 44,36,124
TR 72,13,50880
TR 74,13,51136
v_add_f32 v179, 1.0, v179
v_add_f32 v180, 1.0, v180
v_add_f32 v181, 1.0, v181
MA 36,32,124
TR 76,13,50912
buffer_load_dwordx4 v[164:167], v5, s[16:19], s35 offen
v_rcp_f32 v176, v176
v_rcp_f32 v177, v177
s_add_u32 s35, s35, 8192
MA 52,40,124
TR 78,13,51168
v_rcp_f32 v178, v178
v_rcp_f32 v179, v179
v_rcp_f32 v180, v180
MA 60,44,124
buffer_load_dwordx4 v[168:171], v5, s[16:19], s35 offen
v_rcp_f32 v181, v181
v_mul_f32 v246, v246, v176
s_add_u32 s35, s35, 8192
MA 56,44,120
buffer_load_dwordx4 v[172:175], v5, s[16:19], s35 offen
v_mul_f32 v247, v247, v177
v_mul_f32 v248, v248, v178
v_mul_f32 v249, v249, v179
s_add_u32 s35, s35, 8192
MA 48,40,120
buffer_load_dword v3, v4, s[48:51], s63 offen sc1
v_mul_f32 v250, v250, v180
v_mul_f32 v251, v251, v181
s_waitcnt lgkmcnt(0)
MA 0,48,128
TR 16,13,0
MA 8,52,128
MA 12,52,132
TR 18,13,256
TR 20,13,32
AR 252,124
AR 253,125
MA 4,48,132
TR 22,13,288
TR 24,13,64
AR 254,126
AR 255,127
MA 20,56,132
TR 26,13,320
TR 28,13,96
v_mul_f32 v176, s60, v252
v_mul_f32 v177, s60, v253
MA 28,60,132
v_mul_f32 v178, s60, v254
MA 24,60,128
TR 30,13,352
TR 32,13,128
v_mul_f32 v179, s60, v255
v_exp_f32 v176, v176
MA 16,56,128
TR 34,13,384
TR 36,13,160
v_exp_f32 v177, v177
v_exp_f32 v178, v178
MA 32,64,128
TR 38,13,416
v_exp_f32 v179, v179
MA 40,68,128
v_add_f32 v176, 1.0, v176
v_add_f32 v177, 1.0, v177
MA 44,68,132
TR 40,13,192
TR 42,13,448
v_add_f32 v178, 1.0, v178
v_add_f32 v179, 1.0, v179
MA 36,64,132
TR 44,13,224
v_rcp_f32 v176, v176
v_rcp_f32 v177, v177
MA 52,72,132
TR 46,13,480
v_rcp_f32 v178, v178
MA 60,76,132
v_rcp_f32 v179, v179
v_mul_f32 v252, v252, v176
MA 56,76,128
v_mul_f32 v253, v253, v177
v_mul_f32 v254, v254, v178
MA 48,72,128
v_mul_f32 v255, v255, v179
s_waitcnt vmcnt(0)
v_cmp_ne_u32 vcc, s100, v3
s_cbranch_vccnz L_p2p_slow
L_p2p_ok:
s_waitcnt vmcnt(13) lgkmcnt(0)
s_barrier
MA 0,16,80
TR 48,13,8448
MA 8,20,80
MA 12,20,84
TR 50,13,8704
TR 52,13,8480
MA 4,16,84
TR 54,13,8736
TR 56,13,8512
buffer_load_dwordx4 v[136:139], v11, s[44:47], s62 offen sc1
MA 20,24,84
TR 58,13,8768
TR 60,13,8544
MA 28,28,84
buffer_load_dwordx4 v[140:143], v11, s[44:47], s33 offen sc1
MA 24,28,80
TR 62,13,8800
TR 64,13,8576
buffer_load_dwordx4 v[112:115], v11, s[44:47], s62 offen offset:1024 sc1
MA 16,24,80
TR 66,13,8832
TR 68,13,8608
MA 32,32,80
TR 70,13,8864
buffer_load_dwordx4 v[116:119], v11, s[44:47], s33 offen offset:1024 sc1
MA 40,36,80
buffer_load_dwordx4 v[120:123], v11, s[44:47], s62 offen offset:2048 sc1
MA 44,36,84
TR 72,13,8640
TR 74,13,8896
MA 36,32,84
TR 76,13,8672
buffer_load_dwordx4 v[124:127], v11, s[44:47], s33 offen offset:2048 sc1
MA 52,40,84
TR 78,13,8928
MA 60,44,84
buffer_load_dwordx4 v[128:131], v11, s[44:47], s62 offen offset:3072 sc1
s_add_u32 s62, s62, 4096
MA 56,44,80
buffer_load_dwordx4 v[132:135], v11, s[44:47], s33 offen offset:3072 sc1
s_add_u32 s33, s33, 4096
MA 48,40,80
s_waitcnt lgkmcnt(0)
MA 0,48,88
TR 16,13,16896
MA 8,52,88
MA 12,52,92
TR 18,13,17152
TR 20,13,16928
MA 4,48,92
TR 22,13,17184
TR 24,13,16960
buffer_load_dwordx4 v[80:83], v11, s[44:47], s62 offen sc1
MA 20,56,92
TR 26,13,17216
TR 28,13,16992
MA 28,60,92
buffer_load_dwordx4 v[84:87], v11, s[44:47], s33 offen sc1
MA 24,60,88
TR 30,13,17248
TR 32,13,17024
MA 16,56,88
TR 34,13,17280
TR 36,13,17056
MA 32,64,88
TR 38,13,17312
MA 40,68,88
MA 44,68,92
TR 40,13,17088
TR 42,13,17344
MA 36,64,92
TR 44,13,17120
MA 52,72,92
TR 46,13,17376
MA 60,76,92
MA 56,76,88
MA 48,72,88
s_waitcnt vmcnt(19) lgkmcnt(0)
s_barrier
MA 0,16,96
TR 48,13,25344
MA 8,20,96
MA 12,20,100
TR 50,13,25600
TR 52,13,25376
MA 4,16,100
TR 54,13,25632
TR 56,13,25408
buffer_load_dwordx4 v[88:91], v11, s[44:47], s62 offen offset:1024 sc1
MA 20,24,100
TR 58,13,25664
TR 60,13,25440
MA 28,28,100
buffer_load_dwordx4 v[92:95], v11, s[44:47], s33 offen offset:1024 sc1
MA 24,28,96
TR 62,13,25696
TR 64,13,25472
MA 16,24,96
TR 66,13,25728
TR 68,13,25504
MA 32,32,96
TR 70,13,25760
MA 40,36,96
MA 44,36,100
TR 72,13,25536
TR 74,13,25792
MA 36,32,100
TR 76,13,25568
MA 52,40,100
TR 78,13,25824
MA 60,44,100
MA 56,44,96
MA 48,40,96
s_waitcnt lgkmcnt(0)
MA 0,48,104
MA 8,52,104
MA 12,52,108
MA 4,48,108
buffer_load_dwordx4 v[96:99], v11, s[44:47], s62 offen offset:2048 sc1
MA 20,56,108
MA 28,60,108
buffer_load_dwordx4 v[100:103], v11, s[44:47], s33 offen offset:2048 sc1
MA 24,60,104
MA 16,56,104
MA 32,64,104
MA 40,68,104
MA 44,68,108
MA 36,64,108
MA 52,72,108
MA 60,76,108
MA 56,76,104
MA 48,72,104
buffer_load_dwordx4 v[104:107], v11, s[44:47], s62 offen offset:3072 sc1
buffer_load_dwordx4 v[108:111], v11, s[44:47], s33 offen offset:3072 sc1
s_nop 7
AR 16,0
AR 17,1
AR 18,2
AR 19,3
s_waitcnt vmcnt(14)
v_dot2_f32_bf16 v16, v136, s4, v16
v_dot2_f32_bf16 v17, v136, s5, v17
v_dot2_f32_bf16 v18, v137, s4, v18
v_dot2_f32_bf16 v19, v137, s5, v19
v_dot2_f32_bf16 v16, v140, s4, v16
v_dot2_f32_bf16 v17, v140, s5, v17
v_dot2_f32_bf16 v18, v141, s4, v18
v_dot2_f32_bf16 v19, v141, s5, v19
AR 20,4
AR 21,5
AR 22,6
AR 23,7
PM 16,16,192
PM 18,18,194
ds_write_b128 v8, v[16:19] offset:0
v_dot2_f32_bf16 v20, v138, s4, v20
v_dot2_f32_bf16 v21, v138, s5, v21
v_dot2_f32_bf16 v22, v139, s4, v22
v_dot2_f32_bf16 v23, v139, s5, v23
v_dot2_f32_bf16 v20, v142, s4, v20
v_dot2_f32_bf16 v21, v142, s5, v21
v_dot2_f32_bf16 v22, v143, s4, v22
v_dot2_f32_bf16 v23, v143, s5, v23
AR 24,8
AR 25,9
AR 26,10
AR 27,11
PM 20,20,196
PM 22,22,198
ds_write_b128 v8, v[20:23] offset:8448
s_waitcnt vmcnt(12)
v_dot2_f32_bf16 v24, v112, s4, v24
v_dot2_f32_bf16 v25, v112, s5, v25
v_dot2_f32_bf16 v26, v113, s4, v26
v_dot2_f32_bf16 v27, v113, s5, v27
v_dot2_f32_bf16 v24, v116, s4, v24
v_dot2_f32_bf16 v25, v116, s5, v25
v_dot2_f32_bf16 v26, v117, s4, v26
v_dot2_f32_bf16 v27, v117, s5, v27
AR 28,12
AR 29,13
AR 30,14
AR 31,15
PM 24,24,200
PM 26,26,202
ds_write_b128 v8, v[24:27] offset:64
v_dot2_f32_bf16 v28, v114, s4, v28
v_dot2_f32_bf16 v29, v114, s5, v29
v_dot2_f32_bf16 v30, v115, s4, v30
v_dot2_f32_bf16 v31, v115, s5, v31
v_dot2_f32_bf16 v28, v118, s4, v28
v_dot2_f32_bf16 v29, v118, s5, v29
v_dot2_f32_bf16 v30, v119, s4, v30
v_dot2_f32_bf16 v31, v119, s5, v31
AR 32,16
AR 33,17
AR 34,18
AR 35,19
PM 28,28,204
PM 30,30,206
ds_write_b128 v8, v[28:31] offset:8512
s_waitcnt vmcnt(10)
v_dot2_f32_bf16 v32, v120, s4, v32
v_dot2_f32_bf16 v33, v120, s5, v33
v_dot2_f32_bf16 v34, v121, s4, v34
v_dot2_f32_bf16 v35, v121, s5, v35
v_dot2_f32_bf16 v32, v124, s4, v32
v_dot2_f32_bf16 v33, v124, s5, v33
v_dot2_f32_bf16 v34, v125, s4, v34
v_dot2_f32_bf16 v35, v125, s5, v35
AR 36,20
AR 37,21
AR 38,22
AR 39,23
PM 32,32,208
PM 34,34,210
ds_write_b128 v8, v[32:35] offset:128
v_dot2_f32_bf16 v36, v122, s4, v36
v_dot2_f32_bf16 v37, v122, s5, v37
v_dot2_f32_bf16 v38, v123, s4, v38
v_dot2_f32_bf16 v39, v123, s5, v39
v_dot2_f32_bf16 v36, v126, s4, v36
v_dot2_f32_bf16 v37, v126, s5, v37
v_dot2_f32_bf16 v38, v127, s4, v38
v_dot2_f32_bf16 v39, v127, s5, v39
AR 40,24
AR 41,25
AR 42,26
AR 43,27
PM 36,36,212
PM 38,38,214
ds_write_b128 v8, v[36:39] offset:8576
s_waitcnt vmcnt(8)
v_dot2_f32_bf16 v40, v128, s4, v40
v_dot2_f32_bf16 v41, v128, s5, v41
v_dot2_f32_bf16 v42, v129, s4, v42
v_dot2_f32_bf16 v43, v129, s5, v43
v_dot2_f32_bf16 v40, v132, s4, v40
v_dot2_f32_bf16 v41, v132, s5, v41
v_dot2_f32_bf16 v42, v133, s4, v42
v_dot2_f32_bf16 v43, v133, s5, v43
AR 44,28
AR 45,29
AR 46,30
AR 47,31
PM 40,40,216
PM 42,42,218
ds_write_b128 v8, v[40:43] offset:192
v_dot2_f32_bf16 v44, v130, s4, v44
v_dot2_f32_bf16 v45, v130, s5, v45
v_dot2_f32_bf16 v46, v131, s4, v46
v_dot2_f32_bf16 v47, v131, s5, v47
v_dot2_f32_bf16 v44, v134, s4, v44
v_dot2_f32_bf16 v45, v134, s5, v45
v_dot2_f32_bf16 v46, v135, s4, v46
v_dot2_f32_bf16 v47, v135, s5, v47
AR 48,32
AR 49,33
AR 50,34
AR 51,35
PM 44,44,220
PM 46,46,222
ds_write_b128 v8, v[44:47] offset:8640
s_waitcnt vmcnt(6)
v_dot2_f32_bf16 v48, v80, s4, v48
v_dot2_f32_bf16 v49, v80, s5, v49
v_dot2_f32_bf16 v50, v81, s4, v50
v_dot2_f32_bf16 v51, v81, s5, v51
v_dot2_f32_bf16 v48, v84, s4, v48
v_dot2_f32_bf16 v49, v84, s5, v49
v_dot2_f32_bf16 v50, v85, s4, v50
v_dot2_f32_bf16 v51, v85, s5, v51
AR 52,36
AR 53,37
AR 54,38
AR 55,39
PM 48,48,224
PM 50,50,226
ds_write_b128 v8, v[48:51] offset:256
v_dot2_f32_bf16 v52, v82, s4, v52
v_dot2_f32_bf16 v53, v82, s5, v53
v_dot2_f32_bf16 v54, v83, s4, v54
v_dot2_f32_bf16 v55, v83, s5, v55
v_dot2_f32_bf16 v52, v86, s4, v52
v_dot2_f32_bf16 v53, v86, s5, v53
v_dot2_f32_bf16 v54, v87, s4, v54
v_dot2_f32_bf16 v55, v87, s5, v55
AR 56,40
AR 57,41
AR 58,42
AR 59,43
PM 52,52,228
PM 54,54,230
ds_write_b128 v8, v[52:55] offset:8704
s_waitcnt vmcnt(4)
v_dot2_f32_bf16 v56, v88, s4, v56
v_dot2_f32_bf16 v57, v88, s5, v57
v_dot2_f32_bf16 v58, v89, s4, v58
v_dot2_f32_bf16 v59, v89, s5, v59
v_dot2_f32_bf16 v56, v92, s4, v56
v_dot2_f32_bf16 v57, v92, s5, v57
v_dot2_f32_bf16 v58, v93, s4, v58
v_dot2_f32_bf16 v59, v93, s5, v59
AR 60,44
AR 61,45
AR 62,46
AR 63,47
PM 56,56,232
PM 58,58,234
ds_write_b128 v8, v[56:59] offset:320
v_dot2_f32_bf16 v60, v90, s4, v60
v_dot2_f32_bf16 v61, v90, s5, v61
v_dot2_f32_bf16 v62, v91, s4, v62
v_dot2_f32_bf16 v63, v91, s5, v63
v_dot2_f32_bf16 v60, v94, s4, v60
v_dot2_f32_bf16 v61, v94, s5, v61
v_dot2_f32_bf16 v62, v95, s4, v62
v_dot2_f32_bf16 v63, v95, s5, v63
AR 64,48
AR 65,49
AR 66,50
AR 67,51
PM 60,60,236
PM 62,62,238
ds_write_b128 v8, v[60:63] offset:8768
s_waitcnt vmcnt(2)
v_dot2_f32_bf16 v64, v96, s4, v64
v_dot2_f32_bf16 v65, v96, s5, v65
v_dot2_f32_bf16 v66, v97, s4, v66
v_dot2_f32_bf16 v67, v97, s5, v67
v_dot2_f32_bf16 v64, v100, s4, v64
v_dot2_f32_bf16 v65, v100, s5, v65
v_dot2_f32_bf16 v66, v101, s4, v66
v_dot2_f32_bf16 v67, v101, s5, v67
AR 68,52
AR 69,53
AR 70,54
AR 71,55
PM 64,64,240
PM 66,66,242
ds_write_b128 v8, v[64:67] offset:384
v_dot2_f32_bf16 v68, v98, s4, v68
v_dot2_f32_bf16 v69, v98, s5, v69
v_dot2_f32_bf16 v70, v99, s4, v70
v_dot2_f32_bf16 v71, v99, s5, v71
v_dot2_f32_bf16 v68, v102, s4, v68
v_dot2_f32_bf16 v69, v102, s5, v69
v_dot2_f32_bf16 v70, v103, s4, v70
v_dot2_f32_bf16 v71, v103, s5, v71
AR 72,56
AR 73,57
AR 74,58
AR 75,59
PM 68,68,244
PM 70,70,246
ds_write_b128 v8, v[68:71] offset:8832
s_waitcnt vmcnt(0)
v_dot2_f32_bf16 v72, v104, s4, v72
v_dot2_f32_bf16 v73, v104, s5, v73
v_dot2_f32_bf16 v74, v105, s4, v74
v_dot2_f32_bf16 v75, v105, s5, v75
v_dot2_f32_bf16 v72, v108, s4, v72
v_dot2_f32_bf16 v73, v108, s5, v73
v_dot2_f32_bf16 v74, v109, s4, v74
v_dot2_f32_bf16 v75, v109, s5, v75
AR 76,60
AR 77,61
AR 78,62
AR 79,63
PM 72,72,248
PM 74,74,250
ds_write_b128 v8, v[72:75] offset:448
v_dot2_f32_bf16 v76, v106, s4, v76
v_dot2_f32_bf16 v77, v106, s5, v77
v_dot2_f32_bf16 v78, v107, s4, v78
v_dot2_f32_bf16 v79, v107, s5, v79
v_dot2_f32_bf16 v76, v110, s4, v76
v_dot2_f32_bf16 v77, v110, s5, v77
v_dot2_f32_bf16 v78, v111, s4, v78
v_dot2_f32_bf16 v79, v111, s5, v79
s_nop 2
PM 76,76,252
PM 78,78,254
ds_write_b128 v8, v[76:79] offset:8896
s_waitcnt lgkmcnt(0)
RD 80,9,0
RD 84,9,16
RD 88,9,2112
RD 92,9,2128
RD 96,9,4224
RD 100,9,4240
RD 104,9,6336
RD 108,9,6352
RD 112,9,8448
RD 116,9,8464
RD 120,9,10560
RD 124,9,10576
RD 128,9,12672
RD 132,9,12688
RD 136,9,14784
RD 140,9,14800
v_lshlrev_b32 v192, 16, v144
v_and_b32 v193, 0xffff0000, v144
v_lshlrev_b32 v194, 16, v145
v_and_b32 v195, 0xffff0000, v145
v_lshlrev_b32 v196, 16, v146
v_and_b32 v197, 0xffff0000, v146
v_lshlrev_b32 v198, 16, v147
v_and_b32 v199, 0xffff0000, v147
s_waitcnt lgkmcnt(14)
s_waitcnt lgkmcnt(14)
PD 80,80,192
PD 82,82,194
PD 84,84,196
PD 86,86,198
CV 16,80,81
CV 17,82,83
CV 18,84,85
CV 19,86,87
buffer_store_dwordx4 v[16:19], v5, s[20:23], s34 offen sc1
s_add_u32 s34, s34, 8192
v_lshlrev_b32 v200, 16, v148
v_and_b32 v201, 0xffff0000, v148
v_lshlrev_b32 v202, 16, v149
v_and_b32 v203, 0xffff0000, v149
v_lshlrev_b32 v204, 16, v150
v_and_b32 v205, 0xffff0000, v150
v_lshlrev_b32 v206, 16, v151
v_and_b32 v207, 0xffff0000, v151
s_waitcnt lgkmcnt(12)
PD 88,88,200
PD 90,90,202
PD 92,92,204
PD 94,94,206
CV 20,88,89
CV 21,90,91
CV 22,92,93
CV 23,94,95
buffer_store_dwordx4 v[20:23], v5, s[20:23], s34 offen sc1
s_add_u32 s34, s34, 8192
v_lshlrev_b32 v208, 16, v152
v_and_b32 v209, 0xffff0000, v152
v_lshlrev_b32 v210, 16, v153
v_and_b32 v211, 0xffff0000, v153
v_lshlrev_b32 v212, 16, v154
v_and_b32 v213, 0xffff0000, v154
v_lshlrev_b32 v214, 16, v155
v_and_b32 v215, 0xffff0000, v155
s_waitcnt lgkmcnt(10)
PD 96,96,208
PD 98,98,210
PD 100,100,212
PD 102,102,214
CV 24,96,97
CV 25,98,99
CV 26,100,101
CV 27,102,103
buffer_store_dwordx4 v[24:27], v5, s[20:23], s34 offen sc1
s_add_u32 s34, s34, 8192
v_lshlrev_b32 v216, 16, v156
v_and_b32 v217, 0xffff0000, v156
v_lshlrev_b32 v218, 16, v157
v_and_b32 v219, 0xffff0000, v157
v_lshlrev_b32 v220, 16, v158
v_and_b32 v221, 0xffff0000, v158
v_lshlrev_b32 v222, 16, v159
v_and_b32 v223, 0xffff0000, v159
s_waitcnt lgkmcnt(8)
PD 104,104,216
PD 106,106,218
PD 108,108,220
PD 110,110,222
CV 28,104,105
CV 29,106,107
CV 30,108,109
CV 31,110,111
buffer_store_dwordx4 v[28:31], v5, s[20:23], s34 offen sc1
s_add_u32 s34, s34, 8192
v_lshlrev_b32 v224, 16, v160
v_and_b32 v225, 0xffff0000, v160
v_lshlrev_b32 v226, 16, v161
v_and_b32 v227, 0xffff0000, v161
v_lshlrev_b32 v228, 16, v162
v_and_b32 v229, 0xffff0000, v162
v_lshlrev_b32 v230, 16, v163
v_and_b32 v231, 0xffff0000, v163
s_waitcnt lgkmcnt(6)
PD 112,112,224
PD 114,114,226
PD 116,116,228
PD 118,118,230
CV 32,112,113
CV 33,114,115
CV 34,116,117
CV 35,118,119
buffer_store_dwordx4 v[32:35], v5, s[20:23], s34 offen sc1
s_add_u32 s34, s34, 8192
v_lshlrev_b32 v232, 16, v164
v_and_b32 v233, 0xffff0000, v164
v_lshlrev_b32 v234, 16, v165
v_and_b32 v235, 0xffff0000, v165
v_lshlrev_b32 v236, 16, v166
v_and_b32 v237, 0xffff0000, v166
v_lshlrev_b32 v238, 16, v167
v_and_b32 v239, 0xffff0000, v167
s_waitcnt lgkmcnt(4)
PD 120,120,232
PD 122,122,234
PD 124,124,236
PD 126,126,238
CV 36,120,121
CV 37,122,123
CV 38,124,125
CV 39,126,127
buffer_store_dwordx4 v[36:39], v5, s[20:23], s34 offen sc1
s_add_u32 s34, s34, 8192
v_lshlrev_b32 v240, 16, v168
v_and_b32 v241, 0xffff0000, v168
v_lshlrev_b32 v242, 16, v169
v_and_b32 v243, 0xffff0000, v169
v_lshlrev_b32 v244, 16, v170
v_and_b32 v245, 0xffff0000, v170
v_lshlrev_b32 v246, 16, v171
v_and_b32 v247, 0xffff0000, v171
s_waitcnt lgkmcnt(2)
PD 128,128,240
PD 130,130,242
PD 132,132,244
PD 134,134,246
CV 40,128,129
CV 41,130,131
CV 42,132,133
CV 43,134,135
buffer_store_dwordx4 v[40:43], v5, s[20:23], s34 offen sc1
s_add_u32 s34, s34, 8192
v_lshlrev_b32 v248, 16, v172
v_and_b32 v249, 0xffff0000, v172
v_lshlrev_b32 v250, 16, v173
v_and_b32 v251, 0xffff0000, v173
v_lshlrev_b32 v252, 16, v174
v_and_b32 v253, 0xffff0000, v174
v_lshlrev_b32 v254, 16, v175
v_and_b32 v255, 0xffff0000, v175
s_waitcnt lgkmcnt(0)
PD 136,136,248
PD 138,138,250
PD 140,140,252
PD 142,142,254
CV 44,136,137
CV 45,138,139
CV 46,140,141
CV 47,142,143
buffer_store_dwordx4 v[44:47], v5, s[20:23], s34 offen sc1
s_cmp_lg_u32 s39, 0
s_cbranch_scc1 L_p2_notag
s_mov_b32 s3, 598016
v_mov_b32 v60, s100
s_mov_b64 exec, 1
buffer_store_dword v60, off, s[48:51], s3 sc1
s_mov_b64 exec, -1
L_p2_notag:
s_endpgm
L_p2h_slow:
s_mov_b32 s61, s37
s_mov_b32 s37, 0
L_p2h_poll:
buffer_load_dword v160, v15, s[48:51], s55 offen sc1
s_waitcnt vmcnt(0)
v_cmp_ne_u32 vcc, s100, v160
s_add_u32 s37, s37, 1
s_cmp_ge_u32 s37, 65536
s_cbranch_scc1 L_p2h_poll_done
s_cbranch_vccnz L_p2h_poll
L_p2h_poll_done:
s_mov_b32 s37, s61
s_branch L_p2h_ok
L_p2g_slow:
s_mov_b32 s61, s37
s_mov_b32 s37, 0
L_p2g_poll:
buffer_load_dword v160, v161, s[48:51], s55 offen sc1
s_waitcnt vmcnt(0)
v_cmp_ne_u32 vcc, s100, v160
s_add_u32 s37, s37, 1
s_cmp_ge_u32 s37, 65536
s_cbranch_scc1 L_p2g_poll_done
s_cbranch_vccnz L_p2g_poll
L_p2g_poll_done:
s_mov_b32 s37, s61
s_branch L_p2g_ok
L_p2p_slow:
s_mov_b32 s61, s37
s_mov_b32 s37, 0
L_p2p_poll:
buffer_load_dword v3, v4, s[48:51], s63 offen sc1
s_waitcnt vmcnt(0)
v_cmp_ne_u32 vcc, s100, v3
s_add_u32 s37, s37, 1
s_cmp_ge_u32 s37, 65536
s_cbranch_scc1 L_p2p_poll_done
s_cbranch_vccnz L_p2p_poll
L_p2p_poll_done:
s_mov_b32 s37, s61
s_branch L_p2p_ok
L_p2o_slow:
s_mov_b32 s61, s37
s_mov_b32 s37, 0
L_p2o_poll:
buffer_load_dword v3, v15, s[48:51], s54 offen sc1
s_waitcnt vmcnt(0)
v_cmp_ne_u32 vcc, s100, v3
s_add_u32 s37, s37, 1
s_cmp_ge_u32 s37, 65536
s_cbranch_scc1 L_p2o_poll_done
s_cbranch_vccnz L_p2o_poll
L_p2o_poll_done:
s_mov_b32 s37, s61
s_branch L_p2o_ok
L_b_oslow:
s_mov_b32 s37, 0
L_b_opoll:
buffer_load_dword v138, v15, s[48:51], s59 offen sc1
s_waitcnt vmcnt(0)
v_cmp_ne_u32 vcc, s100, v138
s_add_u32 s37, s37, 1
s_cmp_ge_u32 s37, 65536
s_cbranch_scc1 L_b_opoll_done
s_cbranch_vccnz L_b_opoll
L_b_opoll_done:
s_branch L_b_ook
L_b_zslow:
s_mov_b32 s37, 0
L_b_zpoll:
buffer_load_dword v138, v10, s[48:51], s36 offen sc1
s_waitcnt vmcnt(0)
v_cmp_ne_u32 vcc, s100, v138
s_add_u32 s37, s37, 1
s_cmp_ge_u32 s37, 65536
s_cbranch_scc1 L_b_zpoll_done
s_cbranch_vccnz L_b_zpoll
L_b_zpoll_done:
s_branch L_b_zok
L_code_end:
.section .rodata,"a"
.p2align 6
.amdhsa_kernel recurrent_scan__sliding_block_cached__mixer_gmlp__prompt_kernel
  .amdhsa_next_free_vgpr 512
  .amdhsa_next_free_sgpr 102
  .amdhsa_accum_offset 256
  .amdhsa_group_segment_fixed_size 0
  .amdhsa_kernarg_size 104
  .amdhsa_user_sgpr_count 2
  .amdhsa_user_sgpr_kernarg_segment_ptr 1
  .amdhsa_system_sgpr_workgroup_id_x 1
.end_amdhsa_kernel
```
